```python
import torch

def _softmax(x, axis=-1):
    return torch.softmax(x, dim=axis)

def _gelu(x):
    return torch.nn.functional.gelu(x, approximate='tanh')

def _silu(x):
    return torch.nn.functional.silu(x)

def _sigmoid(x):
    return torch.sigmoid(x)

def _layernorm(x, axis=-1, eps=1e-05):
    m = x.mean(dim=axis, keepdim=True)
    v = x.var(dim=axis, keepdim=True, unbiased=False)
    return (x - m) / torch.sqrt(v + eps)

def _scatter_add(tgt, idx, src, axis=0):
    return tgt.clone().index_add_(axis, idx, src)

def _segment_sum(src, seg, n):
    out = torch.zeros((n,) + src.shape[1:], dtype=src.dtype)
    return out.index_add_(0, seg, src)

def _pad(x, pw):
    flat = tuple((v for pair in reversed(pw) for v in pair))
    return torch.nn.functional.pad(x, flat)
kernel_name = 'adaLN_cond__memory_aug_recurrent_mem_tr__dense_activation_silu__prompt'

def setup_inputs():

    _w = lambda a: (lambda t: t.to(torch.bfloat16) if t.is_floating_point() else t)(torch.as_tensor(a))

    def _A_setup():
        B, S, Dm = (1, 2048, 640)
        H, Dh = (32, 128)
        M, seg = (8, 32)
        seg = min(seg, S)
        S = S // seg * seg
        return {'x': _w((lambda *s: torch.randn(*s, dtype=torch.bfloat16) * 0.05)(B, S, Dm)), 'mem0': _w((lambda *s: torch.randn(*s, dtype=torch.bfloat16) * 0.8)(B, M, Dm)), 'Wq': _w((lambda *s: torch.randn(*s, dtype=torch.bfloat16) * 1.6)(Dm, H, Dh) * Dm ** (-0.5)), 'Wk': _w((lambda *s: torch.randn(*s, dtype=torch.bfloat16) * 1.6)(Dm, H, Dh) * Dm ** (-0.5)), 'Wv': _w((lambda *s: torch.randn(*s, dtype=torch.bfloat16) * 0.8)(Dm, H, Dh) * Dm ** (-0.5)), 'Wo': _w((lambda *s: torch.randn(*s, dtype=torch.bfloat16) * 0.8)(H, Dh, Dm) * (H * Dh) ** (-0.5)), 'seg_len': seg}
    _A_in = _A_setup()

    def _B_setup():
        B, S, D, F = (1, 2048, 640, 1728)
        return {'x': _w((lambda *s: torch.randn(*s, dtype=torch.bfloat16) * 0.05)(B, S, D)), 'w1': _w((lambda *s: torch.randn(*s, dtype=torch.bfloat16) * 3.2)(D, F) * D ** (-0.5)), 'w2': _w((lambda *s: torch.randn(*s, dtype=torch.bfloat16) * 0.2)(F, D) * F ** (-0.5))}
    _B_in = _B_setup()
    return {'A_x': _A_in['x'], 'A_mem0': _A_in['mem0'], 'A_Wq': _A_in['Wq'], 'A_Wk': _A_in['Wk'], 'A_Wv': _A_in['Wv'], 'A_Wo': _A_in['Wo'], 'A_seg_len': _A_in['seg_len'], 'B_x': _B_in['x'], 'B_w1': _B_in['w1'], 'B_w2': _B_in['w2'], 'c': _w((lambda *s: torch.randn(*s, dtype=torch.bfloat16) * 0.1)(1, 640) * 8.0), 'w_mod': _w((lambda *s: torch.randn(*s, dtype=torch.bfloat16) * 0.1)(640, 6 * 640) * 640 ** (-0.5) * 8.0)}

def reference(A_x, A_mem0, A_Wq, A_Wk, A_Wv, A_Wo, A_seg_len, B_x, B_w1, B_w2, c, w_mod):

    def _A_ref(x, mem0, Wq, Wk, Wv, Wo, seg_len):
        B, S, Dm = x.shape
        H, Dh = (Wq.shape[1], Wq.shape[2])
        M = mem0.shape[1]
        scale = Dh ** (-0.5)
        n_seg = S // seg_len
        L = M + seg_len
        idx = torch.arange(L)
        mask = (idx[:, None] < M) | (idx[:, None] >= idx[None, :])
        mem = mem0
        outs = []
        for s in range(n_seg):
            xs = x[:, s * seg_len:(s + 1) * seg_len, :].clone()
            h = torch.concatenate([mem, xs], axis=1)
            q = torch.einsum('btd,dhe->bhte', h, Wq)
            k = torch.einsum('btd,dhe->bhte', h, Wk)
            v = torch.einsum('btd,dhe->bhte', h, Wv)
            scores = torch.einsum('bhqe,bhke->bhqk', q, k) * scale
            scores = torch.where(mask[None, None], scores, -1000000000.0)
            p = _softmax(scores, axis=-1)
            o = torch.einsum('bhqk,bhke->bhqe', p, v)
            o = torch.einsum('bhte,hed->btd', o, Wo)
            mem = o[:, :M, :].clone()
            outs.append(o[:, M:, :])
        return torch.concatenate(outs, axis=1)

    def _B_ref(x, w1, w2):
        h = torch.einsum('bsd,df->bsf', x, w1)
        h = _silu(h)
        out = torch.einsum('bsf,fd->bsd', h, w2)
        return out
    x = A_x
    mod = (_silu(c) @ w_mod).reshape(c.shape[0], 6, 1, -1)
    sa, ca, ga, sb, cb, gb = (mod[:, 0].clone(), mod[:, 1].clone(), mod[:, 2].clone(), mod[:, 3].clone(), mod[:, 4].clone(), mod[:, 5].clone())
    h = _layernorm(x, axis=-1) * (1 + ca) + sa
    x = x + ga * _A_ref(h, A_mem0, A_Wq, A_Wk, A_Wv, A_Wo, A_seg_len)
    h = _layernorm(x, axis=-1) * (1 + cb) + sb
    x = x + gb * _B_ref(h, B_w1, B_w2)
    return x
```

```asm
; @launch grid=(256,1,1) block=(256,1,1) lds=163840
.amdgcn_target "amdgcn-amd-amdhsa--gfx950"
.text
.globl adaLN_cond__memory_aug_recurrent_mem_tr__dense_activation_silu__prompt_kernel
.p2align 8
.type adaLN_cond__memory_aug_recurrent_mem_tr__dense_activation_silu__prompt_kernel,@function
adaLN_cond__memory_aug_recurrent_mem_tr__dense_activation_silu__prompt_kernel:
    s_cmp_ge_u32 s2, 256
s_cbranch_scc1 L_exit
s_load_dwordx2 s[4:5], s[0:1], 112
s_load_dwordx2 s[6:7], s[0:1], 104
s_load_dwordx8 s[60:67], s[0:1], 16
s_getreg_b32 s14, hwreg(HW_REG_XCC_ID, 0, 4)
s_getpc_b64 s[72:73]
L_pc:
s_bfe_u32 s3, s2, 0x30003
s_lshl_b32 s3, s3, 14
v_lshlrev_b32 v6, 6, v0
v_add_u32 v6, s3, v6
v_min_u32 v6, L_codeend-L_pc-4, v6
s_mov_b32 m0, 40960
s_nop 0
global_load_lds_dword v6, s[72:73]
v_lshrrev_b32 v1, 6, v0
s_nop 0
v_readfirstlane_b32 s12, v1
v_and_b32 v15, 63, v0
s_waitcnt lgkmcnt(0)
s_cmp_lg_u32 s12, 0
s_cbranch_scc1 L_tk_done
s_mov_b64 exec, 1
v_mov_b32 v3, 1
s_cmp_ge_u32 s14, 2
s_cbranch_scc1 L_tk_w
s_lshl_b32 s70, s14, 6
s_add_u32 s70, s70, 160
v_mov_b32 v2, s70
global_atomic_add v4, v2, v3, s[6:7] sc0
s_waitcnt vmcnt(0)
v_readfirstlane_b32 s3, v4
s_lshl_b32 s70, s14, 8
s_cmp_lt_u32 s3, 32
s_cbranch_scc1 L_tk_got
L_tk_w:
v_mov_b32 v2, 0
global_atomic_add v4, v2, v3, s[6:7] sc0
s_waitcnt vmcnt(0)
v_readfirstlane_b32 s3, v4
s_mov_b32 s70, 0x20000
s_cmp_lt_u32 s3, 192
s_cbranch_scc1 L_tk_got
v_mov_b32 v2, 160
global_atomic_add v4, v2, v3, s[6:7] sc0
s_waitcnt vmcnt(0)
v_readfirstlane_b32 s3, v4
s_mov_b32 s70, 0x10000
s_cmp_lt_u32 s3, 32
s_cbranch_scc1 L_tk_got
v_mov_b32 v2, 224
global_atomic_add v4, v2, v3, s[6:7] sc0
s_waitcnt vmcnt(0)
v_readfirstlane_b32 s3, v4
s_mov_b32 s70, 0x10100
s_and_b32 s3, s3, 31
L_tk_got:
s_or_b32 s3, s3, s70
v_mov_b32 v4, s3
v_mov_b32 v5, 55296
ds_write_b32 v5, v4
s_bitcmp1_b32 s3, 16
s_cbranch_scc0 L_tk_nat
v_mov_b32 v2, 136
global_store_dword v2, v3, s[6:7] sc1
s_waitcnt vmcnt(0)
L_tk_nat:
s_waitcnt lgkmcnt(0)
s_mov_b64 exec, -1
L_tk_done:
s_barrier
v_mov_b32 v5, 55296
ds_read_b32 v4, v5
s_waitcnt lgkmcnt(0)
v_readfirstlane_b32 s3, v4
s_nop 0
s_and_b32 s13, s3, 255
s_bfe_u32 s14, s3, 0x10008
s_barrier
s_bitcmp1_b32 s3, 17
s_cbranch_scc0 L_chain
s_branch L_worker
L_chain:
s_and_b32 s13, s13, 31
v_lshrrev_b32 v60, 4, v15
v_and_b32 v61, 15, v15
v_lshlrev_b32 v0, 4, v15
s_lshl_b32 s74, s12, 12
s_add_u32 s70, s74, 65536
v_add_u32 v1, s70, v0
v_add_u32 v2, 32768, v1
v_and_b32 v62, 2, v61
v_cmp_ne_u32 vcc, 0, v62
v_mov_b32 v63, 0x4444
v_mov_b32 v64, 0xeeee
v_cndmask_b32 v3, v63, v64, vcc
s_mov_b64 s[24:25], vcc
s_not_b64 s[36:37], vcc
s_cmp_eq_u32 s14, 0
s_cselect_b32 s36, s36, 0
s_cselect_b32 s37, 0, s37
s_lshl_b32 s45, s12, 10
v_add_u32 v5, s45, v0
s_mul_i32 s42, s14, 5120
s_lshl_b32 s3, s14, 14
s_sub_u32 s44, 16384, s3
s_add_u32 s47, s3, 32768
s_lshl_b32 s3, s12, 8
s_add_u32 s46, s3, 2048
v_lshlrev_b32 v62, 2, v15
v_add_u32 v4, s46, v62
s_lshl_b32 s70, s14, 10
s_add_u32 s3, s3, s70
v_add_u32 v18, s3, v62
s_mul_i32 s49, s13, 4224
v_lshrrev_b32 v62, 2, v61
v_mul_u32_u24 v62, 272, v62
v_lshl_add_u32 v62, v60, 6, v62
v_and_b32 v63, 3, v61
v_lshl_add_u32 v62, v63, 1, v62
s_mul_i32 s0, s12, 1088
s_add_u32 s3, s0, 57856
v_add_u32 v6, s3, v62
v_mul_u32_u24 v62, 272, v60
v_lshl_add_u32 v62, v61, 4, v62
v_add_u32 v19, 57856, v62
s_lshl_b32 s3, s14, 11
s_sub_u32 s1, 2048, s3
v_mov_b32 v7, v0
s_lshl_b32 s3, s14, 12
s_add_u32 s3, s3, 8192
v_add_u32 v8, s3, v5
v_xor_b32 v62, 2, v61
v_lshlrev_b32 v62, 4, v62
v_lshl_add_u32 v62, v60, 2, v62
s_lshl_b32 s3, s12, 8
s_lshl_b32 s70, s14, 10
s_add_u32 s3, s3, s70
s_add_u32 s3, s3, 53248
v_add_u32 v9, s3, v62
s_mul_i32 s3, s12, 42240
s_lshl_b32 s70, s13, 7
s_add_u32 s3, s3, s70
v_lshrrev_b32 v62, 5, v15
v_mul_u32_u24 v62, 4224, v62
v_and_b32 v63, 31, v15
v_lshl_add_u32 v62, v63, 2, v62
v_add_u32 v10, s3, v62
s_lshl_b32 s71, s12, 5
s_add_u32 s71, s71, s13
s_cmp_lt_u32 s71, 40
s_cselect_b32 s28, 1, 0
s_mul_i32 s3, s71, 4224
v_add_u32 v11, s3, v0
v_bfe_u32 v62, v15, 2, 1
v_and_b32 v63, 3, v15
v_lshlrev_b32 v64, 6, v62
v_lshl_add_u32 v64, v60, 4, v64
v_lshl_add_u32 v64, v63, 2, v64
s_lshl_b32 s72, s71, 7
v_add_u32 v12, s72, v64
v_bfe_u32 v62, v61, 2, 1
v_lshlrev_b32 v62, 4, v62
v_mov_b32 v63, 0x3f80
v_lshlrev_b32 v62, v62, v63
v_lshrrev_b32 v63, 3, v61
v_lshlrev_b32 v63, 1, v63
v_and_b32 v64, 3, v61
v_add_u32 v63, v63, v64
v_or_b32 v66, 8, v63
v_cndmask_b32 v63, v63, v66, s[24:25]
v_cmp_eq_u32 vcc, 0, v63
s_nop 1
v_cndmask_b32 v68, 0, v62, vcc
v_cmp_eq_u32 vcc, 1, v63
s_nop 1
v_cndmask_b32 v69, 0, v62, vcc
v_cmp_eq_u32 vcc, 2, v63
s_nop 1
v_cndmask_b32 v70, 0, v62, vcc
v_cmp_eq_u32 vcc, 3, v63
s_nop 1
v_cndmask_b32 v71, 0, v62, vcc
v_lshrrev_b32 v62, 2, v61
v_and_b32 v63, 1, v61
v_lshl_add_u32 v62, v62, 1, v63
v_lshlrev_b32 v62, 4, v62
v_lshl_add_u32 v62, v60, 7, v62
s_lshl_b32 s3, s12, 9
s_add_u32 s3, s3, 2048
v_add_u32 v13, s3, v62
s_cmp_lg_u32 s12, 3
s_cbranch_scc1 L_not3a
v_min_u32 v62, 39, v15
v_lshlrev_b32 v62, 7, v62
v_add_u32 v12, 10240, v62
s_lshr_b32 s3, s13, 1
s_lshl_b32 s3, s3, 7
s_add_u32 s3, s3, 68158464
v_and_b32 v62, 7, v15
v_lshlrev_b32 v62, 2, v62
v_add_u32 v11, s3, v62
L_not3a:
s_lshl_b32 s3, s13, 15
s_lshl_b32 s39, s12, 12
s_add_u32 s3, s3, s39
s_and_b32 s70, s39, 8192
s_add_u32 s3, s3, s70
s_add_u32 s3, s3, 201326592
s_add_u32 s16, s4, s3
s_addc_u32 s17, s5, 0
s_add_u32 s3, s42, 60817408
s_add_u32 s18, s4, s3
s_addc_u32 s19, s5, 0
s_add_u32 s98, s4, 69206016
s_addc_u32 s99, s5, 0
s_add_u32 s100, s4, 71303168
s_addc_u32 s101, s5, 0
s_lshr_b32 s3, s13, 1
s_lshl_b32 s3, s3, 14
s_and_b32 s70, s13, 1
s_lshl_b32 s70, s70, 12
s_add_u32 s3, s3, s70
s_add_u32 s3, s3, 167772160
s_add_u32 s34, s4, s3
s_addc_u32 s35, s5, 0
s_mul_i32 s3, s14, 168960
s_add_u32 s3, s3, 58720256
s_add_u32 s8, s4, s3
s_addc_u32 s9, s5, 0
s_mov_b32 s10, 0xce400
s_mov_b32 s11, 0x20000
s_mov_b32 s30, 0xff00ff
s_mov_b32 s31, s30
s_mov_b32 s32, 0x3e0293ee
s_mov_b32 s48, 0xbe0293ee
s_mov_b32 s38, 0xffbfffbf
s_mov_b32 s15, 0
s_mov_b32 s27, 0
s_cmp_lg_u32 s12, 2
s_cbranch_scc1 L_init_done
s_mov_b64 exec, 1
v_mov_b32 v62, 64
v_mov_b32 v63, 1
global_atomic_add v63, v62, v63, s[6:7] sc0
s_waitcnt vmcnt(0)
v_cmp_ne_u32 vcc, 137, v63
s_nop 0
s_cbranch_vccnz L_ar_1
v_mov_b32 v63, 1
global_store_dword v62, v63, s[6:7] offset:64 sc1
L_ar_1:
s_mov_b64 exec, -1
L_init_done:
v_lshrrev_b32 v40, 4, v0
v_add_u32 v50, 0, v40
v_mul_u32_u24 v51, 1639, v50
v_lshrrev_b32 v51, 16, v51
v_mul_u32_u24 v52, 40, v51
v_sub_u32 v52, v50, v52
v_mul_u32_u24 v51, 1280, v51
v_lshl_add_u32 v41, v52, 4, v51
v_add_u32 v50, 64, v40
v_mul_u32_u24 v51, 1639, v50
v_lshrrev_b32 v51, 16, v51
v_mul_u32_u24 v52, 40, v51
v_sub_u32 v52, v50, v52
v_mul_u32_u24 v51, 1280, v51
v_lshl_add_u32 v42, v52, 4, v51
v_add_u32 v50, 128, v40
v_mul_u32_u24 v51, 1639, v50
v_lshrrev_b32 v51, 16, v51
v_mul_u32_u24 v52, 40, v51
v_sub_u32 v52, v50, v52
v_mul_u32_u24 v51, 1280, v51
v_lshl_add_u32 v43, v52, 4, v51
v_add_u32 v50, 192, v40
v_mul_u32_u24 v51, 1639, v50
v_lshrrev_b32 v51, 16, v51
v_mul_u32_u24 v52, 40, v51
v_sub_u32 v52, v50, v52
v_mul_u32_u24 v51, 1280, v51
v_lshl_add_u32 v44, v52, 4, v51
v_add_u32 v50, 256, v40
v_mul_u32_u24 v51, 1639, v50
v_lshrrev_b32 v51, 16, v51
v_mul_u32_u24 v52, 40, v51
v_sub_u32 v52, v50, v52
v_mul_u32_u24 v51, 1280, v51
v_lshl_add_u32 v45, v52, 4, v51
v_lshrrev_b32 v50, 4, v40
v_bfe_u32 v51, v40, 2, 2
v_lshl_add_u32 v53, v50, 3, v51
v_and_b32 v52, 3, v40
v_lshlrev_b32 v52, 3, v52
v_mul_u32_u24 v46, 640, v53
s_mul_i32 s3, s12, 160
s_add_u32 s3, s3, 65536
v_add3_u32 v46, v46, v52, s3
v_add_u32 v59, 40960, v46
v_and_b32 v54, 1, v50
v_lshl_add_u32 v54, v54, 2, v51
v_lshl_add_u32 v55, v53, 8, v52
s_lshl_b32 s3, s12, 1
s_add_u32 s3, s3, 0
v_xor_b32 v56, s3, v54
v_lshl_add_u32 v96, v56, 5, v55
v_add_u32 v98, 65536, v96
v_add_u32 v100, 131072, v96
s_lshl_b32 s3, s12, 1
s_add_u32 s3, s3, 1
v_xor_b32 v56, s3, v54
v_lshl_add_u32 v97, v56, 5, v55
v_add_u32 v99, 65536, v97
v_add_u32 v101, 131072, v97
v_lshrrev_b32 v56, 1, v54
v_xor_b32 v56, s12, v56
v_lshl_add_u32 v57, v53, 7, v52
v_lshl_add_u32 v57, v56, 5, v57
v_add_u32 v102, 65536, v57
v_add_u32 v103, 131072, v57
v_bfe_u32 v56, v40, 1, 3
v_xor_b32 v56, v56, v50
v_and_b32 v57, 1, v40
v_lshlrev_b32 v47, 13, v50
v_lshl_add_u32 v47, v57, 4, v47
v_xor_b32 v58, 4, v56
v_lshl_add_u32 v48, v58, 5, v47
v_lshl_add_u32 v47, v56, 5, v47
v_lshrrev_b32 v56, 3, v40
v_lshlrev_b32 v49, 13, v56
v_lshl_add_u32 v49, v57, 4, v49
v_bfe_u32 v56, v40, 1, 2
v_bfe_u32 v58, v40, 4, 1
v_xor_b32 v56, v56, v58
v_xor_b32 v58, 2, v56
v_lshl_add_u32 v50, v58, 5, v49
v_lshl_add_u32 v49, v56, 5, v49
s_lshl_b32 s3, s13, 8
s_lshl_b32 s73, s12, 17
s_add_u32 s73, s73, s3
s_add_u32 s60, s60, s73
s_addc_u32 s61, s61, 0
s_add_u32 s62, s62, s73
s_addc_u32 s63, s63, 0
s_mul_i32 s75, s14, 2621440
s_sub_u32 s76, 2621440, s75
s_lshl_b32 s73, s14, 7
s_add_u32 s3, s3, s73
s_and_b32 s73, s12, 1
s_lshl_b32 s73, s73, 18
s_add_u32 s3, s3, s73
s_cmp_lt_u32 s12, 2
s_cselect_b32 s73, s75, s76
s_add_u32 s3, s3, s73
s_add_u32 s64, s64, s3
s_addc_u32 s65, s65, 0
s_mul_i32 s3, s13, 163840
s_mul_i32 s73, s14, 640
s_add_u32 s3, s3, s73
s_mul_i32 s73, s12, 40960
s_add_u32 s3, s3, s73
s_add_u32 s66, s66, s3
s_addc_u32 s67, s67, 0
s_mul_i32 s77, s12, 20480
s_add_u32 s77, s77, 65536
s_add_u32 m0, s77, 0
s_nop 0
global_load_lds_dwordx4 v41, s[66:67]
s_add_u32 m0, s77, 1024
s_nop 0
global_load_lds_dwordx4 v42, s[66:67]
s_add_u32 m0, s77, 2048
s_nop 0
global_load_lds_dwordx4 v43, s[66:67]
s_add_u32 m0, s77, 3072
s_nop 0
global_load_lds_dwordx4 v44, s[66:67]
s_add_u32 m0, s77, 4096
s_nop 0
global_load_lds_dwordx4 v45, s[66:67]
s_add_u32 s66, s66, 10240
s_addc_u32 s67, s67, 0
s_add_u32 m0, s77, 5120
s_nop 0
global_load_lds_dwordx4 v41, s[66:67]
s_add_u32 m0, s77, 6144
s_nop 0
global_load_lds_dwordx4 v42, s[66:67]
s_add_u32 m0, s77, 7168
s_nop 0
global_load_lds_dwordx4 v43, s[66:67]
s_add_u32 m0, s77, 8192
s_nop 0
global_load_lds_dwordx4 v44, s[66:67]
s_add_u32 m0, s77, 9216
s_nop 0
global_load_lds_dwordx4 v45, s[66:67]
s_add_u32 s66, s66, 10240
s_addc_u32 s67, s67, 0
s_add_u32 m0, s77, 10240
s_nop 0
global_load_lds_dwordx4 v41, s[66:67]
s_add_u32 m0, s77, 11264
s_nop 0
global_load_lds_dwordx4 v42, s[66:67]
s_add_u32 m0, s77, 12288
s_nop 0
global_load_lds_dwordx4 v43, s[66:67]
s_add_u32 m0, s77, 13312
s_nop 0
global_load_lds_dwordx4 v44, s[66:67]
s_add_u32 m0, s77, 14336
s_nop 0
global_load_lds_dwordx4 v45, s[66:67]
s_add_u32 s66, s66, 10240
s_addc_u32 s67, s67, 0
s_add_u32 m0, s77, 15360
s_nop 0
global_load_lds_dwordx4 v41, s[66:67]
s_add_u32 m0, s77, 16384
s_nop 0
global_load_lds_dwordx4 v42, s[66:67]
s_add_u32 m0, s77, 17408
s_nop 0
global_load_lds_dwordx4 v43, s[66:67]
s_add_u32 m0, s77, 18432
s_nop 0
global_load_lds_dwordx4 v44, s[66:67]
s_add_u32 m0, s77, 19456
s_nop 0
global_load_lds_dwordx4 v45, s[66:67]
s_add_u32 s66, s66, 10240
s_addc_u32 s67, s67, 0
s_add_u32 s3, s76, 0
s_add_u32 s68, s60, s3
s_addc_u32 s69, s61, 0
s_add_u32 m0, s74, 147456
s_nop 0
global_load_lds_dwordx4 v47, s[68:69]
s_add_u32 s68, s68, 32768
s_addc_u32 s69, s69, 0
s_add_u32 m0, s74, 148480
s_nop 0
global_load_lds_dwordx4 v47, s[68:69]
s_add_u32 s68, s68, 32768
s_addc_u32 s69, s69, 0
s_add_u32 m0, s74, 149504
s_nop 0
global_load_lds_dwordx4 v48, s[68:69]
s_add_u32 s68, s68, 32768
s_addc_u32 s69, s69, 0
s_add_u32 m0, s74, 150528
s_nop 0
global_load_lds_dwordx4 v48, s[68:69]
s_add_u32 s3, s76, 0
s_add_u32 s68, s62, s3
s_addc_u32 s69, s63, 0
s_add_u32 m0, s74, 0
s_nop 0
global_load_lds_dwordx4 v47, s[68:69]
s_add_u32 s68, s68, 32768
s_addc_u32 s69, s69, 0
s_add_u32 m0, s74, 1024
s_nop 0
global_load_lds_dwordx4 v47, s[68:69]
s_add_u32 s68, s68, 32768
s_addc_u32 s69, s69, 0
s_add_u32 m0, s74, 2048
s_nop 0
global_load_lds_dwordx4 v48, s[68:69]
s_add_u32 s68, s68, 32768
s_addc_u32 s69, s69, 0
s_add_u32 m0, s74, 3072
s_nop 0
global_load_lds_dwordx4 v48, s[68:69]
s_add_u32 s3, s76, 524288
s_add_u32 s68, s60, s3
s_addc_u32 s69, s61, 0
s_add_u32 m0, s74, 16384
s_nop 0
global_load_lds_dwordx4 v47, s[68:69]
s_add_u32 s68, s68, 32768
s_addc_u32 s69, s69, 0
s_add_u32 m0, s74, 17408
s_nop 0
global_load_lds_dwordx4 v47, s[68:69]
s_add_u32 s68, s68, 32768
s_addc_u32 s69, s69, 0
s_add_u32 m0, s74, 18432
s_nop 0
global_load_lds_dwordx4 v48, s[68:69]
s_add_u32 s68, s68, 32768
s_addc_u32 s69, s69, 0
s_add_u32 m0, s74, 19456
s_nop 0
global_load_lds_dwordx4 v48, s[68:69]
s_add_u32 s3, s76, 524288
s_add_u32 s68, s62, s3
s_addc_u32 s69, s63, 0
s_add_u32 m0, s74, 32768
s_nop 0
global_load_lds_dwordx4 v47, s[68:69]
s_add_u32 s68, s68, 32768
s_addc_u32 s69, s69, 0
s_add_u32 m0, s74, 33792
s_nop 0
global_load_lds_dwordx4 v47, s[68:69]
s_add_u32 s68, s68, 32768
s_addc_u32 s69, s69, 0
s_add_u32 m0, s74, 34816
s_nop 0
global_load_lds_dwordx4 v48, s[68:69]
s_add_u32 s68, s68, 32768
s_addc_u32 s69, s69, 0
s_add_u32 m0, s74, 35840
s_nop 0
global_load_lds_dwordx4 v48, s[68:69]
s_add_u32 s3, s76, 1048576
s_add_u32 s68, s60, s3
s_addc_u32 s69, s61, 0
s_add_u32 m0, s74, 49152
s_nop 0
global_load_lds_dwordx4 v47, s[68:69]
s_add_u32 s68, s68, 32768
s_addc_u32 s69, s69, 0
s_add_u32 m0, s74, 50176
s_nop 0
global_load_lds_dwordx4 v47, s[68:69]
s_add_u32 s68, s68, 32768
s_addc_u32 s69, s69, 0
s_add_u32 m0, s74, 51200
s_nop 0
global_load_lds_dwordx4 v48, s[68:69]
s_add_u32 s68, s68, 32768
s_addc_u32 s69, s69, 0
s_add_u32 m0, s74, 52224
s_nop 0
global_load_lds_dwordx4 v48, s[68:69]
s_waitcnt vmcnt(20)
s_barrier
ds_read_b64_tr_b16 v[128:129], v46 offset:0
ds_read_b64_tr_b16 v[130:131], v46 offset:2560
ds_read_b64_tr_b16 v[132:133], v46 offset:20480
ds_read_b64_tr_b16 v[134:135], v46 offset:23040
ds_read_b64_tr_b16 v[144:145], v46 offset:32
ds_read_b64_tr_b16 v[146:147], v46 offset:2592
ds_read_b64_tr_b16 v[148:149], v46 offset:20512
ds_read_b64_tr_b16 v[150:151], v46 offset:23072
ds_read_b64_tr_b16 v[160:161], v46 offset:64
ds_read_b64_tr_b16 v[162:163], v46 offset:2624
ds_read_b64_tr_b16 v[164:165], v46 offset:20544
ds_read_b64_tr_b16 v[166:167], v46 offset:23104
ds_read_b64_tr_b16 v[176:177], v46 offset:96
ds_read_b64_tr_b16 v[178:179], v46 offset:2656
ds_read_b64_tr_b16 v[180:181], v46 offset:20576
ds_read_b64_tr_b16 v[182:183], v46 offset:23136
ds_read_b64_tr_b16 v[192:193], v46 offset:128
ds_read_b64_tr_b16 v[194:195], v46 offset:2688
ds_read_b64_tr_b16 v[196:197], v46 offset:20608
ds_read_b64_tr_b16 v[198:199], v46 offset:23168
ds_read_b64_tr_b16 v[136:137], v59 offset:0
ds_read_b64_tr_b16 v[138:139], v59 offset:2560
ds_read_b64_tr_b16 v[140:141], v59 offset:20480
ds_read_b64_tr_b16 v[142:143], v59 offset:23040
ds_read_b64_tr_b16 v[152:153], v59 offset:32
ds_read_b64_tr_b16 v[154:155], v59 offset:2592
ds_read_b64_tr_b16 v[156:157], v59 offset:20512
ds_read_b64_tr_b16 v[158:159], v59 offset:23072
ds_read_b64_tr_b16 v[168:169], v59 offset:64
ds_read_b64_tr_b16 v[170:171], v59 offset:2624
ds_read_b64_tr_b16 v[172:173], v59 offset:20544
ds_read_b64_tr_b16 v[174:175], v59 offset:23104
ds_read_b64_tr_b16 v[184:185], v59 offset:96
ds_read_b64_tr_b16 v[186:187], v59 offset:2656
ds_read_b64_tr_b16 v[188:189], v59 offset:20576
ds_read_b64_tr_b16 v[190:191], v59 offset:23136
ds_read_b64_tr_b16 v[200:201], v59 offset:128
ds_read_b64_tr_b16 v[202:203], v59 offset:2688
ds_read_b64_tr_b16 v[204:205], v59 offset:20608
ds_read_b64_tr_b16 v[206:207], v59 offset:23168
s_waitcnt lgkmcnt(0)
s_barrier
s_add_u32 s3, s76, 1048576
s_add_u32 s68, s62, s3
s_addc_u32 s69, s63, 0
s_add_u32 m0, s74, 65536
s_nop 0
global_load_lds_dwordx4 v47, s[68:69]
s_add_u32 s68, s68, 32768
s_addc_u32 s69, s69, 0
s_add_u32 m0, s74, 66560
s_nop 0
global_load_lds_dwordx4 v47, s[68:69]
s_add_u32 s68, s68, 32768
s_addc_u32 s69, s69, 0
s_add_u32 m0, s74, 67584
s_nop 0
global_load_lds_dwordx4 v48, s[68:69]
s_add_u32 s68, s68, 32768
s_addc_u32 s69, s69, 0
s_add_u32 m0, s74, 68608
s_nop 0
global_load_lds_dwordx4 v48, s[68:69]
s_add_u32 s3, s76, 1572864
s_add_u32 s68, s60, s3
s_addc_u32 s69, s61, 0
s_add_u32 m0, s74, 81920
s_nop 0
global_load_lds_dwordx4 v47, s[68:69]
s_add_u32 s68, s68, 32768
s_addc_u32 s69, s69, 0
s_add_u32 m0, s74, 82944
s_nop 0
global_load_lds_dwordx4 v47, s[68:69]
s_add_u32 s68, s68, 32768
s_addc_u32 s69, s69, 0
s_add_u32 m0, s74, 83968
s_nop 0
global_load_lds_dwordx4 v48, s[68:69]
s_add_u32 s68, s68, 32768
s_addc_u32 s69, s69, 0
s_add_u32 m0, s74, 84992
s_nop 0
global_load_lds_dwordx4 v48, s[68:69]
s_add_u32 s3, s76, 1572864
s_add_u32 s68, s62, s3
s_addc_u32 s69, s63, 0
s_add_u32 m0, s74, 98304
s_nop 0
global_load_lds_dwordx4 v47, s[68:69]
s_add_u32 s68, s68, 32768
s_addc_u32 s69, s69, 0
s_add_u32 m0, s74, 99328
s_nop 0
global_load_lds_dwordx4 v47, s[68:69]
s_add_u32 s68, s68, 32768
s_addc_u32 s69, s69, 0
s_add_u32 m0, s74, 100352
s_nop 0
global_load_lds_dwordx4 v48, s[68:69]
s_add_u32 s68, s68, 32768
s_addc_u32 s69, s69, 0
s_add_u32 m0, s74, 101376
s_nop 0
global_load_lds_dwordx4 v48, s[68:69]
s_add_u32 s3, s76, 2097152
s_add_u32 s68, s60, s3
s_addc_u32 s69, s61, 0
s_add_u32 m0, s74, 114688
s_nop 0
global_load_lds_dwordx4 v47, s[68:69]
s_add_u32 s68, s68, 32768
s_addc_u32 s69, s69, 0
s_add_u32 m0, s74, 115712
s_nop 0
global_load_lds_dwordx4 v47, s[68:69]
s_add_u32 s68, s68, 32768
s_addc_u32 s69, s69, 0
s_add_u32 m0, s74, 116736
s_nop 0
global_load_lds_dwordx4 v48, s[68:69]
s_add_u32 s68, s68, 32768
s_addc_u32 s69, s69, 0
s_add_u32 m0, s74, 117760
s_nop 0
global_load_lds_dwordx4 v48, s[68:69]
s_add_u32 s3, s76, 2097152
s_add_u32 s68, s62, s3
s_addc_u32 s69, s63, 0
s_add_u32 m0, s74, 131072
s_nop 0
global_load_lds_dwordx4 v47, s[68:69]
s_add_u32 s68, s68, 32768
s_addc_u32 s69, s69, 0
s_add_u32 m0, s74, 132096
s_nop 0
global_load_lds_dwordx4 v47, s[68:69]
s_add_u32 s68, s68, 32768
s_addc_u32 s69, s69, 0
s_add_u32 m0, s74, 133120
s_nop 0
global_load_lds_dwordx4 v48, s[68:69]
s_add_u32 s68, s68, 32768
s_addc_u32 s69, s69, 0
s_add_u32 m0, s74, 134144
s_nop 0
global_load_lds_dwordx4 v48, s[68:69]
s_waitcnt vmcnt(36)
s_waitcnt lgkmcnt(0)
s_barrier
ds_read_b64_tr_b16 a[0:1], v100 offset:16384
ds_read_b64_tr_b16 a[2:3], v100 offset:17408
ds_read_b64_tr_b16 a[4:5], v100 offset:24576
ds_read_b64_tr_b16 a[6:7], v100 offset:25600
ds_read_b64_tr_b16 a[8:9], v101 offset:16384
ds_read_b64_tr_b16 a[10:11], v101 offset:17408
ds_read_b64_tr_b16 a[12:13], v101 offset:24576
ds_read_b64_tr_b16 a[14:15], v101 offset:25600
s_waitcnt vmcnt(32)
s_waitcnt lgkmcnt(0)
s_barrier
s_add_u32 s3, s75, 0
s_add_u32 s68, s60, s3
s_addc_u32 s69, s61, 0
s_add_u32 m0, s74, 147456
s_nop 0
global_load_lds_dwordx4 v47, s[68:69]
s_add_u32 s68, s68, 32768
s_addc_u32 s69, s69, 0
s_add_u32 m0, s74, 148480
s_nop 0
global_load_lds_dwordx4 v47, s[68:69]
s_add_u32 s68, s68, 32768
s_addc_u32 s69, s69, 0
s_add_u32 m0, s74, 149504
s_nop 0
global_load_lds_dwordx4 v48, s[68:69]
s_add_u32 s68, s68, 32768
s_addc_u32 s69, s69, 0
s_add_u32 m0, s74, 150528
s_nop 0
global_load_lds_dwordx4 v48, s[68:69]
ds_read_b64_tr_b16 a[16:17], v96 offset:0
ds_read_b64_tr_b16 a[18:19], v96 offset:1024
ds_read_b64_tr_b16 a[20:21], v96 offset:8192
ds_read_b64_tr_b16 a[22:23], v96 offset:9216
ds_read_b64_tr_b16 a[24:25], v97 offset:0
ds_read_b64_tr_b16 a[26:27], v97 offset:1024
ds_read_b64_tr_b16 a[28:29], v97 offset:8192
ds_read_b64_tr_b16 a[30:31], v97 offset:9216
s_waitcnt vmcnt(32)
s_waitcnt lgkmcnt(0)
s_barrier
s_add_u32 s3, s75, 524288
s_add_u32 s68, s60, s3
s_addc_u32 s69, s61, 0
s_add_u32 m0, s74, 0
s_nop 0
global_load_lds_dwordx4 v47, s[68:69]
s_add_u32 s68, s68, 32768
s_addc_u32 s69, s69, 0
s_add_u32 m0, s74, 1024
s_nop 0
global_load_lds_dwordx4 v47, s[68:69]
s_add_u32 s68, s68, 32768
s_addc_u32 s69, s69, 0
s_add_u32 m0, s74, 2048
s_nop 0
global_load_lds_dwordx4 v48, s[68:69]
s_add_u32 s68, s68, 32768
s_addc_u32 s69, s69, 0
s_add_u32 m0, s74, 3072
s_nop 0
global_load_lds_dwordx4 v48, s[68:69]
ds_read_b64_tr_b16 a[32:33], v96 offset:16384
ds_read_b64_tr_b16 a[34:35], v96 offset:17408
ds_read_b64_tr_b16 a[36:37], v96 offset:24576
ds_read_b64_tr_b16 a[38:39], v96 offset:25600
ds_read_b64_tr_b16 a[40:41], v97 offset:16384
ds_read_b64_tr_b16 a[42:43], v97 offset:17408
ds_read_b64_tr_b16 a[44:45], v97 offset:24576
ds_read_b64_tr_b16 a[46:47], v97 offset:25600
s_waitcnt vmcnt(32)
s_waitcnt lgkmcnt(0)
s_barrier
s_add_u32 s3, s75, 524288
s_add_u32 s68, s62, s3
s_addc_u32 s69, s63, 0
s_add_u32 m0, s74, 16384
s_nop 0
global_load_lds_dwordx4 v47, s[68:69]
s_add_u32 s68, s68, 32768
s_addc_u32 s69, s69, 0
s_add_u32 m0, s74, 17408
s_nop 0
global_load_lds_dwordx4 v47, s[68:69]
s_add_u32 s68, s68, 32768
s_addc_u32 s69, s69, 0
s_add_u32 m0, s74, 18432
s_nop 0
global_load_lds_dwordx4 v48, s[68:69]
s_add_u32 s68, s68, 32768
s_addc_u32 s69, s69, 0
s_add_u32 m0, s74, 19456
s_nop 0
global_load_lds_dwordx4 v48, s[68:69]
ds_read_b64_tr_b16 a[48:49], v96 offset:32768
ds_read_b64_tr_b16 a[50:51], v96 offset:33792
ds_read_b64_tr_b16 a[52:53], v96 offset:40960
ds_read_b64_tr_b16 a[54:55], v96 offset:41984
ds_read_b64_tr_b16 a[56:57], v97 offset:32768
ds_read_b64_tr_b16 a[58:59], v97 offset:33792
ds_read_b64_tr_b16 a[60:61], v97 offset:40960
ds_read_b64_tr_b16 a[62:63], v97 offset:41984
s_waitcnt vmcnt(32)
s_waitcnt lgkmcnt(0)
s_barrier
s_add_u32 s3, s75, 1048576
s_add_u32 s68, s60, s3
s_addc_u32 s69, s61, 0
s_add_u32 m0, s74, 32768
s_nop 0
global_load_lds_dwordx4 v47, s[68:69]
s_add_u32 s68, s68, 32768
s_addc_u32 s69, s69, 0
s_add_u32 m0, s74, 33792
s_nop 0
global_load_lds_dwordx4 v47, s[68:69]
s_add_u32 s68, s68, 32768
s_addc_u32 s69, s69, 0
s_add_u32 m0, s74, 34816
s_nop 0
global_load_lds_dwordx4 v48, s[68:69]
s_add_u32 s68, s68, 32768
s_addc_u32 s69, s69, 0
s_add_u32 m0, s74, 35840
s_nop 0
global_load_lds_dwordx4 v48, s[68:69]
ds_read_b64_tr_b16 a[64:65], v96 offset:49152
ds_read_b64_tr_b16 a[66:67], v96 offset:50176
ds_read_b64_tr_b16 a[68:69], v96 offset:57344
ds_read_b64_tr_b16 a[70:71], v96 offset:58368
ds_read_b64_tr_b16 a[72:73], v97 offset:49152
ds_read_b64_tr_b16 a[74:75], v97 offset:50176
ds_read_b64_tr_b16 a[76:77], v97 offset:57344
ds_read_b64_tr_b16 a[78:79], v97 offset:58368
s_waitcnt vmcnt(32)
s_waitcnt lgkmcnt(0)
s_barrier
s_add_u32 s3, s75, 1048576
s_add_u32 s68, s62, s3
s_addc_u32 s69, s63, 0
s_add_u32 m0, s74, 49152
s_nop 0
global_load_lds_dwordx4 v47, s[68:69]
s_add_u32 s68, s68, 32768
s_addc_u32 s69, s69, 0
s_add_u32 m0, s74, 50176
s_nop 0
global_load_lds_dwordx4 v47, s[68:69]
s_add_u32 s68, s68, 32768
s_addc_u32 s69, s69, 0
s_add_u32 m0, s74, 51200
s_nop 0
global_load_lds_dwordx4 v48, s[68:69]
s_add_u32 s68, s68, 32768
s_addc_u32 s69, s69, 0
s_add_u32 m0, s74, 52224
s_nop 0
global_load_lds_dwordx4 v48, s[68:69]
ds_read_b64_tr_b16 a[80:81], v98 offset:0
ds_read_b64_tr_b16 a[82:83], v98 offset:1024
ds_read_b64_tr_b16 a[84:85], v98 offset:8192
ds_read_b64_tr_b16 a[86:87], v98 offset:9216
ds_read_b64_tr_b16 a[88:89], v99 offset:0
ds_read_b64_tr_b16 a[90:91], v99 offset:1024
ds_read_b64_tr_b16 a[92:93], v99 offset:8192
ds_read_b64_tr_b16 a[94:95], v99 offset:9216
s_waitcnt vmcnt(32)
s_waitcnt lgkmcnt(0)
s_barrier
s_add_u32 s68, s64, 0
s_addc_u32 s69, s65, 0
s_add_u32 m0, s74, 65536
s_nop 0
global_load_lds_dwordx4 v49, s[68:69]
s_add_u32 s68, s68, 65536
s_addc_u32 s69, s69, 0
s_add_u32 m0, s74, 66560
s_nop 0
global_load_lds_dwordx4 v50, s[68:69]
s_add_u32 s68, s68, 65536
s_addc_u32 s69, s69, 0
s_add_u32 m0, s74, 67584
s_nop 0
global_load_lds_dwordx4 v49, s[68:69]
s_add_u32 s68, s68, 65536
s_addc_u32 s69, s69, 0
s_add_u32 m0, s74, 68608
s_nop 0
global_load_lds_dwordx4 v50, s[68:69]
ds_read_b64_tr_b16 a[96:97], v98 offset:16384
ds_read_b64_tr_b16 a[98:99], v98 offset:17408
ds_read_b64_tr_b16 a[100:101], v98 offset:24576
ds_read_b64_tr_b16 a[102:103], v98 offset:25600
ds_read_b64_tr_b16 a[104:105], v99 offset:16384
ds_read_b64_tr_b16 a[106:107], v99 offset:17408
ds_read_b64_tr_b16 a[108:109], v99 offset:24576
ds_read_b64_tr_b16 a[110:111], v99 offset:25600
s_waitcnt vmcnt(32)
s_waitcnt lgkmcnt(0)
s_barrier
s_add_u32 s68, s64, 524288
s_addc_u32 s69, s65, 0
s_add_u32 m0, s74, 81920
s_nop 0
global_load_lds_dwordx4 v49, s[68:69]
s_add_u32 s68, s68, 65536
s_addc_u32 s69, s69, 0
s_add_u32 m0, s74, 82944
s_nop 0
global_load_lds_dwordx4 v50, s[68:69]
s_add_u32 s68, s68, 65536
s_addc_u32 s69, s69, 0
s_add_u32 m0, s74, 83968
s_nop 0
global_load_lds_dwordx4 v49, s[68:69]
s_add_u32 s68, s68, 65536
s_addc_u32 s69, s69, 0
s_add_u32 m0, s74, 84992
s_nop 0
global_load_lds_dwordx4 v50, s[68:69]
ds_read_b64_tr_b16 a[112:113], v98 offset:32768
ds_read_b64_tr_b16 a[114:115], v98 offset:33792
ds_read_b64_tr_b16 a[116:117], v98 offset:40960
ds_read_b64_tr_b16 a[118:119], v98 offset:41984
ds_read_b64_tr_b16 a[120:121], v99 offset:32768
ds_read_b64_tr_b16 a[122:123], v99 offset:33792
ds_read_b64_tr_b16 a[124:125], v99 offset:40960
ds_read_b64_tr_b16 a[126:127], v99 offset:41984
s_waitcnt vmcnt(32)
s_waitcnt lgkmcnt(0)
s_barrier
s_add_u32 s68, s64, 1048576
s_addc_u32 s69, s65, 0
s_add_u32 m0, s74, 98304
s_nop 0
global_load_lds_dwordx4 v49, s[68:69]
s_add_u32 s68, s68, 65536
s_addc_u32 s69, s69, 0
s_add_u32 m0, s74, 99328
s_nop 0
global_load_lds_dwordx4 v50, s[68:69]
s_add_u32 s68, s68, 65536
s_addc_u32 s69, s69, 0
s_add_u32 m0, s74, 100352
s_nop 0
global_load_lds_dwordx4 v49, s[68:69]
s_add_u32 s68, s68, 65536
s_addc_u32 s69, s69, 0
s_add_u32 m0, s74, 101376
s_nop 0
global_load_lds_dwordx4 v50, s[68:69]
ds_read_b64_tr_b16 a[128:129], v98 offset:49152
ds_read_b64_tr_b16 a[130:131], v98 offset:50176
ds_read_b64_tr_b16 a[132:133], v98 offset:57344
ds_read_b64_tr_b16 a[134:135], v98 offset:58368
ds_read_b64_tr_b16 a[136:137], v99 offset:49152
ds_read_b64_tr_b16 a[138:139], v99 offset:50176
ds_read_b64_tr_b16 a[140:141], v99 offset:57344
ds_read_b64_tr_b16 a[142:143], v99 offset:58368
s_waitcnt vmcnt(32)
s_waitcnt lgkmcnt(0)
s_barrier
s_add_u32 s68, s64, 1572864
s_addc_u32 s69, s65, 0
s_add_u32 m0, s74, 114688
s_nop 0
global_load_lds_dwordx4 v49, s[68:69]
s_add_u32 s68, s68, 65536
s_addc_u32 s69, s69, 0
s_add_u32 m0, s74, 115712
s_nop 0
global_load_lds_dwordx4 v50, s[68:69]
s_add_u32 s68, s68, 65536
s_addc_u32 s69, s69, 0
s_add_u32 m0, s74, 116736
s_nop 0
global_load_lds_dwordx4 v49, s[68:69]
s_add_u32 s68, s68, 65536
s_addc_u32 s69, s69, 0
s_add_u32 m0, s74, 117760
s_nop 0
global_load_lds_dwordx4 v50, s[68:69]
ds_read_b64_tr_b16 a[144:145], v100 offset:0
ds_read_b64_tr_b16 a[146:147], v100 offset:1024
ds_read_b64_tr_b16 a[148:149], v100 offset:8192
ds_read_b64_tr_b16 a[150:151], v100 offset:9216
ds_read_b64_tr_b16 a[152:153], v101 offset:0
ds_read_b64_tr_b16 a[154:155], v101 offset:1024
ds_read_b64_tr_b16 a[156:157], v101 offset:8192
ds_read_b64_tr_b16 a[158:159], v101 offset:9216
s_waitcnt vmcnt(32)
s_waitcnt lgkmcnt(0)
s_barrier
s_add_u32 s68, s64, 2097152
s_addc_u32 s69, s65, 0
s_add_u32 m0, s74, 131072
s_nop 0
global_load_lds_dwordx4 v49, s[68:69]
s_add_u32 s68, s68, 65536
s_addc_u32 s69, s69, 0
s_add_u32 m0, s74, 132096
s_nop 0
global_load_lds_dwordx4 v50, s[68:69]
s_add_u32 s68, s68, 65536
s_addc_u32 s69, s69, 0
s_add_u32 m0, s74, 133120
s_nop 0
global_load_lds_dwordx4 v49, s[68:69]
s_add_u32 s68, s68, 65536
s_addc_u32 s69, s69, 0
s_add_u32 m0, s74, 134144
s_nop 0
global_load_lds_dwordx4 v50, s[68:69]
ds_read_b64_tr_b16 a[160:161], v100 offset:16384
ds_read_b64_tr_b16 a[162:163], v100 offset:17408
ds_read_b64_tr_b16 a[164:165], v100 offset:24576
ds_read_b64_tr_b16 a[166:167], v100 offset:25600
ds_read_b64_tr_b16 a[168:169], v101 offset:16384
ds_read_b64_tr_b16 a[170:171], v101 offset:17408
ds_read_b64_tr_b16 a[172:173], v101 offset:24576
ds_read_b64_tr_b16 a[174:175], v101 offset:25600
s_waitcnt vmcnt(32)
s_waitcnt lgkmcnt(0)
s_barrier
s_add_u32 s3, s75, 0
s_add_u32 s68, s62, s3
s_addc_u32 s69, s63, 0
s_add_u32 m0, s74, 147456
s_nop 0
global_load_lds_dwordx4 v47, s[68:69]
s_add_u32 s68, s68, 32768
s_addc_u32 s69, s69, 0
s_add_u32 m0, s74, 148480
s_nop 0
global_load_lds_dwordx4 v47, s[68:69]
s_add_u32 s68, s68, 32768
s_addc_u32 s69, s69, 0
s_add_u32 m0, s74, 149504
s_nop 0
global_load_lds_dwordx4 v48, s[68:69]
s_add_u32 s68, s68, 32768
s_addc_u32 s69, s69, 0
s_add_u32 m0, s74, 150528
s_nop 0
global_load_lds_dwordx4 v48, s[68:69]
ds_read_b64_tr_b16 a[176:177], v96 offset:0
ds_read_b64_tr_b16 a[178:179], v96 offset:1024
ds_read_b64_tr_b16 a[180:181], v96 offset:8192
ds_read_b64_tr_b16 a[182:183], v96 offset:9216
ds_read_b64_tr_b16 a[184:185], v97 offset:0
ds_read_b64_tr_b16 a[186:187], v97 offset:1024
ds_read_b64_tr_b16 a[188:189], v97 offset:8192
ds_read_b64_tr_b16 a[190:191], v97 offset:9216
s_waitcnt vmcnt(32)
s_waitcnt lgkmcnt(0)
s_barrier
s_add_u32 s3, s75, 1572864
s_add_u32 s68, s60, s3
s_addc_u32 s69, s61, 0
s_add_u32 m0, s74, 0
s_nop 0
global_load_lds_dwordx4 v47, s[68:69]
s_add_u32 s68, s68, 32768
s_addc_u32 s69, s69, 0
s_add_u32 m0, s74, 1024
s_nop 0
global_load_lds_dwordx4 v47, s[68:69]
s_add_u32 s68, s68, 32768
s_addc_u32 s69, s69, 0
s_add_u32 m0, s74, 2048
s_nop 0
global_load_lds_dwordx4 v48, s[68:69]
s_add_u32 s68, s68, 32768
s_addc_u32 s69, s69, 0
s_add_u32 m0, s74, 3072
s_nop 0
global_load_lds_dwordx4 v48, s[68:69]
ds_read_b64_tr_b16 a[192:193], v96 offset:16384
ds_read_b64_tr_b16 a[194:195], v96 offset:17408
ds_read_b64_tr_b16 a[196:197], v96 offset:24576
ds_read_b64_tr_b16 a[198:199], v96 offset:25600
ds_read_b64_tr_b16 a[200:201], v97 offset:16384
ds_read_b64_tr_b16 a[202:203], v97 offset:17408
ds_read_b64_tr_b16 a[204:205], v97 offset:24576
ds_read_b64_tr_b16 a[206:207], v97 offset:25600
s_waitcnt vmcnt(32)
s_waitcnt lgkmcnt(0)
s_barrier
s_add_u32 s3, s75, 1572864
s_add_u32 s68, s62, s3
s_addc_u32 s69, s63, 0
s_add_u32 m0, s74, 16384
s_nop 0
global_load_lds_dwordx4 v47, s[68:69]
s_add_u32 s68, s68, 32768
s_addc_u32 s69, s69, 0
s_add_u32 m0, s74, 17408
s_nop 0
global_load_lds_dwordx4 v47, s[68:69]
s_add_u32 s68, s68, 32768
s_addc_u32 s69, s69, 0
s_add_u32 m0, s74, 18432
s_nop 0
global_load_lds_dwordx4 v48, s[68:69]
s_add_u32 s68, s68, 32768
s_addc_u32 s69, s69, 0
s_add_u32 m0, s74, 19456
s_nop 0
global_load_lds_dwordx4 v48, s[68:69]
ds_read_b64_tr_b16 a[208:209], v96 offset:32768
ds_read_b64_tr_b16 a[210:211], v96 offset:33792
ds_read_b64_tr_b16 a[212:213], v96 offset:40960
ds_read_b64_tr_b16 a[214:215], v96 offset:41984
ds_read_b64_tr_b16 a[216:217], v97 offset:32768
ds_read_b64_tr_b16 a[218:219], v97 offset:33792
ds_read_b64_tr_b16 a[220:221], v97 offset:40960
ds_read_b64_tr_b16 a[222:223], v97 offset:41984
s_waitcnt vmcnt(32)
s_waitcnt lgkmcnt(0)
s_barrier
s_add_u32 s3, s75, 2097152
s_add_u32 s68, s60, s3
s_addc_u32 s69, s61, 0
s_add_u32 m0, s74, 32768
s_nop 0
global_load_lds_dwordx4 v47, s[68:69]
s_add_u32 s68, s68, 32768
s_addc_u32 s69, s69, 0
s_add_u32 m0, s74, 33792
s_nop 0
global_load_lds_dwordx4 v47, s[68:69]
s_add_u32 s68, s68, 32768
s_addc_u32 s69, s69, 0
s_add_u32 m0, s74, 34816
s_nop 0
global_load_lds_dwordx4 v48, s[68:69]
s_add_u32 s68, s68, 32768
s_addc_u32 s69, s69, 0
s_add_u32 m0, s74, 35840
s_nop 0
global_load_lds_dwordx4 v48, s[68:69]
ds_read_b64_tr_b16 a[224:225], v96 offset:49152
ds_read_b64_tr_b16 a[226:227], v96 offset:50176
ds_read_b64_tr_b16 a[228:229], v96 offset:57344
ds_read_b64_tr_b16 a[230:231], v96 offset:58368
ds_read_b64_tr_b16 a[232:233], v97 offset:49152
ds_read_b64_tr_b16 a[234:235], v97 offset:50176
ds_read_b64_tr_b16 a[236:237], v97 offset:57344
ds_read_b64_tr_b16 a[238:239], v97 offset:58368
s_waitcnt vmcnt(32)
s_waitcnt lgkmcnt(0)
s_barrier
s_add_u32 s3, s75, 2097152
s_add_u32 s68, s62, s3
s_addc_u32 s69, s63, 0
s_add_u32 m0, s74, 49152
s_nop 0
global_load_lds_dwordx4 v47, s[68:69]
s_add_u32 s68, s68, 32768
s_addc_u32 s69, s69, 0
s_add_u32 m0, s74, 50176
s_nop 0
global_load_lds_dwordx4 v47, s[68:69]
s_add_u32 s68, s68, 32768
s_addc_u32 s69, s69, 0
s_add_u32 m0, s74, 51200
s_nop 0
global_load_lds_dwordx4 v48, s[68:69]
s_add_u32 s68, s68, 32768
s_addc_u32 s69, s69, 0
s_add_u32 m0, s74, 52224
s_nop 0
global_load_lds_dwordx4 v48, s[68:69]
ds_read_b64_tr_b16 v[80:81], v102 offset:0
ds_read_b64_tr_b16 v[82:83], v102 offset:512
ds_read_b64_tr_b16 v[84:85], v102 offset:4096
ds_read_b64_tr_b16 v[86:87], v102 offset:4608
ds_read_b64_tr_b16 v[88:89], v102 offset:8192
ds_read_b64_tr_b16 v[90:91], v102 offset:8704
ds_read_b64_tr_b16 v[92:93], v102 offset:12288
ds_read_b64_tr_b16 v[94:95], v102 offset:12800
s_waitcnt lgkmcnt(0)
s_barrier
ds_write_b128 v1, v[80:83] offset:0
ds_write_b128 v1, v[84:87] offset:1024
ds_write_b128 v1, v[88:91] offset:2048
ds_write_b128 v1, v[92:95] offset:3072
s_waitcnt vmcnt(32)
s_waitcnt lgkmcnt(0)
s_barrier
ds_read_b64_tr_b16 v[80:81], v102 offset:16384
ds_read_b64_tr_b16 v[82:83], v102 offset:16896
ds_read_b64_tr_b16 v[84:85], v102 offset:20480
ds_read_b64_tr_b16 v[86:87], v102 offset:20992
ds_read_b64_tr_b16 v[88:89], v102 offset:24576
ds_read_b64_tr_b16 v[90:91], v102 offset:25088
ds_read_b64_tr_b16 v[92:93], v102 offset:28672
ds_read_b64_tr_b16 v[94:95], v102 offset:29184
s_waitcnt lgkmcnt(0)
s_barrier
ds_write_b128 v1, v[80:83] offset:16384
ds_write_b128 v1, v[84:87] offset:17408
ds_write_b128 v1, v[88:91] offset:18432
ds_write_b128 v1, v[92:95] offset:19456
s_waitcnt vmcnt(28)
s_waitcnt lgkmcnt(0)
s_barrier
ds_read_b64_tr_b16 v[80:81], v102 offset:32768
ds_read_b64_tr_b16 v[82:83], v102 offset:33280
ds_read_b64_tr_b16 v[84:85], v102 offset:36864
ds_read_b64_tr_b16 v[86:87], v102 offset:37376
ds_read_b64_tr_b16 v[88:89], v102 offset:40960
ds_read_b64_tr_b16 v[90:91], v102 offset:41472
ds_read_b64_tr_b16 v[92:93], v102 offset:45056
ds_read_b64_tr_b16 v[94:95], v102 offset:45568
s_waitcnt lgkmcnt(0)
s_barrier
ds_write_b128 v2, v[80:83] offset:0
ds_write_b128 v2, v[84:87] offset:1024
ds_write_b128 v2, v[88:91] offset:2048
ds_write_b128 v2, v[92:95] offset:3072
s_waitcnt vmcnt(24)
s_waitcnt lgkmcnt(0)
s_barrier
ds_read_b64_tr_b16 v[80:81], v102 offset:49152
ds_read_b64_tr_b16 v[82:83], v102 offset:49664
ds_read_b64_tr_b16 v[84:85], v102 offset:53248
ds_read_b64_tr_b16 v[86:87], v102 offset:53760
ds_read_b64_tr_b16 v[88:89], v102 offset:57344
ds_read_b64_tr_b16 v[90:91], v102 offset:57856
ds_read_b64_tr_b16 v[92:93], v102 offset:61440
ds_read_b64_tr_b16 v[94:95], v102 offset:61952
s_waitcnt lgkmcnt(0)
s_barrier
ds_write_b128 v2, v[80:83] offset:16384
ds_write_b128 v2, v[84:87] offset:17408
ds_write_b128 v2, v[88:91] offset:18432
ds_write_b128 v2, v[92:95] offset:19456
s_waitcnt vmcnt(20)
s_waitcnt lgkmcnt(0)
s_barrier
ds_read_b64_tr_b16 v[80:81], v103 offset:0
ds_read_b64_tr_b16 v[82:83], v103 offset:512
ds_read_b64_tr_b16 v[84:85], v103 offset:4096
ds_read_b64_tr_b16 v[86:87], v103 offset:4608
ds_read_b64_tr_b16 v[88:89], v103 offset:8192
ds_read_b64_tr_b16 v[90:91], v103 offset:8704
ds_read_b64_tr_b16 v[92:93], v103 offset:12288
ds_read_b64_tr_b16 v[94:95], v103 offset:12800
s_waitcnt lgkmcnt(0)
s_barrier
ds_write_b128 v2, v[80:83] offset:32768
ds_write_b128 v2, v[84:87] offset:33792
ds_write_b128 v2, v[88:91] offset:34816
ds_write_b128 v2, v[92:95] offset:35840
s_waitcnt vmcnt(16)
s_waitcnt lgkmcnt(0)
s_barrier
ds_read_b64_tr_b16 v[80:81], v100 offset:16384
ds_read_b64_tr_b16 v[82:83], v100 offset:17408
ds_read_b64_tr_b16 v[84:85], v100 offset:24576
ds_read_b64_tr_b16 v[86:87], v100 offset:25600
ds_read_b64_tr_b16 v[88:89], v101 offset:16384
ds_read_b64_tr_b16 v[90:91], v101 offset:17408
ds_read_b64_tr_b16 v[92:93], v101 offset:24576
ds_read_b64_tr_b16 v[94:95], v101 offset:25600
s_waitcnt lgkmcnt(0)
s_barrier
ds_write_b128 v2, v[80:83] offset:49152
ds_write_b128 v2, v[84:87] offset:50176
ds_write_b128 v2, v[88:91] offset:51200
ds_write_b128 v2, v[92:95] offset:52224
s_waitcnt vmcnt(12)
s_waitcnt lgkmcnt(0)
s_barrier
ds_read_b64_tr_b16 a[240:241], v96 offset:0
ds_read_b64_tr_b16 a[242:243], v96 offset:1024
ds_read_b64_tr_b16 a[244:245], v96 offset:8192
ds_read_b64_tr_b16 a[246:247], v96 offset:9216
ds_read_b64_tr_b16 a[248:249], v97 offset:0
ds_read_b64_tr_b16 a[250:251], v97 offset:1024
ds_read_b64_tr_b16 a[252:253], v97 offset:8192
ds_read_b64_tr_b16 a[254:255], v97 offset:9216
v_mov_b32 v60, 20
v_mov_b32 v61, 1
s_cmp_lg_u32 s12, 2
s_cbranch_scc1 L_wl_skip
s_mov_b64 exec, 1
global_atomic_add v61, v60, v61, s[6:7] sc0
s_mov_b64 exec, -1
L_wl_skip:
v_mov_b32 v62, 128
s_lshr_b32 s26, s13, 1
s_lshl_b32 s26, s26, 7
s_add_u32 s26, s26, 68158464
v_mov_b32 v63, s26
global_load_dwordx4 v[64:67], v62, s[6:7] sc1
global_load_dwordx4 v[20:23], v63, s[4:5] sc1
global_load_dwordx4 v[24:27], v63, s[4:5] offset:16 sc1
s_waitcnt vmcnt(11)
s_waitcnt lgkmcnt(0)
s_barrier
ds_read_b64_tr_b16 v[208:209], v96 offset:16384
ds_read_b64_tr_b16 v[210:211], v96 offset:17408
ds_read_b64_tr_b16 v[212:213], v96 offset:24576
ds_read_b64_tr_b16 v[214:215], v96 offset:25600
ds_read_b64_tr_b16 v[216:217], v97 offset:16384
ds_read_b64_tr_b16 v[218:219], v97 offset:17408
ds_read_b64_tr_b16 v[220:221], v97 offset:24576
ds_read_b64_tr_b16 v[222:223], v97 offset:25600
s_waitcnt vmcnt(7)
s_waitcnt lgkmcnt(0)
s_barrier
ds_read_b64_tr_b16 v[224:225], v96 offset:32768
ds_read_b64_tr_b16 v[226:227], v96 offset:33792
ds_read_b64_tr_b16 v[228:229], v96 offset:40960
ds_read_b64_tr_b16 v[230:231], v96 offset:41984
ds_read_b64_tr_b16 v[232:233], v97 offset:32768
ds_read_b64_tr_b16 v[234:235], v97 offset:33792
ds_read_b64_tr_b16 v[236:237], v97 offset:40960
ds_read_b64_tr_b16 v[238:239], v97 offset:41984
s_waitcnt vmcnt(3)
s_waitcnt lgkmcnt(0)
s_barrier
ds_read_b64_tr_b16 v[240:241], v96 offset:49152
ds_read_b64_tr_b16 v[242:243], v96 offset:50176
ds_read_b64_tr_b16 v[244:245], v96 offset:57344
ds_read_b64_tr_b16 v[246:247], v96 offset:58368
ds_read_b64_tr_b16 v[248:249], v97 offset:49152
ds_read_b64_tr_b16 v[250:251], v97 offset:50176
ds_read_b64_tr_b16 v[252:253], v97 offset:57344
ds_read_b64_tr_b16 v[254:255], v97 offset:58368
s_waitcnt vmcnt(0) lgkmcnt(0)
v_readfirstlane_b32 s3, v61
s_lshl_b32 s70, s12, 8
s_add_u32 s3, s3, s70
s_cmp_lg_u32 s3, 575
s_cbranch_scc1 L_wl_done
v_mov_b32 v61, 1
s_mov_b64 exec, 1
global_store_dword v60, v61, s[6:7] offset:128 sc1
s_mov_b64 exec, -1
L_wl_done:
s_mov_b32 s29, 0x40000
L_wait64:
v_readfirstlane_b32 s3, v64
v_readfirstlane_b32 s43, v65
v_readfirstlane_b32 s76, v66
v_min_u32 v20, v20, v24
v_lshrrev_b32 v24, 4, v20
v_lshl_add_u32 v20, v24, 5, v20
v_lshl_add_u32 v20, v20, 1, 0
v_min_u32 v21, v21, v25
v_lshrrev_b32 v25, 4, v21
v_lshl_add_u32 v21, v25, 5, v21
v_lshl_add_u32 v21, v21, 1, 1
v_min_u32 v22, v22, v26
v_lshl_add_u32 v22, v22, 1, 32
v_min_u32 v23, v23, v27
v_lshl_add_u32 v23, v23, 1, 33
v_min3_u32 v20, v20, v21, v22
v_min_u32 v20, v20, v23
s_nop 0
v_readfirstlane_b32 s42, v20
v_mov_b64 v[20:21], 0
v_mov_b64 v[22:23], 0
v_mov_b64 v[24:25], 0
v_mov_b64 v[26:27], 0
s_cmp_eq_u32 s3, 0
s_cselect_b32 s42, 0, s42
s_cmp_gt_u32 s42, 1
s_cbranch_scc1 L_wait64_done
s_sleep 4
v_mov_b32 v62, 128
s_lshr_b32 s26, s13, 1
s_lshl_b32 s26, s26, 7
s_add_u32 s26, s26, 68158464
v_mov_b32 v63, s26
global_load_dwordx4 v[64:67], v62, s[6:7] sc1
global_load_dwordx4 v[20:23], v63, s[4:5] sc1
global_load_dwordx4 v[24:27], v63, s[4:5] offset:16 sc1
s_waitcnt vmcnt(0)
s_sub_u32 s29, s29, 1
s_cbranch_scc0 L_wait64
s_branch L_abort
L_wait64_done:
s_bitcmp1_b32 s43, 0
s_cselect_b32 s3, 8192, 0
s_add_u32 s98, s98, s3
s_addc_u32 s99, s99, 0
s_bitcmp1_b32 s43, 1
s_cselect_b32 s3, 8192, 0
s_add_u32 s100, s100, s3
s_addc_u32 s101, s101, 0
v_mov_b32 v112, 0x3f803f80
v_mov_b32 v113, 0x3f803f80
v_mov_b32 v114, 0x3f803f80
v_mov_b32 v115, 0x3f803f80
v_mov_b64 v[116:117], 0
v_mov_b64 v[118:119], 0
v_mov_b64 v[120:121], 0
v_mov_b64 v[122:123], 0
v_mov_b64 v[124:125], 0
v_mov_b64 v[126:127], 0
s_bitcmp1_b32 s43, 2
s_cselect_b32 s3, 0, 8192
s_add_u32 s20, s34, s3
s_addc_u32 s21, s35, 0
v_lshrrev_b32 v62, 4, v0
s_lshr_b32 s3, s12, 1
s_lshl_b32 s3, s3, 10
s_and_b32 s70, s12, 1
s_lshl_b32 s70, s70, 3
s_add_u32 s3, s3, s70
v_add_u32 v17, s3, v0
v_lshrrev_b32 v63, 4, v62
v_mul_u32_u24 v63, 20, v63
v_sub_u32 v62, v62, v63
v_mov_b32 v63, 0x3f80
v_cmp_eq_u32 vcc, 0, v62
s_nop 1
v_cndmask_b32 v126, 0, v63, vcc
v_cmp_eq_u32 vcc, 1, v62
s_nop 1
v_cndmask_b32 v126, v126, 1.0, vcc
v_mov_b32 v120, s38
v_mov_b32 v121, s38
v_mov_b32 v122, s38
v_mov_b32 v123, s38
v_and_b32 v62, 0x380, v0
v_bfe_u32 v63, v0, 4, 2
v_lshl_add_u32 v62, v63, 5, v62
v_bfe_u32 v63, v0, 6, 1
v_lshl_add_u32 v125, v63, 4, v62
s_barrier
v_and_b32 v62, 255, v0
ds_write_b128 v62, v[116:119] offset:57600
ds_write_b128 v62, v[68:71] offset:57344
v_add_u32 v63, s0, v19
ds_write_b128 v63, v[116:119]
s_waitcnt lgkmcnt(0)
s_bitcmp1_b32 s43, 2
s_cselect_b32 s3, 8192, 0
s_lshl_b32 s41, s3, 1
s_sub_u32 s41, 1056768, s41
s_add_u32 s16, s16, s3
s_addc_u32 s17, s17, 0
s_mov_b32 s40, 0x100000
s_mov_b32 m0, s39
s_nop 0
global_load_lds_dwordx4 v0, s[16:17] offset:0 sc1
global_load_lds_dwordx4 v0, s[16:17] offset:1024 sc1
global_load_lds_dwordx4 v0, s[16:17] offset:2048 sc1
global_load_lds_dwordx4 v0, s[16:17] offset:3072 sc1
s_add_u32 s16, s16, s40
s_addc_u32 s17, s17, 0
s_xor_b32 s39, s39, 16384
s_sub_u32 s3, 0x200000, s40
s_mov_b32 s40, s41
s_mov_b32 s41, s3
s_cmp_lg_u32 s76, 0
s_cbranch_scc1 L_slow
s_cmp_eq_u32 s12, 3
s_cbranch_scc1 L_enter_w3f
s_cmp_eq_u32 s28, 0
s_cbranch_scc1 L_enter_nrf
s_branch L_enter_redf
L_slow:
s_cmp_eq_u32 s12, 3
s_cbranch_scc1 L_enter_w3s
s_cmp_eq_u32 s28, 0
s_cbranch_scc1 L_enter_nrs
s_branch L_enter_reds
L_enter_redf:
s_mov_b32 s27, 675840
s_mov_b32 s3, 0
buffer_load_dwordx4 v[40:43], v11, s[8:11], s3 offen offset:0 sc1
buffer_load_dwordx4 v[44:47], v11, s[8:11], s3 offen offset:1024 sc1
buffer_load_dwordx4 v[48:51], v11, s[8:11], s3 offen offset:2048 sc1
buffer_load_dwordx4 v[52:55], v11, s[8:11], s3 offen offset:3072 sc1
s_mov_b32 s3, 337920
buffer_load_dwordx4 v[40:43], v11, s[8:11], s3 offen offset:0 sc1
buffer_load_dwordx4 v[44:47], v11, s[8:11], s3 offen offset:1024 sc1
buffer_load_dwordx4 v[48:51], v11, s[8:11], s3 offen offset:2048 sc1
buffer_load_dwordx4 v[52:55], v11, s[8:11], s3 offen offset:3072 sc1
s_mov_b32 s3, 675840
buffer_load_dwordx4 v[40:43], v11, s[8:11], s3 offen offset:0 sc1
buffer_load_dwordx4 v[44:47], v11, s[8:11], s3 offen offset:1024 sc1
buffer_load_dwordx4 v[48:51], v11, s[8:11], s3 offen offset:2048 sc1
buffer_load_dwordx4 v[52:55], v11, s[8:11], s3 offen offset:3072 sc1
ds_read_b128 v[80:83], v1 offset:0
ds_read_b128 v[84:87], v1 offset:1024
ds_read_b128 v[88:91], v1 offset:16384
ds_read_b128 v[92:95], v1 offset:17408
ds_read_b128 v[96:99], v2 offset:0
ds_read_b128 v[100:103], v2 offset:1024
ds_read_b128 v[104:107], v2 offset:16384
ds_read_b128 v[108:111], v2 offset:17408
v_mov_b64 v[20:21], 0
v_mov_b64 v[22:23], 0
v_mov_b64 v[24:25], 0
v_mov_b64 v[26:27], 0
v_mov_b64 v[28:29], 0
v_mov_b64 v[30:31], 0
v_mov_b64 v[32:33], 0
v_mov_b64 v[34:35], 0
v_mov_b64 v[36:37], 0
v_mov_b64 v[38:39], 0
.p2align 6
L_loop_redf:
s_add_u32 s2, s27, s49
s_add_u32 s27, s27, 337920
s_cmp_ge_u32 s27, 1013760
s_cselect_b32 s27, 0, s27
s_add_u32 s3, s15, 1
s_min_u32 s3, s3, 63
s_cmp_le_u32 s42, s3
s_cbranch_scc1 L_kvpl_redf
s_nop 15
s_nop 11
L_kvokl_redf:
s_add_u32 s50, s98, s44
s_addc_u32 s51, s99, 0
s_add_u32 s52, s100, s44
s_addc_u32 s53, s101, 0
s_mov_b32 s29, 0x40000
s_nop 9
s_add_u32 m0, s45, 32768
s_nop 0
global_load_lds_dwordx4 v5, s[18:19] sc1
s_add_u32 m0, s46, 32768
s_nop 0
global_load_lds_dword v4, s[18:19] offset:2048 sc1
ds_read_b128 v[60:63], v2 offset:49152
ds_read_b128 v[64:67], v2 offset:50176
ds_read_b128 v[68:71], v2 offset:51200
ds_read_b128 v[72:75], v2 offset:52224
s_cmp_ge_u32 s15, 62
s_cselect_b32 s40, 0, s40
s_lshr_b32 s3, s15, 3
s_add_u32 s3, s3, 2
s_bitcmp1_b32 s43, s3
s_cselect_b32 s3, 8192, 0
s_mov_b64 s[96:97], s[20:21]
s_add_u32 s20, s34, s3
s_addc_u32 s21, s35, 0
v_xor_b32 v16, 4096, v8
s_nop 13
s_add_u32 m0, s45, 32768
s_nop 0
global_load_lds_dwordx4 v5, s[18:19] sc1
s_add_u32 m0, s46, 32768
s_nop 0
global_load_lds_dword v4, s[18:19] offset:2048 sc1
s_barrier
s_add_u32 m0, s45, 37888
s_nop 0
global_load_lds_dwordx4 v5, s[50:51] sc1
s_add_u32 m0, s46, 37888
s_nop 0
global_load_lds_dword v4, s[50:51] offset:2048 sc1
s_waitcnt lgkmcnt(0)
s_waitcnt vmcnt(4)
s_barrier
ds_read_b128 v[40:43], v0 offset:32768
ds_read_b128 v[44:47], v0 offset:33792
ds_read_b128 v[48:51], v0 offset:34816
ds_read_b128 v[52:55], v0 offset:35840
ds_read_b128 v[56:59], v0 offset:36864
s_add_u32 m0, s45, 43008
s_nop 0
global_load_lds_dwordx4 v5, s[52:53] sc1
s_add_u32 m0, s46, 43008
s_nop 0
global_load_lds_dword v4, s[52:53] offset:2048 sc1
L_Lgo_redf:
s_waitcnt lgkmcnt(4)
v_smfmac_f32_16x16x64_bf16 v[20:23], v[40:43], a[160:167], v3
s_waitcnt lgkmcnt(3)
v_smfmac_f32_16x16x64_bf16 v[20:23], v[44:47], a[176:183], v3
s_waitcnt lgkmcnt(2)
v_smfmac_f32_16x16x64_bf16 v[20:23], v[48:51], a[208:215], v3
s_waitcnt lgkmcnt(1)
v_smfmac_f32_16x16x64_bf16 v[20:23], v[52:55], a[240:247], v3
s_waitcnt lgkmcnt(0)
v_smfmac_f32_16x16x64_bf16 v[20:23], v[56:59], v[224:231], v3
v_smfmac_f32_16x16x64_bf16 v[28:31], v[40:43], v[60:67], v3
v_smfmac_f32_16x16x64_bf16 v[32:35], v[40:43], v[68:75], v3
s_nop 0
v_cmp_u_f32 vcc, v20, v21
v_cmp_u_f32 s[24:25], v22, v23
v_smfmac_f32_16x16x64_bf16 v[24:27], v[40:43], a[168:175], v3
v_smfmac_f32_16x16x64_bf16 v[24:27], v[44:47], a[184:191], v3
s_or_b64 vcc, vcc, s[24:25]
s_cbranch_scc1 L_Lf_redf
L_Lok_redf:
s_mov_b32 m0, s39
v_smfmac_f32_16x16x64_bf16 v[36:39], v[40:43], v[80:87], v3
ds_read_b128 v[80:83], v2 offset:32768
v_smfmac_f32_16x16x64_bf16 v[36:39], v[44:47], v[88:95], v3
ds_read_b128 v[84:87], v2 offset:33792
global_load_lds_dwordx4 v0, s[16:17] offset:0 sc1
v_smfmac_f32_16x16x64_bf16 v[36:39], v[48:51], v[96:103], v3
ds_read_b128 v[88:91], v1 offset:18432
v_smfmac_f32_16x16x64_bf16 v[36:39], v[52:55], v[104:111], v3
ds_read_b128 v[92:95], v1 offset:19456
s_mov_b64 exec, s[36:37]
global_store_dwordx4 v13, v[76:79], s[96:97] sc1
s_mov_b64 exec, -1
v_smfmac_f32_16x16x64_bf16 v[28:31], v[44:47], a[192:199], v3
ds_read_b128 v[96:99], v2 offset:2048
v_smfmac_f32_16x16x64_bf16 v[32:35], v[44:47], a[200:207], v3
ds_read_b128 v[100:103], v2 offset:3072
global_load_lds_dwordx4 v0, s[16:17] offset:1024 sc1
v_smfmac_f32_16x16x64_bf16 v[24:27], v[48:51], a[216:223], v3
ds_read_b128 v[104:107], v2 offset:18432
s_waitcnt lgkmcnt(5)
v_smfmac_f32_16x16x64_bf16 v[36:39], v[56:59], v[80:87], v3
ds_read_b128 v[108:111], v2 offset:19456
v_smfmac_f32_16x16x64_bf16 v[28:31], v[48:51], a[224:231], v3
ds_read_b128 v[40:43], v2 offset:34816
v_smfmac_f32_16x16x64_bf16 v[32:35], v[48:51], a[232:239], v3
ds_read_b128 v[44:47], v2 offset:35840
v_smfmac_f32_16x16x64_bf16 v[24:27], v[52:55], a[248:255], v3
ds_read_b128 v[80:83], v1 offset:2048
s_add_u32 s96, s20, s1
s_addc_u32 s97, s21, 0
v_smfmac_f32_16x16x64_bf16 v[24:27], v[56:59], v[232:239], v3
ds_read_b128 v[84:87], v1 offset:3072
v_smfmac_f32_16x16x64_bf16 v[28:31], v[52:55], v[208:215], v3
s_waitcnt vmcnt(5)
s_barrier
ds_read_b128 v[60:63], v0 offset:37888
ds_read_b128 v[64:67], v0 offset:38912
ds_read_b128 v[68:71], v0 offset:39936
ds_read_b128 v[72:75], v0 offset:40960
ds_read_b128 v[76:79], v0 offset:41984
v_add_f32 v14, v36, v38
v_add_f32 v15, v37, v39
s_waitcnt lgkmcnt(4)
v_smfmac_f32_16x16x64_bf16 v[36:39], v[60:63], v[80:87], v3
s_waitcnt lgkmcnt(3)
v_smfmac_f32_16x16x64_bf16 v[36:39], v[64:67], v[88:95], v3
s_waitcnt lgkmcnt(2)
v_smfmac_f32_16x16x64_bf16 v[36:39], v[68:71], v[96:103], v3
s_waitcnt lgkmcnt(1)
v_smfmac_f32_16x16x64_bf16 v[36:39], v[72:75], v[104:111], v3
s_waitcnt lgkmcnt(0)
v_smfmac_f32_16x16x64_bf16 v[36:39], v[76:79], v[40:47], v3
v_smfmac_f32_16x16x64_bf16 v[32:35], v[52:55], v[216:223], v3
v_smfmac_f32_16x16x64_bf16 v[28:31], v[56:59], v[240:247], v3
s_nop 0
v_add_f32 v36, v36, v38
v_add_f32 v37, v37, v39
v_cmp_u_f32 vcc, v36, v37
v_cvt_pk_bf16_f32 v36, v36, v37
v_min_u32 v124, -2, v36
v_smfmac_f32_16x16x64_bf16 v[32:35], v[56:59], v[248:255], v3
s_cbranch_vccnz L_Rf_redf
L_Rok_redf:
global_store_dword v18, v124, s[20:21] sc1
v_smfmac_f32_16x16x64_bf16 v[20:23], v[60:63], a[0:7], v3
s_mov_b32 m0, s39
ds_read_b128 v[80:83], v7 offset:0
v_smfmac_f32_16x16x64_bf16 v[20:23], v[64:67], a[32:39], v3
ds_read_b128 v[84:87], v7 offset:4096
v_smfmac_f32_16x16x64_bf16 v[20:23], v[68:71], a[64:71], v3
global_load_lds_dwordx4 v0, s[16:17] offset:2048 sc1
ds_read_b128 v[88:91], v7 offset:1024
v_smfmac_f32_16x16x64_bf16 v[20:23], v[72:75], a[96:103], v3
v_add_u32 v15, s0, v19
ds_read_b128 v[92:95], v7 offset:5120
v_smfmac_f32_16x16x64_bf16 v[20:23], v[76:79], a[128:135], v3
ds_read_b128 v[96:99], v7 offset:2048
v_smfmac_f32_16x16x64_bf16 v[24:27], v[60:63], a[8:15], v3
global_load_lds_dwordx4 v0, s[16:17] offset:3072 sc1
ds_read_b128 v[100:103], v7 offset:6144
v_smfmac_f32_16x16x64_bf16 v[24:27], v[64:67], a[40:47], v3
v_smfmac_f32_16x16x64_bf16 v[24:27], v[68:71], a[72:79], v3
v_add_f32 v20, v20, v22
v_add_f32 v21, v21, v23
v_cvt_pk_bf16_f32 v20, v20, v21
v_smfmac_f32_16x16x64_bf16 v[24:27], v[72:75], a[104:111], v3
buffer_store_dwordx4 v[120:123], v5, s[8:11], s2 offen
s_add_u32 s2, s2, 135168
ds_write_b16 v6, v20 offset:32
v_smfmac_f32_16x16x64_bf16 v[24:27], v[76:79], a[136:143], v3
ds_write_b16_d16_hi v6, v20 offset:48
v_smfmac_f32_16x16x64_bf16 v[28:31], v[60:63], a[16:23], v3
ds_read_b128 v[104:107], v7 offset:3072
v_smfmac_f32_16x16x64_bf16 v[28:31], v[64:67], a[48:55], v3
ds_read_b128 v[108:111], v7 offset:7168
v_smfmac_f32_16x16x64_bf16 v[28:31], v[68:71], a[80:87], v3
s_cmp_lt_u32 s13, 8
s_cbranch_scc1 L_rs2_redf
L_rs2d_redf:
v_add_f32 v24, v24, v26
v_add_f32 v25, v25, v27
v_cvt_pk_bf16_f32 v24, v24, v25
ds_write_b16 v6, v24 offset:40
v_smfmac_f32_16x16x64_bf16 v[28:31], v[72:75], a[112:119], v3
ds_write_b16_d16_hi v6, v24 offset:56
v_smfmac_f32_16x16x64_bf16 v[28:31], v[76:79], a[144:151], v3
v_smfmac_f32_16x16x64_bf16 v[32:35], v[60:63], a[24:31], v3
v_smfmac_f32_16x16x64_bf16 v[32:35], v[64:67], a[56:63], v3
v_smfmac_f32_16x16x64_bf16 v[32:35], v[68:71], a[88:95], v3
s_waitcnt lgkmcnt(0)
s_barrier
ds_read_b128 v[40:43], v19 offset:0
ds_read_b128 v[44:47], v19 offset:1088
ds_read_b128 v[48:51], v19 offset:2176
ds_read_b128 v[52:55], v19 offset:3264
ds_read_b128 v[56:59], v15
v_add_f32 v28, v28, v30
v_add_f32 v29, v29, v31
v_cvt_pk_bf16_f32 v116, v28, v29
v_smfmac_f32_16x16x64_bf16 v[32:35], v[72:75], a[120:127], v3
v_smfmac_f32_16x16x64_bf16 v[32:35], v[76:79], a[152:159], v3
v_mfma_f32_16x16x32_bf16 v[60:63], v[116:119], v[126:129], 0
v_mov_b32 v37, 0
v_mov_b64 v[38:39], 0
s_waitcnt lgkmcnt(4)
v_mfma_f32_16x16x32_bf16 v[20:23], v[80:83], v[40:43], 0
s_nop 0
v_add_f32 v32, v32, v34
v_add_f32 v33, v33, v35
v_cvt_pk_bf16_f32 v116, v32, v33
v_cvt_pk_bf16_f32 v68, v60, v61
v_cvt_pk_bf16_f32 v69, v62, v63
v_mfma_f32_16x16x32_bf16 v[64:67], v[116:119], v[126:129], 0
global_load_dword v36, v18, s[96:97] offset:-1024 sc1
v_mfma_f32_16x16x32_bf16 v[24:27], v[84:87], v[40:43], 0
v_mov_b64 v[72:73], 0
v_mov_b64 v[74:75], 0
s_waitcnt lgkmcnt(0)
v_mfma_f32_16x16x32_bf16 v[20:23], v[88:91], v[44:47], v[20:23]
s_nop 0
v_cvt_pk_bf16_f32 v70, v64, v65
v_cvt_pk_bf16_f32 v71, v66, v67
s_cmp_eq_u32 s15, 63
s_cbranch_scc1 L_end
v_mfma_f32_16x16x32_bf16 v[76:79], v[68:71], v[56:59], 0
v_mfma_f32_16x16x32_bf16 v[24:27], v[92:95], v[44:47], v[24:27]
v_mov_b64 v[28:29], 0
v_mov_b64 v[30:31], 0
v_mfma_f32_16x16x32_bf16 v[20:23], v[96:99], v[48:51], v[20:23]
s_nop 0
ds_write_b64 v17, v[76:77] offset:62464
v_mfma_f32_16x16x32_bf16 v[24:27], v[100:103], v[48:51], v[24:27]
ds_read_b128 v[88:91], v8
ds_read_b128 v[92:95], v16
v_mov_b64 v[80:81], 0
v_mov_b64 v[82:83], 0
v_mfma_f32_16x16x32_bf16 v[20:23], v[104:107], v[52:55], v[20:23]
v_mov_b64 v[84:85], 0
v_mov_b64 v[86:87], 0
v_mfma_f32_16x16x32_bf16 v[24:27], v[108:111], v[52:55], v[24:27]
s_waitcnt lgkmcnt(2)
s_barrier
ds_read_b128 v[60:63], v0 offset:62464
ds_read_b128 v[64:67], v0 offset:63488
s_nop 0
v_max3_f32 v14, v20, v21, v22
s_nop 1
v_max3_f32 v15, v23, v24, v25
v_max3_f32 v14, v14, v26, v27
v_max_f32 v14, v14, v15
v_xor_b32 v16, 1024, v9
s_waitcnt lgkmcnt(1)
v_pk_add_f32 v[60:61], v[60:61], v[62:63]
s_waitcnt lgkmcnt(0)
v_pk_add_f32 v[64:65], v[64:65], v[66:67]
v_pk_add_f32 v[76:77], v[60:61], v[64:65]
v_max3_f32 v15, v14, v76, v77
v_max3_f32 v14, v14, v76, v77
v_mov_b64 v[52:53], 0
v_mov_b64 v[54:55], 0
v_permlane32_swap_b32 v14, v15
v_max_f32 v14, v14, v15
v_max_f32 v15, v14, v15
s_nop 1
v_permlane16_swap_b32 v14, v15
v_max_f32 v14, v14, v15
v_mul_f32 v14, s48, v14
v_pk_fma_f32 v[20:21], v[20:21], s[32:33], v[14:15] op_sel_hi:[1,0,0]
v_pk_fma_f32 v[22:23], v[22:23], s[32:33], v[14:15] op_sel_hi:[1,0,0]
v_pk_fma_f32 v[24:25], v[24:25], s[32:33], v[14:15] op_sel_hi:[1,0,0]
v_pk_fma_f32 v[26:27], v[26:27], s[32:33], v[14:15] op_sel_hi:[1,0,0]
v_pk_fma_f32 v[76:77], v[76:77], s[32:33], v[14:15] op_sel_hi:[1,0,0]
v_exp_f32 v20, v20
v_exp_f32 v21, v21
v_exp_f32 v22, v22
v_exp_f32 v23, v23
v_exp_f32 v24, v24
v_exp_f32 v25, v25
v_exp_f32 v26, v26
v_exp_f32 v27, v27
v_cvt_pk_bf16_f32 v96, v20, v21
v_cvt_pk_bf16_f32 v97, v22, v23
v_cvt_pk_bf16_f32 v98, v24, v25
v_cvt_pk_bf16_f32 v99, v26, v27
v_exp_f32 v76, v76
s_waitcnt lgkmcnt(0)
v_mfma_f32_16x16x32_bf16 v[32:35], v[112:115], v[96:99], 0
v_exp_f32 v77, v77
v_mfma_f32_16x16x32_bf16 v[40:43], v[88:91], v[96:99], 0
v_cvt_pk_bf16_f32 v116, v76, v77
s_mov_b32 vcc_lo, 0xcccccccc
s_mov_b32 vcc_hi, 0xcccccccc
v_mfma_f32_16x16x32_bf16 v[32:35], v[112:115], v[116:119], v[32:35]
v_and_b32 v15, 255, v0
v_mfma_f32_16x16x32_bf16 v[40:43], v[124:127], v[116:119], v[40:43]
v_mfma_f32_16x16x32_bf16 v[44:47], v[92:95], v[96:99], 0
s_waitcnt vmcnt(0)
v_cmp_eq_u32 s[24:25], -1, v36
v_rcp_f32 v14, v32
L_Vok_redf:
v_mfma_f32_16x16x32_bf16 v[44:47], v[36:39], v[116:119], v[44:47]
s_nop 0
v_mul_f32 v50, v42, v14
v_mul_f32 v51, v43, v14
v_mul_f32 v48, v40, v14
v_mul_f32 v49, v41, v14
v_cvt_pk_bf16_f32 v50, v50, v51
v_cvt_pk_bf16_f32 v48, v48, v49
s_cmp_lg_u64 s[24:25], 0
s_cbranch_scc1 L_Vf_redf
v_cndmask_b32_dpp v48, v50, v48, vcc quad_perm:[2,3,2,3] row_mask:0xf bank_mask:0xf
v_pk_mul_f32 v[46:47], v[46:47], v[14:15] op_sel_hi:[1,0]
v_pk_mul_f32 v[44:45], v[44:45], v[14:15] op_sel_hi:[1,0]
v_cvt_pk_bf16_f32 v46, v46, v47
v_cvt_pk_bf16_f32 v44, v44, v45
ds_write_b32 v9, v48
s_nop 0
v_cndmask_b32_dpp v44, v46, v44, vcc quad_perm:[2,3,2,3] row_mask:0xf bank_mask:0xf
ds_write_b32 v16, v44
s_waitcnt lgkmcnt(0)
s_barrier
ds_read_b128 v[60:63], v0 offset:53248
ds_read_b128 v[64:67], v0 offset:54272
ds_read_b128 v[20:23], v15 offset:57344
s_add_u32 s22, s27, 0
s_add_u32 s23, s27, 8448
s_add_u32 s24, s27, 16896
s_add_u32 s25, s27, 25344
s_add_u32 s26, s27, 33792
s_waitcnt lgkmcnt(2)
v_smfmac_f32_16x16x64_bf16 v[72:75], v[60:63], v[128:135], v3
s_waitcnt lgkmcnt(1)
v_smfmac_f32_16x16x64_bf16 v[72:75], v[64:67], v[136:143], v3
v_smfmac_f32_16x16x64_bf16 v[28:31], v[60:63], v[144:151], v3
v_smfmac_f32_16x16x64_bf16 v[28:31], v[64:67], v[152:159], v3
v_smfmac_f32_16x16x64_bf16 v[80:83], v[60:63], v[160:167], v3
v_add_f32 v72, v72, v74
v_add_f32 v73, v73, v75
v_cvt_pk_bf16_f32 v72, v72, v73
v_smfmac_f32_16x16x64_bf16 v[80:83], v[64:67], v[168:175], v3
buffer_store_dword v72, v10, s[8:11], s22 offen
v_smfmac_f32_16x16x64_bf16 v[84:87], v[60:63], v[176:183], v3
v_add_f32 v28, v28, v30
v_add_f32 v29, v29, v31
v_cvt_pk_bf16_f32 v28, v28, v29
v_smfmac_f32_16x16x64_bf16 v[84:87], v[64:67], v[184:191], v3
buffer_store_dword v28, v10, s[8:11], s23 offen
v_smfmac_f32_16x16x64_bf16 v[52:55], v[60:63], v[192:199], v3
v_add_f32 v80, v80, v82
v_add_f32 v81, v81, v83
v_cvt_pk_bf16_f32 v80, v80, v81
v_smfmac_f32_16x16x64_bf16 v[52:55], v[64:67], v[200:207], v3
buffer_store_dword v80, v10, s[8:11], s24 offen
v_add_f32 v84, v84, v86
v_add_f32 v85, v85, v87
v_cvt_pk_bf16_f32 v84, v84, v85
buffer_store_dword v84, v10, s[8:11], s25 offen
s_nop 2
v_pk_add_f32 v[52:53], v[52:53], v[54:55]
v_cvt_pk_bf16_f32 v52, v52, v53
buffer_store_dword v52, v10, s[8:11], s26 offen
s_add_u32 s50, s98, s47
s_addc_u32 s51, s99, 0
s_add_u32 s52, s100, s47
s_addc_u32 s53, s101, 0
s_mov_b32 s29, 0x100000
s_nop 11
buffer_load_dwordx4 v[40:43], v11, s[8:11], s27 offen offset:0 sc1
buffer_load_dwordx4 v[44:47], v11, s[8:11], s27 offen offset:1024 sc1
buffer_load_dwordx4 v[48:51], v11, s[8:11], s27 offen offset:2048 sc1
buffer_load_dwordx4 v[52:55], v11, s[8:11], s27 offen offset:3072 sc1
v_min_u32 v76, -2, v68
v_min_u32 v77, -2, v69
v_min_u32 v78, -2, v70
v_min_u32 v79, -2, v71
s_add_u32 s18, s18, 10240
s_addc_u32 s19, s19, 0
v_xor_b32 v7, 16384, v7
v_xor_b32 v8, 16384, v8
s_add_u32 s16, s16, s40
s_addc_u32 s17, s17, 0
s_xor_b32 s39, s39, 16384
s_sub_u32 s3, 0x200000, s40
s_mov_b32 s40, s41
s_mov_b32 s41, s3
s_add_u32 s34, s34, 262144
s_addc_u32 s35, s35, 0
s_add_u32 s98, s98, 32768
s_addc_u32 s99, s99, 0
s_add_u32 s100, s100, 32768
s_addc_u32 s101, s101, 0
s_add_u32 s15, s15, 1
buffer_load_dwordx4 v[40:43], v11, s[8:11], s27 offen offset:0 sc1
buffer_load_dwordx4 v[44:47], v11, s[8:11], s27 offen offset:1024 sc1
buffer_load_dwordx4 v[48:51], v11, s[8:11], s27 offen offset:2048 sc1
buffer_load_dwordx4 v[52:55], v11, s[8:11], s27 offen offset:3072 sc1
s_nop 15
s_nop 1
buffer_load_dwordx4 v[40:43], v11, s[8:11], s27 offen offset:0 sc1
buffer_load_dwordx4 v[44:47], v11, s[8:11], s27 offen offset:1024 sc1
buffer_load_dwordx4 v[48:51], v11, s[8:11], s27 offen offset:2048 sc1
buffer_load_dwordx4 v[52:55], v11, s[8:11], s27 offen offset:3072 sc1
s_waitcnt vmcnt(8) lgkmcnt(0)
L_red_pf:
v_mfma_f32_16x16x32_bf16 v[56:59], v[20:23], v[40:43], 0
buffer_load_dwordx4 v[40:43], v11, s[8:11], s27 offen offset:0 sc1
v_mfma_f32_16x16x32_bf16 v[56:59], v[20:23], v[44:47], v[56:59]
buffer_load_dwordx4 v[44:47], v11, s[8:11], s27 offen offset:1024 sc1
v_mfma_f32_16x16x32_bf16 v[56:59], v[20:23], v[48:51], v[56:59]
buffer_load_dwordx4 v[48:51], v11, s[8:11], s27 offen offset:2048 sc1
v_mfma_f32_16x16x32_bf16 v[56:59], v[20:23], v[52:55], v[56:59]
buffer_load_dwordx4 v[52:55], v11, s[8:11], s27 offen offset:3072 sc1
s_sub_u32 s29, s29, 1
s_and_b32 s3, s29, 63
s_cbranch_scc0 L_red_xf
s_waitcnt vmcnt(36)
s_nop 2
v_cmp_u_f32 vcc, v56, v57
v_add_f32_dpp v14, v56, v56 row_ror:8 row_mask:0xf bank_mask:0xf
v_add_f32_dpp v15, v57, v57 row_ror:8 row_mask:0xf bank_mask:0xf
v_cvt_pk_bf16_f32 v14, v14, v15
v_min_u32 v14, -2, v14
s_cbranch_vccnz L_red_pf
L_red_gof:
s_mov_b64 exec, s[30:31]
global_store_dword v12, v14, s[18:19]
s_barrier
global_store_dword v12, v14, s[50:51] sc1
global_store_dword v12, v14, s[52:53] sc1
s_mov_b64 exec, -1
L_gatef:
s_nop 3
ds_read_b128 v[80:83], v1 offset:0
ds_read_b128 v[84:87], v1 offset:1024
ds_read_b128 v[88:91], v1 offset:16384
ds_read_b128 v[92:95], v1 offset:17408
ds_read_b128 v[96:99], v2 offset:0
ds_read_b128 v[100:103], v2 offset:1024
ds_read_b128 v[104:107], v2 offset:16384
ds_read_b128 v[108:111], v2 offset:17408
v_mov_b64 v[20:21], 0
v_mov_b64 v[22:23], 0
v_mov_b64 v[24:25], 0
v_mov_b64 v[26:27], 0
v_mov_b64 v[28:29], 0
v_mov_b64 v[30:31], 0
v_mov_b64 v[32:33], 0
v_mov_b64 v[34:35], 0
v_mov_b64 v[36:37], 0
v_mov_b64 v[38:39], 0
s_branch L_loop_redf
L_kvpl_redf:
v_mov_b32 v15, 57600
ds_read_b128 v[20:23], v15
ds_read_b128 v[24:27], v15 offset:16
s_waitcnt lgkmcnt(0)
v_min_u32 v20, v20, v24
v_lshrrev_b32 v24, 4, v20
v_lshl_add_u32 v20, v24, 5, v20
v_lshl_add_u32 v20, v20, 1, 0
v_min_u32 v21, v21, v25
v_lshrrev_b32 v25, 4, v21
v_lshl_add_u32 v21, v25, 5, v21
v_lshl_add_u32 v21, v21, 1, 1
v_min_u32 v22, v22, v26
v_lshl_add_u32 v22, v22, 1, 32
v_min_u32 v23, v23, v27
v_lshl_add_u32 v23, v23, 1, 33
v_min3_u32 v20, v20, v21, v22
v_min_u32 v20, v20, v23
s_nop 0
v_readfirstlane_b32 s42, v20
v_mov_b64 v[20:21], 0
v_mov_b64 v[22:23], 0
v_mov_b64 v[24:25], 0
v_mov_b64 v[26:27], 0
s_cmp_gt_u32 s42, s3
s_cbranch_scc1 L_kvokl_redf
s_lshr_b32 s26, s13, 1
s_lshl_b32 s26, s26, 7
s_add_u32 s26, s26, 68158464
v_mov_b32 v14, s26
s_mov_b32 s29, 0x40000
L_kvw_2:
global_load_dwordx4 v[20:23], v14, s[4:5] sc1
global_load_dwordx4 v[24:27], v14, s[4:5] offset:16 sc1
s_waitcnt vmcnt(0)
v_min_u32 v20, v20, v24
v_lshrrev_b32 v24, 4, v20
v_lshl_add_u32 v20, v24, 5, v20
v_lshl_add_u32 v20, v20, 1, 0
v_min_u32 v21, v21, v25
v_lshrrev_b32 v25, 4, v21
v_lshl_add_u32 v21, v25, 5, v21
v_lshl_add_u32 v21, v21, 1, 1
v_min_u32 v22, v22, v26
v_lshl_add_u32 v22, v22, 1, 32
v_min_u32 v23, v23, v27
v_lshl_add_u32 v23, v23, 1, 33
v_min3_u32 v20, v20, v21, v22
v_min_u32 v20, v20, v23
s_nop 0
v_readfirstlane_b32 s42, v20
v_mov_b64 v[20:21], 0
v_mov_b64 v[22:23], 0
v_mov_b64 v[24:25], 0
v_mov_b64 v[26:27], 0
s_cmp_gt_u32 s42, s3
s_cbranch_scc1 L_kvokl_redf
s_sleep 2
s_sub_u32 s29, s29, 1
s_cbranch_scc0 L_kvw_2
s_branch L_abort
L_red_xf:
s_cmp_lt_i32 s29, 0
s_cbranch_scc1 L_abort
s_waitcnt vmcnt(0)
s_mov_b64 s[24:25], 0
v_cmp_eq_u32 vcc, s38, v40
s_nop 0
s_or_b64 s[24:25], s[24:25], vcc
v_cmp_eq_u32 vcc, s38, v41
s_nop 0
s_or_b64 s[24:25], s[24:25], vcc
v_cmp_eq_u32 vcc, s38, v42
s_nop 0
s_or_b64 s[24:25], s[24:25], vcc
v_cmp_eq_u32 vcc, s38, v43
s_nop 0
s_or_b64 s[24:25], s[24:25], vcc
v_cmp_eq_u32 vcc, s38, v44
s_nop 0
s_or_b64 s[24:25], s[24:25], vcc
v_cmp_eq_u32 vcc, s38, v45
s_nop 0
s_or_b64 s[24:25], s[24:25], vcc
v_cmp_eq_u32 vcc, s38, v46
s_nop 0
s_or_b64 s[24:25], s[24:25], vcc
v_cmp_eq_u32 vcc, s38, v47
s_nop 0
s_or_b64 s[24:25], s[24:25], vcc
v_cmp_eq_u32 vcc, s38, v48
s_nop 0
s_or_b64 s[24:25], s[24:25], vcc
v_cmp_eq_u32 vcc, s38, v49
s_nop 0
s_or_b64 s[24:25], s[24:25], vcc
v_cmp_eq_u32 vcc, s38, v50
s_nop 0
s_or_b64 s[24:25], s[24:25], vcc
v_cmp_eq_u32 vcc, s38, v51
s_nop 0
s_or_b64 s[24:25], s[24:25], vcc
v_cmp_eq_u32 vcc, s38, v52
s_nop 0
s_or_b64 s[24:25], s[24:25], vcc
v_cmp_eq_u32 vcc, s38, v53
s_nop 0
s_or_b64 s[24:25], s[24:25], vcc
v_cmp_eq_u32 vcc, s38, v54
s_nop 0
s_or_b64 s[24:25], s[24:25], vcc
v_cmp_eq_u32 vcc, s38, v55
s_nop 0
s_or_b64 s[24:25], s[24:25], vcc
s_mov_b64 vcc, -1
s_cbranch_scc1 L_red_pf
v_mfma_f32_16x16x32_bf16 v[56:59], v[20:23], v[40:43], 0
v_mfma_f32_16x16x32_bf16 v[56:59], v[20:23], v[44:47], v[56:59]
v_mfma_f32_16x16x32_bf16 v[56:59], v[20:23], v[48:51], v[56:59]
v_mfma_f32_16x16x32_bf16 v[56:59], v[20:23], v[52:55], v[56:59]
s_nop 7
v_add_f32_dpp v14, v56, v56 row_ror:8 row_mask:0xf bank_mask:0xf
v_add_f32_dpp v15, v57, v57 row_ror:8 row_mask:0xf bank_mask:0xf
v_cvt_pk_bf16_f32 v14, v14, v15
v_min_u32 v14, -2, v14
s_branch L_red_gof
L_Lf_redf:
s_waitcnt lgkmcnt(0)
s_sub_u32 s29, s29, 1
s_cbranch_scc1 L_abort
s_and_b32 s3, s29, 1
s_cbranch_scc1 L_Lq_redf
v_max3_u32 v116, v40, v41, v42
v_max_u32 v116, v116, v43
v_max3_u32 v116, v116, v44, v45
v_max3_u32 v116, v116, v46, v47
v_max3_u32 v116, v116, v48, v49
v_max3_u32 v116, v116, v50, v51
v_max3_u32 v116, v116, v52, v53
v_max3_u32 v116, v116, v54, v55
v_max3_u32 v116, v116, v56, v57
v_max3_u32 v116, v116, v58, v59
v_cmp_eq_u32 vcc, -1, v116
s_nop 0
s_cbranch_vccz L_Lok_redf
s_add_u32 m0, s45, 32768
s_nop 0
global_load_lds_dwordx4 v5, s[18:19] sc1
s_add_u32 m0, s46, 32768
s_nop 0
global_load_lds_dword v4, s[18:19] offset:2048 sc1
s_waitcnt vmcnt(0)
L_Lq_redf:
ds_read_b128 v[40:43], v0 offset:32768
ds_read_b128 v[44:47], v0 offset:33792
ds_read_b128 v[48:51], v0 offset:34816
ds_read_b128 v[52:55], v0 offset:35840
ds_read_b128 v[56:59], v0 offset:36864
s_nop 7
v_mov_b64 v[20:21], 0
v_mov_b64 v[22:23], 0
v_mov_b64 v[24:25], 0
v_mov_b64 v[26:27], 0
v_mov_b64 v[28:29], 0
v_mov_b64 v[30:31], 0
v_mov_b64 v[32:33], 0
v_mov_b64 v[34:35], 0
s_branch L_Lgo_redf
s_waitcnt lgkmcnt(0)
L_Rf_redf:
v_max3_u32 v116, v60, v61, v62
v_max_u32 v116, v116, v63
v_max3_u32 v116, v116, v64, v65
v_max3_u32 v116, v116, v66, v67
v_max3_u32 v116, v116, v68, v69
v_max3_u32 v116, v116, v70, v71
v_max3_u32 v116, v116, v72, v73
v_max3_u32 v116, v116, v74, v75
v_max3_u32 v116, v116, v76, v77
v_max3_u32 v116, v116, v78, v79
v_cmp_eq_u32 vcc, -1, v116
s_waitcnt vmcnt(3)
s_cbranch_vccz L_Rok_redf
L_Rp_redf:
s_barrier
ds_read_b128 v[60:63], v0 offset:43008
ds_read_b128 v[64:67], v0 offset:44032
ds_read_b128 v[68:71], v0 offset:45056
ds_read_b128 v[72:75], v0 offset:46080
ds_read_b128 v[76:79], v0 offset:47104
v_mov_b64 v[36:37], v[14:15]
v_mov_b64 v[38:39], 0
s_waitcnt lgkmcnt(4)
s_nop 0
v_smfmac_f32_16x16x64_bf16 v[36:39], v[60:63], v[80:87], v3
s_waitcnt lgkmcnt(3)
v_smfmac_f32_16x16x64_bf16 v[36:39], v[64:67], v[88:95], v3
s_waitcnt lgkmcnt(2)
v_smfmac_f32_16x16x64_bf16 v[36:39], v[68:71], v[96:103], v3
s_waitcnt lgkmcnt(1)
v_smfmac_f32_16x16x64_bf16 v[36:39], v[72:75], v[104:111], v3
s_waitcnt lgkmcnt(0)
v_smfmac_f32_16x16x64_bf16 v[36:39], v[76:79], v[40:47], v3
s_nop 7
v_add_f32 v36, v36, v38
v_add_f32 v37, v37, v39
v_cmp_u_f32 vcc, v36, v37
v_cvt_pk_bf16_f32 v36, v36, v37
v_min_u32 v124, -2, v36
s_cbranch_vccz L_Rok_redf
v_max3_u32 v116, v60, v61, v62
v_max_u32 v116, v116, v63
v_max3_u32 v116, v116, v64, v65
v_max3_u32 v116, v116, v66, v67
v_max3_u32 v116, v116, v68, v69
v_max3_u32 v116, v116, v70, v71
v_max3_u32 v116, v116, v72, v73
v_max3_u32 v116, v116, v74, v75
v_max3_u32 v116, v116, v76, v77
v_max3_u32 v116, v116, v78, v79
v_cmp_eq_u32 vcc, -1, v116
s_nop 0
s_cbranch_vccz L_Rok_redf
s_sub_u32 s29, s29, 1
s_cbranch_scc1 L_abort
s_barrier
s_add_u32 m0, s45, 43008
s_nop 0
global_load_lds_dwordx4 v5, s[52:53] sc1
s_add_u32 m0, s46, 43008
s_nop 0
global_load_lds_dword v4, s[52:53] offset:2048 sc1
s_waitcnt vmcnt(0)
s_branch L_Rp_redf
L_rs2_redf:
buffer_store_dwordx4 v[120:123], v5, s[8:11], s2 offen
s_branch L_rs2d_redf
L_Vf_redf:
global_load_dword v36, v18, s[96:97] offset:-1024 sc1
s_sub_u32 s29, s29, 1
s_cbranch_scc1 L_abort
s_waitcnt vmcnt(0)
v_cmp_eq_u32 s[24:25], -1, v36
v_mfma_f32_16x16x32_bf16 v[44:47], v[92:95], v[96:99], 0
s_branch L_Vok_redf
s_waitcnt vmcnt(0) lgkmcnt(0)
L_enter_nrf:
s_mov_b32 s27, 675840
ds_read_b128 v[80:83], v1 offset:0
ds_read_b128 v[84:87], v1 offset:1024
ds_read_b128 v[88:91], v1 offset:16384
ds_read_b128 v[92:95], v1 offset:17408
ds_read_b128 v[96:99], v2 offset:0
ds_read_b128 v[100:103], v2 offset:1024
ds_read_b128 v[104:107], v2 offset:16384
ds_read_b128 v[108:111], v2 offset:17408
v_mov_b64 v[20:21], 0
v_mov_b64 v[22:23], 0
v_mov_b64 v[24:25], 0
v_mov_b64 v[26:27], 0
v_mov_b64 v[28:29], 0
v_mov_b64 v[30:31], 0
v_mov_b64 v[32:33], 0
v_mov_b64 v[34:35], 0
v_mov_b64 v[36:37], 0
v_mov_b64 v[38:39], 0
.p2align 6
L_loop_nrf:
s_add_u32 s2, s27, s49
s_add_u32 s27, s27, 337920
s_cmp_ge_u32 s27, 1013760
s_cselect_b32 s27, 0, s27
s_add_u32 s3, s15, 1
s_min_u32 s3, s3, 63
s_cmp_le_u32 s42, s3
s_cbranch_scc1 L_kvpl_nrf
s_nop 15
s_nop 3
L_kvokl_nrf:
s_add_u32 s50, s98, s44
s_addc_u32 s51, s99, 0
s_add_u32 s52, s100, s44
s_addc_u32 s53, s101, 0
s_mov_b32 s29, 0x40000
s_add_u32 m0, s45, 32768
s_nop 0
global_load_lds_dwordx4 v5, s[18:19] sc1
s_add_u32 m0, s46, 32768
s_nop 0
global_load_lds_dword v4, s[18:19] offset:2048 sc1
ds_read_b128 v[60:63], v2 offset:49152
ds_read_b128 v[64:67], v2 offset:50176
ds_read_b128 v[68:71], v2 offset:51200
ds_read_b128 v[72:75], v2 offset:52224
s_cmp_ge_u32 s15, 62
s_cselect_b32 s40, 0, s40
s_lshr_b32 s3, s15, 3
s_add_u32 s3, s3, 2
s_bitcmp1_b32 s43, s3
s_cselect_b32 s3, 8192, 0
s_mov_b64 s[96:97], s[20:21]
s_add_u32 s20, s34, s3
s_addc_u32 s21, s35, 0
v_xor_b32 v16, 4096, v8
s_nop 13
s_add_u32 m0, s45, 32768
s_nop 0
global_load_lds_dwordx4 v5, s[18:19] sc1
s_add_u32 m0, s46, 32768
s_nop 0
global_load_lds_dword v4, s[18:19] offset:2048 sc1
s_barrier
s_add_u32 m0, s45, 37888
s_nop 0
global_load_lds_dwordx4 v5, s[50:51] sc1
s_add_u32 m0, s46, 37888
s_nop 0
global_load_lds_dword v4, s[50:51] offset:2048 sc1
s_waitcnt lgkmcnt(0)
s_waitcnt vmcnt(4)
s_barrier
ds_read_b128 v[40:43], v0 offset:32768
ds_read_b128 v[44:47], v0 offset:33792
ds_read_b128 v[48:51], v0 offset:34816
ds_read_b128 v[52:55], v0 offset:35840
ds_read_b128 v[56:59], v0 offset:36864
s_add_u32 m0, s45, 43008
s_nop 0
global_load_lds_dwordx4 v5, s[52:53] sc1
s_add_u32 m0, s46, 43008
s_nop 0
global_load_lds_dword v4, s[52:53] offset:2048 sc1
L_Lgo_nrf:
s_waitcnt lgkmcnt(4)
v_smfmac_f32_16x16x64_bf16 v[20:23], v[40:43], a[160:167], v3
s_waitcnt lgkmcnt(3)
v_smfmac_f32_16x16x64_bf16 v[20:23], v[44:47], a[176:183], v3
s_waitcnt lgkmcnt(2)
v_smfmac_f32_16x16x64_bf16 v[20:23], v[48:51], a[208:215], v3
s_waitcnt lgkmcnt(1)
v_smfmac_f32_16x16x64_bf16 v[20:23], v[52:55], a[240:247], v3
s_waitcnt lgkmcnt(0)
v_smfmac_f32_16x16x64_bf16 v[20:23], v[56:59], v[224:231], v3
v_smfmac_f32_16x16x64_bf16 v[28:31], v[40:43], v[60:67], v3
v_smfmac_f32_16x16x64_bf16 v[32:35], v[40:43], v[68:75], v3
s_nop 0
v_cmp_u_f32 vcc, v20, v21
v_cmp_u_f32 s[24:25], v22, v23
v_smfmac_f32_16x16x64_bf16 v[24:27], v[40:43], a[168:175], v3
v_smfmac_f32_16x16x64_bf16 v[24:27], v[44:47], a[184:191], v3
s_or_b64 vcc, vcc, s[24:25]
s_cbranch_scc1 L_Lf_nrf
L_Lok_nrf:
s_mov_b32 m0, s39
v_smfmac_f32_16x16x64_bf16 v[36:39], v[40:43], v[80:87], v3
ds_read_b128 v[80:83], v2 offset:32768
v_smfmac_f32_16x16x64_bf16 v[36:39], v[44:47], v[88:95], v3
ds_read_b128 v[84:87], v2 offset:33792
global_load_lds_dwordx4 v0, s[16:17] offset:0 sc1
v_smfmac_f32_16x16x64_bf16 v[36:39], v[48:51], v[96:103], v3
ds_read_b128 v[88:91], v1 offset:18432
v_smfmac_f32_16x16x64_bf16 v[36:39], v[52:55], v[104:111], v3
ds_read_b128 v[92:95], v1 offset:19456
s_mov_b64 exec, s[36:37]
global_store_dwordx4 v13, v[76:79], s[96:97] sc1
s_mov_b64 exec, -1
v_smfmac_f32_16x16x64_bf16 v[28:31], v[44:47], a[192:199], v3
ds_read_b128 v[96:99], v2 offset:2048
v_smfmac_f32_16x16x64_bf16 v[32:35], v[44:47], a[200:207], v3
ds_read_b128 v[100:103], v2 offset:3072
global_load_lds_dwordx4 v0, s[16:17] offset:1024 sc1
v_smfmac_f32_16x16x64_bf16 v[24:27], v[48:51], a[216:223], v3
ds_read_b128 v[104:107], v2 offset:18432
s_waitcnt lgkmcnt(5)
v_smfmac_f32_16x16x64_bf16 v[36:39], v[56:59], v[80:87], v3
ds_read_b128 v[108:111], v2 offset:19456
v_smfmac_f32_16x16x64_bf16 v[28:31], v[48:51], a[224:231], v3
ds_read_b128 v[40:43], v2 offset:34816
v_smfmac_f32_16x16x64_bf16 v[32:35], v[48:51], a[232:239], v3
ds_read_b128 v[44:47], v2 offset:35840
v_smfmac_f32_16x16x64_bf16 v[24:27], v[52:55], a[248:255], v3
ds_read_b128 v[80:83], v1 offset:2048
s_add_u32 s96, s20, s1
s_addc_u32 s97, s21, 0
v_smfmac_f32_16x16x64_bf16 v[24:27], v[56:59], v[232:239], v3
ds_read_b128 v[84:87], v1 offset:3072
v_smfmac_f32_16x16x64_bf16 v[28:31], v[52:55], v[208:215], v3
s_waitcnt vmcnt(5)
s_barrier
ds_read_b128 v[60:63], v0 offset:37888
ds_read_b128 v[64:67], v0 offset:38912
ds_read_b128 v[68:71], v0 offset:39936
ds_read_b128 v[72:75], v0 offset:40960
ds_read_b128 v[76:79], v0 offset:41984
v_add_f32 v14, v36, v38
v_add_f32 v15, v37, v39
s_waitcnt lgkmcnt(4)
v_smfmac_f32_16x16x64_bf16 v[36:39], v[60:63], v[80:87], v3
s_waitcnt lgkmcnt(3)
v_smfmac_f32_16x16x64_bf16 v[36:39], v[64:67], v[88:95], v3
s_waitcnt lgkmcnt(2)
v_smfmac_f32_16x16x64_bf16 v[36:39], v[68:71], v[96:103], v3
s_waitcnt lgkmcnt(1)
v_smfmac_f32_16x16x64_bf16 v[36:39], v[72:75], v[104:111], v3
s_waitcnt lgkmcnt(0)
v_smfmac_f32_16x16x64_bf16 v[36:39], v[76:79], v[40:47], v3
v_smfmac_f32_16x16x64_bf16 v[32:35], v[52:55], v[216:223], v3
v_smfmac_f32_16x16x64_bf16 v[28:31], v[56:59], v[240:247], v3
s_nop 0
v_add_f32 v36, v36, v38
v_add_f32 v37, v37, v39
v_cmp_u_f32 vcc, v36, v37
v_cvt_pk_bf16_f32 v36, v36, v37
v_min_u32 v124, -2, v36
v_smfmac_f32_16x16x64_bf16 v[32:35], v[56:59], v[248:255], v3
s_cbranch_vccnz L_Rf_nrf
L_Rok_nrf:
global_store_dword v18, v124, s[20:21] sc1
v_smfmac_f32_16x16x64_bf16 v[20:23], v[60:63], a[0:7], v3
s_mov_b32 m0, s39
ds_read_b128 v[80:83], v7 offset:0
v_smfmac_f32_16x16x64_bf16 v[20:23], v[64:67], a[32:39], v3
ds_read_b128 v[84:87], v7 offset:4096
v_smfmac_f32_16x16x64_bf16 v[20:23], v[68:71], a[64:71], v3
global_load_lds_dwordx4 v0, s[16:17] offset:2048 sc1
ds_read_b128 v[88:91], v7 offset:1024
v_smfmac_f32_16x16x64_bf16 v[20:23], v[72:75], a[96:103], v3
v_add_u32 v15, s0, v19
ds_read_b128 v[92:95], v7 offset:5120
v_smfmac_f32_16x16x64_bf16 v[20:23], v[76:79], a[128:135], v3
ds_read_b128 v[96:99], v7 offset:2048
v_smfmac_f32_16x16x64_bf16 v[24:27], v[60:63], a[8:15], v3
global_load_lds_dwordx4 v0, s[16:17] offset:3072 sc1
ds_read_b128 v[100:103], v7 offset:6144
v_smfmac_f32_16x16x64_bf16 v[24:27], v[64:67], a[40:47], v3
v_smfmac_f32_16x16x64_bf16 v[24:27], v[68:71], a[72:79], v3
v_add_f32 v20, v20, v22
v_add_f32 v21, v21, v23
v_cvt_pk_bf16_f32 v20, v20, v21
v_smfmac_f32_16x16x64_bf16 v[24:27], v[72:75], a[104:111], v3
ds_write_b16 v6, v20 offset:32
v_smfmac_f32_16x16x64_bf16 v[24:27], v[76:79], a[136:143], v3
buffer_store_dwordx4 v[120:123], v5, s[8:11], s2 offen
s_add_u32 s2, s2, 135168
ds_write_b16_d16_hi v6, v20 offset:48
v_smfmac_f32_16x16x64_bf16 v[28:31], v[60:63], a[16:23], v3
ds_read_b128 v[104:107], v7 offset:3072
v_smfmac_f32_16x16x64_bf16 v[28:31], v[64:67], a[48:55], v3
ds_read_b128 v[108:111], v7 offset:7168
v_smfmac_f32_16x16x64_bf16 v[28:31], v[68:71], a[80:87], v3
v_add_f32 v24, v24, v26
v_add_f32 v25, v25, v27
v_cvt_pk_bf16_f32 v24, v24, v25
ds_write_b16 v6, v24 offset:40
v_smfmac_f32_16x16x64_bf16 v[28:31], v[72:75], a[112:119], v3
s_cmp_lt_u32 s13, 8
s_cbranch_scc1 L_rs2_nrf
L_rs2d_nrf:
ds_write_b16_d16_hi v6, v24 offset:56
v_smfmac_f32_16x16x64_bf16 v[28:31], v[76:79], a[144:151], v3
v_smfmac_f32_16x16x64_bf16 v[32:35], v[60:63], a[24:31], v3
v_smfmac_f32_16x16x64_bf16 v[32:35], v[64:67], a[56:63], v3
v_smfmac_f32_16x16x64_bf16 v[32:35], v[68:71], a[88:95], v3
s_waitcnt lgkmcnt(0)
s_barrier
ds_read_b128 v[40:43], v19 offset:0
ds_read_b128 v[44:47], v19 offset:1088
ds_read_b128 v[48:51], v19 offset:2176
ds_read_b128 v[52:55], v19 offset:3264
ds_read_b128 v[56:59], v15
v_add_f32 v28, v28, v30
v_add_f32 v29, v29, v31
v_cvt_pk_bf16_f32 v116, v28, v29
v_smfmac_f32_16x16x64_bf16 v[32:35], v[72:75], a[120:127], v3
v_smfmac_f32_16x16x64_bf16 v[32:35], v[76:79], a[152:159], v3
v_mfma_f32_16x16x32_bf16 v[60:63], v[116:119], v[126:129], 0
v_mov_b32 v37, 0
v_mov_b64 v[38:39], 0
s_waitcnt lgkmcnt(4)
v_mfma_f32_16x16x32_bf16 v[20:23], v[80:83], v[40:43], 0
s_nop 0
v_add_f32 v32, v32, v34
v_add_f32 v33, v33, v35
v_cvt_pk_bf16_f32 v116, v32, v33
v_cvt_pk_bf16_f32 v68, v60, v61
v_cvt_pk_bf16_f32 v69, v62, v63
v_mfma_f32_16x16x32_bf16 v[64:67], v[116:119], v[126:129], 0
global_load_dword v36, v18, s[96:97] offset:-1024 sc1
v_mfma_f32_16x16x32_bf16 v[24:27], v[84:87], v[40:43], 0
v_mov_b64 v[72:73], 0
v_mov_b64 v[74:75], 0
s_waitcnt lgkmcnt(0)
v_mfma_f32_16x16x32_bf16 v[20:23], v[88:91], v[44:47], v[20:23]
s_nop 0
v_cvt_pk_bf16_f32 v70, v64, v65
v_cvt_pk_bf16_f32 v71, v66, v67
s_cmp_eq_u32 s15, 63
s_cbranch_scc1 L_end
v_mfma_f32_16x16x32_bf16 v[76:79], v[68:71], v[56:59], 0
v_mfma_f32_16x16x32_bf16 v[24:27], v[92:95], v[44:47], v[24:27]
v_mov_b64 v[28:29], 0
v_mov_b64 v[30:31], 0
v_mfma_f32_16x16x32_bf16 v[20:23], v[96:99], v[48:51], v[20:23]
s_nop 0
ds_write_b64 v17, v[76:77] offset:62464
v_mfma_f32_16x16x32_bf16 v[24:27], v[100:103], v[48:51], v[24:27]
ds_read_b128 v[88:91], v8
ds_read_b128 v[92:95], v16
v_mov_b64 v[80:81], 0
v_mov_b64 v[82:83], 0
v_mfma_f32_16x16x32_bf16 v[20:23], v[104:107], v[52:55], v[20:23]
v_mov_b64 v[84:85], 0
v_mov_b64 v[86:87], 0
v_mfma_f32_16x16x32_bf16 v[24:27], v[108:111], v[52:55], v[24:27]
s_waitcnt lgkmcnt(2)
s_barrier
ds_read_b128 v[60:63], v0 offset:62464
ds_read_b128 v[64:67], v0 offset:63488
s_nop 0
v_max3_f32 v14, v20, v21, v22
s_nop 1
v_max3_f32 v15, v23, v24, v25
v_max3_f32 v14, v14, v26, v27
v_max_f32 v14, v14, v15
v_xor_b32 v16, 1024, v9
s_waitcnt lgkmcnt(1)
v_pk_add_f32 v[60:61], v[60:61], v[62:63]
s_waitcnt lgkmcnt(0)
v_pk_add_f32 v[64:65], v[64:65], v[66:67]
v_pk_add_f32 v[76:77], v[60:61], v[64:65]
v_max3_f32 v15, v14, v76, v77
v_max3_f32 v14, v14, v76, v77
v_mov_b64 v[52:53], 0
v_mov_b64 v[54:55], 0
v_permlane32_swap_b32 v14, v15
v_max_f32 v14, v14, v15
v_max_f32 v15, v14, v15
s_nop 1
v_permlane16_swap_b32 v14, v15
v_max_f32 v14, v14, v15
v_mul_f32 v14, s48, v14
v_pk_fma_f32 v[20:21], v[20:21], s[32:33], v[14:15] op_sel_hi:[1,0,0]
v_pk_fma_f32 v[22:23], v[22:23], s[32:33], v[14:15] op_sel_hi:[1,0,0]
v_pk_fma_f32 v[24:25], v[24:25], s[32:33], v[14:15] op_sel_hi:[1,0,0]
v_pk_fma_f32 v[26:27], v[26:27], s[32:33], v[14:15] op_sel_hi:[1,0,0]
v_pk_fma_f32 v[76:77], v[76:77], s[32:33], v[14:15] op_sel_hi:[1,0,0]
v_exp_f32 v20, v20
v_exp_f32 v21, v21
v_exp_f32 v22, v22
v_exp_f32 v23, v23
v_exp_f32 v24, v24
v_exp_f32 v25, v25
v_exp_f32 v26, v26
v_exp_f32 v27, v27
v_cvt_pk_bf16_f32 v96, v20, v21
v_cvt_pk_bf16_f32 v97, v22, v23
v_cvt_pk_bf16_f32 v98, v24, v25
v_cvt_pk_bf16_f32 v99, v26, v27
v_exp_f32 v76, v76
s_waitcnt lgkmcnt(0)
v_mfma_f32_16x16x32_bf16 v[32:35], v[112:115], v[96:99], 0
v_exp_f32 v77, v77
v_mfma_f32_16x16x32_bf16 v[40:43], v[88:91], v[96:99], 0
v_cvt_pk_bf16_f32 v116, v76, v77
s_mov_b32 vcc_lo, 0xcccccccc
s_mov_b32 vcc_hi, 0xcccccccc
v_mfma_f32_16x16x32_bf16 v[32:35], v[112:115], v[116:119], v[32:35]
v_mfma_f32_16x16x32_bf16 v[40:43], v[124:127], v[116:119], v[40:43]
v_mfma_f32_16x16x32_bf16 v[44:47], v[92:95], v[96:99], 0
s_waitcnt vmcnt(0)
v_cmp_eq_u32 s[24:25], -1, v36
v_rcp_f32 v14, v32
L_Vok_nrf:
v_mfma_f32_16x16x32_bf16 v[44:47], v[36:39], v[116:119], v[44:47]
s_nop 0
v_mul_f32 v50, v42, v14
v_mul_f32 v51, v43, v14
v_mul_f32 v48, v40, v14
v_mul_f32 v49, v41, v14
v_cvt_pk_bf16_f32 v50, v50, v51
v_cvt_pk_bf16_f32 v48, v48, v49
s_cmp_lg_u64 s[24:25], 0
s_cbranch_scc1 L_Vf_nrf
v_cndmask_b32_dpp v48, v50, v48, vcc quad_perm:[2,3,2,3] row_mask:0xf bank_mask:0xf
v_pk_mul_f32 v[46:47], v[46:47], v[14:15] op_sel_hi:[1,0]
v_pk_mul_f32 v[44:45], v[44:45], v[14:15] op_sel_hi:[1,0]
v_cvt_pk_bf16_f32 v46, v46, v47
v_cvt_pk_bf16_f32 v44, v44, v45
ds_write_b32 v9, v48
s_nop 0
v_cndmask_b32_dpp v44, v46, v44, vcc quad_perm:[2,3,2,3] row_mask:0xf bank_mask:0xf
ds_write_b32 v16, v44
s_waitcnt lgkmcnt(0)
s_barrier
ds_read_b128 v[60:63], v0 offset:53248
ds_read_b128 v[64:67], v0 offset:54272
s_add_u32 s22, s27, 0
s_add_u32 s23, s27, 8448
s_add_u32 s24, s27, 16896
s_add_u32 s25, s27, 25344
s_add_u32 s26, s27, 33792
s_waitcnt lgkmcnt(1)
v_smfmac_f32_16x16x64_bf16 v[72:75], v[60:63], v[128:135], v3
s_waitcnt lgkmcnt(0)
v_smfmac_f32_16x16x64_bf16 v[72:75], v[64:67], v[136:143], v3
v_smfmac_f32_16x16x64_bf16 v[28:31], v[60:63], v[144:151], v3
v_smfmac_f32_16x16x64_bf16 v[28:31], v[64:67], v[152:159], v3
v_smfmac_f32_16x16x64_bf16 v[80:83], v[60:63], v[160:167], v3
v_add_f32 v72, v72, v74
v_add_f32 v73, v73, v75
v_cvt_pk_bf16_f32 v72, v72, v73
v_smfmac_f32_16x16x64_bf16 v[80:83], v[64:67], v[168:175], v3
buffer_store_dword v72, v10, s[8:11], s22 offen
v_smfmac_f32_16x16x64_bf16 v[84:87], v[60:63], v[176:183], v3
v_add_f32 v28, v28, v30
v_add_f32 v29, v29, v31
v_cvt_pk_bf16_f32 v28, v28, v29
v_smfmac_f32_16x16x64_bf16 v[84:87], v[64:67], v[184:191], v3
buffer_store_dword v28, v10, s[8:11], s23 offen
v_smfmac_f32_16x16x64_bf16 v[52:55], v[60:63], v[192:199], v3
v_add_f32 v80, v80, v82
v_add_f32 v81, v81, v83
v_cvt_pk_bf16_f32 v80, v80, v81
v_smfmac_f32_16x16x64_bf16 v[52:55], v[64:67], v[200:207], v3
buffer_store_dword v80, v10, s[8:11], s24 offen
v_add_f32 v84, v84, v86
v_add_f32 v85, v85, v87
v_cvt_pk_bf16_f32 v84, v84, v85
buffer_store_dword v84, v10, s[8:11], s25 offen
s_nop 2
v_pk_add_f32 v[52:53], v[52:53], v[54:55]
v_cvt_pk_bf16_f32 v52, v52, v53
buffer_store_dword v52, v10, s[8:11], s26 offen
s_waitcnt vmcnt(0)
s_barrier
v_min_u32 v76, -2, v68
v_min_u32 v77, -2, v69
v_min_u32 v78, -2, v70
v_min_u32 v79, -2, v71
s_add_u32 s18, s18, 10240
s_addc_u32 s19, s19, 0
v_xor_b32 v7, 16384, v7
v_xor_b32 v8, 16384, v8
s_add_u32 s16, s16, s40
s_addc_u32 s17, s17, 0
s_xor_b32 s39, s39, 16384
s_sub_u32 s3, 0x200000, s40
s_mov_b32 s40, s41
s_mov_b32 s41, s3
s_add_u32 s34, s34, 262144
s_addc_u32 s35, s35, 0
s_add_u32 s98, s98, 32768
s_addc_u32 s99, s99, 0
s_add_u32 s100, s100, 32768
s_addc_u32 s101, s101, 0
s_add_u32 s15, s15, 1
ds_read_b128 v[80:83], v1 offset:0
ds_read_b128 v[84:87], v1 offset:1024
ds_read_b128 v[88:91], v1 offset:16384
ds_read_b128 v[92:95], v1 offset:17408
ds_read_b128 v[96:99], v2 offset:0
ds_read_b128 v[100:103], v2 offset:1024
ds_read_b128 v[104:107], v2 offset:16384
ds_read_b128 v[108:111], v2 offset:17408
v_mov_b64 v[20:21], 0
v_mov_b64 v[22:23], 0
v_mov_b64 v[24:25], 0
v_mov_b64 v[26:27], 0
v_mov_b64 v[28:29], 0
v_mov_b64 v[30:31], 0
v_mov_b64 v[32:33], 0
v_mov_b64 v[34:35], 0
v_mov_b64 v[36:37], 0
v_mov_b64 v[38:39], 0
s_branch L_loop_nrf
L_kvpl_nrf:
v_mov_b32 v15, 57600
ds_read_b128 v[20:23], v15
ds_read_b128 v[24:27], v15 offset:16
s_waitcnt lgkmcnt(0)
v_min_u32 v20, v20, v24
v_lshrrev_b32 v24, 4, v20
v_lshl_add_u32 v20, v24, 5, v20
v_lshl_add_u32 v20, v20, 1, 0
v_min_u32 v21, v21, v25
v_lshrrev_b32 v25, 4, v21
v_lshl_add_u32 v21, v25, 5, v21
v_lshl_add_u32 v21, v21, 1, 1
v_min_u32 v22, v22, v26
v_lshl_add_u32 v22, v22, 1, 32
v_min_u32 v23, v23, v27
v_lshl_add_u32 v23, v23, 1, 33
v_min3_u32 v20, v20, v21, v22
v_min_u32 v20, v20, v23
s_nop 0
v_readfirstlane_b32 s42, v20
v_mov_b64 v[20:21], 0
v_mov_b64 v[22:23], 0
v_mov_b64 v[24:25], 0
v_mov_b64 v[26:27], 0
s_cmp_gt_u32 s42, s3
s_cbranch_scc1 L_kvokl_nrf
s_lshr_b32 s26, s13, 1
s_lshl_b32 s26, s26, 7
s_add_u32 s26, s26, 68158464
v_mov_b32 v14, s26
s_mov_b32 s29, 0x40000
L_kvw_3:
global_load_dwordx4 v[20:23], v14, s[4:5] sc1
global_load_dwordx4 v[24:27], v14, s[4:5] offset:16 sc1
s_waitcnt vmcnt(0)
v_min_u32 v20, v20, v24
v_lshrrev_b32 v24, 4, v20
v_lshl_add_u32 v20, v24, 5, v20
v_lshl_add_u32 v20, v20, 1, 0
v_min_u32 v21, v21, v25
v_lshrrev_b32 v25, 4, v21
v_lshl_add_u32 v21, v25, 5, v21
v_lshl_add_u32 v21, v21, 1, 1
v_min_u32 v22, v22, v26
v_lshl_add_u32 v22, v22, 1, 32
v_min_u32 v23, v23, v27
v_lshl_add_u32 v23, v23, 1, 33
v_min3_u32 v20, v20, v21, v22
v_min_u32 v20, v20, v23
s_nop 0
v_readfirstlane_b32 s42, v20
v_mov_b64 v[20:21], 0
v_mov_b64 v[22:23], 0
v_mov_b64 v[24:25], 0
v_mov_b64 v[26:27], 0
s_cmp_gt_u32 s42, s3
s_cbranch_scc1 L_kvokl_nrf
s_sleep 2
s_sub_u32 s29, s29, 1
s_cbranch_scc0 L_kvw_3
s_branch L_abort
L_Lf_nrf:
s_waitcnt lgkmcnt(0)
s_sub_u32 s29, s29, 1
s_cbranch_scc1 L_abort
s_and_b32 s3, s29, 1
s_cbranch_scc1 L_Lq_nrf
v_max3_u32 v116, v40, v41, v42
v_max_u32 v116, v116, v43
v_max3_u32 v116, v116, v44, v45
v_max3_u32 v116, v116, v46, v47
v_max3_u32 v116, v116, v48, v49
v_max3_u32 v116, v116, v50, v51
v_max3_u32 v116, v116, v52, v53
v_max3_u32 v116, v116, v54, v55
v_max3_u32 v116, v116, v56, v57
v_max3_u32 v116, v116, v58, v59
v_cmp_eq_u32 vcc, -1, v116
s_nop 0
s_cbranch_vccz L_Lok_nrf
s_add_u32 m0, s45, 32768
s_nop 0
global_load_lds_dwordx4 v5, s[18:19] sc1
s_add_u32 m0, s46, 32768
s_nop 0
global_load_lds_dword v4, s[18:19] offset:2048 sc1
s_waitcnt vmcnt(0)
L_Lq_nrf:
ds_read_b128 v[40:43], v0 offset:32768
ds_read_b128 v[44:47], v0 offset:33792
ds_read_b128 v[48:51], v0 offset:34816
ds_read_b128 v[52:55], v0 offset:35840
ds_read_b128 v[56:59], v0 offset:36864
s_nop 7
v_mov_b64 v[20:21], 0
v_mov_b64 v[22:23], 0
v_mov_b64 v[24:25], 0
v_mov_b64 v[26:27], 0
v_mov_b64 v[28:29], 0
v_mov_b64 v[30:31], 0
v_mov_b64 v[32:33], 0
v_mov_b64 v[34:35], 0
s_branch L_Lgo_nrf
s_waitcnt lgkmcnt(0)
L_Rf_nrf:
v_max3_u32 v116, v60, v61, v62
v_max_u32 v116, v116, v63
v_max3_u32 v116, v116, v64, v65
v_max3_u32 v116, v116, v66, v67
v_max3_u32 v116, v116, v68, v69
v_max3_u32 v116, v116, v70, v71
v_max3_u32 v116, v116, v72, v73
v_max3_u32 v116, v116, v74, v75
v_max3_u32 v116, v116, v76, v77
v_max3_u32 v116, v116, v78, v79
v_cmp_eq_u32 vcc, -1, v116
s_waitcnt vmcnt(3)
s_cbranch_vccz L_Rok_nrf
L_Rp_nrf:
s_barrier
ds_read_b128 v[60:63], v0 offset:43008
ds_read_b128 v[64:67], v0 offset:44032
ds_read_b128 v[68:71], v0 offset:45056
ds_read_b128 v[72:75], v0 offset:46080
ds_read_b128 v[76:79], v0 offset:47104
v_mov_b64 v[36:37], v[14:15]
v_mov_b64 v[38:39], 0
s_waitcnt lgkmcnt(4)
s_nop 0
v_smfmac_f32_16x16x64_bf16 v[36:39], v[60:63], v[80:87], v3
s_waitcnt lgkmcnt(3)
v_smfmac_f32_16x16x64_bf16 v[36:39], v[64:67], v[88:95], v3
s_waitcnt lgkmcnt(2)
v_smfmac_f32_16x16x64_bf16 v[36:39], v[68:71], v[96:103], v3
s_waitcnt lgkmcnt(1)
v_smfmac_f32_16x16x64_bf16 v[36:39], v[72:75], v[104:111], v3
s_waitcnt lgkmcnt(0)
v_smfmac_f32_16x16x64_bf16 v[36:39], v[76:79], v[40:47], v3
s_nop 7
v_add_f32 v36, v36, v38
v_add_f32 v37, v37, v39
v_cmp_u_f32 vcc, v36, v37
v_cvt_pk_bf16_f32 v36, v36, v37
v_min_u32 v124, -2, v36
s_cbranch_vccz L_Rok_nrf
v_max3_u32 v116, v60, v61, v62
v_max_u32 v116, v116, v63
v_max3_u32 v116, v116, v64, v65
v_max3_u32 v116, v116, v66, v67
v_max3_u32 v116, v116, v68, v69
v_max3_u32 v116, v116, v70, v71
v_max3_u32 v116, v116, v72, v73
v_max3_u32 v116, v116, v74, v75
v_max3_u32 v116, v116, v76, v77
v_max3_u32 v116, v116, v78, v79
v_cmp_eq_u32 vcc, -1, v116
s_nop 0
s_cbranch_vccz L_Rok_nrf
s_sub_u32 s29, s29, 1
s_cbranch_scc1 L_abort
s_barrier
s_add_u32 m0, s45, 43008
s_nop 0
global_load_lds_dwordx4 v5, s[52:53] sc1
s_add_u32 m0, s46, 43008
s_nop 0
global_load_lds_dword v4, s[52:53] offset:2048 sc1
s_waitcnt vmcnt(0)
s_branch L_Rp_nrf
L_rs2_nrf:
buffer_store_dwordx4 v[120:123], v5, s[8:11], s2 offen
s_branch L_rs2d_nrf
L_Vf_nrf:
global_load_dword v36, v18, s[96:97] offset:-1024 sc1
s_sub_u32 s29, s29, 1
s_cbranch_scc1 L_abort
s_waitcnt vmcnt(0)
v_cmp_eq_u32 s[24:25], -1, v36
v_mfma_f32_16x16x32_bf16 v[44:47], v[92:95], v[96:99], 0
s_branch L_Vok_nrf
s_waitcnt vmcnt(0) lgkmcnt(0)
L_enter_w3f:
s_mov_b32 s27, 675840
ds_read_b128 v[80:83], v1 offset:0
ds_read_b128 v[84:87], v1 offset:1024
ds_read_b128 v[88:91], v1 offset:16384
ds_read_b128 v[92:95], v1 offset:17408
ds_read_b128 v[96:99], v2 offset:0
ds_read_b128 v[100:103], v2 offset:1024
ds_read_b128 v[104:107], v2 offset:16384
ds_read_b128 v[108:111], v2 offset:17408
v_mov_b64 v[20:21], 0
v_mov_b64 v[22:23], 0
v_mov_b64 v[24:25], 0
v_mov_b64 v[26:27], 0
v_mov_b64 v[28:29], 0
v_mov_b64 v[30:31], 0
v_mov_b64 v[32:33], 0
v_mov_b64 v[34:35], 0
v_mov_b64 v[36:37], 0
v_mov_b64 v[38:39], 0
.p2align 6
L_loop_w3f:
s_add_u32 s2, s27, s49
s_add_u32 s27, s27, 337920
s_cmp_ge_u32 s27, 1013760
s_cselect_b32 s27, 0, s27
s_add_u32 s3, s15, 1
s_min_u32 s3, s3, 63
s_cmp_le_u32 s42, s3
s_cbranch_scc1 L_kvpl_w3f
s_nop 15
s_nop 3
L_kvokl_w3f:
s_add_u32 s50, s98, s44
s_addc_u32 s51, s99, 0
s_add_u32 s52, s100, s44
s_addc_u32 s53, s101, 0
s_mov_b32 s29, 0x40000
s_add_u32 m0, s45, 32768
s_nop 0
global_load_lds_dwordx4 v5, s[18:19] sc1
s_add_u32 m0, s46, 32768
s_nop 0
global_load_lds_dword v4, s[18:19] offset:2048 sc1
ds_read_b128 v[60:63], v2 offset:49152
ds_read_b128 v[64:67], v2 offset:50176
ds_read_b128 v[68:71], v2 offset:51200
ds_read_b128 v[72:75], v2 offset:52224
s_cmp_ge_u32 s15, 62
s_cselect_b32 s40, 0, s40
s_lshr_b32 s3, s15, 3
s_add_u32 s3, s3, 2
s_bitcmp1_b32 s43, s3
s_cselect_b32 s3, 8192, 0
s_mov_b64 s[96:97], s[20:21]
s_add_u32 s20, s34, s3
s_addc_u32 s21, s35, 0
v_xor_b32 v16, 4096, v8
s_nop 13
s_add_u32 m0, s45, 32768
s_nop 0
global_load_lds_dwordx4 v5, s[18:19] sc1
s_add_u32 m0, s46, 32768
s_nop 0
global_load_lds_dword v4, s[18:19] offset:2048 sc1
s_barrier
s_add_u32 m0, s45, 37888
s_nop 0
global_load_lds_dwordx4 v5, s[50:51] sc1
s_add_u32 m0, s46, 37888
s_nop 0
global_load_lds_dword v4, s[50:51] offset:2048 sc1
s_waitcnt lgkmcnt(0)
s_waitcnt vmcnt(4)
s_barrier
ds_read_b128 v[40:43], v0 offset:32768
ds_read_b128 v[44:47], v0 offset:33792
ds_read_b128 v[48:51], v0 offset:34816
ds_read_b128 v[52:55], v0 offset:35840
ds_read_b128 v[56:59], v0 offset:36864
s_add_u32 m0, s45, 43008
s_nop 0
global_load_lds_dwordx4 v5, s[52:53] sc1
s_add_u32 m0, s46, 43008
s_nop 0
global_load_lds_dword v4, s[52:53] offset:2048 sc1
L_Lgo_w3f:
s_waitcnt lgkmcnt(4)
v_smfmac_f32_16x16x64_bf16 v[20:23], v[40:43], a[160:167], v3
s_waitcnt lgkmcnt(3)
v_smfmac_f32_16x16x64_bf16 v[20:23], v[44:47], a[176:183], v3
s_waitcnt lgkmcnt(2)
v_smfmac_f32_16x16x64_bf16 v[20:23], v[48:51], a[208:215], v3
s_waitcnt lgkmcnt(1)
v_smfmac_f32_16x16x64_bf16 v[20:23], v[52:55], a[240:247], v3
s_waitcnt lgkmcnt(0)
v_smfmac_f32_16x16x64_bf16 v[20:23], v[56:59], v[224:231], v3
v_smfmac_f32_16x16x64_bf16 v[28:31], v[40:43], v[60:67], v3
v_smfmac_f32_16x16x64_bf16 v[32:35], v[40:43], v[68:75], v3
s_nop 0
v_cmp_u_f32 vcc, v20, v21
v_cmp_u_f32 s[24:25], v22, v23
v_smfmac_f32_16x16x64_bf16 v[24:27], v[40:43], a[168:175], v3
v_smfmac_f32_16x16x64_bf16 v[24:27], v[44:47], a[184:191], v3
s_or_b64 vcc, vcc, s[24:25]
s_cbranch_scc1 L_Lf_w3f
L_Lok_w3f:
s_mov_b32 m0, s39
v_smfmac_f32_16x16x64_bf16 v[36:39], v[40:43], v[80:87], v3
ds_read_b128 v[80:83], v2 offset:32768
v_smfmac_f32_16x16x64_bf16 v[36:39], v[44:47], v[88:95], v3
ds_read_b128 v[84:87], v2 offset:33792
global_load_lds_dwordx4 v0, s[16:17] offset:0 sc1
v_smfmac_f32_16x16x64_bf16 v[36:39], v[48:51], v[96:103], v3
ds_read_b128 v[88:91], v1 offset:18432
v_smfmac_f32_16x16x64_bf16 v[36:39], v[52:55], v[104:111], v3
ds_read_b128 v[92:95], v1 offset:19456
s_mov_b64 exec, s[36:37]
global_store_dwordx4 v13, v[76:79], s[96:97] sc1
s_mov_b64 exec, -1
v_smfmac_f32_16x16x64_bf16 v[28:31], v[44:47], a[192:199], v3
ds_read_b128 v[96:99], v2 offset:2048
v_smfmac_f32_16x16x64_bf16 v[32:35], v[44:47], a[200:207], v3
ds_read_b128 v[100:103], v2 offset:3072
global_load_lds_dwordx4 v0, s[16:17] offset:1024 sc1
v_smfmac_f32_16x16x64_bf16 v[24:27], v[48:51], a[216:223], v3
ds_read_b128 v[104:107], v2 offset:18432
s_waitcnt lgkmcnt(5)
v_smfmac_f32_16x16x64_bf16 v[36:39], v[56:59], v[80:87], v3
ds_read_b128 v[108:111], v2 offset:19456
s_mov_b32 m0, 56064
s_nop 0
global_load_lds_dword v12, s[18:19] sc1
s_mov_b32 m0, 57600
s_nop 0
global_load_lds_dword v11, s[4:5] sc1
s_mov_b32 m0, s39
v_smfmac_f32_16x16x64_bf16 v[28:31], v[48:51], a[224:231], v3
ds_read_b128 v[40:43], v2 offset:34816
v_smfmac_f32_16x16x64_bf16 v[32:35], v[48:51], a[232:239], v3
ds_read_b128 v[44:47], v2 offset:35840
v_smfmac_f32_16x16x64_bf16 v[24:27], v[52:55], a[248:255], v3
ds_read_b128 v[80:83], v1 offset:2048
s_add_u32 s96, s20, s1
s_addc_u32 s97, s21, 0
v_smfmac_f32_16x16x64_bf16 v[24:27], v[56:59], v[232:239], v3
ds_read_b128 v[84:87], v1 offset:3072
v_smfmac_f32_16x16x64_bf16 v[28:31], v[52:55], v[208:215], v3
s_waitcnt vmcnt(7)
s_barrier
ds_read_b128 v[60:63], v0 offset:37888
ds_read_b128 v[64:67], v0 offset:38912
ds_read_b128 v[68:71], v0 offset:39936
ds_read_b128 v[72:75], v0 offset:40960
ds_read_b128 v[76:79], v0 offset:41984
v_add_f32 v14, v36, v38
v_add_f32 v15, v37, v39
s_waitcnt lgkmcnt(4)
v_smfmac_f32_16x16x64_bf16 v[36:39], v[60:63], v[80:87], v3
s_waitcnt lgkmcnt(3)
v_smfmac_f32_16x16x64_bf16 v[36:39], v[64:67], v[88:95], v3
s_waitcnt lgkmcnt(2)
v_smfmac_f32_16x16x64_bf16 v[36:39], v[68:71], v[96:103], v3
s_waitcnt lgkmcnt(1)
v_smfmac_f32_16x16x64_bf16 v[36:39], v[72:75], v[104:111], v3
s_waitcnt lgkmcnt(0)
v_smfmac_f32_16x16x64_bf16 v[36:39], v[76:79], v[40:47], v3
v_smfmac_f32_16x16x64_bf16 v[32:35], v[52:55], v[216:223], v3
v_smfmac_f32_16x16x64_bf16 v[28:31], v[56:59], v[240:247], v3
s_nop 0
v_add_f32 v36, v36, v38
v_add_f32 v37, v37, v39
v_cmp_u_f32 vcc, v36, v37
v_cvt_pk_bf16_f32 v36, v36, v37
v_min_u32 v124, -2, v36
v_smfmac_f32_16x16x64_bf16 v[32:35], v[56:59], v[248:255], v3
s_cbranch_vccnz L_Rf_w3f
L_Rok_w3f:
global_store_dword v18, v124, s[20:21] sc1
v_smfmac_f32_16x16x64_bf16 v[20:23], v[60:63], a[0:7], v3
s_mov_b32 m0, s39
ds_read_b128 v[80:83], v7 offset:0
v_smfmac_f32_16x16x64_bf16 v[20:23], v[64:67], a[32:39], v3
ds_read_b128 v[84:87], v7 offset:4096
v_smfmac_f32_16x16x64_bf16 v[20:23], v[68:71], a[64:71], v3
global_load_lds_dwordx4 v0, s[16:17] offset:2048 sc1
ds_read_b128 v[88:91], v7 offset:1024
v_smfmac_f32_16x16x64_bf16 v[20:23], v[72:75], a[96:103], v3
v_add_u32 v15, s0, v19
ds_read_b128 v[92:95], v7 offset:5120
v_smfmac_f32_16x16x64_bf16 v[20:23], v[76:79], a[128:135], v3
ds_read_b128 v[96:99], v7 offset:2048
v_smfmac_f32_16x16x64_bf16 v[24:27], v[60:63], a[8:15], v3
global_load_lds_dwordx4 v0, s[16:17] offset:3072 sc1
ds_read_b128 v[100:103], v7 offset:6144
v_smfmac_f32_16x16x64_bf16 v[24:27], v[64:67], a[40:47], v3
v_smfmac_f32_16x16x64_bf16 v[24:27], v[68:71], a[72:79], v3
v_add_f32 v20, v20, v22
v_add_f32 v21, v21, v23
v_cvt_pk_bf16_f32 v20, v20, v21
v_smfmac_f32_16x16x64_bf16 v[24:27], v[72:75], a[104:111], v3
ds_write_b16 v6, v20 offset:32
v_smfmac_f32_16x16x64_bf16 v[24:27], v[76:79], a[136:143], v3
ds_write_b16_d16_hi v6, v20 offset:48
v_smfmac_f32_16x16x64_bf16 v[28:31], v[60:63], a[16:23], v3
ds_read_b128 v[104:107], v7 offset:3072
v_smfmac_f32_16x16x64_bf16 v[28:31], v[64:67], a[48:55], v3
buffer_store_dwordx4 v[120:123], v5, s[8:11], s2 offen
s_add_u32 s2, s2, 135168
ds_read_b128 v[108:111], v7 offset:7168
v_smfmac_f32_16x16x64_bf16 v[28:31], v[68:71], a[80:87], v3
v_add_f32 v24, v24, v26
v_add_f32 v25, v25, v27
v_cvt_pk_bf16_f32 v24, v24, v25
ds_write_b16 v6, v24 offset:40
v_smfmac_f32_16x16x64_bf16 v[28:31], v[72:75], a[112:119], v3
ds_write_b16_d16_hi v6, v24 offset:56
v_smfmac_f32_16x16x64_bf16 v[28:31], v[76:79], a[144:151], v3
s_cmp_lt_u32 s13, 8
s_cbranch_scc1 L_rs2_w3f
L_rs2d_w3f:
v_smfmac_f32_16x16x64_bf16 v[32:35], v[60:63], a[24:31], v3
v_smfmac_f32_16x16x64_bf16 v[32:35], v[64:67], a[56:63], v3
v_smfmac_f32_16x16x64_bf16 v[32:35], v[68:71], a[88:95], v3
s_waitcnt lgkmcnt(0)
s_barrier
ds_read_b128 v[40:43], v19 offset:0
ds_read_b128 v[44:47], v19 offset:1088
ds_read_b128 v[48:51], v19 offset:2176
ds_read_b128 v[52:55], v19 offset:3264
ds_read_b128 v[56:59], v15
v_add_f32 v28, v28, v30
v_add_f32 v29, v29, v31
v_cvt_pk_bf16_f32 v116, v28, v29
v_smfmac_f32_16x16x64_bf16 v[32:35], v[72:75], a[120:127], v3
v_smfmac_f32_16x16x64_bf16 v[32:35], v[76:79], a[152:159], v3
v_mfma_f32_16x16x32_bf16 v[60:63], v[116:119], v[126:129], 0
v_mov_b32 v37, 0
v_mov_b64 v[38:39], 0
s_waitcnt lgkmcnt(4)
v_mfma_f32_16x16x32_bf16 v[20:23], v[80:83], v[40:43], 0
s_nop 0
v_add_f32 v32, v32, v34
v_add_f32 v33, v33, v35
v_cvt_pk_bf16_f32 v116, v32, v33
v_cvt_pk_bf16_f32 v68, v60, v61
v_cvt_pk_bf16_f32 v69, v62, v63
v_mfma_f32_16x16x32_bf16 v[64:67], v[116:119], v[126:129], 0
global_load_dword v36, v18, s[96:97] offset:-1024 sc1
v_mfma_f32_16x16x32_bf16 v[24:27], v[84:87], v[40:43], 0
v_mov_b64 v[72:73], 0
v_mov_b64 v[74:75], 0
s_waitcnt lgkmcnt(0)
v_mfma_f32_16x16x32_bf16 v[20:23], v[88:91], v[44:47], v[20:23]
s_nop 0
v_cvt_pk_bf16_f32 v70, v64, v65
v_cvt_pk_bf16_f32 v71, v66, v67
s_cmp_eq_u32 s15, 63
s_cbranch_scc1 L_end
v_mfma_f32_16x16x32_bf16 v[76:79], v[68:71], v[56:59], 0
v_mfma_f32_16x16x32_bf16 v[24:27], v[92:95], v[44:47], v[24:27]
v_mov_b64 v[28:29], 0
v_mov_b64 v[30:31], 0
v_mfma_f32_16x16x32_bf16 v[20:23], v[96:99], v[48:51], v[20:23]
s_nop 0
ds_write_b64 v17, v[76:77] offset:62464
v_mfma_f32_16x16x32_bf16 v[24:27], v[100:103], v[48:51], v[24:27]
ds_read_b128 v[88:91], v8
ds_read_b128 v[92:95], v16
v_mov_b64 v[80:81], 0
v_mov_b64 v[82:83], 0
v_mfma_f32_16x16x32_bf16 v[20:23], v[104:107], v[52:55], v[20:23]
v_mov_b64 v[84:85], 0
v_mov_b64 v[86:87], 0
v_mfma_f32_16x16x32_bf16 v[24:27], v[108:111], v[52:55], v[24:27]
s_waitcnt lgkmcnt(2)
s_barrier
ds_read_b128 v[60:63], v0 offset:62464
ds_read_b128 v[64:67], v0 offset:63488
s_nop 0
v_max3_f32 v14, v20, v21, v22
s_nop 1
v_max3_f32 v15, v23, v24, v25
v_max3_f32 v14, v14, v26, v27
v_max_f32 v14, v14, v15
v_xor_b32 v16, 1024, v9
s_waitcnt lgkmcnt(1)
v_pk_add_f32 v[60:61], v[60:61], v[62:63]
s_waitcnt lgkmcnt(0)
v_pk_add_f32 v[64:65], v[64:65], v[66:67]
v_pk_add_f32 v[76:77], v[60:61], v[64:65]
v_max3_f32 v15, v14, v76, v77
v_max3_f32 v14, v14, v76, v77
v_mov_b64 v[52:53], 0
v_mov_b64 v[54:55], 0
v_permlane32_swap_b32 v14, v15
v_max_f32 v14, v14, v15
v_max_f32 v15, v14, v15
s_nop 1
v_permlane16_swap_b32 v14, v15
v_max_f32 v14, v14, v15
v_mul_f32 v14, s48, v14
v_pk_fma_f32 v[20:21], v[20:21], s[32:33], v[14:15] op_sel_hi:[1,0,0]
v_pk_fma_f32 v[22:23], v[22:23], s[32:33], v[14:15] op_sel_hi:[1,0,0]
v_pk_fma_f32 v[24:25], v[24:25], s[32:33], v[14:15] op_sel_hi:[1,0,0]
v_pk_fma_f32 v[26:27], v[26:27], s[32:33], v[14:15] op_sel_hi:[1,0,0]
v_pk_fma_f32 v[76:77], v[76:77], s[32:33], v[14:15] op_sel_hi:[1,0,0]
v_exp_f32 v20, v20
v_exp_f32 v21, v21
v_exp_f32 v22, v22
v_exp_f32 v23, v23
v_exp_f32 v24, v24
v_exp_f32 v25, v25
v_exp_f32 v26, v26
v_exp_f32 v27, v27
v_cvt_pk_bf16_f32 v96, v20, v21
v_cvt_pk_bf16_f32 v97, v22, v23
v_cvt_pk_bf16_f32 v98, v24, v25
v_cvt_pk_bf16_f32 v99, v26, v27
v_exp_f32 v76, v76
s_waitcnt lgkmcnt(0)
v_mfma_f32_16x16x32_bf16 v[32:35], v[112:115], v[96:99], 0
v_exp_f32 v77, v77
v_mfma_f32_16x16x32_bf16 v[40:43], v[88:91], v[96:99], 0
v_cvt_pk_bf16_f32 v116, v76, v77
s_mov_b32 vcc_lo, 0xcccccccc
s_mov_b32 vcc_hi, 0xcccccccc
v_mfma_f32_16x16x32_bf16 v[32:35], v[112:115], v[116:119], v[32:35]
v_mfma_f32_16x16x32_bf16 v[40:43], v[124:127], v[116:119], v[40:43]
v_mfma_f32_16x16x32_bf16 v[44:47], v[92:95], v[96:99], 0
s_waitcnt vmcnt(0)
v_cmp_eq_u32 s[24:25], -1, v36
v_rcp_f32 v14, v32
L_Vok_w3f:
v_mfma_f32_16x16x32_bf16 v[44:47], v[36:39], v[116:119], v[44:47]
s_nop 0
v_mul_f32 v50, v42, v14
v_mul_f32 v51, v43, v14
v_mul_f32 v48, v40, v14
v_mul_f32 v49, v41, v14
v_cvt_pk_bf16_f32 v50, v50, v51
v_cvt_pk_bf16_f32 v48, v48, v49
s_cmp_lg_u64 s[24:25], 0
s_cbranch_scc1 L_Vf_w3f
v_cndmask_b32_dpp v48, v50, v48, vcc quad_perm:[2,3,2,3] row_mask:0xf bank_mask:0xf
v_pk_mul_f32 v[46:47], v[46:47], v[14:15] op_sel_hi:[1,0]
v_pk_mul_f32 v[44:45], v[44:45], v[14:15] op_sel_hi:[1,0]
v_cvt_pk_bf16_f32 v46, v46, v47
v_cvt_pk_bf16_f32 v44, v44, v45
ds_write_b32 v9, v48
s_nop 0
v_cndmask_b32_dpp v44, v46, v44, vcc quad_perm:[2,3,2,3] row_mask:0xf bank_mask:0xf
ds_write_b32 v16, v44
s_waitcnt lgkmcnt(0)
s_barrier
ds_read_b128 v[60:63], v0 offset:53248
ds_read_b128 v[64:67], v0 offset:54272
s_add_u32 s22, s27, 0
s_add_u32 s23, s27, 8448
s_add_u32 s24, s27, 16896
s_add_u32 s25, s27, 25344
s_add_u32 s26, s27, 33792
s_waitcnt lgkmcnt(1)
v_smfmac_f32_16x16x64_bf16 v[72:75], v[60:63], v[128:135], v3
s_waitcnt lgkmcnt(0)
v_smfmac_f32_16x16x64_bf16 v[72:75], v[64:67], v[136:143], v3
v_smfmac_f32_16x16x64_bf16 v[28:31], v[60:63], v[144:151], v3
v_smfmac_f32_16x16x64_bf16 v[28:31], v[64:67], v[152:159], v3
v_smfmac_f32_16x16x64_bf16 v[80:83], v[60:63], v[160:167], v3
v_add_f32 v72, v72, v74
v_add_f32 v73, v73, v75
v_cvt_pk_bf16_f32 v72, v72, v73
v_smfmac_f32_16x16x64_bf16 v[80:83], v[64:67], v[168:175], v3
buffer_store_dword v72, v10, s[8:11], s22 offen
v_smfmac_f32_16x16x64_bf16 v[84:87], v[60:63], v[176:183], v3
v_add_f32 v28, v28, v30
v_add_f32 v29, v29, v31
v_cvt_pk_bf16_f32 v28, v28, v29
v_smfmac_f32_16x16x64_bf16 v[84:87], v[64:67], v[184:191], v3
buffer_store_dword v28, v10, s[8:11], s23 offen
v_smfmac_f32_16x16x64_bf16 v[52:55], v[60:63], v[192:199], v3
v_add_f32 v80, v80, v82
v_add_f32 v81, v81, v83
v_cvt_pk_bf16_f32 v80, v80, v81
v_smfmac_f32_16x16x64_bf16 v[52:55], v[64:67], v[200:207], v3
buffer_store_dword v80, v10, s[8:11], s24 offen
v_add_f32 v84, v84, v86
v_add_f32 v85, v85, v87
v_cvt_pk_bf16_f32 v84, v84, v85
buffer_store_dword v84, v10, s[8:11], s25 offen
s_nop 2
v_pk_add_f32 v[52:53], v[52:53], v[54:55]
v_cvt_pk_bf16_f32 v52, v52, v53
buffer_store_dword v52, v10, s[8:11], s26 offen
s_waitcnt vmcnt(0)
s_barrier
v_min_u32 v76, -2, v68
v_min_u32 v77, -2, v69
v_min_u32 v78, -2, v70
v_min_u32 v79, -2, v71
s_add_u32 s18, s18, 10240
s_addc_u32 s19, s19, 0
v_xor_b32 v7, 16384, v7
v_xor_b32 v8, 16384, v8
s_add_u32 s16, s16, s40
s_addc_u32 s17, s17, 0
s_xor_b32 s39, s39, 16384
s_sub_u32 s3, 0x200000, s40
s_mov_b32 s40, s41
s_mov_b32 s41, s3
s_add_u32 s34, s34, 262144
s_addc_u32 s35, s35, 0
s_add_u32 s98, s98, 32768
s_addc_u32 s99, s99, 0
s_add_u32 s100, s100, 32768
s_addc_u32 s101, s101, 0
s_add_u32 s15, s15, 1
ds_read_b128 v[80:83], v1 offset:0
ds_read_b128 v[84:87], v1 offset:1024
ds_read_b128 v[88:91], v1 offset:16384
ds_read_b128 v[92:95], v1 offset:17408
ds_read_b128 v[96:99], v2 offset:0
ds_read_b128 v[100:103], v2 offset:1024
ds_read_b128 v[104:107], v2 offset:16384
ds_read_b128 v[108:111], v2 offset:17408
v_mov_b64 v[20:21], 0
v_mov_b64 v[22:23], 0
v_mov_b64 v[24:25], 0
v_mov_b64 v[26:27], 0
v_mov_b64 v[28:29], 0
v_mov_b64 v[30:31], 0
v_mov_b64 v[32:33], 0
v_mov_b64 v[34:35], 0
v_mov_b64 v[36:37], 0
v_mov_b64 v[38:39], 0
s_branch L_loop_w3f
L_kvpl_w3f:
v_mov_b32 v15, 57600
ds_read_b128 v[20:23], v15
ds_read_b128 v[24:27], v15 offset:16
s_waitcnt lgkmcnt(0)
v_min_u32 v20, v20, v24
v_lshrrev_b32 v24, 4, v20
v_lshl_add_u32 v20, v24, 5, v20
v_lshl_add_u32 v20, v20, 1, 0
v_min_u32 v21, v21, v25
v_lshrrev_b32 v25, 4, v21
v_lshl_add_u32 v21, v25, 5, v21
v_lshl_add_u32 v21, v21, 1, 1
v_min_u32 v22, v22, v26
v_lshl_add_u32 v22, v22, 1, 32
v_min_u32 v23, v23, v27
v_lshl_add_u32 v23, v23, 1, 33
v_min3_u32 v20, v20, v21, v22
v_min_u32 v20, v20, v23
s_nop 0
v_readfirstlane_b32 s42, v20
v_mov_b64 v[20:21], 0
v_mov_b64 v[22:23], 0
v_mov_b64 v[24:25], 0
v_mov_b64 v[26:27], 0
s_cmp_gt_u32 s42, s3
s_cbranch_scc1 L_kvokl_w3f
s_lshr_b32 s26, s13, 1
s_lshl_b32 s26, s26, 7
s_add_u32 s26, s26, 68158464
v_mov_b32 v14, s26
s_mov_b32 s29, 0x40000
L_kvw_4:
global_load_dwordx4 v[20:23], v14, s[4:5] sc1
global_load_dwordx4 v[24:27], v14, s[4:5] offset:16 sc1
s_waitcnt vmcnt(0)
v_min_u32 v20, v20, v24
v_lshrrev_b32 v24, 4, v20
v_lshl_add_u32 v20, v24, 5, v20
v_lshl_add_u32 v20, v20, 1, 0
v_min_u32 v21, v21, v25
v_lshrrev_b32 v25, 4, v21
v_lshl_add_u32 v21, v25, 5, v21
v_lshl_add_u32 v21, v21, 1, 1
v_min_u32 v22, v22, v26
v_lshl_add_u32 v22, v22, 1, 32
v_min_u32 v23, v23, v27
v_lshl_add_u32 v23, v23, 1, 33
v_min3_u32 v20, v20, v21, v22
v_min_u32 v20, v20, v23
s_nop 0
v_readfirstlane_b32 s42, v20
v_mov_b64 v[20:21], 0
v_mov_b64 v[22:23], 0
v_mov_b64 v[24:25], 0
v_mov_b64 v[26:27], 0
s_cmp_gt_u32 s42, s3
s_cbranch_scc1 L_kvokl_w3f
s_sleep 2
s_sub_u32 s29, s29, 1
s_cbranch_scc0 L_kvw_4
s_branch L_abort
L_Lf_w3f:
s_waitcnt lgkmcnt(0)
s_sub_u32 s29, s29, 1
s_cbranch_scc1 L_abort
s_and_b32 s3, s29, 1
s_cbranch_scc1 L_Lq_w3f
v_max3_u32 v116, v40, v41, v42
v_max_u32 v116, v116, v43
v_max3_u32 v116, v116, v44, v45
v_max3_u32 v116, v116, v46, v47
v_max3_u32 v116, v116, v48, v49
v_max3_u32 v116, v116, v50, v51
v_max3_u32 v116, v116, v52, v53
v_max3_u32 v116, v116, v54, v55
v_max3_u32 v116, v116, v56, v57
v_max3_u32 v116, v116, v58, v59
v_cmp_eq_u32 vcc, -1, v116
s_nop 0
s_cbranch_vccz L_Lok_w3f
s_add_u32 m0, s45, 32768
s_nop 0
global_load_lds_dwordx4 v5, s[18:19] sc1
s_add_u32 m0, s46, 32768
s_nop 0
global_load_lds_dword v4, s[18:19] offset:2048 sc1
s_waitcnt vmcnt(0)
L_Lq_w3f:
ds_read_b128 v[40:43], v0 offset:32768
ds_read_b128 v[44:47], v0 offset:33792
ds_read_b128 v[48:51], v0 offset:34816
ds_read_b128 v[52:55], v0 offset:35840
ds_read_b128 v[56:59], v0 offset:36864
s_nop 7
v_mov_b64 v[20:21], 0
v_mov_b64 v[22:23], 0
v_mov_b64 v[24:25], 0
v_mov_b64 v[26:27], 0
v_mov_b64 v[28:29], 0
v_mov_b64 v[30:31], 0
v_mov_b64 v[32:33], 0
v_mov_b64 v[34:35], 0
s_branch L_Lgo_w3f
s_waitcnt lgkmcnt(0)
L_Rf_w3f:
v_max3_u32 v116, v60, v61, v62
v_max_u32 v116, v116, v63
v_max3_u32 v116, v116, v64, v65
v_max3_u32 v116, v116, v66, v67
v_max3_u32 v116, v116, v68, v69
v_max3_u32 v116, v116, v70, v71
v_max3_u32 v116, v116, v72, v73
v_max3_u32 v116, v116, v74, v75
v_max3_u32 v116, v116, v76, v77
v_max3_u32 v116, v116, v78, v79
v_cmp_eq_u32 vcc, -1, v116
s_waitcnt vmcnt(5)
s_cbranch_vccz L_Rok_w3f
L_Rp_w3f:
s_barrier
ds_read_b128 v[60:63], v0 offset:43008
ds_read_b128 v[64:67], v0 offset:44032
ds_read_b128 v[68:71], v0 offset:45056
ds_read_b128 v[72:75], v0 offset:46080
ds_read_b128 v[76:79], v0 offset:47104
v_mov_b64 v[36:37], v[14:15]
v_mov_b64 v[38:39], 0
s_waitcnt lgkmcnt(4)
s_nop 0
v_smfmac_f32_16x16x64_bf16 v[36:39], v[60:63], v[80:87], v3
s_waitcnt lgkmcnt(3)
v_smfmac_f32_16x16x64_bf16 v[36:39], v[64:67], v[88:95], v3
s_waitcnt lgkmcnt(2)
v_smfmac_f32_16x16x64_bf16 v[36:39], v[68:71], v[96:103], v3
s_waitcnt lgkmcnt(1)
v_smfmac_f32_16x16x64_bf16 v[36:39], v[72:75], v[104:111], v3
s_waitcnt lgkmcnt(0)
v_smfmac_f32_16x16x64_bf16 v[36:39], v[76:79], v[40:47], v3
s_nop 7
v_add_f32 v36, v36, v38
v_add_f32 v37, v37, v39
v_cmp_u_f32 vcc, v36, v37
v_cvt_pk_bf16_f32 v36, v36, v37
v_min_u32 v124, -2, v36
s_cbranch_vccz L_Rok_w3f
v_max3_u32 v116, v60, v61, v62
v_max_u32 v116, v116, v63
v_max3_u32 v116, v116, v64, v65
v_max3_u32 v116, v116, v66, v67
v_max3_u32 v116, v116, v68, v69
v_max3_u32 v116, v116, v70, v71
v_max3_u32 v116, v116, v72, v73
v_max3_u32 v116, v116, v74, v75
v_max3_u32 v116, v116, v76, v77
v_max3_u32 v116, v116, v78, v79
v_cmp_eq_u32 vcc, -1, v116
s_nop 0
s_cbranch_vccz L_Rok_w3f
s_sub_u32 s29, s29, 1
s_cbranch_scc1 L_abort
s_barrier
s_add_u32 m0, s45, 43008
s_nop 0
global_load_lds_dwordx4 v5, s[52:53] sc1
s_add_u32 m0, s46, 43008
s_nop 0
global_load_lds_dword v4, s[52:53] offset:2048 sc1
s_waitcnt vmcnt(0)
s_branch L_Rp_w3f
L_rs2_w3f:
buffer_store_dwordx4 v[120:123], v5, s[8:11], s2 offen
s_branch L_rs2d_w3f
L_Vf_w3f:
global_load_dword v36, v18, s[96:97] offset:-1024 sc1
s_sub_u32 s29, s29, 1
s_cbranch_scc1 L_abort
s_waitcnt vmcnt(0)
v_cmp_eq_u32 s[24:25], -1, v36
v_mfma_f32_16x16x32_bf16 v[44:47], v[92:95], v[96:99], 0
s_branch L_Vok_w3f
s_waitcnt vmcnt(0) lgkmcnt(0)
L_enter_reds:
s_mov_b32 s27, 675840
s_mov_b32 s3, 0
buffer_load_dwordx4 v[40:43], v11, s[8:11], s3 offen offset:0 sc1
s_nop 2
buffer_load_dwordx4 v[44:47], v11, s[8:11], s3 offen offset:1024 sc1
buffer_load_dwordx4 v[48:51], v11, s[8:11], s3 offen offset:2048 sc1
buffer_load_dwordx4 v[52:55], v11, s[8:11], s3 offen offset:3072 sc1
s_mov_b32 s3, 337920
buffer_load_dwordx4 v[40:43], v11, s[8:11], s3 offen offset:0 sc1
buffer_load_dwordx4 v[44:47], v11, s[8:11], s3 offen offset:1024 sc1
buffer_load_dwordx4 v[48:51], v11, s[8:11], s3 offen offset:2048 sc1
buffer_load_dwordx4 v[52:55], v11, s[8:11], s3 offen offset:3072 sc1
s_mov_b32 s3, 675840
buffer_load_dwordx4 v[40:43], v11, s[8:11], s3 offen offset:0 sc1
buffer_load_dwordx4 v[44:47], v11, s[8:11], s3 offen offset:1024 sc1
buffer_load_dwordx4 v[48:51], v11, s[8:11], s3 offen offset:2048 sc1
buffer_load_dwordx4 v[52:55], v11, s[8:11], s3 offen offset:3072 sc1
ds_read_b128 v[80:83], v1 offset:0
ds_read_b128 v[84:87], v1 offset:1024
ds_read_b128 v[88:91], v1 offset:16384
ds_read_b128 v[92:95], v1 offset:17408
ds_read_b128 v[96:99], v2 offset:0
ds_read_b128 v[100:103], v2 offset:1024
ds_read_b128 v[104:107], v2 offset:16384
ds_read_b128 v[108:111], v2 offset:17408
v_mov_b64 v[20:21], 0
v_mov_b64 v[22:23], 0
v_mov_b64 v[24:25], 0
v_mov_b64 v[26:27], 0
v_mov_b64 v[28:29], 0
v_mov_b64 v[30:31], 0
v_mov_b64 v[32:33], 0
v_mov_b64 v[34:35], 0
v_mov_b64 v[36:37], 0
v_mov_b64 v[38:39], 0
.p2align 6
L_loop_reds:
s_add_u32 s2, s27, s49
s_add_u32 s27, s27, 337920
s_cmp_ge_u32 s27, 1013760
s_cselect_b32 s27, 0, s27
s_add_u32 s3, s15, 1
s_min_u32 s3, s3, 63
s_cmp_le_u32 s42, s3
s_cbranch_scc1 L_kvpl_reds
s_nop 15
s_nop 11
L_kvokl_reds:
s_add_u32 s50, s98, s44
s_addc_u32 s51, s99, 0
s_add_u32 s52, s100, s44
s_addc_u32 s53, s101, 0
s_mov_b32 s29, 0x40000
s_nop 9
s_add_u32 m0, s45, 32768
s_nop 0
global_load_lds_dwordx4 v5, s[18:19] sc1
s_add_u32 m0, s46, 32768
s_nop 0
global_load_lds_dword v4, s[18:19] offset:2048 sc1
ds_read_b128 v[60:63], v2 offset:49152
ds_read_b128 v[64:67], v2 offset:50176
ds_read_b128 v[68:71], v2 offset:51200
ds_read_b128 v[72:75], v2 offset:52224
s_cmp_ge_u32 s15, 62
s_cselect_b32 s40, 0, s40
s_lshr_b32 s3, s15, 3
s_add_u32 s3, s3, 2
s_bitcmp1_b32 s43, s3
s_cselect_b32 s3, 8192, 0
s_mov_b64 s[96:97], s[20:21]
s_add_u32 s20, s34, s3
s_addc_u32 s21, s35, 0
v_xor_b32 v16, 4096, v8
s_nop 13
s_add_u32 m0, s45, 32768
s_nop 0
global_load_lds_dwordx4 v5, s[18:19] sc1
s_add_u32 m0, s46, 32768
s_nop 0
global_load_lds_dword v4, s[18:19] offset:2048 sc1
s_barrier
s_add_u32 m0, s45, 37888
s_nop 0
global_load_lds_dwordx4 v5, s[50:51] sc1
s_add_u32 m0, s46, 37888
s_nop 0
global_load_lds_dword v4, s[50:51] offset:2048 sc1
s_waitcnt lgkmcnt(0)
s_waitcnt vmcnt(4)
s_barrier
ds_read_b128 v[40:43], v0 offset:32768
ds_read_b128 v[44:47], v0 offset:33792
ds_read_b128 v[48:51], v0 offset:34816
ds_read_b128 v[52:55], v0 offset:35840
ds_read_b128 v[56:59], v0 offset:36864
s_add_u32 m0, s45, 43008
s_nop 0
global_load_lds_dwordx4 v5, s[52:53] sc1
s_add_u32 m0, s46, 43008
s_nop 0
global_load_lds_dword v4, s[52:53] offset:2048 sc1
L_Lgo_reds:
s_waitcnt lgkmcnt(4)
v_smfmac_f32_16x16x64_bf16 v[20:23], v[40:43], a[160:167], v3
s_waitcnt lgkmcnt(3)
v_smfmac_f32_16x16x64_bf16 v[20:23], v[44:47], a[176:183], v3
s_waitcnt lgkmcnt(2)
v_smfmac_f32_16x16x64_bf16 v[20:23], v[48:51], a[208:215], v3
s_waitcnt lgkmcnt(1)
v_smfmac_f32_16x16x64_bf16 v[20:23], v[52:55], a[240:247], v3
s_waitcnt lgkmcnt(0)
v_smfmac_f32_16x16x64_bf16 v[20:23], v[56:59], v[224:231], v3
v_smfmac_f32_16x16x64_bf16 v[28:31], v[40:43], v[60:67], v3
v_smfmac_f32_16x16x64_bf16 v[32:35], v[40:43], v[68:75], v3
s_nop 0
v_cmp_u_f32 vcc, v20, v21
v_cmp_u_f32 s[24:25], v22, v23
v_smfmac_f32_16x16x64_bf16 v[24:27], v[40:43], a[168:175], v3
v_smfmac_f32_16x16x64_bf16 v[24:27], v[44:47], a[184:191], v3
s_or_b64 vcc, vcc, s[24:25]
s_cbranch_scc1 L_Lf_reds
L_Lok_reds:
s_mov_b32 m0, s39
v_smfmac_f32_16x16x64_bf16 v[36:39], v[40:43], v[80:87], v3
ds_read_b128 v[80:83], v2 offset:32768
v_smfmac_f32_16x16x64_bf16 v[36:39], v[44:47], v[88:95], v3
ds_read_b128 v[84:87], v2 offset:33792
global_load_lds_dwordx4 v0, s[16:17] offset:0 sc1
v_smfmac_f32_16x16x64_bf16 v[36:39], v[48:51], v[96:103], v3
ds_read_b128 v[88:91], v1 offset:18432
v_smfmac_f32_16x16x64_bf16 v[36:39], v[52:55], v[104:111], v3
ds_read_b128 v[92:95], v1 offset:19456
s_mov_b64 exec, s[36:37]
global_store_dwordx4 v13, v[76:79], s[96:97] sc1
s_mov_b64 exec, -1
v_smfmac_f32_16x16x64_bf16 v[28:31], v[44:47], a[192:199], v3
ds_read_b128 v[96:99], v2 offset:2048
v_smfmac_f32_16x16x64_bf16 v[32:35], v[44:47], a[200:207], v3
ds_read_b128 v[100:103], v2 offset:3072
global_load_lds_dwordx4 v0, s[16:17] offset:1024 sc1
v_smfmac_f32_16x16x64_bf16 v[24:27], v[48:51], a[216:223], v3
ds_read_b128 v[104:107], v2 offset:18432
s_waitcnt lgkmcnt(5)
v_smfmac_f32_16x16x64_bf16 v[36:39], v[56:59], v[80:87], v3
ds_read_b128 v[108:111], v2 offset:19456
v_smfmac_f32_16x16x64_bf16 v[28:31], v[48:51], a[224:231], v3
ds_read_b128 v[40:43], v2 offset:34816
v_smfmac_f32_16x16x64_bf16 v[32:35], v[48:51], a[232:239], v3
ds_read_b128 v[44:47], v2 offset:35840
v_smfmac_f32_16x16x64_bf16 v[24:27], v[52:55], a[248:255], v3
ds_read_b128 v[80:83], v1 offset:2048
s_add_u32 s96, s20, s1
s_addc_u32 s97, s21, 0
v_smfmac_f32_16x16x64_bf16 v[24:27], v[56:59], v[232:239], v3
ds_read_b128 v[84:87], v1 offset:3072
v_smfmac_f32_16x16x64_bf16 v[28:31], v[52:55], v[208:215], v3
s_waitcnt vmcnt(5)
s_barrier
ds_read_b128 v[60:63], v0 offset:37888
ds_read_b128 v[64:67], v0 offset:38912
ds_read_b128 v[68:71], v0 offset:39936
ds_read_b128 v[72:75], v0 offset:40960
ds_read_b128 v[76:79], v0 offset:41984
v_add_f32 v14, v36, v38
v_add_f32 v15, v37, v39
s_waitcnt lgkmcnt(4)
v_smfmac_f32_16x16x64_bf16 v[36:39], v[60:63], v[80:87], v3
s_waitcnt lgkmcnt(3)
v_smfmac_f32_16x16x64_bf16 v[36:39], v[64:67], v[88:95], v3
s_waitcnt lgkmcnt(2)
v_smfmac_f32_16x16x64_bf16 v[36:39], v[68:71], v[96:103], v3
s_waitcnt lgkmcnt(1)
v_smfmac_f32_16x16x64_bf16 v[36:39], v[72:75], v[104:111], v3
s_waitcnt lgkmcnt(0)
v_smfmac_f32_16x16x64_bf16 v[36:39], v[76:79], v[40:47], v3
v_smfmac_f32_16x16x64_bf16 v[32:35], v[52:55], v[216:223], v3
v_smfmac_f32_16x16x64_bf16 v[28:31], v[56:59], v[240:247], v3
s_nop 0
v_add_f32 v36, v36, v38
v_add_f32 v37, v37, v39
v_cmp_u_f32 vcc, v36, v37
v_cvt_pk_bf16_f32 v36, v36, v37
v_min_u32 v124, -2, v36
v_smfmac_f32_16x16x64_bf16 v[32:35], v[56:59], v[248:255], v3
s_cbranch_vccnz L_Rf_reds
L_Rok_reds:
global_store_dword v18, v124, s[20:21] sc1
v_smfmac_f32_16x16x64_bf16 v[20:23], v[60:63], a[0:7], v3
s_mov_b32 m0, s39
ds_read_b128 v[80:83], v7 offset:0
v_smfmac_f32_16x16x64_bf16 v[20:23], v[64:67], a[32:39], v3
ds_read_b128 v[84:87], v7 offset:4096
v_smfmac_f32_16x16x64_bf16 v[20:23], v[68:71], a[64:71], v3
global_load_lds_dwordx4 v0, s[16:17] offset:2048 sc1
ds_read_b128 v[88:91], v7 offset:1024
v_smfmac_f32_16x16x64_bf16 v[20:23], v[72:75], a[96:103], v3
v_add_u32 v15, s0, v19
ds_read_b128 v[92:95], v7 offset:5120
v_smfmac_f32_16x16x64_bf16 v[20:23], v[76:79], a[128:135], v3
ds_read_b128 v[96:99], v7 offset:2048
v_smfmac_f32_16x16x64_bf16 v[24:27], v[60:63], a[8:15], v3
global_load_lds_dwordx4 v0, s[16:17] offset:3072 sc1
ds_read_b128 v[100:103], v7 offset:6144
v_smfmac_f32_16x16x64_bf16 v[24:27], v[64:67], a[40:47], v3
v_smfmac_f32_16x16x64_bf16 v[24:27], v[68:71], a[72:79], v3
v_add_f32 v20, v20, v22
v_add_f32 v21, v21, v23
v_cvt_pk_bf16_f32 v20, v20, v21
v_smfmac_f32_16x16x64_bf16 v[24:27], v[72:75], a[104:111], v3
buffer_store_dwordx4 v[120:123], v5, s[8:11], s2 offen sc1
s_add_u32 s2, s2, 135168
ds_write_b16 v6, v20 offset:32
v_smfmac_f32_16x16x64_bf16 v[24:27], v[76:79], a[136:143], v3
ds_write_b16_d16_hi v6, v20 offset:48
v_smfmac_f32_16x16x64_bf16 v[28:31], v[60:63], a[16:23], v3
ds_read_b128 v[104:107], v7 offset:3072
v_smfmac_f32_16x16x64_bf16 v[28:31], v[64:67], a[48:55], v3
ds_read_b128 v[108:111], v7 offset:7168
v_smfmac_f32_16x16x64_bf16 v[28:31], v[68:71], a[80:87], v3
s_cmp_lt_u32 s13, 8
s_cbranch_scc1 L_rs2_reds
L_rs2d_reds:
v_add_f32 v24, v24, v26
v_add_f32 v25, v25, v27
v_cvt_pk_bf16_f32 v24, v24, v25
ds_write_b16 v6, v24 offset:40
v_smfmac_f32_16x16x64_bf16 v[28:31], v[72:75], a[112:119], v3
ds_write_b16_d16_hi v6, v24 offset:56
v_smfmac_f32_16x16x64_bf16 v[28:31], v[76:79], a[144:151], v3
v_smfmac_f32_16x16x64_bf16 v[32:35], v[60:63], a[24:31], v3
v_smfmac_f32_16x16x64_bf16 v[32:35], v[64:67], a[56:63], v3
v_smfmac_f32_16x16x64_bf16 v[32:35], v[68:71], a[88:95], v3
s_waitcnt lgkmcnt(0)
s_barrier
ds_read_b128 v[40:43], v19 offset:0
ds_read_b128 v[44:47], v19 offset:1088
ds_read_b128 v[48:51], v19 offset:2176
ds_read_b128 v[52:55], v19 offset:3264
ds_read_b128 v[56:59], v15
v_add_f32 v28, v28, v30
v_add_f32 v29, v29, v31
v_cvt_pk_bf16_f32 v116, v28, v29
v_smfmac_f32_16x16x64_bf16 v[32:35], v[72:75], a[120:127], v3
v_smfmac_f32_16x16x64_bf16 v[32:35], v[76:79], a[152:159], v3
v_mfma_f32_16x16x32_bf16 v[60:63], v[116:119], v[126:129], 0
v_mov_b32 v37, 0
v_mov_b64 v[38:39], 0
s_waitcnt lgkmcnt(4)
v_mfma_f32_16x16x32_bf16 v[20:23], v[80:83], v[40:43], 0
s_nop 0
v_add_f32 v32, v32, v34
v_add_f32 v33, v33, v35
v_cvt_pk_bf16_f32 v116, v32, v33
v_cvt_pk_bf16_f32 v68, v60, v61
v_cvt_pk_bf16_f32 v69, v62, v63
v_mfma_f32_16x16x32_bf16 v[64:67], v[116:119], v[126:129], 0
global_load_dword v36, v18, s[96:97] offset:-1024 sc1
v_mfma_f32_16x16x32_bf16 v[24:27], v[84:87], v[40:43], 0
v_mov_b64 v[72:73], 0
v_mov_b64 v[74:75], 0
s_waitcnt lgkmcnt(0)
v_mfma_f32_16x16x32_bf16 v[20:23], v[88:91], v[44:47], v[20:23]
s_nop 0
v_cvt_pk_bf16_f32 v70, v64, v65
v_cvt_pk_bf16_f32 v71, v66, v67
s_cmp_eq_u32 s15, 63
s_cbranch_scc1 L_end
v_mfma_f32_16x16x32_bf16 v[76:79], v[68:71], v[56:59], 0
v_mfma_f32_16x16x32_bf16 v[24:27], v[92:95], v[44:47], v[24:27]
v_mov_b64 v[28:29], 0
v_mov_b64 v[30:31], 0
v_mfma_f32_16x16x32_bf16 v[20:23], v[96:99], v[48:51], v[20:23]
s_nop 0
ds_write_b64 v17, v[76:77] offset:62464
v_mfma_f32_16x16x32_bf16 v[24:27], v[100:103], v[48:51], v[24:27]
ds_read_b128 v[88:91], v8
ds_read_b128 v[92:95], v16
v_mov_b64 v[80:81], 0
v_mov_b64 v[82:83], 0
v_mfma_f32_16x16x32_bf16 v[20:23], v[104:107], v[52:55], v[20:23]
v_mov_b64 v[84:85], 0
v_mov_b64 v[86:87], 0
v_mfma_f32_16x16x32_bf16 v[24:27], v[108:111], v[52:55], v[24:27]
s_waitcnt lgkmcnt(2)
s_barrier
ds_read_b128 v[60:63], v0 offset:62464
ds_read_b128 v[64:67], v0 offset:63488
s_nop 0
v_max3_f32 v14, v20, v21, v22
s_nop 1
v_max3_f32 v15, v23, v24, v25
v_max3_f32 v14, v14, v26, v27
v_max_f32 v14, v14, v15
v_xor_b32 v16, 1024, v9
s_waitcnt lgkmcnt(1)
v_pk_add_f32 v[60:61], v[60:61], v[62:63]
s_waitcnt lgkmcnt(0)
v_pk_add_f32 v[64:65], v[64:65], v[66:67]
v_pk_add_f32 v[76:77], v[60:61], v[64:65]
v_max3_f32 v15, v14, v76, v77
v_max3_f32 v14, v14, v76, v77
v_mov_b64 v[52:53], 0
v_mov_b64 v[54:55], 0
v_permlane32_swap_b32 v14, v15
v_max_f32 v14, v14, v15
v_max_f32 v15, v14, v15
s_nop 1
v_permlane16_swap_b32 v14, v15
v_max_f32 v14, v14, v15
v_mul_f32 v14, s48, v14
v_pk_fma_f32 v[20:21], v[20:21], s[32:33], v[14:15] op_sel_hi:[1,0,0]
v_pk_fma_f32 v[22:23], v[22:23], s[32:33], v[14:15] op_sel_hi:[1,0,0]
v_pk_fma_f32 v[24:25], v[24:25], s[32:33], v[14:15] op_sel_hi:[1,0,0]
v_pk_fma_f32 v[26:27], v[26:27], s[32:33], v[14:15] op_sel_hi:[1,0,0]
v_pk_fma_f32 v[76:77], v[76:77], s[32:33], v[14:15] op_sel_hi:[1,0,0]
v_exp_f32 v20, v20
v_exp_f32 v21, v21
v_exp_f32 v22, v22
v_exp_f32 v23, v23
v_exp_f32 v24, v24
v_exp_f32 v25, v25
v_exp_f32 v26, v26
v_exp_f32 v27, v27
v_cvt_pk_bf16_f32 v96, v20, v21
v_cvt_pk_bf16_f32 v97, v22, v23
v_cvt_pk_bf16_f32 v98, v24, v25
v_cvt_pk_bf16_f32 v99, v26, v27
v_exp_f32 v76, v76
s_waitcnt lgkmcnt(0)
v_mfma_f32_16x16x32_bf16 v[32:35], v[112:115], v[96:99], 0
v_exp_f32 v77, v77
v_mfma_f32_16x16x32_bf16 v[40:43], v[88:91], v[96:99], 0
v_cvt_pk_bf16_f32 v116, v76, v77
s_mov_b32 vcc_lo, 0xcccccccc
s_mov_b32 vcc_hi, 0xcccccccc
v_mfma_f32_16x16x32_bf16 v[32:35], v[112:115], v[116:119], v[32:35]
v_and_b32 v15, 255, v0
v_mfma_f32_16x16x32_bf16 v[40:43], v[124:127], v[116:119], v[40:43]
v_mfma_f32_16x16x32_bf16 v[44:47], v[92:95], v[96:99], 0
s_waitcnt vmcnt(0)
v_cmp_eq_u32 s[24:25], -1, v36
v_rcp_f32 v14, v32
L_Vok_reds:
v_mfma_f32_16x16x32_bf16 v[44:47], v[36:39], v[116:119], v[44:47]
s_nop 0
v_mul_f32 v50, v42, v14
v_mul_f32 v51, v43, v14
v_mul_f32 v48, v40, v14
v_mul_f32 v49, v41, v14
v_cvt_pk_bf16_f32 v50, v50, v51
v_cvt_pk_bf16_f32 v48, v48, v49
s_cmp_lg_u64 s[24:25], 0
s_cbranch_scc1 L_Vf_reds
v_cndmask_b32_dpp v48, v50, v48, vcc quad_perm:[2,3,2,3] row_mask:0xf bank_mask:0xf
v_pk_mul_f32 v[46:47], v[46:47], v[14:15] op_sel_hi:[1,0]
v_pk_mul_f32 v[44:45], v[44:45], v[14:15] op_sel_hi:[1,0]
v_cvt_pk_bf16_f32 v46, v46, v47
v_cvt_pk_bf16_f32 v44, v44, v45
ds_write_b32 v9, v48
s_nop 0
v_cndmask_b32_dpp v44, v46, v44, vcc quad_perm:[2,3,2,3] row_mask:0xf bank_mask:0xf
ds_write_b32 v16, v44
s_waitcnt lgkmcnt(0)
s_barrier
ds_read_b128 v[60:63], v0 offset:53248
ds_read_b128 v[64:67], v0 offset:54272
ds_read_b128 v[20:23], v15 offset:57344
s_add_u32 s22, s27, 0
s_add_u32 s23, s27, 8448
s_add_u32 s24, s27, 16896
s_add_u32 s25, s27, 25344
s_add_u32 s26, s27, 33792
s_waitcnt lgkmcnt(2)
v_smfmac_f32_16x16x64_bf16 v[72:75], v[60:63], v[128:135], v3
s_waitcnt lgkmcnt(1)
v_smfmac_f32_16x16x64_bf16 v[72:75], v[64:67], v[136:143], v3
v_smfmac_f32_16x16x64_bf16 v[28:31], v[60:63], v[144:151], v3
v_smfmac_f32_16x16x64_bf16 v[28:31], v[64:67], v[152:159], v3
v_smfmac_f32_16x16x64_bf16 v[80:83], v[60:63], v[160:167], v3
v_add_f32 v72, v72, v74
v_add_f32 v73, v73, v75
v_cvt_pk_bf16_f32 v72, v72, v73
v_smfmac_f32_16x16x64_bf16 v[80:83], v[64:67], v[168:175], v3
buffer_store_dword v72, v10, s[8:11], s22 offen sc1
v_smfmac_f32_16x16x64_bf16 v[84:87], v[60:63], v[176:183], v3
v_add_f32 v28, v28, v30
v_add_f32 v29, v29, v31
v_cvt_pk_bf16_f32 v28, v28, v29
v_smfmac_f32_16x16x64_bf16 v[84:87], v[64:67], v[184:191], v3
buffer_store_dword v28, v10, s[8:11], s23 offen sc1
v_smfmac_f32_16x16x64_bf16 v[52:55], v[60:63], v[192:199], v3
v_add_f32 v80, v80, v82
v_add_f32 v81, v81, v83
v_cvt_pk_bf16_f32 v80, v80, v81
v_smfmac_f32_16x16x64_bf16 v[52:55], v[64:67], v[200:207], v3
buffer_store_dword v80, v10, s[8:11], s24 offen sc1
v_add_f32 v84, v84, v86
v_add_f32 v85, v85, v87
v_cvt_pk_bf16_f32 v84, v84, v85
buffer_store_dword v84, v10, s[8:11], s25 offen sc1
s_nop 2
v_pk_add_f32 v[52:53], v[52:53], v[54:55]
v_cvt_pk_bf16_f32 v52, v52, v53
buffer_store_dword v52, v10, s[8:11], s26 offen sc1
s_add_u32 s50, s98, s47
s_addc_u32 s51, s99, 0
s_add_u32 s52, s100, s47
s_addc_u32 s53, s101, 0
s_mov_b32 s29, 0x100000
s_nop 11
buffer_load_dwordx4 v[40:43], v11, s[8:11], s27 offen offset:0 sc1
buffer_load_dwordx4 v[44:47], v11, s[8:11], s27 offen offset:1024 sc1
buffer_load_dwordx4 v[48:51], v11, s[8:11], s27 offen offset:2048 sc1
buffer_load_dwordx4 v[52:55], v11, s[8:11], s27 offen offset:3072 sc1
v_min_u32 v76, -2, v68
v_min_u32 v77, -2, v69
v_min_u32 v78, -2, v70
v_min_u32 v79, -2, v71
s_add_u32 s18, s18, 10240
s_addc_u32 s19, s19, 0
v_xor_b32 v7, 16384, v7
v_xor_b32 v8, 16384, v8
s_add_u32 s16, s16, s40
s_addc_u32 s17, s17, 0
s_xor_b32 s39, s39, 16384
s_sub_u32 s3, 0x200000, s40
s_mov_b32 s40, s41
s_mov_b32 s41, s3
s_add_u32 s34, s34, 262144
s_addc_u32 s35, s35, 0
s_add_u32 s98, s98, 32768
s_addc_u32 s99, s99, 0
s_add_u32 s100, s100, 32768
s_addc_u32 s101, s101, 0
s_add_u32 s15, s15, 1
buffer_load_dwordx4 v[40:43], v11, s[8:11], s27 offen offset:0 sc1
buffer_load_dwordx4 v[44:47], v11, s[8:11], s27 offen offset:1024 sc1
buffer_load_dwordx4 v[48:51], v11, s[8:11], s27 offen offset:2048 sc1
buffer_load_dwordx4 v[52:55], v11, s[8:11], s27 offen offset:3072 sc1
s_nop 15
s_nop 1
buffer_load_dwordx4 v[40:43], v11, s[8:11], s27 offen offset:0 sc1
buffer_load_dwordx4 v[44:47], v11, s[8:11], s27 offen offset:1024 sc1
buffer_load_dwordx4 v[48:51], v11, s[8:11], s27 offen offset:2048 sc1
buffer_load_dwordx4 v[52:55], v11, s[8:11], s27 offen offset:3072 sc1
s_waitcnt vmcnt(8) lgkmcnt(0)
L_red_ps:
v_mfma_f32_16x16x32_bf16 v[56:59], v[20:23], v[40:43], 0
buffer_load_dwordx4 v[40:43], v11, s[8:11], s27 offen offset:0 sc1
v_mfma_f32_16x16x32_bf16 v[56:59], v[20:23], v[44:47], v[56:59]
buffer_load_dwordx4 v[44:47], v11, s[8:11], s27 offen offset:1024 sc1
v_mfma_f32_16x16x32_bf16 v[56:59], v[20:23], v[48:51], v[56:59]
buffer_load_dwordx4 v[48:51], v11, s[8:11], s27 offen offset:2048 sc1
v_mfma_f32_16x16x32_bf16 v[56:59], v[20:23], v[52:55], v[56:59]
buffer_load_dwordx4 v[52:55], v11, s[8:11], s27 offen offset:3072 sc1
s_sub_u32 s29, s29, 1
s_and_b32 s3, s29, 63
s_cbranch_scc0 L_red_xs
s_waitcnt vmcnt(36)
s_nop 2
v_cmp_u_f32 vcc, v56, v57
v_add_f32_dpp v14, v56, v56 row_ror:8 row_mask:0xf bank_mask:0xf
v_add_f32_dpp v15, v57, v57 row_ror:8 row_mask:0xf bank_mask:0xf
v_cvt_pk_bf16_f32 v14, v14, v15
v_min_u32 v14, -2, v14
s_cbranch_vccnz L_red_ps
L_red_gos:
s_mov_b64 exec, s[30:31]
global_store_dword v12, v14, s[18:19] sc1
s_barrier
global_store_dword v12, v14, s[50:51] sc1
global_store_dword v12, v14, s[52:53] sc1
s_mov_b64 exec, -1
L_gates:
s_nop 3
ds_read_b128 v[80:83], v1 offset:0
ds_read_b128 v[84:87], v1 offset:1024
ds_read_b128 v[88:91], v1 offset:16384
ds_read_b128 v[92:95], v1 offset:17408
ds_read_b128 v[96:99], v2 offset:0
ds_read_b128 v[100:103], v2 offset:1024
ds_read_b128 v[104:107], v2 offset:16384
ds_read_b128 v[108:111], v2 offset:17408
v_mov_b64 v[20:21], 0
v_mov_b64 v[22:23], 0
v_mov_b64 v[24:25], 0
v_mov_b64 v[26:27], 0
v_mov_b64 v[28:29], 0
v_mov_b64 v[30:31], 0
v_mov_b64 v[32:33], 0
v_mov_b64 v[34:35], 0
v_mov_b64 v[36:37], 0
v_mov_b64 v[38:39], 0
s_branch L_loop_reds
L_kvpl_reds:
v_mov_b32 v15, 57600
ds_read_b128 v[20:23], v15
ds_read_b128 v[24:27], v15 offset:16
s_waitcnt lgkmcnt(0)
v_min_u32 v20, v20, v24
v_lshrrev_b32 v24, 4, v20
v_lshl_add_u32 v20, v24, 5, v20
v_lshl_add_u32 v20, v20, 1, 0
v_min_u32 v21, v21, v25
v_lshrrev_b32 v25, 4, v21
v_lshl_add_u32 v21, v25, 5, v21
v_lshl_add_u32 v21, v21, 1, 1
v_min_u32 v22, v22, v26
v_lshl_add_u32 v22, v22, 1, 32
v_min_u32 v23, v23, v27
v_lshl_add_u32 v23, v23, 1, 33
v_min3_u32 v20, v20, v21, v22
v_min_u32 v20, v20, v23
s_nop 0
v_readfirstlane_b32 s42, v20
v_mov_b64 v[20:21], 0
v_mov_b64 v[22:23], 0
v_mov_b64 v[24:25], 0
v_mov_b64 v[26:27], 0
s_cmp_gt_u32 s42, s3
s_cbranch_scc1 L_kvokl_reds
s_lshr_b32 s26, s13, 1
s_lshl_b32 s26, s26, 7
s_add_u32 s26, s26, 68158464
v_mov_b32 v14, s26
s_mov_b32 s29, 0x40000
L_kvw_5:
global_load_dwordx4 v[20:23], v14, s[4:5] sc1
global_load_dwordx4 v[24:27], v14, s[4:5] offset:16 sc1
s_waitcnt vmcnt(0)
v_min_u32 v20, v20, v24
v_lshrrev_b32 v24, 4, v20
v_lshl_add_u32 v20, v24, 5, v20
v_lshl_add_u32 v20, v20, 1, 0
v_min_u32 v21, v21, v25
v_lshrrev_b32 v25, 4, v21
v_lshl_add_u32 v21, v25, 5, v21
v_lshl_add_u32 v21, v21, 1, 1
v_min_u32 v22, v22, v26
v_lshl_add_u32 v22, v22, 1, 32
v_min_u32 v23, v23, v27
v_lshl_add_u32 v23, v23, 1, 33
v_min3_u32 v20, v20, v21, v22
v_min_u32 v20, v20, v23
s_nop 0
v_readfirstlane_b32 s42, v20
v_mov_b64 v[20:21], 0
v_mov_b64 v[22:23], 0
v_mov_b64 v[24:25], 0
v_mov_b64 v[26:27], 0
s_cmp_gt_u32 s42, s3
s_cbranch_scc1 L_kvokl_reds
s_sleep 2
s_sub_u32 s29, s29, 1
s_cbranch_scc0 L_kvw_5
s_branch L_abort
L_red_xs:
s_cmp_lt_i32 s29, 0
s_cbranch_scc1 L_abort
s_waitcnt vmcnt(0)
s_mov_b64 s[24:25], 0
v_cmp_eq_u32 vcc, s38, v40
s_nop 0
s_or_b64 s[24:25], s[24:25], vcc
v_cmp_eq_u32 vcc, s38, v41
s_nop 0
s_or_b64 s[24:25], s[24:25], vcc
v_cmp_eq_u32 vcc, s38, v42
s_nop 0
s_or_b64 s[24:25], s[24:25], vcc
v_cmp_eq_u32 vcc, s38, v43
s_nop 0
s_or_b64 s[24:25], s[24:25], vcc
v_cmp_eq_u32 vcc, s38, v44
s_nop 0
s_or_b64 s[24:25], s[24:25], vcc
v_cmp_eq_u32 vcc, s38, v45
s_nop 0
s_or_b64 s[24:25], s[24:25], vcc
v_cmp_eq_u32 vcc, s38, v46
s_nop 0
s_or_b64 s[24:25], s[24:25], vcc
v_cmp_eq_u32 vcc, s38, v47
s_nop 0
s_or_b64 s[24:25], s[24:25], vcc
v_cmp_eq_u32 vcc, s38, v48
s_nop 0
s_or_b64 s[24:25], s[24:25], vcc
v_cmp_eq_u32 vcc, s38, v49
s_nop 0
s_or_b64 s[24:25], s[24:25], vcc
v_cmp_eq_u32 vcc, s38, v50
s_nop 0
s_or_b64 s[24:25], s[24:25], vcc
v_cmp_eq_u32 vcc, s38, v51
s_nop 0
s_or_b64 s[24:25], s[24:25], vcc
v_cmp_eq_u32 vcc, s38, v52
s_nop 0
s_or_b64 s[24:25], s[24:25], vcc
v_cmp_eq_u32 vcc, s38, v53
s_nop 0
s_or_b64 s[24:25], s[24:25], vcc
v_cmp_eq_u32 vcc, s38, v54
s_nop 0
s_or_b64 s[24:25], s[24:25], vcc
v_cmp_eq_u32 vcc, s38, v55
s_nop 0
s_or_b64 s[24:25], s[24:25], vcc
s_mov_b64 vcc, -1
s_cbranch_scc1 L_red_ps
v_mfma_f32_16x16x32_bf16 v[56:59], v[20:23], v[40:43], 0
v_mfma_f32_16x16x32_bf16 v[56:59], v[20:23], v[44:47], v[56:59]
v_mfma_f32_16x16x32_bf16 v[56:59], v[20:23], v[48:51], v[56:59]
v_mfma_f32_16x16x32_bf16 v[56:59], v[20:23], v[52:55], v[56:59]
s_nop 7
v_add_f32_dpp v14, v56, v56 row_ror:8 row_mask:0xf bank_mask:0xf
v_add_f32_dpp v15, v57, v57 row_ror:8 row_mask:0xf bank_mask:0xf
v_cvt_pk_bf16_f32 v14, v14, v15
v_min_u32 v14, -2, v14
s_branch L_red_gos
L_Lf_reds:
s_waitcnt lgkmcnt(0)
s_sub_u32 s29, s29, 1
s_cbranch_scc1 L_abort
s_and_b32 s3, s29, 1
s_cbranch_scc1 L_Lq_reds
v_max3_u32 v116, v40, v41, v42
v_max_u32 v116, v116, v43
v_max3_u32 v116, v116, v44, v45
v_max3_u32 v116, v116, v46, v47
v_max3_u32 v116, v116, v48, v49
v_max3_u32 v116, v116, v50, v51
v_max3_u32 v116, v116, v52, v53
v_max3_u32 v116, v116, v54, v55
v_max3_u32 v116, v116, v56, v57
v_max3_u32 v116, v116, v58, v59
v_cmp_eq_u32 vcc, -1, v116
s_nop 0
s_cbranch_vccz L_Lok_reds
s_add_u32 m0, s45, 32768
s_nop 0
global_load_lds_dwordx4 v5, s[18:19] sc1
s_add_u32 m0, s46, 32768
s_nop 0
global_load_lds_dword v4, s[18:19] offset:2048 sc1
s_waitcnt vmcnt(0)
L_Lq_reds:
ds_read_b128 v[40:43], v0 offset:32768
ds_read_b128 v[44:47], v0 offset:33792
ds_read_b128 v[48:51], v0 offset:34816
ds_read_b128 v[52:55], v0 offset:35840
ds_read_b128 v[56:59], v0 offset:36864
s_nop 7
v_mov_b64 v[20:21], 0
v_mov_b64 v[22:23], 0
v_mov_b64 v[24:25], 0
v_mov_b64 v[26:27], 0
v_mov_b64 v[28:29], 0
v_mov_b64 v[30:31], 0
v_mov_b64 v[32:33], 0
v_mov_b64 v[34:35], 0
s_branch L_Lgo_reds
s_waitcnt lgkmcnt(0)
L_Rf_reds:
v_max3_u32 v116, v60, v61, v62
v_max_u32 v116, v116, v63
v_max3_u32 v116, v116, v64, v65
v_max3_u32 v116, v116, v66, v67
v_max3_u32 v116, v116, v68, v69
v_max3_u32 v116, v116, v70, v71
v_max3_u32 v116, v116, v72, v73
v_max3_u32 v116, v116, v74, v75
v_max3_u32 v116, v116, v76, v77
v_max3_u32 v116, v116, v78, v79
v_cmp_eq_u32 vcc, -1, v116
s_waitcnt vmcnt(3)
s_cbranch_vccz L_Rok_reds
L_Rp_reds:
s_barrier
ds_read_b128 v[60:63], v0 offset:43008
ds_read_b128 v[64:67], v0 offset:44032
ds_read_b128 v[68:71], v0 offset:45056
ds_read_b128 v[72:75], v0 offset:46080
ds_read_b128 v[76:79], v0 offset:47104
v_mov_b64 v[36:37], v[14:15]
v_mov_b64 v[38:39], 0
s_waitcnt lgkmcnt(4)
s_nop 0
v_smfmac_f32_16x16x64_bf16 v[36:39], v[60:63], v[80:87], v3
s_waitcnt lgkmcnt(3)
v_smfmac_f32_16x16x64_bf16 v[36:39], v[64:67], v[88:95], v3
s_waitcnt lgkmcnt(2)
v_smfmac_f32_16x16x64_bf16 v[36:39], v[68:71], v[96:103], v3
s_waitcnt lgkmcnt(1)
v_smfmac_f32_16x16x64_bf16 v[36:39], v[72:75], v[104:111], v3
s_waitcnt lgkmcnt(0)
v_smfmac_f32_16x16x64_bf16 v[36:39], v[76:79], v[40:47], v3
s_nop 7
v_add_f32 v36, v36, v38
v_add_f32 v37, v37, v39
v_cmp_u_f32 vcc, v36, v37
v_cvt_pk_bf16_f32 v36, v36, v37
v_min_u32 v124, -2, v36
s_cbranch_vccz L_Rok_reds
v_max3_u32 v116, v60, v61, v62
v_max_u32 v116, v116, v63
v_max3_u32 v116, v116, v64, v65
v_max3_u32 v116, v116, v66, v67
v_max3_u32 v116, v116, v68, v69
v_max3_u32 v116, v116, v70, v71
v_max3_u32 v116, v116, v72, v73
v_max3_u32 v116, v116, v74, v75
v_max3_u32 v116, v116, v76, v77
v_max3_u32 v116, v116, v78, v79
v_cmp_eq_u32 vcc, -1, v116
s_nop 0
s_cbranch_vccz L_Rok_reds
s_sub_u32 s29, s29, 1
s_cbranch_scc1 L_abort
s_barrier
s_add_u32 m0, s45, 43008
s_nop 0
global_load_lds_dwordx4 v5, s[52:53] sc1
s_add_u32 m0, s46, 43008
s_nop 0
global_load_lds_dword v4, s[52:53] offset:2048 sc1
s_waitcnt vmcnt(0)
s_branch L_Rp_reds
L_rs2_reds:
buffer_store_dwordx4 v[120:123], v5, s[8:11], s2 offen sc1
s_branch L_rs2d_reds
L_Vf_reds:
global_load_dword v36, v18, s[96:97] offset:-1024 sc1
s_sub_u32 s29, s29, 1
s_cbranch_scc1 L_abort
s_waitcnt vmcnt(0)
v_cmp_eq_u32 s[24:25], -1, v36
v_mfma_f32_16x16x32_bf16 v[44:47], v[92:95], v[96:99], 0
s_branch L_Vok_reds
s_waitcnt vmcnt(0) lgkmcnt(0)
L_enter_nrs:
s_mov_b32 s27, 675840
ds_read_b128 v[80:83], v1 offset:0
ds_read_b128 v[84:87], v1 offset:1024
ds_read_b128 v[88:91], v1 offset:16384
ds_read_b128 v[92:95], v1 offset:17408
ds_read_b128 v[96:99], v2 offset:0
ds_read_b128 v[100:103], v2 offset:1024
ds_read_b128 v[104:107], v2 offset:16384
ds_read_b128 v[108:111], v2 offset:17408
v_mov_b64 v[20:21], 0
v_mov_b64 v[22:23], 0
v_mov_b64 v[24:25], 0
v_mov_b64 v[26:27], 0
v_mov_b64 v[28:29], 0
v_mov_b64 v[30:31], 0
v_mov_b64 v[32:33], 0
v_mov_b64 v[34:35], 0
v_mov_b64 v[36:37], 0
v_mov_b64 v[38:39], 0
.p2align 6
L_loop_nrs:
s_add_u32 s2, s27, s49
s_add_u32 s27, s27, 337920
s_cmp_ge_u32 s27, 1013760
s_cselect_b32 s27, 0, s27
s_add_u32 s3, s15, 1
s_min_u32 s3, s3, 63
s_cmp_le_u32 s42, s3
s_cbranch_scc1 L_kvpl_nrs
s_nop 15
s_nop 3
L_kvokl_nrs:
s_add_u32 s50, s98, s44
s_addc_u32 s51, s99, 0
s_add_u32 s52, s100, s44
s_addc_u32 s53, s101, 0
s_mov_b32 s29, 0x40000
s_add_u32 m0, s45, 32768
s_nop 0
global_load_lds_dwordx4 v5, s[18:19] sc1
s_add_u32 m0, s46, 32768
s_nop 0
global_load_lds_dword v4, s[18:19] offset:2048 sc1
ds_read_b128 v[60:63], v2 offset:49152
ds_read_b128 v[64:67], v2 offset:50176
ds_read_b128 v[68:71], v2 offset:51200
ds_read_b128 v[72:75], v2 offset:52224
s_cmp_ge_u32 s15, 62
s_cselect_b32 s40, 0, s40
s_lshr_b32 s3, s15, 3
s_add_u32 s3, s3, 2
s_bitcmp1_b32 s43, s3
s_cselect_b32 s3, 8192, 0
s_mov_b64 s[96:97], s[20:21]
s_add_u32 s20, s34, s3
s_addc_u32 s21, s35, 0
v_xor_b32 v16, 4096, v8
s_nop 13
s_add_u32 m0, s45, 32768
s_nop 0
global_load_lds_dwordx4 v5, s[18:19] sc1
s_add_u32 m0, s46, 32768
s_nop 0
global_load_lds_dword v4, s[18:19] offset:2048 sc1
s_barrier
s_add_u32 m0, s45, 37888
s_nop 0
global_load_lds_dwordx4 v5, s[50:51] sc1
s_add_u32 m0, s46, 37888
s_nop 0
global_load_lds_dword v4, s[50:51] offset:2048 sc1
s_waitcnt lgkmcnt(0)
s_waitcnt vmcnt(4)
s_barrier
ds_read_b128 v[40:43], v0 offset:32768
ds_read_b128 v[44:47], v0 offset:33792
ds_read_b128 v[48:51], v0 offset:34816
ds_read_b128 v[52:55], v0 offset:35840
ds_read_b128 v[56:59], v0 offset:36864
s_add_u32 m0, s45, 43008
s_nop 0
global_load_lds_dwordx4 v5, s[52:53] sc1
s_add_u32 m0, s46, 43008
s_nop 0
global_load_lds_dword v4, s[52:53] offset:2048 sc1
L_Lgo_nrs:
s_waitcnt lgkmcnt(4)
v_smfmac_f32_16x16x64_bf16 v[20:23], v[40:43], a[160:167], v3
s_waitcnt lgkmcnt(3)
v_smfmac_f32_16x16x64_bf16 v[20:23], v[44:47], a[176:183], v3
s_waitcnt lgkmcnt(2)
v_smfmac_f32_16x16x64_bf16 v[20:23], v[48:51], a[208:215], v3
s_waitcnt lgkmcnt(1)
v_smfmac_f32_16x16x64_bf16 v[20:23], v[52:55], a[240:247], v3
s_waitcnt lgkmcnt(0)
v_smfmac_f32_16x16x64_bf16 v[20:23], v[56:59], v[224:231], v3
v_smfmac_f32_16x16x64_bf16 v[28:31], v[40:43], v[60:67], v3
v_smfmac_f32_16x16x64_bf16 v[32:35], v[40:43], v[68:75], v3
s_nop 0
v_cmp_u_f32 vcc, v20, v21
v_cmp_u_f32 s[24:25], v22, v23
v_smfmac_f32_16x16x64_bf16 v[24:27], v[40:43], a[168:175], v3
v_smfmac_f32_16x16x64_bf16 v[24:27], v[44:47], a[184:191], v3
s_or_b64 vcc, vcc, s[24:25]
s_cbranch_scc1 L_Lf_nrs
L_Lok_nrs:
s_mov_b32 m0, s39
v_smfmac_f32_16x16x64_bf16 v[36:39], v[40:43], v[80:87], v3
ds_read_b128 v[80:83], v2 offset:32768
v_smfmac_f32_16x16x64_bf16 v[36:39], v[44:47], v[88:95], v3
ds_read_b128 v[84:87], v2 offset:33792
global_load_lds_dwordx4 v0, s[16:17] offset:0 sc1
v_smfmac_f32_16x16x64_bf16 v[36:39], v[48:51], v[96:103], v3
ds_read_b128 v[88:91], v1 offset:18432
v_smfmac_f32_16x16x64_bf16 v[36:39], v[52:55], v[104:111], v3
ds_read_b128 v[92:95], v1 offset:19456
s_mov_b64 exec, s[36:37]
global_store_dwordx4 v13, v[76:79], s[96:97] sc1
s_mov_b64 exec, -1
v_smfmac_f32_16x16x64_bf16 v[28:31], v[44:47], a[192:199], v3
ds_read_b128 v[96:99], v2 offset:2048
v_smfmac_f32_16x16x64_bf16 v[32:35], v[44:47], a[200:207], v3
ds_read_b128 v[100:103], v2 offset:3072
global_load_lds_dwordx4 v0, s[16:17] offset:1024 sc1
v_smfmac_f32_16x16x64_bf16 v[24:27], v[48:51], a[216:223], v3
ds_read_b128 v[104:107], v2 offset:18432
s_waitcnt lgkmcnt(5)
v_smfmac_f32_16x16x64_bf16 v[36:39], v[56:59], v[80:87], v3
ds_read_b128 v[108:111], v2 offset:19456
v_smfmac_f32_16x16x64_bf16 v[28:31], v[48:51], a[224:231], v3
ds_read_b128 v[40:43], v2 offset:34816
v_smfmac_f32_16x16x64_bf16 v[32:35], v[48:51], a[232:239], v3
ds_read_b128 v[44:47], v2 offset:35840
v_smfmac_f32_16x16x64_bf16 v[24:27], v[52:55], a[248:255], v3
ds_read_b128 v[80:83], v1 offset:2048
s_add_u32 s96, s20, s1
s_addc_u32 s97, s21, 0
v_smfmac_f32_16x16x64_bf16 v[24:27], v[56:59], v[232:239], v3
ds_read_b128 v[84:87], v1 offset:3072
v_smfmac_f32_16x16x64_bf16 v[28:31], v[52:55], v[208:215], v3
s_waitcnt vmcnt(5)
s_barrier
ds_read_b128 v[60:63], v0 offset:37888
ds_read_b128 v[64:67], v0 offset:38912
ds_read_b128 v[68:71], v0 offset:39936
ds_read_b128 v[72:75], v0 offset:40960
ds_read_b128 v[76:79], v0 offset:41984
v_add_f32 v14, v36, v38
v_add_f32 v15, v37, v39
s_waitcnt lgkmcnt(4)
v_smfmac_f32_16x16x64_bf16 v[36:39], v[60:63], v[80:87], v3
s_waitcnt lgkmcnt(3)
v_smfmac_f32_16x16x64_bf16 v[36:39], v[64:67], v[88:95], v3
s_waitcnt lgkmcnt(2)
v_smfmac_f32_16x16x64_bf16 v[36:39], v[68:71], v[96:103], v3
s_waitcnt lgkmcnt(1)
v_smfmac_f32_16x16x64_bf16 v[36:39], v[72:75], v[104:111], v3
s_waitcnt lgkmcnt(0)
v_smfmac_f32_16x16x64_bf16 v[36:39], v[76:79], v[40:47], v3
v_smfmac_f32_16x16x64_bf16 v[32:35], v[52:55], v[216:223], v3
v_smfmac_f32_16x16x64_bf16 v[28:31], v[56:59], v[240:247], v3
s_nop 0
v_add_f32 v36, v36, v38
v_add_f32 v37, v37, v39
v_cmp_u_f32 vcc, v36, v37
v_cvt_pk_bf16_f32 v36, v36, v37
v_min_u32 v124, -2, v36
v_smfmac_f32_16x16x64_bf16 v[32:35], v[56:59], v[248:255], v3
s_cbranch_vccnz L_Rf_nrs
L_Rok_nrs:
global_store_dword v18, v124, s[20:21] sc1
v_smfmac_f32_16x16x64_bf16 v[20:23], v[60:63], a[0:7], v3
s_mov_b32 m0, s39
ds_read_b128 v[80:83], v7 offset:0
v_smfmac_f32_16x16x64_bf16 v[20:23], v[64:67], a[32:39], v3
ds_read_b128 v[84:87], v7 offset:4096
v_smfmac_f32_16x16x64_bf16 v[20:23], v[68:71], a[64:71], v3
global_load_lds_dwordx4 v0, s[16:17] offset:2048 sc1
ds_read_b128 v[88:91], v7 offset:1024
v_smfmac_f32_16x16x64_bf16 v[20:23], v[72:75], a[96:103], v3
v_add_u32 v15, s0, v19
ds_read_b128 v[92:95], v7 offset:5120
v_smfmac_f32_16x16x64_bf16 v[20:23], v[76:79], a[128:135], v3
ds_read_b128 v[96:99], v7 offset:2048
v_smfmac_f32_16x16x64_bf16 v[24:27], v[60:63], a[8:15], v3
global_load_lds_dwordx4 v0, s[16:17] offset:3072 sc1
ds_read_b128 v[100:103], v7 offset:6144
v_smfmac_f32_16x16x64_bf16 v[24:27], v[64:67], a[40:47], v3
v_smfmac_f32_16x16x64_bf16 v[24:27], v[68:71], a[72:79], v3
v_add_f32 v20, v20, v22
v_add_f32 v21, v21, v23
v_cvt_pk_bf16_f32 v20, v20, v21
v_smfmac_f32_16x16x64_bf16 v[24:27], v[72:75], a[104:111], v3
ds_write_b16 v6, v20 offset:32
v_smfmac_f32_16x16x64_bf16 v[24:27], v[76:79], a[136:143], v3
buffer_store_dwordx4 v[120:123], v5, s[8:11], s2 offen sc1
s_add_u32 s2, s2, 135168
ds_write_b16_d16_hi v6, v20 offset:48
v_smfmac_f32_16x16x64_bf16 v[28:31], v[60:63], a[16:23], v3
ds_read_b128 v[104:107], v7 offset:3072
v_smfmac_f32_16x16x64_bf16 v[28:31], v[64:67], a[48:55], v3
ds_read_b128 v[108:111], v7 offset:7168
v_smfmac_f32_16x16x64_bf16 v[28:31], v[68:71], a[80:87], v3
v_add_f32 v24, v24, v26
v_add_f32 v25, v25, v27
v_cvt_pk_bf16_f32 v24, v24, v25
ds_write_b16 v6, v24 offset:40
v_smfmac_f32_16x16x64_bf16 v[28:31], v[72:75], a[112:119], v3
s_cmp_lt_u32 s13, 8
s_cbranch_scc1 L_rs2_nrs
L_rs2d_nrs:
ds_write_b16_d16_hi v6, v24 offset:56
v_smfmac_f32_16x16x64_bf16 v[28:31], v[76:79], a[144:151], v3
v_smfmac_f32_16x16x64_bf16 v[32:35], v[60:63], a[24:31], v3
v_smfmac_f32_16x16x64_bf16 v[32:35], v[64:67], a[56:63], v3
v_smfmac_f32_16x16x64_bf16 v[32:35], v[68:71], a[88:95], v3
s_waitcnt lgkmcnt(0)
s_barrier
ds_read_b128 v[40:43], v19 offset:0
ds_read_b128 v[44:47], v19 offset:1088
ds_read_b128 v[48:51], v19 offset:2176
ds_read_b128 v[52:55], v19 offset:3264
ds_read_b128 v[56:59], v15
v_add_f32 v28, v28, v30
v_add_f32 v29, v29, v31
v_cvt_pk_bf16_f32 v116, v28, v29
v_smfmac_f32_16x16x64_bf16 v[32:35], v[72:75], a[120:127], v3
v_smfmac_f32_16x16x64_bf16 v[32:35], v[76:79], a[152:159], v3
v_mfma_f32_16x16x32_bf16 v[60:63], v[116:119], v[126:129], 0
v_mov_b32 v37, 0
v_mov_b64 v[38:39], 0
s_waitcnt lgkmcnt(4)
v_mfma_f32_16x16x32_bf16 v[20:23], v[80:83], v[40:43], 0
s_nop 0
v_add_f32 v32, v32, v34
v_add_f32 v33, v33, v35
v_cvt_pk_bf16_f32 v116, v32, v33
v_cvt_pk_bf16_f32 v68, v60, v61
v_cvt_pk_bf16_f32 v69, v62, v63
v_mfma_f32_16x16x32_bf16 v[64:67], v[116:119], v[126:129], 0
global_load_dword v36, v18, s[96:97] offset:-1024 sc1
v_mfma_f32_16x16x32_bf16 v[24:27], v[84:87], v[40:43], 0
v_mov_b64 v[72:73], 0
v_mov_b64 v[74:75], 0
s_waitcnt lgkmcnt(0)
v_mfma_f32_16x16x32_bf16 v[20:23], v[88:91], v[44:47], v[20:23]
s_nop 0
v_cvt_pk_bf16_f32 v70, v64, v65
v_cvt_pk_bf16_f32 v71, v66, v67
s_cmp_eq_u32 s15, 63
s_cbranch_scc1 L_end
v_mfma_f32_16x16x32_bf16 v[76:79], v[68:71], v[56:59], 0
v_mfma_f32_16x16x32_bf16 v[24:27], v[92:95], v[44:47], v[24:27]
v_mov_b64 v[28:29], 0
v_mov_b64 v[30:31], 0
v_mfma_f32_16x16x32_bf16 v[20:23], v[96:99], v[48:51], v[20:23]
s_nop 0
ds_write_b64 v17, v[76:77] offset:62464
v_mfma_f32_16x16x32_bf16 v[24:27], v[100:103], v[48:51], v[24:27]
ds_read_b128 v[88:91], v8
ds_read_b128 v[92:95], v16
v_mov_b64 v[80:81], 0
v_mov_b64 v[82:83], 0
v_mfma_f32_16x16x32_bf16 v[20:23], v[104:107], v[52:55], v[20:23]
v_mov_b64 v[84:85], 0
v_mov_b64 v[86:87], 0
v_mfma_f32_16x16x32_bf16 v[24:27], v[108:111], v[52:55], v[24:27]
s_waitcnt lgkmcnt(2)
s_barrier
ds_read_b128 v[60:63], v0 offset:62464
ds_read_b128 v[64:67], v0 offset:63488
s_nop 0
v_max3_f32 v14, v20, v21, v22
s_nop 1
v_max3_f32 v15, v23, v24, v25
v_max3_f32 v14, v14, v26, v27
v_max_f32 v14, v14, v15
v_xor_b32 v16, 1024, v9
s_waitcnt lgkmcnt(1)
v_pk_add_f32 v[60:61], v[60:61], v[62:63]
s_waitcnt lgkmcnt(0)
v_pk_add_f32 v[64:65], v[64:65], v[66:67]
v_pk_add_f32 v[76:77], v[60:61], v[64:65]
v_max3_f32 v15, v14, v76, v77
v_max3_f32 v14, v14, v76, v77
v_mov_b64 v[52:53], 0
v_mov_b64 v[54:55], 0
v_permlane32_swap_b32 v14, v15
v_max_f32 v14, v14, v15
v_max_f32 v15, v14, v15
s_nop 1
v_permlane16_swap_b32 v14, v15
v_max_f32 v14, v14, v15
v_mul_f32 v14, s48, v14
v_pk_fma_f32 v[20:21], v[20:21], s[32:33], v[14:15] op_sel_hi:[1,0,0]
v_pk_fma_f32 v[22:23], v[22:23], s[32:33], v[14:15] op_sel_hi:[1,0,0]
v_pk_fma_f32 v[24:25], v[24:25], s[32:33], v[14:15] op_sel_hi:[1,0,0]
v_pk_fma_f32 v[26:27], v[26:27], s[32:33], v[14:15] op_sel_hi:[1,0,0]
v_pk_fma_f32 v[76:77], v[76:77], s[32:33], v[14:15] op_sel_hi:[1,0,0]
v_exp_f32 v20, v20
v_exp_f32 v21, v21
v_exp_f32 v22, v22
v_exp_f32 v23, v23
v_exp_f32 v24, v24
v_exp_f32 v25, v25
v_exp_f32 v26, v26
v_exp_f32 v27, v27
v_cvt_pk_bf16_f32 v96, v20, v21
v_cvt_pk_bf16_f32 v97, v22, v23
v_cvt_pk_bf16_f32 v98, v24, v25
v_cvt_pk_bf16_f32 v99, v26, v27
v_exp_f32 v76, v76
s_waitcnt lgkmcnt(0)
v_mfma_f32_16x16x32_bf16 v[32:35], v[112:115], v[96:99], 0
v_exp_f32 v77, v77
v_mfma_f32_16x16x32_bf16 v[40:43], v[88:91], v[96:99], 0
v_cvt_pk_bf16_f32 v116, v76, v77
s_mov_b32 vcc_lo, 0xcccccccc
s_mov_b32 vcc_hi, 0xcccccccc
v_mfma_f32_16x16x32_bf16 v[32:35], v[112:115], v[116:119], v[32:35]
v_mfma_f32_16x16x32_bf16 v[40:43], v[124:127], v[116:119], v[40:43]
v_mfma_f32_16x16x32_bf16 v[44:47], v[92:95], v[96:99], 0
s_waitcnt vmcnt(0)
v_cmp_eq_u32 s[24:25], -1, v36
v_rcp_f32 v14, v32
L_Vok_nrs:
v_mfma_f32_16x16x32_bf16 v[44:47], v[36:39], v[116:119], v[44:47]
s_nop 0
v_mul_f32 v50, v42, v14
v_mul_f32 v51, v43, v14
v_mul_f32 v48, v40, v14
v_mul_f32 v49, v41, v14
v_cvt_pk_bf16_f32 v50, v50, v51
v_cvt_pk_bf16_f32 v48, v48, v49
s_cmp_lg_u64 s[24:25], 0
s_cbranch_scc1 L_Vf_nrs
v_cndmask_b32_dpp v48, v50, v48, vcc quad_perm:[2,3,2,3] row_mask:0xf bank_mask:0xf
v_pk_mul_f32 v[46:47], v[46:47], v[14:15] op_sel_hi:[1,0]
v_pk_mul_f32 v[44:45], v[44:45], v[14:15] op_sel_hi:[1,0]
v_cvt_pk_bf16_f32 v46, v46, v47
v_cvt_pk_bf16_f32 v44, v44, v45
ds_write_b32 v9, v48
s_nop 0
v_cndmask_b32_dpp v44, v46, v44, vcc quad_perm:[2,3,2,3] row_mask:0xf bank_mask:0xf
ds_write_b32 v16, v44
s_waitcnt lgkmcnt(0)
s_barrier
ds_read_b128 v[60:63], v0 offset:53248
ds_read_b128 v[64:67], v0 offset:54272
s_add_u32 s22, s27, 0
s_add_u32 s23, s27, 8448
s_add_u32 s24, s27, 16896
s_add_u32 s25, s27, 25344
s_add_u32 s26, s27, 33792
s_waitcnt lgkmcnt(1)
v_smfmac_f32_16x16x64_bf16 v[72:75], v[60:63], v[128:135], v3
s_waitcnt lgkmcnt(0)
v_smfmac_f32_16x16x64_bf16 v[72:75], v[64:67], v[136:143], v3
v_smfmac_f32_16x16x64_bf16 v[28:31], v[60:63], v[144:151], v3
v_smfmac_f32_16x16x64_bf16 v[28:31], v[64:67], v[152:159], v3
v_smfmac_f32_16x16x64_bf16 v[80:83], v[60:63], v[160:167], v3
v_add_f32 v72, v72, v74
v_add_f32 v73, v73, v75
v_cvt_pk_bf16_f32 v72, v72, v73
v_smfmac_f32_16x16x64_bf16 v[80:83], v[64:67], v[168:175], v3
buffer_store_dword v72, v10, s[8:11], s22 offen sc1
v_smfmac_f32_16x16x64_bf16 v[84:87], v[60:63], v[176:183], v3
v_add_f32 v28, v28, v30
v_add_f32 v29, v29, v31
v_cvt_pk_bf16_f32 v28, v28, v29
v_smfmac_f32_16x16x64_bf16 v[84:87], v[64:67], v[184:191], v3
buffer_store_dword v28, v10, s[8:11], s23 offen sc1
v_smfmac_f32_16x16x64_bf16 v[52:55], v[60:63], v[192:199], v3
v_add_f32 v80, v80, v82
v_add_f32 v81, v81, v83
v_cvt_pk_bf16_f32 v80, v80, v81
v_smfmac_f32_16x16x64_bf16 v[52:55], v[64:67], v[200:207], v3
buffer_store_dword v80, v10, s[8:11], s24 offen sc1
v_add_f32 v84, v84, v86
v_add_f32 v85, v85, v87
v_cvt_pk_bf16_f32 v84, v84, v85
buffer_store_dword v84, v10, s[8:11], s25 offen sc1
s_nop 2
v_pk_add_f32 v[52:53], v[52:53], v[54:55]
v_cvt_pk_bf16_f32 v52, v52, v53
buffer_store_dword v52, v10, s[8:11], s26 offen sc1
s_waitcnt vmcnt(0)
s_barrier
v_min_u32 v76, -2, v68
v_min_u32 v77, -2, v69
v_min_u32 v78, -2, v70
v_min_u32 v79, -2, v71
s_add_u32 s18, s18, 10240
s_addc_u32 s19, s19, 0
v_xor_b32 v7, 16384, v7
v_xor_b32 v8, 16384, v8
s_add_u32 s16, s16, s40
s_addc_u32 s17, s17, 0
s_xor_b32 s39, s39, 16384
s_sub_u32 s3, 0x200000, s40
s_mov_b32 s40, s41
s_mov_b32 s41, s3
s_add_u32 s34, s34, 262144
s_addc_u32 s35, s35, 0
s_add_u32 s98, s98, 32768
s_addc_u32 s99, s99, 0
s_add_u32 s100, s100, 32768
s_addc_u32 s101, s101, 0
s_add_u32 s15, s15, 1
ds_read_b128 v[80:83], v1 offset:0
ds_read_b128 v[84:87], v1 offset:1024
ds_read_b128 v[88:91], v1 offset:16384
ds_read_b128 v[92:95], v1 offset:17408
ds_read_b128 v[96:99], v2 offset:0
ds_read_b128 v[100:103], v2 offset:1024
ds_read_b128 v[104:107], v2 offset:16384
ds_read_b128 v[108:111], v2 offset:17408
v_mov_b64 v[20:21], 0
v_mov_b64 v[22:23], 0
v_mov_b64 v[24:25], 0
v_mov_b64 v[26:27], 0
v_mov_b64 v[28:29], 0
v_mov_b64 v[30:31], 0
v_mov_b64 v[32:33], 0
v_mov_b64 v[34:35], 0
v_mov_b64 v[36:37], 0
v_mov_b64 v[38:39], 0
s_branch L_loop_nrs
L_kvpl_nrs:
v_mov_b32 v15, 57600
ds_read_b128 v[20:23], v15
ds_read_b128 v[24:27], v15 offset:16
s_waitcnt lgkmcnt(0)
v_min_u32 v20, v20, v24
v_lshrrev_b32 v24, 4, v20
v_lshl_add_u32 v20, v24, 5, v20
v_lshl_add_u32 v20, v20, 1, 0
v_min_u32 v21, v21, v25
v_lshrrev_b32 v25, 4, v21
v_lshl_add_u32 v21, v25, 5, v21
v_lshl_add_u32 v21, v21, 1, 1
v_min_u32 v22, v22, v26
v_lshl_add_u32 v22, v22, 1, 32
v_min_u32 v23, v23, v27
v_lshl_add_u32 v23, v23, 1, 33
v_min3_u32 v20, v20, v21, v22
v_min_u32 v20, v20, v23
s_nop 0
v_readfirstlane_b32 s42, v20
v_mov_b64 v[20:21], 0
v_mov_b64 v[22:23], 0
v_mov_b64 v[24:25], 0
v_mov_b64 v[26:27], 0
s_cmp_gt_u32 s42, s3
s_cbranch_scc1 L_kvokl_nrs
s_lshr_b32 s26, s13, 1
s_lshl_b32 s26, s26, 7
s_add_u32 s26, s26, 68158464
v_mov_b32 v14, s26
s_mov_b32 s29, 0x40000
L_kvw_6:
global_load_dwordx4 v[20:23], v14, s[4:5] sc1
global_load_dwordx4 v[24:27], v14, s[4:5] offset:16 sc1
s_waitcnt vmcnt(0)
v_min_u32 v20, v20, v24
v_lshrrev_b32 v24, 4, v20
v_lshl_add_u32 v20, v24, 5, v20
v_lshl_add_u32 v20, v20, 1, 0
v_min_u32 v21, v21, v25
v_lshrrev_b32 v25, 4, v21
v_lshl_add_u32 v21, v25, 5, v21
v_lshl_add_u32 v21, v21, 1, 1
v_min_u32 v22, v22, v26
v_lshl_add_u32 v22, v22, 1, 32
v_min_u32 v23, v23, v27
v_lshl_add_u32 v23, v23, 1, 33
v_min3_u32 v20, v20, v21, v22
v_min_u32 v20, v20, v23
s_nop 0
v_readfirstlane_b32 s42, v20
v_mov_b64 v[20:21], 0
v_mov_b64 v[22:23], 0
v_mov_b64 v[24:25], 0
v_mov_b64 v[26:27], 0
s_cmp_gt_u32 s42, s3
s_cbranch_scc1 L_kvokl_nrs
s_sleep 2
s_sub_u32 s29, s29, 1
s_cbranch_scc0 L_kvw_6
s_branch L_abort
L_Lf_nrs:
s_waitcnt lgkmcnt(0)
s_sub_u32 s29, s29, 1
s_cbranch_scc1 L_abort
s_and_b32 s3, s29, 1
s_cbranch_scc1 L_Lq_nrs
v_max3_u32 v116, v40, v41, v42
v_max_u32 v116, v116, v43
v_max3_u32 v116, v116, v44, v45
v_max3_u32 v116, v116, v46, v47
v_max3_u32 v116, v116, v48, v49
v_max3_u32 v116, v116, v50, v51
v_max3_u32 v116, v116, v52, v53
v_max3_u32 v116, v116, v54, v55
v_max3_u32 v116, v116, v56, v57
v_max3_u32 v116, v116, v58, v59
v_cmp_eq_u32 vcc, -1, v116
s_nop 0
s_cbranch_vccz L_Lok_nrs
s_add_u32 m0, s45, 32768
s_nop 0
global_load_lds_dwordx4 v5, s[18:19] sc1
s_add_u32 m0, s46, 32768
s_nop 0
global_load_lds_dword v4, s[18:19] offset:2048 sc1
s_waitcnt vmcnt(0)
L_Lq_nrs:
ds_read_b128 v[40:43], v0 offset:32768
ds_read_b128 v[44:47], v0 offset:33792
ds_read_b128 v[48:51], v0 offset:34816
ds_read_b128 v[52:55], v0 offset:35840
ds_read_b128 v[56:59], v0 offset:36864
s_nop 7
v_mov_b64 v[20:21], 0
v_mov_b64 v[22:23], 0
v_mov_b64 v[24:25], 0
v_mov_b64 v[26:27], 0
v_mov_b64 v[28:29], 0
v_mov_b64 v[30:31], 0
v_mov_b64 v[32:33], 0
v_mov_b64 v[34:35], 0
s_branch L_Lgo_nrs
s_waitcnt lgkmcnt(0)
L_Rf_nrs:
v_max3_u32 v116, v60, v61, v62
v_max_u32 v116, v116, v63
v_max3_u32 v116, v116, v64, v65
v_max3_u32 v116, v116, v66, v67
v_max3_u32 v116, v116, v68, v69
v_max3_u32 v116, v116, v70, v71
v_max3_u32 v116, v116, v72, v73
v_max3_u32 v116, v116, v74, v75
v_max3_u32 v116, v116, v76, v77
v_max3_u32 v116, v116, v78, v79
v_cmp_eq_u32 vcc, -1, v116
s_waitcnt vmcnt(3)
s_cbranch_vccz L_Rok_nrs
L_Rp_nrs:
s_barrier
ds_read_b128 v[60:63], v0 offset:43008
ds_read_b128 v[64:67], v0 offset:44032
ds_read_b128 v[68:71], v0 offset:45056
ds_read_b128 v[72:75], v0 offset:46080
ds_read_b128 v[76:79], v0 offset:47104
v_mov_b64 v[36:37], v[14:15]
v_mov_b64 v[38:39], 0
s_waitcnt lgkmcnt(4)
s_nop 0
v_smfmac_f32_16x16x64_bf16 v[36:39], v[60:63], v[80:87], v3
s_waitcnt lgkmcnt(3)
v_smfmac_f32_16x16x64_bf16 v[36:39], v[64:67], v[88:95], v3
s_waitcnt lgkmcnt(2)
v_smfmac_f32_16x16x64_bf16 v[36:39], v[68:71], v[96:103], v3
s_waitcnt lgkmcnt(1)
v_smfmac_f32_16x16x64_bf16 v[36:39], v[72:75], v[104:111], v3
s_waitcnt lgkmcnt(0)
v_smfmac_f32_16x16x64_bf16 v[36:39], v[76:79], v[40:47], v3
s_nop 7
v_add_f32 v36, v36, v38
v_add_f32 v37, v37, v39
v_cmp_u_f32 vcc, v36, v37
v_cvt_pk_bf16_f32 v36, v36, v37
v_min_u32 v124, -2, v36
s_cbranch_vccz L_Rok_nrs
v_max3_u32 v116, v60, v61, v62
v_max_u32 v116, v116, v63
v_max3_u32 v116, v116, v64, v65
v_max3_u32 v116, v116, v66, v67
v_max3_u32 v116, v116, v68, v69
v_max3_u32 v116, v116, v70, v71
v_max3_u32 v116, v116, v72, v73
v_max3_u32 v116, v116, v74, v75
v_max3_u32 v116, v116, v76, v77
v_max3_u32 v116, v116, v78, v79
v_cmp_eq_u32 vcc, -1, v116
s_nop 0
s_cbranch_vccz L_Rok_nrs
s_sub_u32 s29, s29, 1
s_cbranch_scc1 L_abort
s_barrier
s_add_u32 m0, s45, 43008
s_nop 0
global_load_lds_dwordx4 v5, s[52:53] sc1
s_add_u32 m0, s46, 43008
s_nop 0
global_load_lds_dword v4, s[52:53] offset:2048 sc1
s_waitcnt vmcnt(0)
s_branch L_Rp_nrs
L_rs2_nrs:
buffer_store_dwordx4 v[120:123], v5, s[8:11], s2 offen sc1
s_branch L_rs2d_nrs
L_Vf_nrs:
global_load_dword v36, v18, s[96:97] offset:-1024 sc1
s_sub_u32 s29, s29, 1
s_cbranch_scc1 L_abort
s_waitcnt vmcnt(0)
v_cmp_eq_u32 s[24:25], -1, v36
v_mfma_f32_16x16x32_bf16 v[44:47], v[92:95], v[96:99], 0
s_branch L_Vok_nrs
s_waitcnt vmcnt(0) lgkmcnt(0)
L_enter_w3s:
s_mov_b32 s27, 675840
ds_read_b128 v[80:83], v1 offset:0
ds_read_b128 v[84:87], v1 offset:1024
ds_read_b128 v[88:91], v1 offset:16384
ds_read_b128 v[92:95], v1 offset:17408
ds_read_b128 v[96:99], v2 offset:0
ds_read_b128 v[100:103], v2 offset:1024
ds_read_b128 v[104:107], v2 offset:16384
ds_read_b128 v[108:111], v2 offset:17408
v_mov_b64 v[20:21], 0
v_mov_b64 v[22:23], 0
v_mov_b64 v[24:25], 0
v_mov_b64 v[26:27], 0
v_mov_b64 v[28:29], 0
v_mov_b64 v[30:31], 0
v_mov_b64 v[32:33], 0
v_mov_b64 v[34:35], 0
v_mov_b64 v[36:37], 0
v_mov_b64 v[38:39], 0
.p2align 6
L_loop_w3s:
s_add_u32 s2, s27, s49
s_add_u32 s27, s27, 337920
s_cmp_ge_u32 s27, 1013760
s_cselect_b32 s27, 0, s27
s_add_u32 s3, s15, 1
s_min_u32 s3, s3, 63
s_cmp_le_u32 s42, s3
s_cbranch_scc1 L_kvpl_w3s
s_nop 15
s_nop 3
L_kvokl_w3s:
s_add_u32 s50, s98, s44
s_addc_u32 s51, s99, 0
s_add_u32 s52, s100, s44
s_addc_u32 s53, s101, 0
s_mov_b32 s29, 0x40000
s_add_u32 m0, s45, 32768
s_nop 0
global_load_lds_dwordx4 v5, s[18:19] sc1
s_add_u32 m0, s46, 32768
s_nop 0
global_load_lds_dword v4, s[18:19] offset:2048 sc1
ds_read_b128 v[60:63], v2 offset:49152
ds_read_b128 v[64:67], v2 offset:50176
ds_read_b128 v[68:71], v2 offset:51200
ds_read_b128 v[72:75], v2 offset:52224
s_cmp_ge_u32 s15, 62
s_cselect_b32 s40, 0, s40
s_lshr_b32 s3, s15, 3
s_add_u32 s3, s3, 2
s_bitcmp1_b32 s43, s3
s_cselect_b32 s3, 8192, 0
s_mov_b64 s[96:97], s[20:21]
s_add_u32 s20, s34, s3
s_addc_u32 s21, s35, 0
v_xor_b32 v16, 4096, v8
s_nop 13
s_add_u32 m0, s45, 32768
s_nop 0
global_load_lds_dwordx4 v5, s[18:19] sc1
s_add_u32 m0, s46, 32768
s_nop 0
global_load_lds_dword v4, s[18:19] offset:2048 sc1
s_barrier
s_add_u32 m0, s45, 37888
s_nop 0
global_load_lds_dwordx4 v5, s[50:51] sc1
s_add_u32 m0, s46, 37888
s_nop 0
global_load_lds_dword v4, s[50:51] offset:2048 sc1
s_waitcnt lgkmcnt(0)
s_waitcnt vmcnt(4)
s_barrier
ds_read_b128 v[40:43], v0 offset:32768
ds_read_b128 v[44:47], v0 offset:33792
ds_read_b128 v[48:51], v0 offset:34816
ds_read_b128 v[52:55], v0 offset:35840
ds_read_b128 v[56:59], v0 offset:36864
s_add_u32 m0, s45, 43008
s_nop 0
global_load_lds_dwordx4 v5, s[52:53] sc1
s_add_u32 m0, s46, 43008
s_nop 0
global_load_lds_dword v4, s[52:53] offset:2048 sc1
L_Lgo_w3s:
s_waitcnt lgkmcnt(4)
v_smfmac_f32_16x16x64_bf16 v[20:23], v[40:43], a[160:167], v3
s_waitcnt lgkmcnt(3)
v_smfmac_f32_16x16x64_bf16 v[20:23], v[44:47], a[176:183], v3
s_waitcnt lgkmcnt(2)
v_smfmac_f32_16x16x64_bf16 v[20:23], v[48:51], a[208:215], v3
s_waitcnt lgkmcnt(1)
v_smfmac_f32_16x16x64_bf16 v[20:23], v[52:55], a[240:247], v3
s_waitcnt lgkmcnt(0)
v_smfmac_f32_16x16x64_bf16 v[20:23], v[56:59], v[224:231], v3
v_smfmac_f32_16x16x64_bf16 v[28:31], v[40:43], v[60:67], v3
v_smfmac_f32_16x16x64_bf16 v[32:35], v[40:43], v[68:75], v3
s_nop 0
v_cmp_u_f32 vcc, v20, v21
v_cmp_u_f32 s[24:25], v22, v23
v_smfmac_f32_16x16x64_bf16 v[24:27], v[40:43], a[168:175], v3
v_smfmac_f32_16x16x64_bf16 v[24:27], v[44:47], a[184:191], v3
s_or_b64 vcc, vcc, s[24:25]
s_cbranch_scc1 L_Lf_w3s
L_Lok_w3s:
s_mov_b32 m0, s39
v_smfmac_f32_16x16x64_bf16 v[36:39], v[40:43], v[80:87], v3
ds_read_b128 v[80:83], v2 offset:32768
v_smfmac_f32_16x16x64_bf16 v[36:39], v[44:47], v[88:95], v3
ds_read_b128 v[84:87], v2 offset:33792
global_load_lds_dwordx4 v0, s[16:17] offset:0 sc1
v_smfmac_f32_16x16x64_bf16 v[36:39], v[48:51], v[96:103], v3
ds_read_b128 v[88:91], v1 offset:18432
v_smfmac_f32_16x16x64_bf16 v[36:39], v[52:55], v[104:111], v3
ds_read_b128 v[92:95], v1 offset:19456
s_mov_b64 exec, s[36:37]
global_store_dwordx4 v13, v[76:79], s[96:97] sc1
s_mov_b64 exec, -1
v_smfmac_f32_16x16x64_bf16 v[28:31], v[44:47], a[192:199], v3
ds_read_b128 v[96:99], v2 offset:2048
v_smfmac_f32_16x16x64_bf16 v[32:35], v[44:47], a[200:207], v3
ds_read_b128 v[100:103], v2 offset:3072
global_load_lds_dwordx4 v0, s[16:17] offset:1024 sc1
v_smfmac_f32_16x16x64_bf16 v[24:27], v[48:51], a[216:223], v3
ds_read_b128 v[104:107], v2 offset:18432
s_waitcnt lgkmcnt(5)
v_smfmac_f32_16x16x64_bf16 v[36:39], v[56:59], v[80:87], v3
ds_read_b128 v[108:111], v2 offset:19456
s_mov_b32 m0, 56064
s_nop 0
global_load_lds_dword v12, s[18:19] sc1
s_mov_b32 m0, 57600
s_nop 0
global_load_lds_dword v11, s[4:5] sc1
s_mov_b32 m0, s39
v_smfmac_f32_16x16x64_bf16 v[28:31], v[48:51], a[224:231], v3
ds_read_b128 v[40:43], v2 offset:34816
v_smfmac_f32_16x16x64_bf16 v[32:35], v[48:51], a[232:239], v3
ds_read_b128 v[44:47], v2 offset:35840
v_smfmac_f32_16x16x64_bf16 v[24:27], v[52:55], a[248:255], v3
ds_read_b128 v[80:83], v1 offset:2048
s_add_u32 s96, s20, s1
s_addc_u32 s97, s21, 0
v_smfmac_f32_16x16x64_bf16 v[24:27], v[56:59], v[232:239], v3
ds_read_b128 v[84:87], v1 offset:3072
v_smfmac_f32_16x16x64_bf16 v[28:31], v[52:55], v[208:215], v3
s_waitcnt vmcnt(7)
s_barrier
ds_read_b128 v[60:63], v0 offset:37888
ds_read_b128 v[64:67], v0 offset:38912
ds_read_b128 v[68:71], v0 offset:39936
ds_read_b128 v[72:75], v0 offset:40960
ds_read_b128 v[76:79], v0 offset:41984
v_add_f32 v14, v36, v38
v_add_f32 v15, v37, v39
s_waitcnt lgkmcnt(4)
v_smfmac_f32_16x16x64_bf16 v[36:39], v[60:63], v[80:87], v3
s_waitcnt lgkmcnt(3)
v_smfmac_f32_16x16x64_bf16 v[36:39], v[64:67], v[88:95], v3
s_waitcnt lgkmcnt(2)
v_smfmac_f32_16x16x64_bf16 v[36:39], v[68:71], v[96:103], v3
s_waitcnt lgkmcnt(1)
v_smfmac_f32_16x16x64_bf16 v[36:39], v[72:75], v[104:111], v3
s_waitcnt lgkmcnt(0)
v_smfmac_f32_16x16x64_bf16 v[36:39], v[76:79], v[40:47], v3
v_smfmac_f32_16x16x64_bf16 v[32:35], v[52:55], v[216:223], v3
v_smfmac_f32_16x16x64_bf16 v[28:31], v[56:59], v[240:247], v3
s_nop 0
v_add_f32 v36, v36, v38
v_add_f32 v37, v37, v39
v_cmp_u_f32 vcc, v36, v37
v_cvt_pk_bf16_f32 v36, v36, v37
v_min_u32 v124, -2, v36
v_smfmac_f32_16x16x64_bf16 v[32:35], v[56:59], v[248:255], v3
s_cbranch_vccnz L_Rf_w3s
L_Rok_w3s:
global_store_dword v18, v124, s[20:21] sc1
v_smfmac_f32_16x16x64_bf16 v[20:23], v[60:63], a[0:7], v3
s_mov_b32 m0, s39
ds_read_b128 v[80:83], v7 offset:0
v_smfmac_f32_16x16x64_bf16 v[20:23], v[64:67], a[32:39], v3
ds_read_b128 v[84:87], v7 offset:4096
v_smfmac_f32_16x16x64_bf16 v[20:23], v[68:71], a[64:71], v3
global_load_lds_dwordx4 v0, s[16:17] offset:2048 sc1
ds_read_b128 v[88:91], v7 offset:1024
v_smfmac_f32_16x16x64_bf16 v[20:23], v[72:75], a[96:103], v3
v_add_u32 v15, s0, v19
ds_read_b128 v[92:95], v7 offset:5120
v_smfmac_f32_16x16x64_bf16 v[20:23], v[76:79], a[128:135], v3
ds_read_b128 v[96:99], v7 offset:2048
v_smfmac_f32_16x16x64_bf16 v[24:27], v[60:63], a[8:15], v3
global_load_lds_dwordx4 v0, s[16:17] offset:3072 sc1
ds_read_b128 v[100:103], v7 offset:6144
v_smfmac_f32_16x16x64_bf16 v[24:27], v[64:67], a[40:47], v3
v_smfmac_f32_16x16x64_bf16 v[24:27], v[68:71], a[72:79], v3
v_add_f32 v20, v20, v22
v_add_f32 v21, v21, v23
v_cvt_pk_bf16_f32 v20, v20, v21
v_smfmac_f32_16x16x64_bf16 v[24:27], v[72:75], a[104:111], v3
ds_write_b16 v6, v20 offset:32
v_smfmac_f32_16x16x64_bf16 v[24:27], v[76:79], a[136:143], v3
ds_write_b16_d16_hi v6, v20 offset:48
v_smfmac_f32_16x16x64_bf16 v[28:31], v[60:63], a[16:23], v3
ds_read_b128 v[104:107], v7 offset:3072
v_smfmac_f32_16x16x64_bf16 v[28:31], v[64:67], a[48:55], v3
buffer_store_dwordx4 v[120:123], v5, s[8:11], s2 offen sc1
s_add_u32 s2, s2, 135168
ds_read_b128 v[108:111], v7 offset:7168
v_smfmac_f32_16x16x64_bf16 v[28:31], v[68:71], a[80:87], v3
v_add_f32 v24, v24, v26
v_add_f32 v25, v25, v27
v_cvt_pk_bf16_f32 v24, v24, v25
ds_write_b16 v6, v24 offset:40
v_smfmac_f32_16x16x64_bf16 v[28:31], v[72:75], a[112:119], v3
ds_write_b16_d16_hi v6, v24 offset:56
v_smfmac_f32_16x16x64_bf16 v[28:31], v[76:79], a[144:151], v3
s_cmp_lt_u32 s13, 8
s_cbranch_scc1 L_rs2_w3s
L_rs2d_w3s:
v_smfmac_f32_16x16x64_bf16 v[32:35], v[60:63], a[24:31], v3
v_smfmac_f32_16x16x64_bf16 v[32:35], v[64:67], a[56:63], v3
v_smfmac_f32_16x16x64_bf16 v[32:35], v[68:71], a[88:95], v3
s_waitcnt lgkmcnt(0)
s_barrier
ds_read_b128 v[40:43], v19 offset:0
ds_read_b128 v[44:47], v19 offset:1088
ds_read_b128 v[48:51], v19 offset:2176
ds_read_b128 v[52:55], v19 offset:3264
ds_read_b128 v[56:59], v15
v_add_f32 v28, v28, v30
v_add_f32 v29, v29, v31
v_cvt_pk_bf16_f32 v116, v28, v29
v_smfmac_f32_16x16x64_bf16 v[32:35], v[72:75], a[120:127], v3
v_smfmac_f32_16x16x64_bf16 v[32:35], v[76:79], a[152:159], v3
v_mfma_f32_16x16x32_bf16 v[60:63], v[116:119], v[126:129], 0
v_mov_b32 v37, 0
v_mov_b64 v[38:39], 0
s_waitcnt lgkmcnt(4)
v_mfma_f32_16x16x32_bf16 v[20:23], v[80:83], v[40:43], 0
s_nop 0
v_add_f32 v32, v32, v34
v_add_f32 v33, v33, v35
v_cvt_pk_bf16_f32 v116, v32, v33
v_cvt_pk_bf16_f32 v68, v60, v61
v_cvt_pk_bf16_f32 v69, v62, v63
v_mfma_f32_16x16x32_bf16 v[64:67], v[116:119], v[126:129], 0
global_load_dword v36, v18, s[96:97] offset:-1024 sc1
v_mfma_f32_16x16x32_bf16 v[24:27], v[84:87], v[40:43], 0
v_mov_b64 v[72:73], 0
v_mov_b64 v[74:75], 0
s_waitcnt lgkmcnt(0)
v_mfma_f32_16x16x32_bf16 v[20:23], v[88:91], v[44:47], v[20:23]
s_nop 0
v_cvt_pk_bf16_f32 v70, v64, v65
v_cvt_pk_bf16_f32 v71, v66, v67
s_cmp_eq_u32 s15, 63
s_cbranch_scc1 L_end
v_mfma_f32_16x16x32_bf16 v[76:79], v[68:71], v[56:59], 0
v_mfma_f32_16x16x32_bf16 v[24:27], v[92:95], v[44:47], v[24:27]
v_mov_b64 v[28:29], 0
v_mov_b64 v[30:31], 0
v_mfma_f32_16x16x32_bf16 v[20:23], v[96:99], v[48:51], v[20:23]
s_nop 0
ds_write_b64 v17, v[76:77] offset:62464
v_mfma_f32_16x16x32_bf16 v[24:27], v[100:103], v[48:51], v[24:27]
ds_read_b128 v[88:91], v8
ds_read_b128 v[92:95], v16
v_mov_b64 v[80:81], 0
v_mov_b64 v[82:83], 0
v_mfma_f32_16x16x32_bf16 v[20:23], v[104:107], v[52:55], v[20:23]
v_mov_b64 v[84:85], 0
v_mov_b64 v[86:87], 0
v_mfma_f32_16x16x32_bf16 v[24:27], v[108:111], v[52:55], v[24:27]
s_waitcnt lgkmcnt(2)
s_barrier
ds_read_b128 v[60:63], v0 offset:62464
ds_read_b128 v[64:67], v0 offset:63488
s_nop 0
v_max3_f32 v14, v20, v21, v22
s_nop 1
v_max3_f32 v15, v23, v24, v25
v_max3_f32 v14, v14, v26, v27
v_max_f32 v14, v14, v15
v_xor_b32 v16, 1024, v9
s_waitcnt lgkmcnt(1)
v_pk_add_f32 v[60:61], v[60:61], v[62:63]
s_waitcnt lgkmcnt(0)
v_pk_add_f32 v[64:65], v[64:65], v[66:67]
v_pk_add_f32 v[76:77], v[60:61], v[64:65]
v_max3_f32 v15, v14, v76, v77
v_max3_f32 v14, v14, v76, v77
v_mov_b64 v[52:53], 0
v_mov_b64 v[54:55], 0
v_permlane32_swap_b32 v14, v15
v_max_f32 v14, v14, v15
v_max_f32 v15, v14, v15
s_nop 1
v_permlane16_swap_b32 v14, v15
v_max_f32 v14, v14, v15
v_mul_f32 v14, s48, v14
v_pk_fma_f32 v[20:21], v[20:21], s[32:33], v[14:15] op_sel_hi:[1,0,0]
v_pk_fma_f32 v[22:23], v[22:23], s[32:33], v[14:15] op_sel_hi:[1,0,0]
v_pk_fma_f32 v[24:25], v[24:25], s[32:33], v[14:15] op_sel_hi:[1,0,0]
v_pk_fma_f32 v[26:27], v[26:27], s[32:33], v[14:15] op_sel_hi:[1,0,0]
v_pk_fma_f32 v[76:77], v[76:77], s[32:33], v[14:15] op_sel_hi:[1,0,0]
v_exp_f32 v20, v20
v_exp_f32 v21, v21
v_exp_f32 v22, v22
v_exp_f32 v23, v23
v_exp_f32 v24, v24
v_exp_f32 v25, v25
v_exp_f32 v26, v26
v_exp_f32 v27, v27
v_cvt_pk_bf16_f32 v96, v20, v21
v_cvt_pk_bf16_f32 v97, v22, v23
v_cvt_pk_bf16_f32 v98, v24, v25
v_cvt_pk_bf16_f32 v99, v26, v27
v_exp_f32 v76, v76
s_waitcnt lgkmcnt(0)
v_mfma_f32_16x16x32_bf16 v[32:35], v[112:115], v[96:99], 0
v_exp_f32 v77, v77
v_mfma_f32_16x16x32_bf16 v[40:43], v[88:91], v[96:99], 0
v_cvt_pk_bf16_f32 v116, v76, v77
s_mov_b32 vcc_lo, 0xcccccccc
s_mov_b32 vcc_hi, 0xcccccccc
v_mfma_f32_16x16x32_bf16 v[32:35], v[112:115], v[116:119], v[32:35]
v_mfma_f32_16x16x32_bf16 v[40:43], v[124:127], v[116:119], v[40:43]
v_mfma_f32_16x16x32_bf16 v[44:47], v[92:95], v[96:99], 0
s_waitcnt vmcnt(0)
v_cmp_eq_u32 s[24:25], -1, v36
v_rcp_f32 v14, v32
L_Vok_w3s:
v_mfma_f32_16x16x32_bf16 v[44:47], v[36:39], v[116:119], v[44:47]
s_nop 0
v_mul_f32 v50, v42, v14
v_mul_f32 v51, v43, v14
v_mul_f32 v48, v40, v14
v_mul_f32 v49, v41, v14
v_cvt_pk_bf16_f32 v50, v50, v51
v_cvt_pk_bf16_f32 v48, v48, v49
s_cmp_lg_u64 s[24:25], 0
s_cbranch_scc1 L_Vf_w3s
v_cndmask_b32_dpp v48, v50, v48, vcc quad_perm:[2,3,2,3] row_mask:0xf bank_mask:0xf
v_pk_mul_f32 v[46:47], v[46:47], v[14:15] op_sel_hi:[1,0]
v_pk_mul_f32 v[44:45], v[44:45], v[14:15] op_sel_hi:[1,0]
v_cvt_pk_bf16_f32 v46, v46, v47
v_cvt_pk_bf16_f32 v44, v44, v45
ds_write_b32 v9, v48
s_nop 0
v_cndmask_b32_dpp v44, v46, v44, vcc quad_perm:[2,3,2,3] row_mask:0xf bank_mask:0xf
ds_write_b32 v16, v44
s_waitcnt lgkmcnt(0)
s_barrier
ds_read_b128 v[60:63], v0 offset:53248
ds_read_b128 v[64:67], v0 offset:54272
s_add_u32 s22, s27, 0
s_add_u32 s23, s27, 8448
s_add_u32 s24, s27, 16896
s_add_u32 s25, s27, 25344
s_add_u32 s26, s27, 33792
s_waitcnt lgkmcnt(1)
v_smfmac_f32_16x16x64_bf16 v[72:75], v[60:63], v[128:135], v3
s_waitcnt lgkmcnt(0)
v_smfmac_f32_16x16x64_bf16 v[72:75], v[64:67], v[136:143], v3
v_smfmac_f32_16x16x64_bf16 v[28:31], v[60:63], v[144:151], v3
v_smfmac_f32_16x16x64_bf16 v[28:31], v[64:67], v[152:159], v3
v_smfmac_f32_16x16x64_bf16 v[80:83], v[60:63], v[160:167], v3
v_add_f32 v72, v72, v74
v_add_f32 v73, v73, v75
v_cvt_pk_bf16_f32 v72, v72, v73
v_smfmac_f32_16x16x64_bf16 v[80:83], v[64:67], v[168:175], v3
buffer_store_dword v72, v10, s[8:11], s22 offen sc1
v_smfmac_f32_16x16x64_bf16 v[84:87], v[60:63], v[176:183], v3
v_add_f32 v28, v28, v30
v_add_f32 v29, v29, v31
v_cvt_pk_bf16_f32 v28, v28, v29
v_smfmac_f32_16x16x64_bf16 v[84:87], v[64:67], v[184:191], v3
buffer_store_dword v28, v10, s[8:11], s23 offen sc1
v_smfmac_f32_16x16x64_bf16 v[52:55], v[60:63], v[192:199], v3
v_add_f32 v80, v80, v82
v_add_f32 v81, v81, v83
v_cvt_pk_bf16_f32 v80, v80, v81
v_smfmac_f32_16x16x64_bf16 v[52:55], v[64:67], v[200:207], v3
buffer_store_dword v80, v10, s[8:11], s24 offen sc1
v_add_f32 v84, v84, v86
v_add_f32 v85, v85, v87
v_cvt_pk_bf16_f32 v84, v84, v85
buffer_store_dword v84, v10, s[8:11], s25 offen sc1
s_nop 2
v_pk_add_f32 v[52:53], v[52:53], v[54:55]
v_cvt_pk_bf16_f32 v52, v52, v53
buffer_store_dword v52, v10, s[8:11], s26 offen sc1
s_waitcnt vmcnt(0)
s_barrier
v_min_u32 v76, -2, v68
v_min_u32 v77, -2, v69
v_min_u32 v78, -2, v70
v_min_u32 v79, -2, v71
s_add_u32 s18, s18, 10240
s_addc_u32 s19, s19, 0
v_xor_b32 v7, 16384, v7
v_xor_b32 v8, 16384, v8
s_add_u32 s16, s16, s40
s_addc_u32 s17, s17, 0
s_xor_b32 s39, s39, 16384
s_sub_u32 s3, 0x200000, s40
s_mov_b32 s40, s41
s_mov_b32 s41, s3
s_add_u32 s34, s34, 262144
s_addc_u32 s35, s35, 0
s_add_u32 s98, s98, 32768
s_addc_u32 s99, s99, 0
s_add_u32 s100, s100, 32768
s_addc_u32 s101, s101, 0
s_add_u32 s15, s15, 1
ds_read_b128 v[80:83], v1 offset:0
ds_read_b128 v[84:87], v1 offset:1024
ds_read_b128 v[88:91], v1 offset:16384
ds_read_b128 v[92:95], v1 offset:17408
ds_read_b128 v[96:99], v2 offset:0
ds_read_b128 v[100:103], v2 offset:1024
ds_read_b128 v[104:107], v2 offset:16384
ds_read_b128 v[108:111], v2 offset:17408
v_mov_b64 v[20:21], 0
v_mov_b64 v[22:23], 0
v_mov_b64 v[24:25], 0
v_mov_b64 v[26:27], 0
v_mov_b64 v[28:29], 0
v_mov_b64 v[30:31], 0
v_mov_b64 v[32:33], 0
v_mov_b64 v[34:35], 0
v_mov_b64 v[36:37], 0
v_mov_b64 v[38:39], 0
s_branch L_loop_w3s
L_kvpl_w3s:
v_mov_b32 v15, 57600
ds_read_b128 v[20:23], v15
ds_read_b128 v[24:27], v15 offset:16
s_waitcnt lgkmcnt(0)
v_min_u32 v20, v20, v24
v_lshrrev_b32 v24, 4, v20
v_lshl_add_u32 v20, v24, 5, v20
v_lshl_add_u32 v20, v20, 1, 0
v_min_u32 v21, v21, v25
v_lshrrev_b32 v25, 4, v21
v_lshl_add_u32 v21, v25, 5, v21
v_lshl_add_u32 v21, v21, 1, 1
v_min_u32 v22, v22, v26
v_lshl_add_u32 v22, v22, 1, 32
v_min_u32 v23, v23, v27
v_lshl_add_u32 v23, v23, 1, 33
v_min3_u32 v20, v20, v21, v22
v_min_u32 v20, v20, v23
s_nop 0
v_readfirstlane_b32 s42, v20
v_mov_b64 v[20:21], 0
v_mov_b64 v[22:23], 0
v_mov_b64 v[24:25], 0
v_mov_b64 v[26:27], 0
s_cmp_gt_u32 s42, s3
s_cbranch_scc1 L_kvokl_w3s
s_lshr_b32 s26, s13, 1
s_lshl_b32 s26, s26, 7
s_add_u32 s26, s26, 68158464
v_mov_b32 v14, s26
s_mov_b32 s29, 0x40000
L_kvw_7:
global_load_dwordx4 v[20:23], v14, s[4:5] sc1
global_load_dwordx4 v[24:27], v14, s[4:5] offset:16 sc1
s_waitcnt vmcnt(0)
v_min_u32 v20, v20, v24
v_lshrrev_b32 v24, 4, v20
v_lshl_add_u32 v20, v24, 5, v20
v_lshl_add_u32 v20, v20, 1, 0
v_min_u32 v21, v21, v25
v_lshrrev_b32 v25, 4, v21
v_lshl_add_u32 v21, v25, 5, v21
v_lshl_add_u32 v21, v21, 1, 1
v_min_u32 v22, v22, v26
v_lshl_add_u32 v22, v22, 1, 32
v_min_u32 v23, v23, v27
v_lshl_add_u32 v23, v23, 1, 33
v_min3_u32 v20, v20, v21, v22
v_min_u32 v20, v20, v23
s_nop 0
v_readfirstlane_b32 s42, v20
v_mov_b64 v[20:21], 0
v_mov_b64 v[22:23], 0
v_mov_b64 v[24:25], 0
v_mov_b64 v[26:27], 0
s_cmp_gt_u32 s42, s3
s_cbranch_scc1 L_kvokl_w3s
s_sleep 2
s_sub_u32 s29, s29, 1
s_cbranch_scc0 L_kvw_7
s_branch L_abort
L_Lf_w3s:
s_waitcnt lgkmcnt(0)
s_sub_u32 s29, s29, 1
s_cbranch_scc1 L_abort
s_and_b32 s3, s29, 1
s_cbranch_scc1 L_Lq_w3s
v_max3_u32 v116, v40, v41, v42
v_max_u32 v116, v116, v43
v_max3_u32 v116, v116, v44, v45
v_max3_u32 v116, v116, v46, v47
v_max3_u32 v116, v116, v48, v49
v_max3_u32 v116, v116, v50, v51
v_max3_u32 v116, v116, v52, v53
v_max3_u32 v116, v116, v54, v55
v_max3_u32 v116, v116, v56, v57
v_max3_u32 v116, v116, v58, v59
v_cmp_eq_u32 vcc, -1, v116
s_nop 0
s_cbranch_vccz L_Lok_w3s
s_add_u32 m0, s45, 32768
s_nop 0
global_load_lds_dwordx4 v5, s[18:19] sc1
s_add_u32 m0, s46, 32768
s_nop 0
global_load_lds_dword v4, s[18:19] offset:2048 sc1
s_waitcnt vmcnt(0)
L_Lq_w3s:
ds_read_b128 v[40:43], v0 offset:32768
ds_read_b128 v[44:47], v0 offset:33792
ds_read_b128 v[48:51], v0 offset:34816
ds_read_b128 v[52:55], v0 offset:35840
ds_read_b128 v[56:59], v0 offset:36864
s_nop 7
v_mov_b64 v[20:21], 0
v_mov_b64 v[22:23], 0
v_mov_b64 v[24:25], 0
v_mov_b64 v[26:27], 0
v_mov_b64 v[28:29], 0
v_mov_b64 v[30:31], 0
v_mov_b64 v[32:33], 0
v_mov_b64 v[34:35], 0
s_branch L_Lgo_w3s
s_waitcnt lgkmcnt(0)
L_Rf_w3s:
v_max3_u32 v116, v60, v61, v62
v_max_u32 v116, v116, v63
v_max3_u32 v116, v116, v64, v65
v_max3_u32 v116, v116, v66, v67
v_max3_u32 v116, v116, v68, v69
v_max3_u32 v116, v116, v70, v71
v_max3_u32 v116, v116, v72, v73
v_max3_u32 v116, v116, v74, v75
v_max3_u32 v116, v116, v76, v77
v_max3_u32 v116, v116, v78, v79
v_cmp_eq_u32 vcc, -1, v116
s_waitcnt vmcnt(5)
s_cbranch_vccz L_Rok_w3s
L_Rp_w3s:
s_barrier
ds_read_b128 v[60:63], v0 offset:43008
ds_read_b128 v[64:67], v0 offset:44032
ds_read_b128 v[68:71], v0 offset:45056
ds_read_b128 v[72:75], v0 offset:46080
ds_read_b128 v[76:79], v0 offset:47104
v_mov_b64 v[36:37], v[14:15]
v_mov_b64 v[38:39], 0
s_waitcnt lgkmcnt(4)
s_nop 0
v_smfmac_f32_16x16x64_bf16 v[36:39], v[60:63], v[80:87], v3
s_waitcnt lgkmcnt(3)
v_smfmac_f32_16x16x64_bf16 v[36:39], v[64:67], v[88:95], v3
s_waitcnt lgkmcnt(2)
v_smfmac_f32_16x16x64_bf16 v[36:39], v[68:71], v[96:103], v3
s_waitcnt lgkmcnt(1)
v_smfmac_f32_16x16x64_bf16 v[36:39], v[72:75], v[104:111], v3
s_waitcnt lgkmcnt(0)
v_smfmac_f32_16x16x64_bf16 v[36:39], v[76:79], v[40:47], v3
s_nop 7
v_add_f32 v36, v36, v38
v_add_f32 v37, v37, v39
v_cmp_u_f32 vcc, v36, v37
v_cvt_pk_bf16_f32 v36, v36, v37
v_min_u32 v124, -2, v36
s_cbranch_vccz L_Rok_w3s
v_max3_u32 v116, v60, v61, v62
v_max_u32 v116, v116, v63
v_max3_u32 v116, v116, v64, v65
v_max3_u32 v116, v116, v66, v67
v_max3_u32 v116, v116, v68, v69
v_max3_u32 v116, v116, v70, v71
v_max3_u32 v116, v116, v72, v73
v_max3_u32 v116, v116, v74, v75
v_max3_u32 v116, v116, v76, v77
v_max3_u32 v116, v116, v78, v79
v_cmp_eq_u32 vcc, -1, v116
s_nop 0
s_cbranch_vccz L_Rok_w3s
s_sub_u32 s29, s29, 1
s_cbranch_scc1 L_abort
s_barrier
s_add_u32 m0, s45, 43008
s_nop 0
global_load_lds_dwordx4 v5, s[52:53] sc1
s_add_u32 m0, s46, 43008
s_nop 0
global_load_lds_dword v4, s[52:53] offset:2048 sc1
s_waitcnt vmcnt(0)
s_branch L_Rp_w3s
L_rs2_w3s:
buffer_store_dwordx4 v[120:123], v5, s[8:11], s2 offen sc1
s_branch L_rs2d_w3s
L_Vf_w3s:
global_load_dword v36, v18, s[96:97] offset:-1024 sc1
s_sub_u32 s29, s29, 1
s_cbranch_scc1 L_abort
s_waitcnt vmcnt(0)
v_cmp_eq_u32 s[24:25], -1, v36
v_mfma_f32_16x16x32_bf16 v[44:47], v[92:95], v[96:99], 0
s_branch L_Vok_w3s
s_waitcnt vmcnt(0) lgkmcnt(0)
L_abort:
s_waitcnt vmcnt(0)
v_mov_b32 v62, 192
v_mov_b32 v63, 1
s_mov_b64 exec, 1
global_atomic_add v62, v63, s[6:7]
s_endpgm
L_end:
v_min_u32 v68, -2, v68
v_min_u32 v69, -2, v69
v_min_u32 v70, -2, v70
v_min_u32 v71, -2, v71
s_mov_b64 exec, s[36:37]
global_store_dwordx4 v13, v[68:71], s[20:21] sc1
s_mov_b64 exec, -1
L_exit:
s_endpgm
L_worker:
s_mov_b32 s90, s13
s_mov_b64 s[8:9], s[4:5]
s_mov_b64 s[94:95], s[6:7]
s_sub_u32 s3, s90, 40
s_cmp_ge_u32 s3, 24
s_cbranch_scc1 L_nofill
s_sub_u32 s13, s90, 40
v_lshlrev_b32 v2, 4, v0
v_mov_b32 v4, -1
v_mov_b32 v8, 0xffbfffbf
v_mov_b32 v12, 0
v_mov_b32 v5, -1
v_mov_b32 v9, 0xffbfffbf
v_mov_b32 v13, 0
v_mov_b32 v6, -1
v_mov_b32 v10, 0xffbfffbf
v_mov_b32 v14, 0
v_mov_b32 v7, -1
v_mov_b32 v11, 0xffbfffbf
v_mov_b32 v15, 0
s_mov_b32 s16, s8
s_mov_b32 s17, s9
s_mov_b32 s19, 0x20000
s_mov_b32 s18, 68169728
s_mul_i32 s3, s13, 4096
s_add_u32 s3, s3, 68157440
buffer_store_dwordx4 v[12:15], v2, s[16:19], s3 offen sc1
s_waitcnt vmcnt(0)
s_barrier
s_cmp_lg_u32 s12, 3
s_cbranch_scc1 L_sg_8
s_mov_b64 exec, 1
v_mov_b32 v16, 12
v_mov_b32 v17, 1
global_atomic_add v17, v16, v17, s[94:95] sc0
s_waitcnt vmcnt(0)
v_cmp_ne_u32 vcc, 63, v17
s_nop 0
s_cbranch_vccnz L_ar_9
v_mov_b32 v17, 1
global_store_dword v16, v17, s[94:95] offset:128 sc1
L_ar_9:
s_mov_b64 exec, -1
L_sg_8:
s_cmp_ge_u32 s13, 10
s_cbranch_scc1 L_nom0
s_load_dwordx2 s[4:5], s[0:1], 8
s_cmp_ge_u32 s13, 5
s_cselect_b32 s14, 1, 0
s_mul_i32 s3, s14, 5
s_sub_u32 s15, s13, s3
v_bfe_u32 v18, v0, 4, 2
v_bfe_u32 v19, v0, 2, 1
v_lshl_add_u32 v18, v18, 1, v19
v_mul_u32_u24 v18, 1280, v18
v_lshrrev_b32 v19, 6, v0
v_lshl_add_u32 v18, v19, 5, v18
v_and_b32 v19, 3, v0
v_lshl_add_u32 v18, v19, 3, v18
v_bfe_u32 v19, v0, 3, 1
v_lshl_add_u32 v18, v19, 2, v18
s_lshl_b32 s3, s13, 7
v_add_u32 v18, s3, v18
s_waitcnt lgkmcnt(0)
global_load_dword v20, v18, s[4:5]
v_lshlrev_b32 v18, 2, v0
s_lshl_b32 s20, s13, 10
s_add_u32 s20, s20, 60817408
s_lshl_b32 s21, s15, 10
s_lshl_b32 s3, s14, 14
s_add_u32 s21, s21, s3
s_mov_b32 s18, 0x10000000
s_waitcnt vmcnt(0)
v_min_u32 v20, -2, v20
buffer_store_dword v20, v18, s[16:19], s20 offen sc1
s_add_u32 s3, s21, 69206016
buffer_store_dword v20, v18, s[16:19], s3 offen sc1
s_add_u32 s3, s21, 69214208
buffer_store_dword v20, v18, s[16:19], s3 offen sc1
s_add_u32 s3, s21, 71303168
buffer_store_dword v20, v18, s[16:19], s3 offen sc1
s_add_u32 s3, s21, 71311360
buffer_store_dword v20, v18, s[16:19], s3 offen sc1
s_waitcnt vmcnt(0)
s_barrier
s_cmp_lg_u32 s12, 3
s_cbranch_scc1 L_sg_10
s_mov_b64 exec, 1
v_mov_b32 v16, 64
v_mov_b32 v17, 1
global_atomic_add v17, v16, v17, s[94:95] sc0
s_waitcnt vmcnt(0)
v_cmp_ne_u32 vcc, 137, v17
s_nop 0
s_cbranch_vccnz L_ar_11
v_mov_b32 v17, 1
global_store_dword v16, v17, s[94:95] offset:64 sc1
L_ar_11:
s_mov_b64 exec, -1
L_sg_10:
L_nom0:
s_sub_u32 s14, s13, 10
s_cmp_ge_u32 s14, 10
s_cbranch_scc1 L_nocal
s_cmp_lg_u32 s12, 0
s_cbranch_scc1 L_cal_done
s_lshl_b32 s3, s14, 21
s_add_u32 s15, s3, 69212160
s_add_u32 s3, s3, 163579904
s_cmp_ge_u32 s14, 2
s_cselect_b32 s15, s3, s15
s_mov_b64 exec, 1
v_mov_b32 v18, s15
s_mov_b32 s20, -1
s_memtime s[22:23]
s_waitcnt lgkmcnt(0)
global_store_dword v18, v18, s[8:9] sc1
s_waitcnt vmcnt(0)
s_memtime s[24:25]
s_waitcnt lgkmcnt(0)
s_sub_u32 s3, s24, s22
s_min_u32 s20, s20, s3
s_memtime s[22:23]
s_waitcnt lgkmcnt(0)
global_store_dword v18, v18, s[8:9] sc1
s_waitcnt vmcnt(0)
s_memtime s[24:25]
s_waitcnt lgkmcnt(0)
s_sub_u32 s3, s24, s22
s_min_u32 s20, s20, s3
s_memtime s[22:23]
s_waitcnt lgkmcnt(0)
global_store_dword v18, v18, s[8:9] sc1
s_waitcnt vmcnt(0)
s_memtime s[24:25]
s_waitcnt lgkmcnt(0)
s_sub_u32 s3, s24, s22
s_min_u32 s20, s20, s3
s_memtime s[22:23]
s_waitcnt lgkmcnt(0)
global_store_dword v18, v18, s[8:9] sc1
s_waitcnt vmcnt(0)
s_memtime s[24:25]
s_waitcnt lgkmcnt(0)
s_sub_u32 s3, s24, s22
s_min_u32 s20, s20, s3
s_add_u32 s15, s15, 8192
v_mov_b32 v18, s15
s_mov_b32 s21, -1
s_memtime s[22:23]
s_waitcnt lgkmcnt(0)
global_store_dword v18, v18, s[8:9] sc1
s_waitcnt vmcnt(0)
s_memtime s[24:25]
s_waitcnt lgkmcnt(0)
s_sub_u32 s3, s24, s22
s_min_u32 s21, s21, s3
s_memtime s[22:23]
s_waitcnt lgkmcnt(0)
global_store_dword v18, v18, s[8:9] sc1
s_waitcnt vmcnt(0)
s_memtime s[24:25]
s_waitcnt lgkmcnt(0)
s_sub_u32 s3, s24, s22
s_min_u32 s21, s21, s3
s_memtime s[22:23]
s_waitcnt lgkmcnt(0)
global_store_dword v18, v18, s[8:9] sc1
s_waitcnt vmcnt(0)
s_memtime s[24:25]
s_waitcnt lgkmcnt(0)
s_sub_u32 s3, s24, s22
s_min_u32 s21, s21, s3
s_memtime s[22:23]
s_waitcnt lgkmcnt(0)
global_store_dword v18, v18, s[8:9] sc1
s_waitcnt vmcnt(0)
s_memtime s[24:25]
s_waitcnt lgkmcnt(0)
s_sub_u32 s3, s24, s22
s_min_u32 s21, s21, s3
s_add_u32 s15, s15, 8192
s_cmp_lt_u32 s21, s20
s_cselect_b32 s3, 1, 0
s_getreg_b32 s20, hwreg(HW_REG_XCC_ID, 2, 1)
s_xor_b32 s3, s3, s20
s_lshl_b32 s3, s3, s14
v_mov_b32 v18, 132
v_mov_b32 v19, s3
global_atomic_or v18, v19, s[94:95]
s_mov_b64 exec, -1
s_waitcnt vmcnt(0)
s_mov_b64 exec, 1
v_mov_b32 v16, 24
v_mov_b32 v17, 1
global_atomic_add v17, v16, v17, s[94:95] sc0
s_waitcnt vmcnt(0)
v_cmp_ne_u32 vcc, 9, v17
s_nop 0
s_cbranch_vccnz L_ar_13
v_mov_b32 v17, 1
global_store_dword v16, v17, s[94:95] offset:128 sc1
L_ar_13:
s_mov_b64 exec, -1
L_sg_12:
L_cal_done:
s_barrier
L_nocal:
L_nofill:
s_mov_b32 s2, s90
s_cmp_ge_u32 s2, 40
s_cbranch_scc1 L_mod_donea
s_load_dwordx4 s[4:7], s[0:1], 80
v_lshrrev_b32 v1, 2, v0
v_and_b32 v2, 3, v0
v_mul_u32_u24 v3, 7680, v1
v_lshl_add_u32 v3, v2, 4, v3
s_lshl_b32 s3, s2, 6
v_add_u32 v3, s3, v3
v_lshlrev_b32 v4, 1, v1
s_waitcnt lgkmcnt(0)
global_load_ushort v10, v4, s[4:5] offset:0
global_load_ushort v11, v4, s[4:5] offset:128
global_load_ushort v12, v4, s[4:5] offset:256
global_load_ushort v13, v4, s[4:5] offset:384
global_load_ushort v14, v4, s[4:5] offset:512
global_load_ushort v15, v4, s[4:5] offset:640
global_load_ushort v16, v4, s[4:5] offset:768
global_load_ushort v17, v4, s[4:5] offset:896
global_load_ushort v18, v4, s[4:5] offset:1024
global_load_ushort v19, v4, s[4:5] offset:1152
global_load_dwordx4 v[20:23], v3, s[6:7]
v_add_u32 v3, 491520, v3
global_load_dwordx4 v[24:27], v3, s[6:7]
v_add_u32 v3, 491520, v3
global_load_dwordx4 v[28:31], v3, s[6:7]
v_add_u32 v3, 491520, v3
global_load_dwordx4 v[32:35], v3, s[6:7]
v_add_u32 v3, 491520, v3
global_load_dwordx4 v[36:39], v3, s[6:7]
v_add_u32 v3, 491520, v3
global_load_dwordx4 v[40:43], v3, s[6:7]
v_add_u32 v3, 491520, v3
global_load_dwordx4 v[44:47], v3, s[6:7]
v_add_u32 v3, 491520, v3
global_load_dwordx4 v[48:51], v3, s[6:7]
v_add_u32 v3, 491520, v3
global_load_dwordx4 v[52:55], v3, s[6:7]
v_add_u32 v3, 491520, v3
global_load_dwordx4 v[56:59], v3, s[6:7]
s_mov_b32 s10, 0xbfb8aa3b
s_waitcnt vmcnt(10)
v_lshlrev_b32 v10, 16, v10
v_mul_f32 v5, s10, v10
v_exp_f32 v5, v5
s_nop 0
v_add_f32 v5, 1.0, v5
v_rcp_f32 v5, v5
s_nop 0
v_mul_f32 v10, v10, v5
v_cvt_pk_bf16_f32 v10, v10, v10
v_and_b32 v10, 0xffff0000, v10
v_lshlrev_b32 v11, 16, v11
v_mul_f32 v5, s10, v11
v_exp_f32 v5, v5
s_nop 0
v_add_f32 v5, 1.0, v5
v_rcp_f32 v5, v5
s_nop 0
v_mul_f32 v11, v11, v5
v_cvt_pk_bf16_f32 v11, v11, v11
v_and_b32 v11, 0xffff0000, v11
v_lshlrev_b32 v12, 16, v12
v_mul_f32 v5, s10, v12
v_exp_f32 v5, v5
s_nop 0
v_add_f32 v5, 1.0, v5
v_rcp_f32 v5, v5
s_nop 0
v_mul_f32 v12, v12, v5
v_cvt_pk_bf16_f32 v12, v12, v12
v_and_b32 v12, 0xffff0000, v12
v_lshlrev_b32 v13, 16, v13
v_mul_f32 v5, s10, v13
v_exp_f32 v5, v5
s_nop 0
v_add_f32 v5, 1.0, v5
v_rcp_f32 v5, v5
s_nop 0
v_mul_f32 v13, v13, v5
v_cvt_pk_bf16_f32 v13, v13, v13
v_and_b32 v13, 0xffff0000, v13
v_lshlrev_b32 v14, 16, v14
v_mul_f32 v5, s10, v14
v_exp_f32 v5, v5
s_nop 0
v_add_f32 v5, 1.0, v5
v_rcp_f32 v5, v5
s_nop 0
v_mul_f32 v14, v14, v5
v_cvt_pk_bf16_f32 v14, v14, v14
v_and_b32 v14, 0xffff0000, v14
v_lshlrev_b32 v15, 16, v15
v_mul_f32 v5, s10, v15
v_exp_f32 v5, v5
s_nop 0
v_add_f32 v5, 1.0, v5
v_rcp_f32 v5, v5
s_nop 0
v_mul_f32 v15, v15, v5
v_cvt_pk_bf16_f32 v15, v15, v15
v_and_b32 v15, 0xffff0000, v15
v_lshlrev_b32 v16, 16, v16
v_mul_f32 v5, s10, v16
v_exp_f32 v5, v5
s_nop 0
v_add_f32 v5, 1.0, v5
v_rcp_f32 v5, v5
s_nop 0
v_mul_f32 v16, v16, v5
v_cvt_pk_bf16_f32 v16, v16, v16
v_and_b32 v16, 0xffff0000, v16
v_lshlrev_b32 v17, 16, v17
v_mul_f32 v5, s10, v17
v_exp_f32 v5, v5
s_nop 0
v_add_f32 v5, 1.0, v5
v_rcp_f32 v5, v5
s_nop 0
v_mul_f32 v17, v17, v5
v_cvt_pk_bf16_f32 v17, v17, v17
v_and_b32 v17, 0xffff0000, v17
v_lshlrev_b32 v18, 16, v18
v_mul_f32 v5, s10, v18
v_exp_f32 v5, v5
s_nop 0
v_add_f32 v5, 1.0, v5
v_rcp_f32 v5, v5
s_nop 0
v_mul_f32 v18, v18, v5
v_cvt_pk_bf16_f32 v18, v18, v18
v_and_b32 v18, 0xffff0000, v18
v_lshlrev_b32 v19, 16, v19
v_mul_f32 v5, s10, v19
v_exp_f32 v5, v5
s_nop 0
v_add_f32 v5, 1.0, v5
v_rcp_f32 v5, v5
s_nop 0
v_mul_f32 v19, v19, v5
v_cvt_pk_bf16_f32 v19, v19, v19
v_and_b32 v19, 0xffff0000, v19
v_mov_b32 v60, 0
v_mov_b32 v61, 0
v_mov_b32 v62, 0
v_mov_b32 v63, 0
v_mov_b32 v64, 0
v_mov_b32 v65, 0
v_mov_b32 v66, 0
v_mov_b32 v67, 0
s_waitcnt vmcnt(9)
v_lshlrev_b32 v5, 16, v20
v_and_b32 v6, 0xffff0000, v20
v_fmac_f32 v60, v5, v10
v_fmac_f32 v61, v6, v10
v_lshlrev_b32 v5, 16, v21
v_and_b32 v6, 0xffff0000, v21
v_fmac_f32 v62, v5, v10
v_fmac_f32 v63, v6, v10
v_lshlrev_b32 v5, 16, v22
v_and_b32 v6, 0xffff0000, v22
v_fmac_f32 v64, v5, v10
v_fmac_f32 v65, v6, v10
v_lshlrev_b32 v5, 16, v23
v_and_b32 v6, 0xffff0000, v23
v_fmac_f32 v66, v5, v10
v_fmac_f32 v67, v6, v10
s_waitcnt vmcnt(8)
v_lshlrev_b32 v5, 16, v24
v_and_b32 v6, 0xffff0000, v24
v_fmac_f32 v60, v5, v11
v_fmac_f32 v61, v6, v11
v_lshlrev_b32 v5, 16, v25
v_and_b32 v6, 0xffff0000, v25
v_fmac_f32 v62, v5, v11
v_fmac_f32 v63, v6, v11
v_lshlrev_b32 v5, 16, v26
v_and_b32 v6, 0xffff0000, v26
v_fmac_f32 v64, v5, v11
v_fmac_f32 v65, v6, v11
v_lshlrev_b32 v5, 16, v27
v_and_b32 v6, 0xffff0000, v27
v_fmac_f32 v66, v5, v11
v_fmac_f32 v67, v6, v11
s_waitcnt vmcnt(7)
v_lshlrev_b32 v5, 16, v28
v_and_b32 v6, 0xffff0000, v28
v_fmac_f32 v60, v5, v12
v_fmac_f32 v61, v6, v12
v_lshlrev_b32 v5, 16, v29
v_and_b32 v6, 0xffff0000, v29
v_fmac_f32 v62, v5, v12
v_fmac_f32 v63, v6, v12
v_lshlrev_b32 v5, 16, v30
v_and_b32 v6, 0xffff0000, v30
v_fmac_f32 v64, v5, v12
v_fmac_f32 v65, v6, v12
v_lshlrev_b32 v5, 16, v31
v_and_b32 v6, 0xffff0000, v31
v_fmac_f32 v66, v5, v12
v_fmac_f32 v67, v6, v12
s_waitcnt vmcnt(6)
v_lshlrev_b32 v5, 16, v32
v_and_b32 v6, 0xffff0000, v32
v_fmac_f32 v60, v5, v13
v_fmac_f32 v61, v6, v13
v_lshlrev_b32 v5, 16, v33
v_and_b32 v6, 0xffff0000, v33
v_fmac_f32 v62, v5, v13
v_fmac_f32 v63, v6, v13
v_lshlrev_b32 v5, 16, v34
v_and_b32 v6, 0xffff0000, v34
v_fmac_f32 v64, v5, v13
v_fmac_f32 v65, v6, v13
v_lshlrev_b32 v5, 16, v35
v_and_b32 v6, 0xffff0000, v35
v_fmac_f32 v66, v5, v13
v_fmac_f32 v67, v6, v13
s_waitcnt vmcnt(5)
v_lshlrev_b32 v5, 16, v36
v_and_b32 v6, 0xffff0000, v36
v_fmac_f32 v60, v5, v14
v_fmac_f32 v61, v6, v14
v_lshlrev_b32 v5, 16, v37
v_and_b32 v6, 0xffff0000, v37
v_fmac_f32 v62, v5, v14
v_fmac_f32 v63, v6, v14
v_lshlrev_b32 v5, 16, v38
v_and_b32 v6, 0xffff0000, v38
v_fmac_f32 v64, v5, v14
v_fmac_f32 v65, v6, v14
v_lshlrev_b32 v5, 16, v39
v_and_b32 v6, 0xffff0000, v39
v_fmac_f32 v66, v5, v14
v_fmac_f32 v67, v6, v14
s_waitcnt vmcnt(4)
v_lshlrev_b32 v5, 16, v40
v_and_b32 v6, 0xffff0000, v40
v_fmac_f32 v60, v5, v15
v_fmac_f32 v61, v6, v15
v_lshlrev_b32 v5, 16, v41
v_and_b32 v6, 0xffff0000, v41
v_fmac_f32 v62, v5, v15
v_fmac_f32 v63, v6, v15
v_lshlrev_b32 v5, 16, v42
v_and_b32 v6, 0xffff0000, v42
v_fmac_f32 v64, v5, v15
v_fmac_f32 v65, v6, v15
v_lshlrev_b32 v5, 16, v43
v_and_b32 v6, 0xffff0000, v43
v_fmac_f32 v66, v5, v15
v_fmac_f32 v67, v6, v15
s_waitcnt vmcnt(3)
v_lshlrev_b32 v5, 16, v44
v_and_b32 v6, 0xffff0000, v44
v_fmac_f32 v60, v5, v16
v_fmac_f32 v61, v6, v16
v_lshlrev_b32 v5, 16, v45
v_and_b32 v6, 0xffff0000, v45
v_fmac_f32 v62, v5, v16
v_fmac_f32 v63, v6, v16
v_lshlrev_b32 v5, 16, v46
v_and_b32 v6, 0xffff0000, v46
v_fmac_f32 v64, v5, v16
v_fmac_f32 v65, v6, v16
v_lshlrev_b32 v5, 16, v47
v_and_b32 v6, 0xffff0000, v47
v_fmac_f32 v66, v5, v16
v_fmac_f32 v67, v6, v16
s_waitcnt vmcnt(2)
v_lshlrev_b32 v5, 16, v48
v_and_b32 v6, 0xffff0000, v48
v_fmac_f32 v60, v5, v17
v_fmac_f32 v61, v6, v17
v_lshlrev_b32 v5, 16, v49
v_and_b32 v6, 0xffff0000, v49
v_fmac_f32 v62, v5, v17
v_fmac_f32 v63, v6, v17
v_lshlrev_b32 v5, 16, v50
v_and_b32 v6, 0xffff0000, v50
v_fmac_f32 v64, v5, v17
v_fmac_f32 v65, v6, v17
v_lshlrev_b32 v5, 16, v51
v_and_b32 v6, 0xffff0000, v51
v_fmac_f32 v66, v5, v17
v_fmac_f32 v67, v6, v17
s_waitcnt vmcnt(1)
v_lshlrev_b32 v5, 16, v52
v_and_b32 v6, 0xffff0000, v52
v_fmac_f32 v60, v5, v18
v_fmac_f32 v61, v6, v18
v_lshlrev_b32 v5, 16, v53
v_and_b32 v6, 0xffff0000, v53
v_fmac_f32 v62, v5, v18
v_fmac_f32 v63, v6, v18
v_lshlrev_b32 v5, 16, v54
v_and_b32 v6, 0xffff0000, v54
v_fmac_f32 v64, v5, v18
v_fmac_f32 v65, v6, v18
v_lshlrev_b32 v5, 16, v55
v_and_b32 v6, 0xffff0000, v55
v_fmac_f32 v66, v5, v18
v_fmac_f32 v67, v6, v18
s_waitcnt vmcnt(0)
v_lshlrev_b32 v5, 16, v56
v_and_b32 v6, 0xffff0000, v56
v_fmac_f32 v60, v5, v19
v_fmac_f32 v61, v6, v19
v_lshlrev_b32 v5, 16, v57
v_and_b32 v6, 0xffff0000, v57
v_fmac_f32 v62, v5, v19
v_fmac_f32 v63, v6, v19
v_lshlrev_b32 v5, 16, v58
v_and_b32 v6, 0xffff0000, v58
v_fmac_f32 v64, v5, v19
v_fmac_f32 v65, v6, v19
v_lshlrev_b32 v5, 16, v59
v_and_b32 v6, 0xffff0000, v59
v_fmac_f32 v66, v5, v19
v_fmac_f32 v67, v6, v19
v_add_f32_dpp v60, v60, v60 row_ror:4 row_mask:0xf bank_mask:0xf
v_add_f32_dpp v61, v61, v61 row_ror:4 row_mask:0xf bank_mask:0xf
v_add_f32_dpp v62, v62, v62 row_ror:4 row_mask:0xf bank_mask:0xf
v_add_f32_dpp v63, v63, v63 row_ror:4 row_mask:0xf bank_mask:0xf
v_add_f32_dpp v64, v64, v64 row_ror:4 row_mask:0xf bank_mask:0xf
v_add_f32_dpp v65, v65, v65 row_ror:4 row_mask:0xf bank_mask:0xf
v_add_f32_dpp v66, v66, v66 row_ror:4 row_mask:0xf bank_mask:0xf
v_add_f32_dpp v67, v67, v67 row_ror:4 row_mask:0xf bank_mask:0xf
v_add_f32_dpp v60, v60, v60 row_ror:8 row_mask:0xf bank_mask:0xf
v_add_f32_dpp v61, v61, v61 row_ror:8 row_mask:0xf bank_mask:0xf
v_add_f32_dpp v62, v62, v62 row_ror:8 row_mask:0xf bank_mask:0xf
v_add_f32_dpp v63, v63, v63 row_ror:8 row_mask:0xf bank_mask:0xf
v_add_f32_dpp v64, v64, v64 row_ror:8 row_mask:0xf bank_mask:0xf
v_add_f32_dpp v65, v65, v65 row_ror:8 row_mask:0xf bank_mask:0xf
v_add_f32_dpp v66, v66, v66 row_ror:8 row_mask:0xf bank_mask:0xf
v_add_f32_dpp v67, v67, v67 row_ror:8 row_mask:0xf bank_mask:0xf
v_lshrrev_b32 v5, 4, v0
v_lshlrev_b32 v5, 7, v5
v_lshl_add_u32 v5, v2, 5, v5
v_and_b32 v6, 12, v0
v_cmp_eq_u32 vcc, 0, v6
s_nop 0
s_and_saveexec_b64 s[14:15], vcc
ds_write_b128 v5, v[60:63]
ds_write_b128 v5, v[64:67] offset:16
s_mov_b64 exec, s[14:15]
s_waitcnt lgkmcnt(0)
s_barrier
s_cmp_lg_u32 s12, 0
s_cbranch_scc1 L_mod_donea
v_and_b32 v7, 31, v0
v_lshlrev_b32 v5, 2, v7
ds_read2_b32 v[20:21], v5 offset0:0 offset1:32
ds_read2_b32 v[22:23], v5 offset0:64 offset1:96
ds_read2_b32 v[24:25], v5 offset0:128 offset1:160
ds_read2_b32 v[26:27], v5 offset0:192 offset1:224
v_add_u32 v5, 1024, v5
ds_read2_b32 v[28:29], v5 offset0:0 offset1:32
ds_read2_b32 v[30:31], v5 offset0:64 offset1:96
ds_read2_b32 v[32:33], v5 offset0:128 offset1:160
ds_read2_b32 v[34:35], v5 offset0:192 offset1:224
s_waitcnt lgkmcnt(0)
v_add_f32 v20, v20, v28
v_add_f32 v21, v21, v29
v_add_f32 v22, v22, v30
v_add_f32 v23, v23, v31
v_add_f32 v24, v24, v32
v_add_f32 v25, v25, v33
v_add_f32 v26, v26, v34
v_add_f32 v27, v27, v35
v_add_f32 v20, v20, v24
v_add_f32 v21, v21, v25
v_add_f32 v22, v22, v26
v_add_f32 v23, v23, v27
v_add_f32 v20, v20, v22
v_add_f32 v21, v21, v23
v_add_f32 v20, v20, v21
v_cvt_pk_bf16_f32 v20, v20, v20
v_and_b32 v20, 0xffff0000, v20
v_add_f32 v21, 1.0, v20
v_cvt_pk_bf16_f32 v21, v21, v21
v_and_b32 v21, 0xffff0000, v21
s_sub_u32 s14, s2, 20
s_cmp_lt_u32 s14, 20
s_cselect_b32 s15, 1, 0
s_sub_u32 s14, s2, 80
s_cmp_lt_u32 s14, 20
s_cselect_b32 s15, 1, s15
s_cmp_eq_u32 s15, 1
s_cselect_b64 vcc, -1, 0
v_cndmask_b32 v20, v20, v21, vcc
s_lshl_b32 s3, s2, 7
s_add_u32 s3, s3, 62914560
v_lshlrev_b32 v5, 2, v7
v_add_u32 v5, s3, v5
global_store_dword v5, v20, s[8:9] sc1
s_waitcnt vmcnt(0)
s_mov_b64 exec, 1
v_mov_b32 v5, 12
v_mov_b32 v6, 1
global_atomic_add v6, v5, v6, s[94:95] sc0
s_waitcnt vmcnt(0)
v_cmp_ne_u32 vcc, 63, v6
s_nop 0
s_cbranch_vccnz L_ar_15
v_mov_b32 v6, 1
global_store_dword v5, v6, s[94:95] offset:128 sc1
L_ar_15:
s_mov_b64 exec, -1
L_sg_14:
L_mod_donea:
s_cmp_ge_u32 s90, 128
s_cbranch_scc1 L_ln1_done
s_xor_b32 s2, s90, 64
s_load_dwordx2 s[4:5], s[0:1], 0
v_and_b32 v1, 63, v0
v_lshrrev_b32 v2, 4, v1
v_and_b32 v3, 15, v1
v_lshlrev_b32 v6, 4, v1
s_lshl_b32 s3, s12, 6
v_lshlrev_b32 v7, 2, v3
v_add_u32 v4, s3, v7
s_waitcnt lgkmcnt(0)
v_mul_u32_u24 v5, 1280, v3
v_lshl_add_u32 v5, v2, 3, v5
s_mul_i32 s3, s2, 20480
s_mul_i32 s13, s12, 320
s_add_u32 s3, s3, s13
v_add_u32 v5, s3, v5
global_load_dwordx2 v[10:11], v5, s[4:5] offset:0
global_load_dwordx2 v[12:13], v5, s[4:5] offset:32
global_load_dwordx2 v[14:15], v5, s[4:5] offset:64
global_load_dwordx2 v[16:17], v5, s[4:5] offset:96
global_load_dwordx2 v[18:19], v5, s[4:5] offset:128
global_load_dwordx2 v[20:21], v5, s[4:5] offset:160
global_load_dwordx2 v[22:23], v5, s[4:5] offset:192
global_load_dwordx2 v[24:25], v5, s[4:5] offset:224
global_load_dwordx2 v[26:27], v5, s[4:5] offset:256
global_load_dwordx2 v[28:29], v5, s[4:5] offset:288
s_waitcnt vmcnt(0)
v_lshlrev_b32 v32, 16, v10
v_and_b32 v33, 0xffff0000, v10
v_lshlrev_b32 v34, 16, v11
v_and_b32 v35, 0xffff0000, v11
v_lshlrev_b32 v36, 16, v12
v_and_b32 v37, 0xffff0000, v12
v_lshlrev_b32 v38, 16, v13
v_and_b32 v39, 0xffff0000, v13
v_lshlrev_b32 v40, 16, v14
v_and_b32 v41, 0xffff0000, v14
v_lshlrev_b32 v42, 16, v15
v_and_b32 v43, 0xffff0000, v15
v_lshlrev_b32 v44, 16, v16
v_and_b32 v45, 0xffff0000, v16
v_lshlrev_b32 v46, 16, v17
v_and_b32 v47, 0xffff0000, v17
v_lshlrev_b32 v48, 16, v18
v_and_b32 v49, 0xffff0000, v18
v_lshlrev_b32 v50, 16, v19
v_and_b32 v51, 0xffff0000, v19
v_lshlrev_b32 v52, 16, v20
v_and_b32 v53, 0xffff0000, v20
v_lshlrev_b32 v54, 16, v21
v_and_b32 v55, 0xffff0000, v21
v_lshlrev_b32 v56, 16, v22
v_and_b32 v57, 0xffff0000, v22
v_lshlrev_b32 v58, 16, v23
v_and_b32 v59, 0xffff0000, v23
v_lshlrev_b32 v60, 16, v24
v_and_b32 v61, 0xffff0000, v24
v_lshlrev_b32 v62, 16, v25
v_and_b32 v63, 0xffff0000, v25
v_lshlrev_b32 v64, 16, v26
v_and_b32 v65, 0xffff0000, v26
v_lshlrev_b32 v66, 16, v27
v_and_b32 v67, 0xffff0000, v27
v_lshlrev_b32 v68, 16, v28
v_and_b32 v69, 0xffff0000, v28
v_lshlrev_b32 v70, 16, v29
v_and_b32 v71, 0xffff0000, v29
v_pk_add_f32 v[8:9], v[32:33], v[34:35]
v_pk_add_f32 v[8:9], v[8:9], v[36:37]
v_pk_add_f32 v[8:9], v[8:9], v[38:39]
v_pk_add_f32 v[8:9], v[8:9], v[40:41]
v_pk_add_f32 v[8:9], v[8:9], v[42:43]
v_pk_add_f32 v[8:9], v[8:9], v[44:45]
v_pk_add_f32 v[8:9], v[8:9], v[46:47]
v_pk_add_f32 v[8:9], v[8:9], v[48:49]
v_pk_add_f32 v[8:9], v[8:9], v[50:51]
v_pk_add_f32 v[8:9], v[8:9], v[52:53]
v_pk_add_f32 v[8:9], v[8:9], v[54:55]
v_pk_add_f32 v[8:9], v[8:9], v[56:57]
v_pk_add_f32 v[8:9], v[8:9], v[58:59]
v_pk_add_f32 v[8:9], v[8:9], v[60:61]
v_pk_add_f32 v[8:9], v[8:9], v[62:63]
v_pk_add_f32 v[8:9], v[8:9], v[64:65]
v_pk_add_f32 v[8:9], v[8:9], v[66:67]
v_pk_add_f32 v[8:9], v[8:9], v[68:69]
v_pk_add_f32 v[8:9], v[8:9], v[70:71]
v_add_f32 v8, v8, v9
v_mov_b32 v9, v8
s_nop 1
v_permlane32_swap_b32 v8, v9
v_add_f32 v8, v8, v9
v_mov_b32 v9, v8
s_nop 1
v_permlane16_swap_b32 v8, v9
v_add_f32 v8, v8, v9
ds_write_b32 v4, v8 offset:4096
s_waitcnt lgkmcnt(0)
s_barrier
ds_read_b32 v10, v7 offset:4096
ds_read_b32 v11, v7 offset:4160
ds_read_b32 v12, v7 offset:4224
ds_read_b32 v13, v7 offset:4288
s_waitcnt lgkmcnt(0)
v_add_f32 v10, v10, v11
v_add_f32 v12, v12, v13
v_add_f32 v8, v10, v12
v_mul_f32 v14, 0x3acccccd, v8
v_mov_b32 v15, v14
v_cvt_pk_bf16_f32 v15, v15, v15
v_and_b32 v15, 0xffff0000, v15
v_mov_b32 v8, 0
v_mov_b32 v9, 0
v_sub_f32 v16, v32, v14
v_sub_f32 v17, v33, v14
v_fmac_f32 v8, v16, v16
v_fmac_f32 v9, v17, v17
v_sub_f32 v32, v32, v15
v_sub_f32 v33, v33, v15
v_cvt_pk_bf16_f32 v18, v32, v33
v_lshlrev_b32 v32, 16, v18
v_and_b32 v33, 0xffff0000, v18
v_sub_f32 v16, v34, v14
v_sub_f32 v17, v35, v14
v_fmac_f32 v8, v16, v16
v_fmac_f32 v9, v17, v17
v_sub_f32 v34, v34, v15
v_sub_f32 v35, v35, v15
v_cvt_pk_bf16_f32 v18, v34, v35
v_lshlrev_b32 v34, 16, v18
v_and_b32 v35, 0xffff0000, v18
v_sub_f32 v16, v36, v14
v_sub_f32 v17, v37, v14
v_fmac_f32 v8, v16, v16
v_fmac_f32 v9, v17, v17
v_sub_f32 v36, v36, v15
v_sub_f32 v37, v37, v15
v_cvt_pk_bf16_f32 v18, v36, v37
v_lshlrev_b32 v36, 16, v18
v_and_b32 v37, 0xffff0000, v18
v_sub_f32 v16, v38, v14
v_sub_f32 v17, v39, v14
v_fmac_f32 v8, v16, v16
v_fmac_f32 v9, v17, v17
v_sub_f32 v38, v38, v15
v_sub_f32 v39, v39, v15
v_cvt_pk_bf16_f32 v18, v38, v39
v_lshlrev_b32 v38, 16, v18
v_and_b32 v39, 0xffff0000, v18
v_sub_f32 v16, v40, v14
v_sub_f32 v17, v41, v14
v_fmac_f32 v8, v16, v16
v_fmac_f32 v9, v17, v17
v_sub_f32 v40, v40, v15
v_sub_f32 v41, v41, v15
v_cvt_pk_bf16_f32 v18, v40, v41
v_lshlrev_b32 v40, 16, v18
v_and_b32 v41, 0xffff0000, v18
v_sub_f32 v16, v42, v14
v_sub_f32 v17, v43, v14
v_fmac_f32 v8, v16, v16
v_fmac_f32 v9, v17, v17
v_sub_f32 v42, v42, v15
v_sub_f32 v43, v43, v15
v_cvt_pk_bf16_f32 v18, v42, v43
v_lshlrev_b32 v42, 16, v18
v_and_b32 v43, 0xffff0000, v18
v_sub_f32 v16, v44, v14
v_sub_f32 v17, v45, v14
v_fmac_f32 v8, v16, v16
v_fmac_f32 v9, v17, v17
v_sub_f32 v44, v44, v15
v_sub_f32 v45, v45, v15
v_cvt_pk_bf16_f32 v18, v44, v45
v_lshlrev_b32 v44, 16, v18
v_and_b32 v45, 0xffff0000, v18
v_sub_f32 v16, v46, v14
v_sub_f32 v17, v47, v14
v_fmac_f32 v8, v16, v16
v_fmac_f32 v9, v17, v17
v_sub_f32 v46, v46, v15
v_sub_f32 v47, v47, v15
v_cvt_pk_bf16_f32 v18, v46, v47
v_lshlrev_b32 v46, 16, v18
v_and_b32 v47, 0xffff0000, v18
v_sub_f32 v16, v48, v14
v_sub_f32 v17, v49, v14
v_fmac_f32 v8, v16, v16
v_fmac_f32 v9, v17, v17
v_sub_f32 v48, v48, v15
v_sub_f32 v49, v49, v15
v_cvt_pk_bf16_f32 v18, v48, v49
v_lshlrev_b32 v48, 16, v18
v_and_b32 v49, 0xffff0000, v18
v_sub_f32 v16, v50, v14
v_sub_f32 v17, v51, v14
v_fmac_f32 v8, v16, v16
v_fmac_f32 v9, v17, v17
v_sub_f32 v50, v50, v15
v_sub_f32 v51, v51, v15
v_cvt_pk_bf16_f32 v18, v50, v51
v_lshlrev_b32 v50, 16, v18
v_and_b32 v51, 0xffff0000, v18
v_sub_f32 v16, v52, v14
v_sub_f32 v17, v53, v14
v_fmac_f32 v8, v16, v16
v_fmac_f32 v9, v17, v17
v_sub_f32 v52, v52, v15
v_sub_f32 v53, v53, v15
v_cvt_pk_bf16_f32 v18, v52, v53
v_lshlrev_b32 v52, 16, v18
v_and_b32 v53, 0xffff0000, v18
v_sub_f32 v16, v54, v14
v_sub_f32 v17, v55, v14
v_fmac_f32 v8, v16, v16
v_fmac_f32 v9, v17, v17
v_sub_f32 v54, v54, v15
v_sub_f32 v55, v55, v15
v_cvt_pk_bf16_f32 v18, v54, v55
v_lshlrev_b32 v54, 16, v18
v_and_b32 v55, 0xffff0000, v18
v_sub_f32 v16, v56, v14
v_sub_f32 v17, v57, v14
v_fmac_f32 v8, v16, v16
v_fmac_f32 v9, v17, v17
v_sub_f32 v56, v56, v15
v_sub_f32 v57, v57, v15
v_cvt_pk_bf16_f32 v18, v56, v57
v_lshlrev_b32 v56, 16, v18
v_and_b32 v57, 0xffff0000, v18
v_sub_f32 v16, v58, v14
v_sub_f32 v17, v59, v14
v_fmac_f32 v8, v16, v16
v_fmac_f32 v9, v17, v17
v_sub_f32 v58, v58, v15
v_sub_f32 v59, v59, v15
v_cvt_pk_bf16_f32 v18, v58, v59
v_lshlrev_b32 v58, 16, v18
v_and_b32 v59, 0xffff0000, v18
v_sub_f32 v16, v60, v14
v_sub_f32 v17, v61, v14
v_fmac_f32 v8, v16, v16
v_fmac_f32 v9, v17, v17
v_sub_f32 v60, v60, v15
v_sub_f32 v61, v61, v15
v_cvt_pk_bf16_f32 v18, v60, v61
v_lshlrev_b32 v60, 16, v18
v_and_b32 v61, 0xffff0000, v18
v_sub_f32 v16, v62, v14
v_sub_f32 v17, v63, v14
v_fmac_f32 v8, v16, v16
v_fmac_f32 v9, v17, v17
v_sub_f32 v62, v62, v15
v_sub_f32 v63, v63, v15
v_cvt_pk_bf16_f32 v18, v62, v63
v_lshlrev_b32 v62, 16, v18
v_and_b32 v63, 0xffff0000, v18
v_sub_f32 v16, v64, v14
v_sub_f32 v17, v65, v14
v_fmac_f32 v8, v16, v16
v_fmac_f32 v9, v17, v17
v_sub_f32 v64, v64, v15
v_sub_f32 v65, v65, v15
v_cvt_pk_bf16_f32 v18, v64, v65
v_lshlrev_b32 v64, 16, v18
v_and_b32 v65, 0xffff0000, v18
v_sub_f32 v16, v66, v14
v_sub_f32 v17, v67, v14
v_fmac_f32 v8, v16, v16
v_fmac_f32 v9, v17, v17
v_sub_f32 v66, v66, v15
v_sub_f32 v67, v67, v15
v_cvt_pk_bf16_f32 v18, v66, v67
v_lshlrev_b32 v66, 16, v18
v_and_b32 v67, 0xffff0000, v18
v_sub_f32 v16, v68, v14
v_sub_f32 v17, v69, v14
v_fmac_f32 v8, v16, v16
v_fmac_f32 v9, v17, v17
v_sub_f32 v68, v68, v15
v_sub_f32 v69, v69, v15
v_cvt_pk_bf16_f32 v18, v68, v69
v_lshlrev_b32 v68, 16, v18
v_and_b32 v69, 0xffff0000, v18
v_sub_f32 v16, v70, v14
v_sub_f32 v17, v71, v14
v_fmac_f32 v8, v16, v16
v_fmac_f32 v9, v17, v17
v_sub_f32 v70, v70, v15
v_sub_f32 v71, v71, v15
v_cvt_pk_bf16_f32 v18, v70, v71
v_lshlrev_b32 v70, 16, v18
v_and_b32 v71, 0xffff0000, v18
v_add_f32 v8, v8, v9
v_mov_b32 v9, v8
s_nop 1
v_permlane32_swap_b32 v8, v9
v_add_f32 v8, v8, v9
v_mov_b32 v9, v8
s_nop 1
v_permlane16_swap_b32 v8, v9
v_add_f32 v8, v8, v9
ds_write_b32 v4, v8 offset:4352
s_waitcnt lgkmcnt(0)
s_barrier
ds_read_b32 v10, v7 offset:4352
ds_read_b32 v11, v7 offset:4416
ds_read_b32 v12, v7 offset:4480
ds_read_b32 v13, v7 offset:4544
s_waitcnt lgkmcnt(0)
v_add_f32 v10, v10, v11
v_add_f32 v12, v12, v13
v_add_f32 v8, v10, v12
v_mul_f32 v8, 0x3acccccd, v8
v_cvt_pk_bf16_f32 v8, v8, v8
v_and_b32 v8, 0xffff0000, v8
v_add_f32 v8, 0x3727c5ac, v8
v_cvt_pk_bf16_f32 v8, v8, v8
v_and_b32 v8, 0xffff0000, v8
v_sqrt_f32 v8, v8
s_nop 0
v_cvt_pk_bf16_f32 v8, v8, v8
v_and_b32 v8, 0xffff0000, v8
v_rcp_f32 v8, v8
s_nop 0
v_mul_f32 v32, v32, v8
v_mul_f32 v33, v33, v8
v_cvt_pk_bf16_f32 v9, v32, v33
v_lshlrev_b32 v32, 16, v9
v_and_b32 v33, 0xffff0000, v9
v_mul_f32 v34, v34, v8
v_mul_f32 v35, v35, v8
v_cvt_pk_bf16_f32 v9, v34, v35
v_lshlrev_b32 v34, 16, v9
v_and_b32 v35, 0xffff0000, v9
v_mul_f32 v36, v36, v8
v_mul_f32 v37, v37, v8
v_cvt_pk_bf16_f32 v9, v36, v37
v_lshlrev_b32 v36, 16, v9
v_and_b32 v37, 0xffff0000, v9
v_mul_f32 v38, v38, v8
v_mul_f32 v39, v39, v8
v_cvt_pk_bf16_f32 v9, v38, v39
v_lshlrev_b32 v38, 16, v9
v_and_b32 v39, 0xffff0000, v9
v_mul_f32 v40, v40, v8
v_mul_f32 v41, v41, v8
v_cvt_pk_bf16_f32 v9, v40, v41
v_lshlrev_b32 v40, 16, v9
v_and_b32 v41, 0xffff0000, v9
v_mul_f32 v42, v42, v8
v_mul_f32 v43, v43, v8
v_cvt_pk_bf16_f32 v9, v42, v43
v_lshlrev_b32 v42, 16, v9
v_and_b32 v43, 0xffff0000, v9
v_mul_f32 v44, v44, v8
v_mul_f32 v45, v45, v8
v_cvt_pk_bf16_f32 v9, v44, v45
v_lshlrev_b32 v44, 16, v9
v_and_b32 v45, 0xffff0000, v9
v_mul_f32 v46, v46, v8
v_mul_f32 v47, v47, v8
v_cvt_pk_bf16_f32 v9, v46, v47
v_lshlrev_b32 v46, 16, v9
v_and_b32 v47, 0xffff0000, v9
v_mul_f32 v48, v48, v8
v_mul_f32 v49, v49, v8
v_cvt_pk_bf16_f32 v9, v48, v49
v_lshlrev_b32 v48, 16, v9
v_and_b32 v49, 0xffff0000, v9
v_mul_f32 v50, v50, v8
v_mul_f32 v51, v51, v8
v_cvt_pk_bf16_f32 v9, v50, v51
v_lshlrev_b32 v50, 16, v9
v_and_b32 v51, 0xffff0000, v9
v_mul_f32 v52, v52, v8
v_mul_f32 v53, v53, v8
v_cvt_pk_bf16_f32 v9, v52, v53
v_lshlrev_b32 v52, 16, v9
v_and_b32 v53, 0xffff0000, v9
v_mul_f32 v54, v54, v8
v_mul_f32 v55, v55, v8
v_cvt_pk_bf16_f32 v9, v54, v55
v_lshlrev_b32 v54, 16, v9
v_and_b32 v55, 0xffff0000, v9
v_mul_f32 v56, v56, v8
v_mul_f32 v57, v57, v8
v_cvt_pk_bf16_f32 v9, v56, v57
v_lshlrev_b32 v56, 16, v9
v_and_b32 v57, 0xffff0000, v9
v_mul_f32 v58, v58, v8
v_mul_f32 v59, v59, v8
v_cvt_pk_bf16_f32 v9, v58, v59
v_lshlrev_b32 v58, 16, v9
v_and_b32 v59, 0xffff0000, v9
v_mul_f32 v60, v60, v8
v_mul_f32 v61, v61, v8
v_cvt_pk_bf16_f32 v9, v60, v61
v_lshlrev_b32 v60, 16, v9
v_and_b32 v61, 0xffff0000, v9
v_mul_f32 v62, v62, v8
v_mul_f32 v63, v63, v8
v_cvt_pk_bf16_f32 v9, v62, v63
v_lshlrev_b32 v62, 16, v9
v_and_b32 v63, 0xffff0000, v9
v_mul_f32 v64, v64, v8
v_mul_f32 v65, v65, v8
v_cvt_pk_bf16_f32 v9, v64, v65
v_lshlrev_b32 v64, 16, v9
v_and_b32 v65, 0xffff0000, v9
v_mul_f32 v66, v66, v8
v_mul_f32 v67, v67, v8
v_cvt_pk_bf16_f32 v9, v66, v67
v_lshlrev_b32 v66, 16, v9
v_and_b32 v67, 0xffff0000, v9
v_mul_f32 v68, v68, v8
v_mul_f32 v69, v69, v8
v_cvt_pk_bf16_f32 v9, v68, v69
v_lshlrev_b32 v68, 16, v9
v_and_b32 v69, 0xffff0000, v9
v_mul_f32 v70, v70, v8
v_mul_f32 v71, v71, v8
v_cvt_pk_bf16_f32 v9, v70, v71
v_lshlrev_b32 v70, 16, v9
v_and_b32 v71, 0xffff0000, v9
s_mul_i32 s3, s12, 640
s_add_u32 s3, s3, 62914560
v_lshlrev_b32 v5, 4, v2
v_add_u32 v5, s3, v5
s_mul_i32 s3, s2, 20
s_mul_i32 s13, s12, 5
s_add_u32 s3, s3, s13
s_lshl_b32 s3, s3, 10
s_add_u32 s3, s3, 63965184
s_add_u32 s16, s8, s3
s_addc_u32 s17, s9, 0
s_cmp_lt_u32 s90, 64
s_cbranch_scc1 L_nf0_16
v_lshlrev_b32 v80, 4, v0
v_mov_b32 v72, -1
v_mov_b32 v76, 0xffbfffbf
v_mov_b32 v73, -1
v_mov_b32 v77, 0xffbfffbf
v_mov_b32 v74, -1
v_mov_b32 v78, 0xffbfffbf
v_mov_b32 v75, -1
v_mov_b32 v79, 0xffbfffbf
s_mov_b32 s20, s8
s_mov_b32 s21, s9
s_mov_b32 s23, 0x20000
s_mov_b32 s22, 59734016
s_sub_u32 s3, s90, 64
s_mul_i32 s3, s3, 16384
s_add_u32 s3, s3, 58720256
buffer_store_dwordx4 v[76:79], v80, s[20:23], s3 offen sc1
s_add_u32 s3, s3, 4096
buffer_store_dwordx4 v[76:79], v80, s[20:23], s3 offen sc1
s_add_u32 s3, s3, 4096
buffer_store_dwordx4 v[76:79], v80, s[20:23], s3 offen sc1
s_add_u32 s3, s3, 4096
buffer_store_dwordx4 v[76:79], v80, s[20:23], s3 offen sc1
s_add_u32 s3, s3, 4096
s_mov_b32 s22, 61472768
s_sub_u32 s3, s90, 64
s_mul_i32 s3, s3, 16384
s_add_u32 s3, s3, 60827648
buffer_store_dwordx4 v[72:75], v80, s[20:23], s3 offen sc1
s_add_u32 s3, s3, 4096
buffer_store_dwordx4 v[72:75], v80, s[20:23], s3 offen sc1
s_add_u32 s3, s3, 4096
buffer_store_dwordx4 v[72:75], v80, s[20:23], s3 offen sc1
s_add_u32 s3, s3, 4096
buffer_store_dwordx4 v[72:75], v80, s[20:23], s3 offen sc1
s_add_u32 s3, s3, 4096
L_nf0_16:
v_mov_b32 v11, 140
s_cmp_lg_u32 s12, 0
s_cbranch_scc1 L_wd_18
s_mov_b32 s96, 0x80000
L_wf_17:
global_load_dword v12, v11, s[94:95] sc1
s_waitcnt vmcnt(0)
v_cmp_gt_u32 vcc, 1, v12
s_nop 0
s_cbranch_vccz L_wd_18
s_sleep 2
s_sub_u32 s96, s96, 1
s_cbranch_scc0 L_wf_17
s_branch L_wabort
L_wd_18:
s_barrier
s_waitcnt vmcnt(0)
global_load_dwordx4 v[112:115], v5, s[8:9] offset:2560 sc1
global_load_dwordx4 v[72:75], v5, s[8:9] offset:0 sc1
global_load_dwordx4 v[116:119], v5, s[8:9] offset:2624 sc1
global_load_dwordx4 v[76:79], v5, s[8:9] offset:64 sc1
global_load_dwordx4 v[120:123], v5, s[8:9] offset:2688 sc1
global_load_dwordx4 v[80:83], v5, s[8:9] offset:128 sc1
global_load_dwordx4 v[124:127], v5, s[8:9] offset:2752 sc1
global_load_dwordx4 v[84:87], v5, s[8:9] offset:192 sc1
global_load_dwordx4 v[128:131], v5, s[8:9] offset:2816 sc1
global_load_dwordx4 v[88:91], v5, s[8:9] offset:256 sc1
global_load_dwordx4 v[132:135], v5, s[8:9] offset:2880 sc1
global_load_dwordx4 v[92:95], v5, s[8:9] offset:320 sc1
global_load_dwordx4 v[136:139], v5, s[8:9] offset:2944 sc1
global_load_dwordx4 v[96:99], v5, s[8:9] offset:384 sc1
global_load_dwordx4 v[140:143], v5, s[8:9] offset:3008 sc1
global_load_dwordx4 v[100:103], v5, s[8:9] offset:448 sc1
global_load_dwordx4 v[144:147], v5, s[8:9] offset:3072 sc1
global_load_dwordx4 v[104:107], v5, s[8:9] offset:512 sc1
global_load_dwordx4 v[148:151], v5, s[8:9] offset:3136 sc1
global_load_dwordx4 v[108:111], v5, s[8:9] offset:576 sc1
s_waitcnt vmcnt(18)
v_mul_f32 v32, v32, v112
v_mul_f32 v33, v33, v113
v_cvt_pk_bf16_f32 v9, v32, v33
v_lshlrev_b32 v32, 16, v9
v_and_b32 v33, 0xffff0000, v9
v_add_f32 v32, v32, v72
v_add_f32 v33, v33, v73
v_cvt_pk_bf16_f32 v12, v32, v33
v_mul_f32 v34, v34, v114
v_mul_f32 v35, v35, v115
v_cvt_pk_bf16_f32 v9, v34, v35
v_lshlrev_b32 v34, 16, v9
v_and_b32 v35, 0xffff0000, v9
v_add_f32 v34, v34, v74
v_add_f32 v35, v35, v75
v_cvt_pk_bf16_f32 v13, v34, v35
s_waitcnt vmcnt(16)
v_mul_f32 v36, v36, v116
v_mul_f32 v37, v37, v117
v_cvt_pk_bf16_f32 v9, v36, v37
v_lshlrev_b32 v36, 16, v9
v_and_b32 v37, 0xffff0000, v9
v_add_f32 v36, v36, v76
v_add_f32 v37, v37, v77
v_cvt_pk_bf16_f32 v14, v36, v37
v_mul_f32 v38, v38, v118
v_mul_f32 v39, v39, v119
v_cvt_pk_bf16_f32 v9, v38, v39
v_lshlrev_b32 v38, 16, v9
v_and_b32 v39, 0xffff0000, v9
v_add_f32 v38, v38, v78
v_add_f32 v39, v39, v79
v_cvt_pk_bf16_f32 v15, v38, v39
global_store_dwordx4 v6, v[12:15], s[16:17] offset:-2048 sc1
s_waitcnt vmcnt(15)
v_mul_f32 v40, v40, v120
v_mul_f32 v41, v41, v121
v_cvt_pk_bf16_f32 v9, v40, v41
v_lshlrev_b32 v40, 16, v9
v_and_b32 v41, 0xffff0000, v9
v_add_f32 v40, v40, v80
v_add_f32 v41, v41, v81
v_cvt_pk_bf16_f32 v16, v40, v41
v_mul_f32 v42, v42, v122
v_mul_f32 v43, v43, v123
v_cvt_pk_bf16_f32 v9, v42, v43
v_lshlrev_b32 v42, 16, v9
v_and_b32 v43, 0xffff0000, v9
v_add_f32 v42, v42, v82
v_add_f32 v43, v43, v83
v_cvt_pk_bf16_f32 v17, v42, v43
s_waitcnt vmcnt(13)
v_mul_f32 v44, v44, v124
v_mul_f32 v45, v45, v125
v_cvt_pk_bf16_f32 v9, v44, v45
v_lshlrev_b32 v44, 16, v9
v_and_b32 v45, 0xffff0000, v9
v_add_f32 v44, v44, v84
v_add_f32 v45, v45, v85
v_cvt_pk_bf16_f32 v18, v44, v45
v_mul_f32 v46, v46, v126
v_mul_f32 v47, v47, v127
v_cvt_pk_bf16_f32 v9, v46, v47
v_lshlrev_b32 v46, 16, v9
v_and_b32 v47, 0xffff0000, v9
v_add_f32 v46, v46, v86
v_add_f32 v47, v47, v87
v_cvt_pk_bf16_f32 v19, v46, v47
global_store_dwordx4 v6, v[16:19], s[16:17] offset:-1024 sc1
s_waitcnt vmcnt(12)
v_mul_f32 v48, v48, v128
v_mul_f32 v49, v49, v129
v_cvt_pk_bf16_f32 v9, v48, v49
v_lshlrev_b32 v48, 16, v9
v_and_b32 v49, 0xffff0000, v9
v_add_f32 v48, v48, v88
v_add_f32 v49, v49, v89
v_cvt_pk_bf16_f32 v20, v48, v49
v_mul_f32 v50, v50, v130
v_mul_f32 v51, v51, v131
v_cvt_pk_bf16_f32 v9, v50, v51
v_lshlrev_b32 v50, 16, v9
v_and_b32 v51, 0xffff0000, v9
v_add_f32 v50, v50, v90
v_add_f32 v51, v51, v91
v_cvt_pk_bf16_f32 v21, v50, v51
s_waitcnt vmcnt(10)
v_mul_f32 v52, v52, v132
v_mul_f32 v53, v53, v133
v_cvt_pk_bf16_f32 v9, v52, v53
v_lshlrev_b32 v52, 16, v9
v_and_b32 v53, 0xffff0000, v9
v_add_f32 v52, v52, v92
v_add_f32 v53, v53, v93
v_cvt_pk_bf16_f32 v22, v52, v53
v_mul_f32 v54, v54, v134
v_mul_f32 v55, v55, v135
v_cvt_pk_bf16_f32 v9, v54, v55
v_lshlrev_b32 v54, 16, v9
v_and_b32 v55, 0xffff0000, v9
v_add_f32 v54, v54, v94
v_add_f32 v55, v55, v95
v_cvt_pk_bf16_f32 v23, v54, v55
global_store_dwordx4 v6, v[20:23], s[16:17] offset:0 sc1
s_waitcnt vmcnt(9)
v_mul_f32 v56, v56, v136
v_mul_f32 v57, v57, v137
v_cvt_pk_bf16_f32 v9, v56, v57
v_lshlrev_b32 v56, 16, v9
v_and_b32 v57, 0xffff0000, v9
v_add_f32 v56, v56, v96
v_add_f32 v57, v57, v97
v_cvt_pk_bf16_f32 v24, v56, v57
v_mul_f32 v58, v58, v138
v_mul_f32 v59, v59, v139
v_cvt_pk_bf16_f32 v9, v58, v59
v_lshlrev_b32 v58, 16, v9
v_and_b32 v59, 0xffff0000, v9
v_add_f32 v58, v58, v98
v_add_f32 v59, v59, v99
v_cvt_pk_bf16_f32 v25, v58, v59
s_waitcnt vmcnt(7)
v_mul_f32 v60, v60, v140
v_mul_f32 v61, v61, v141
v_cvt_pk_bf16_f32 v9, v60, v61
v_lshlrev_b32 v60, 16, v9
v_and_b32 v61, 0xffff0000, v9
v_add_f32 v60, v60, v100
v_add_f32 v61, v61, v101
v_cvt_pk_bf16_f32 v26, v60, v61
v_mul_f32 v62, v62, v142
v_mul_f32 v63, v63, v143
v_cvt_pk_bf16_f32 v9, v62, v63
v_lshlrev_b32 v62, 16, v9
v_and_b32 v63, 0xffff0000, v9
v_add_f32 v62, v62, v102
v_add_f32 v63, v63, v103
v_cvt_pk_bf16_f32 v27, v62, v63
global_store_dwordx4 v6, v[24:27], s[16:17] offset:1024 sc1
s_waitcnt vmcnt(6)
v_mul_f32 v64, v64, v144
v_mul_f32 v65, v65, v145
v_cvt_pk_bf16_f32 v9, v64, v65
v_lshlrev_b32 v64, 16, v9
v_and_b32 v65, 0xffff0000, v9
v_add_f32 v64, v64, v104
v_add_f32 v65, v65, v105
v_cvt_pk_bf16_f32 v28, v64, v65
v_mul_f32 v66, v66, v146
v_mul_f32 v67, v67, v147
v_cvt_pk_bf16_f32 v9, v66, v67
v_lshlrev_b32 v66, 16, v9
v_and_b32 v67, 0xffff0000, v9
v_add_f32 v66, v66, v106
v_add_f32 v67, v67, v107
v_cvt_pk_bf16_f32 v29, v66, v67
s_waitcnt vmcnt(4)
v_mul_f32 v68, v68, v148
v_mul_f32 v69, v69, v149
v_cvt_pk_bf16_f32 v9, v68, v69
v_lshlrev_b32 v68, 16, v9
v_and_b32 v69, 0xffff0000, v9
v_add_f32 v68, v68, v108
v_add_f32 v69, v69, v109
v_cvt_pk_bf16_f32 v30, v68, v69
v_mul_f32 v70, v70, v150
v_mul_f32 v71, v71, v151
v_cvt_pk_bf16_f32 v9, v70, v71
v_lshlrev_b32 v70, 16, v9
v_and_b32 v71, 0xffff0000, v9
v_add_f32 v70, v70, v110
v_add_f32 v71, v71, v111
v_cvt_pk_bf16_f32 v31, v70, v71
global_store_dwordx4 v6, v[28:31], s[16:17] offset:2048 sc1
s_lshr_b32 s13, s2, 6
s_lshl_b32 s13, s13, 8
s_add_u32 s13, s13, 68157440
s_waitcnt vmcnt(0)
s_barrier
s_cmp_lg_u32 s12, 3
s_cbranch_scc1 L_sg_19
s_mov_b64 exec, 1
v_mov_b32 v2, s13
v_mov_b32 v3, 1
global_atomic_add v3, v2, v3, s[8:9] sc0
s_waitcnt vmcnt(0)
v_cmp_ne_u32 vcc, 63, v3
s_nop 0
s_cbranch_vccnz L_ar_20
v_mov_b32 v3, 1
global_store_dword v2, v3, s[8:9] offset:128 sc1
L_ar_20:
s_mov_b64 exec, -1
L_sg_19:
v_mov_b32 v2, 152
s_cmp_lg_u32 s12, 0
s_cbranch_scc1 L_wd_22
s_mov_b32 s96, 0x80000
L_wf_21:
global_load_dword v3, v2, s[94:95] sc1
s_waitcnt vmcnt(0)
v_cmp_gt_u32 vcc, 1, v3
s_nop 0
s_cbranch_vccz L_wd_22
s_sleep 3
s_sub_u32 s96, s96, 1
s_cbranch_scc0 L_wf_21
s_branch L_wabort
L_wd_22:
s_barrier
v_mov_b32 v2, 132
global_load_dword v3, v2, s[94:95] sc1
v_lshlrev_b32 v2, 4, v0
v_mov_b32 v4, -1
v_mov_b32 v8, 0xffbfffbf
v_mov_b32 v20, 0
v_mov_b32 v5, -1
v_mov_b32 v9, 0xffbfffbf
v_mov_b32 v21, 0
v_mov_b32 v6, -1
v_mov_b32 v10, 0xffbfffbf
v_mov_b32 v22, 0
v_mov_b32 v7, -1
v_mov_b32 v11, 0xffbfffbf
v_mov_b32 v23, 0
s_mov_b32 s16, s8
s_mov_b32 s17, s9
s_mov_b32 s19, 0x20000
s_waitcnt vmcnt(0)
v_readfirstlane_b32 s20, v3
v_add_u32 v12, 4096, v2
s_cmp_lt_u32 s90, 64
s_cbranch_scc1 L_fl2_b
s_sub_u32 s50, s90, 64
s_lshl_b32 s50, s50, 1
L_fl2_loop:
s_mov_b32 s18, 0x10000000
s_cmp_lt_u32 s50, 2
s_cbranch_scc1 L_f2_nor
s_bitcmp1_b32 s20, 0
s_cselect_b32 s3, 8192, 0
s_lshl_b32 s13, s50, 14
s_add_u32 s3, s3, s13
s_add_u32 s3, s3, 69206016
s_add_u32 s18, s3, 5120
buffer_store_dwordx4 v[4:7], v2, s[16:19], s3 offen sc1
buffer_store_dwordx4 v[4:7], v12, s[16:19], s3 offen sc1
s_bitcmp1_b32 s20, 1
s_cselect_b32 s3, 8192, 0
s_lshl_b32 s13, s50, 14
s_add_u32 s3, s3, s13
s_add_u32 s3, s3, 71303168
s_add_u32 s18, s3, 5120
buffer_store_dwordx4 v[4:7], v2, s[16:19], s3 offen sc1
buffer_store_dwordx4 v[4:7], v12, s[16:19], s3 offen sc1
s_mov_b32 s18, 0x10000000
L_f2_nor:
s_lshr_b32 s3, s50, 7
s_add_u32 s3, s3, 2
s_bitcmp1_b32 s20, s3
s_cselect_b32 s3, 8192, 0
s_lshl_b32 s13, s50, 14
s_add_u32 s3, s3, s13
s_add_u32 s3, s3, 167772160
buffer_store_dwordx4 v[4:7], v2, s[16:19], s3 offen sc1
buffer_store_dwordx4 v[4:7], v12, s[16:19], s3 offen sc1
s_add_u32 s50, s50, 1
s_bitcmp1_b32 s50, 0
s_cbranch_scc1 L_fl2_loop
s_waitcnt vmcnt(0)
s_barrier
s_cmp_lg_u32 s12, 3
s_cbranch_scc1 L_sg_23
s_mov_b64 exec, 1
v_mov_b32 v16, 64
v_mov_b32 v17, 1
global_atomic_add v17, v16, v17, s[94:95] sc0
s_waitcnt vmcnt(0)
v_cmp_ne_u32 vcc, 137, v17
s_nop 0
s_cbranch_vccnz L_ar_24
v_mov_b32 v17, 1
global_store_dword v16, v17, s[94:95] offset:64 sc1
L_ar_24:
s_mov_b64 exec, -1
L_sg_23:
L_fl2_b:
s_add_u32 s2, s90, 40
s_cmp_ge_u32 s2, 120
s_cbranch_scc1 L_mod_doneb
s_load_dwordx4 s[4:7], s[0:1], 80
v_lshrrev_b32 v1, 2, v0
v_and_b32 v2, 3, v0
v_mul_u32_u24 v3, 7680, v1
v_lshl_add_u32 v3, v2, 4, v3
s_lshl_b32 s3, s2, 6
v_add_u32 v3, s3, v3
v_lshlrev_b32 v4, 1, v1
s_waitcnt lgkmcnt(0)
global_load_ushort v10, v4, s[4:5] offset:0
global_load_ushort v11, v4, s[4:5] offset:128
global_load_ushort v12, v4, s[4:5] offset:256
global_load_ushort v13, v4, s[4:5] offset:384
global_load_ushort v14, v4, s[4:5] offset:512
global_load_ushort v15, v4, s[4:5] offset:640
global_load_ushort v16, v4, s[4:5] offset:768
global_load_ushort v17, v4, s[4:5] offset:896
global_load_ushort v18, v4, s[4:5] offset:1024
global_load_ushort v19, v4, s[4:5] offset:1152
global_load_dwordx4 v[20:23], v3, s[6:7]
v_add_u32 v3, 491520, v3
global_load_dwordx4 v[24:27], v3, s[6:7]
v_add_u32 v3, 491520, v3
global_load_dwordx4 v[28:31], v3, s[6:7]
v_add_u32 v3, 491520, v3
global_load_dwordx4 v[32:35], v3, s[6:7]
v_add_u32 v3, 491520, v3
global_load_dwordx4 v[36:39], v3, s[6:7]
v_add_u32 v3, 491520, v3
global_load_dwordx4 v[40:43], v3, s[6:7]
v_add_u32 v3, 491520, v3
global_load_dwordx4 v[44:47], v3, s[6:7]
v_add_u32 v3, 491520, v3
global_load_dwordx4 v[48:51], v3, s[6:7]
v_add_u32 v3, 491520, v3
global_load_dwordx4 v[52:55], v3, s[6:7]
v_add_u32 v3, 491520, v3
global_load_dwordx4 v[56:59], v3, s[6:7]
s_mov_b32 s10, 0xbfb8aa3b
s_waitcnt vmcnt(10)
v_lshlrev_b32 v10, 16, v10
v_mul_f32 v5, s10, v10
v_exp_f32 v5, v5
s_nop 0
v_add_f32 v5, 1.0, v5
v_rcp_f32 v5, v5
s_nop 0
v_mul_f32 v10, v10, v5
v_cvt_pk_bf16_f32 v10, v10, v10
v_and_b32 v10, 0xffff0000, v10
v_lshlrev_b32 v11, 16, v11
v_mul_f32 v5, s10, v11
v_exp_f32 v5, v5
s_nop 0
v_add_f32 v5, 1.0, v5
v_rcp_f32 v5, v5
s_nop 0
v_mul_f32 v11, v11, v5
v_cvt_pk_bf16_f32 v11, v11, v11
v_and_b32 v11, 0xffff0000, v11
v_lshlrev_b32 v12, 16, v12
v_mul_f32 v5, s10, v12
v_exp_f32 v5, v5
s_nop 0
v_add_f32 v5, 1.0, v5
v_rcp_f32 v5, v5
s_nop 0
v_mul_f32 v12, v12, v5
v_cvt_pk_bf16_f32 v12, v12, v12
v_and_b32 v12, 0xffff0000, v12
v_lshlrev_b32 v13, 16, v13
v_mul_f32 v5, s10, v13
v_exp_f32 v5, v5
s_nop 0
v_add_f32 v5, 1.0, v5
v_rcp_f32 v5, v5
s_nop 0
v_mul_f32 v13, v13, v5
v_cvt_pk_bf16_f32 v13, v13, v13
v_and_b32 v13, 0xffff0000, v13
v_lshlrev_b32 v14, 16, v14
v_mul_f32 v5, s10, v14
v_exp_f32 v5, v5
s_nop 0
v_add_f32 v5, 1.0, v5
v_rcp_f32 v5, v5
s_nop 0
v_mul_f32 v14, v14, v5
v_cvt_pk_bf16_f32 v14, v14, v14
v_and_b32 v14, 0xffff0000, v14
v_lshlrev_b32 v15, 16, v15
v_mul_f32 v5, s10, v15
v_exp_f32 v5, v5
s_nop 0
v_add_f32 v5, 1.0, v5
v_rcp_f32 v5, v5
s_nop 0
v_mul_f32 v15, v15, v5
v_cvt_pk_bf16_f32 v15, v15, v15
v_and_b32 v15, 0xffff0000, v15
v_lshlrev_b32 v16, 16, v16
v_mul_f32 v5, s10, v16
v_exp_f32 v5, v5
s_nop 0
v_add_f32 v5, 1.0, v5
v_rcp_f32 v5, v5
s_nop 0
v_mul_f32 v16, v16, v5
v_cvt_pk_bf16_f32 v16, v16, v16
v_and_b32 v16, 0xffff0000, v16
v_lshlrev_b32 v17, 16, v17
v_mul_f32 v5, s10, v17
v_exp_f32 v5, v5
s_nop 0
v_add_f32 v5, 1.0, v5
v_rcp_f32 v5, v5
s_nop 0
v_mul_f32 v17, v17, v5
v_cvt_pk_bf16_f32 v17, v17, v17
v_and_b32 v17, 0xffff0000, v17
v_lshlrev_b32 v18, 16, v18
v_mul_f32 v5, s10, v18
v_exp_f32 v5, v5
s_nop 0
v_add_f32 v5, 1.0, v5
v_rcp_f32 v5, v5
s_nop 0
v_mul_f32 v18, v18, v5
v_cvt_pk_bf16_f32 v18, v18, v18
v_and_b32 v18, 0xffff0000, v18
v_lshlrev_b32 v19, 16, v19
v_mul_f32 v5, s10, v19
v_exp_f32 v5, v5
s_nop 0
v_add_f32 v5, 1.0, v5
v_rcp_f32 v5, v5
s_nop 0
v_mul_f32 v19, v19, v5
v_cvt_pk_bf16_f32 v19, v19, v19
v_and_b32 v19, 0xffff0000, v19
v_mov_b32 v60, 0
v_mov_b32 v61, 0
v_mov_b32 v62, 0
v_mov_b32 v63, 0
v_mov_b32 v64, 0
v_mov_b32 v65, 0
v_mov_b32 v66, 0
v_mov_b32 v67, 0
s_waitcnt vmcnt(9)
v_lshlrev_b32 v5, 16, v20
v_and_b32 v6, 0xffff0000, v20
v_fmac_f32 v60, v5, v10
v_fmac_f32 v61, v6, v10
v_lshlrev_b32 v5, 16, v21
v_and_b32 v6, 0xffff0000, v21
v_fmac_f32 v62, v5, v10
v_fmac_f32 v63, v6, v10
v_lshlrev_b32 v5, 16, v22
v_and_b32 v6, 0xffff0000, v22
v_fmac_f32 v64, v5, v10
v_fmac_f32 v65, v6, v10
v_lshlrev_b32 v5, 16, v23
v_and_b32 v6, 0xffff0000, v23
v_fmac_f32 v66, v5, v10
v_fmac_f32 v67, v6, v10
s_waitcnt vmcnt(8)
v_lshlrev_b32 v5, 16, v24
v_and_b32 v6, 0xffff0000, v24
v_fmac_f32 v60, v5, v11
v_fmac_f32 v61, v6, v11
v_lshlrev_b32 v5, 16, v25
v_and_b32 v6, 0xffff0000, v25
v_fmac_f32 v62, v5, v11
v_fmac_f32 v63, v6, v11
v_lshlrev_b32 v5, 16, v26
v_and_b32 v6, 0xffff0000, v26
v_fmac_f32 v64, v5, v11
v_fmac_f32 v65, v6, v11
v_lshlrev_b32 v5, 16, v27
v_and_b32 v6, 0xffff0000, v27
v_fmac_f32 v66, v5, v11
v_fmac_f32 v67, v6, v11
s_waitcnt vmcnt(7)
v_lshlrev_b32 v5, 16, v28
v_and_b32 v6, 0xffff0000, v28
v_fmac_f32 v60, v5, v12
v_fmac_f32 v61, v6, v12
v_lshlrev_b32 v5, 16, v29
v_and_b32 v6, 0xffff0000, v29
v_fmac_f32 v62, v5, v12
v_fmac_f32 v63, v6, v12
v_lshlrev_b32 v5, 16, v30
v_and_b32 v6, 0xffff0000, v30
v_fmac_f32 v64, v5, v12
v_fmac_f32 v65, v6, v12
v_lshlrev_b32 v5, 16, v31
v_and_b32 v6, 0xffff0000, v31
v_fmac_f32 v66, v5, v12
v_fmac_f32 v67, v6, v12
s_waitcnt vmcnt(6)
v_lshlrev_b32 v5, 16, v32
v_and_b32 v6, 0xffff0000, v32
v_fmac_f32 v60, v5, v13
v_fmac_f32 v61, v6, v13
v_lshlrev_b32 v5, 16, v33
v_and_b32 v6, 0xffff0000, v33
v_fmac_f32 v62, v5, v13
v_fmac_f32 v63, v6, v13
v_lshlrev_b32 v5, 16, v34
v_and_b32 v6, 0xffff0000, v34
v_fmac_f32 v64, v5, v13
v_fmac_f32 v65, v6, v13
v_lshlrev_b32 v5, 16, v35
v_and_b32 v6, 0xffff0000, v35
v_fmac_f32 v66, v5, v13
v_fmac_f32 v67, v6, v13
s_waitcnt vmcnt(5)
v_lshlrev_b32 v5, 16, v36
v_and_b32 v6, 0xffff0000, v36
v_fmac_f32 v60, v5, v14
v_fmac_f32 v61, v6, v14
v_lshlrev_b32 v5, 16, v37
v_and_b32 v6, 0xffff0000, v37
v_fmac_f32 v62, v5, v14
v_fmac_f32 v63, v6, v14
v_lshlrev_b32 v5, 16, v38
v_and_b32 v6, 0xffff0000, v38
v_fmac_f32 v64, v5, v14
v_fmac_f32 v65, v6, v14
v_lshlrev_b32 v5, 16, v39
v_and_b32 v6, 0xffff0000, v39
v_fmac_f32 v66, v5, v14
v_fmac_f32 v67, v6, v14
s_waitcnt vmcnt(4)
v_lshlrev_b32 v5, 16, v40
v_and_b32 v6, 0xffff0000, v40
v_fmac_f32 v60, v5, v15
v_fmac_f32 v61, v6, v15
v_lshlrev_b32 v5, 16, v41
v_and_b32 v6, 0xffff0000, v41
v_fmac_f32 v62, v5, v15
v_fmac_f32 v63, v6, v15
v_lshlrev_b32 v5, 16, v42
v_and_b32 v6, 0xffff0000, v42
v_fmac_f32 v64, v5, v15
v_fmac_f32 v65, v6, v15
v_lshlrev_b32 v5, 16, v43
v_and_b32 v6, 0xffff0000, v43
v_fmac_f32 v66, v5, v15
v_fmac_f32 v67, v6, v15
s_waitcnt vmcnt(3)
v_lshlrev_b32 v5, 16, v44
v_and_b32 v6, 0xffff0000, v44
v_fmac_f32 v60, v5, v16
v_fmac_f32 v61, v6, v16
v_lshlrev_b32 v5, 16, v45
v_and_b32 v6, 0xffff0000, v45
v_fmac_f32 v62, v5, v16
v_fmac_f32 v63, v6, v16
v_lshlrev_b32 v5, 16, v46
v_and_b32 v6, 0xffff0000, v46
v_fmac_f32 v64, v5, v16
v_fmac_f32 v65, v6, v16
v_lshlrev_b32 v5, 16, v47
v_and_b32 v6, 0xffff0000, v47
v_fmac_f32 v66, v5, v16
v_fmac_f32 v67, v6, v16
s_waitcnt vmcnt(2)
v_lshlrev_b32 v5, 16, v48
v_and_b32 v6, 0xffff0000, v48
v_fmac_f32 v60, v5, v17
v_fmac_f32 v61, v6, v17
v_lshlrev_b32 v5, 16, v49
v_and_b32 v6, 0xffff0000, v49
v_fmac_f32 v62, v5, v17
v_fmac_f32 v63, v6, v17
v_lshlrev_b32 v5, 16, v50
v_and_b32 v6, 0xffff0000, v50
v_fmac_f32 v64, v5, v17
v_fmac_f32 v65, v6, v17
v_lshlrev_b32 v5, 16, v51
v_and_b32 v6, 0xffff0000, v51
v_fmac_f32 v66, v5, v17
v_fmac_f32 v67, v6, v17
s_waitcnt vmcnt(1)
v_lshlrev_b32 v5, 16, v52
v_and_b32 v6, 0xffff0000, v52
v_fmac_f32 v60, v5, v18
v_fmac_f32 v61, v6, v18
v_lshlrev_b32 v5, 16, v53
v_and_b32 v6, 0xffff0000, v53
v_fmac_f32 v62, v5, v18
v_fmac_f32 v63, v6, v18
v_lshlrev_b32 v5, 16, v54
v_and_b32 v6, 0xffff0000, v54
v_fmac_f32 v64, v5, v18
v_fmac_f32 v65, v6, v18
v_lshlrev_b32 v5, 16, v55
v_and_b32 v6, 0xffff0000, v55
v_fmac_f32 v66, v5, v18
v_fmac_f32 v67, v6, v18
s_waitcnt vmcnt(0)
v_lshlrev_b32 v5, 16, v56
v_and_b32 v6, 0xffff0000, v56
v_fmac_f32 v60, v5, v19
v_fmac_f32 v61, v6, v19
v_lshlrev_b32 v5, 16, v57
v_and_b32 v6, 0xffff0000, v57
v_fmac_f32 v62, v5, v19
v_fmac_f32 v63, v6, v19
v_lshlrev_b32 v5, 16, v58
v_and_b32 v6, 0xffff0000, v58
v_fmac_f32 v64, v5, v19
v_fmac_f32 v65, v6, v19
v_lshlrev_b32 v5, 16, v59
v_and_b32 v6, 0xffff0000, v59
v_fmac_f32 v66, v5, v19
v_fmac_f32 v67, v6, v19
v_add_f32_dpp v60, v60, v60 row_ror:4 row_mask:0xf bank_mask:0xf
v_add_f32_dpp v61, v61, v61 row_ror:4 row_mask:0xf bank_mask:0xf
v_add_f32_dpp v62, v62, v62 row_ror:4 row_mask:0xf bank_mask:0xf
v_add_f32_dpp v63, v63, v63 row_ror:4 row_mask:0xf bank_mask:0xf
v_add_f32_dpp v64, v64, v64 row_ror:4 row_mask:0xf bank_mask:0xf
v_add_f32_dpp v65, v65, v65 row_ror:4 row_mask:0xf bank_mask:0xf
v_add_f32_dpp v66, v66, v66 row_ror:4 row_mask:0xf bank_mask:0xf
v_add_f32_dpp v67, v67, v67 row_ror:4 row_mask:0xf bank_mask:0xf
v_add_f32_dpp v60, v60, v60 row_ror:8 row_mask:0xf bank_mask:0xf
v_add_f32_dpp v61, v61, v61 row_ror:8 row_mask:0xf bank_mask:0xf
v_add_f32_dpp v62, v62, v62 row_ror:8 row_mask:0xf bank_mask:0xf
v_add_f32_dpp v63, v63, v63 row_ror:8 row_mask:0xf bank_mask:0xf
v_add_f32_dpp v64, v64, v64 row_ror:8 row_mask:0xf bank_mask:0xf
v_add_f32_dpp v65, v65, v65 row_ror:8 row_mask:0xf bank_mask:0xf
v_add_f32_dpp v66, v66, v66 row_ror:8 row_mask:0xf bank_mask:0xf
v_add_f32_dpp v67, v67, v67 row_ror:8 row_mask:0xf bank_mask:0xf
v_lshrrev_b32 v5, 4, v0
v_lshlrev_b32 v5, 7, v5
v_lshl_add_u32 v5, v2, 5, v5
v_and_b32 v6, 12, v0
v_cmp_eq_u32 vcc, 0, v6
s_nop 0
s_and_saveexec_b64 s[14:15], vcc
ds_write_b128 v5, v[60:63]
ds_write_b128 v5, v[64:67] offset:16
s_mov_b64 exec, s[14:15]
s_waitcnt lgkmcnt(0)
s_barrier
s_cmp_lg_u32 s12, 0
s_cbranch_scc1 L_mod_doneb
v_and_b32 v7, 31, v0
v_lshlrev_b32 v5, 2, v7
ds_read2_b32 v[20:21], v5 offset0:0 offset1:32
ds_read2_b32 v[22:23], v5 offset0:64 offset1:96
ds_read2_b32 v[24:25], v5 offset0:128 offset1:160
ds_read2_b32 v[26:27], v5 offset0:192 offset1:224
v_add_u32 v5, 1024, v5
ds_read2_b32 v[28:29], v5 offset0:0 offset1:32
ds_read2_b32 v[30:31], v5 offset0:64 offset1:96
ds_read2_b32 v[32:33], v5 offset0:128 offset1:160
ds_read2_b32 v[34:35], v5 offset0:192 offset1:224
s_waitcnt lgkmcnt(0)
v_add_f32 v20, v20, v28
v_add_f32 v21, v21, v29
v_add_f32 v22, v22, v30
v_add_f32 v23, v23, v31
v_add_f32 v24, v24, v32
v_add_f32 v25, v25, v33
v_add_f32 v26, v26, v34
v_add_f32 v27, v27, v35
v_add_f32 v20, v20, v24
v_add_f32 v21, v21, v25
v_add_f32 v22, v22, v26
v_add_f32 v23, v23, v27
v_add_f32 v20, v20, v22
v_add_f32 v21, v21, v23
v_add_f32 v20, v20, v21
v_cvt_pk_bf16_f32 v20, v20, v20
v_and_b32 v20, 0xffff0000, v20
v_add_f32 v21, 1.0, v20
v_cvt_pk_bf16_f32 v21, v21, v21
v_and_b32 v21, 0xffff0000, v21
s_sub_u32 s14, s2, 20
s_cmp_lt_u32 s14, 20
s_cselect_b32 s15, 1, 0
s_sub_u32 s14, s2, 80
s_cmp_lt_u32 s14, 20
s_cselect_b32 s15, 1, s15
s_cmp_eq_u32 s15, 1
s_cselect_b64 vcc, -1, 0
v_cndmask_b32 v20, v20, v21, vcc
s_lshl_b32 s3, s2, 7
s_add_u32 s3, s3, 62914560
v_lshlrev_b32 v5, 2, v7
v_add_u32 v5, s3, v5
global_store_dword v5, v20, s[8:9] sc1
s_waitcnt vmcnt(0)
s_mov_b64 exec, 1
v_mov_b32 v5, 16
v_mov_b32 v6, 1
global_atomic_add v6, v5, v6, s[94:95] sc0
s_waitcnt vmcnt(0)
v_cmp_ne_u32 vcc, 79, v6
s_nop 0
s_cbranch_vccnz L_ar_26
v_mov_b32 v6, 1
global_store_dword v5, v6, s[94:95] offset:128 sc1
L_ar_26:
s_mov_b64 exec, -1
L_sg_25:
L_mod_doneb:
v_mov_b32 v2, 148
s_cmp_lg_u32 s12, 0
s_cbranch_scc1 L_wd_28
s_mov_b32 s96, 0x80000
L_wf_27:
global_load_dword v3, v2, s[94:95] sc1
s_waitcnt vmcnt(0)
v_cmp_gt_u32 vcc, 1, v3
s_nop 0
s_cbranch_vccz L_wd_28
s_sleep 16
s_sub_u32 s96, s96, 1
s_cbranch_scc0 L_wf_27
s_branch L_wabort
L_wd_28:
s_barrier
v_lshlrev_b32 v2, 4, v0
v_add_u32 v12, 4096, v2
v_mov_b32 v4, -1
v_mov_b32 v20, 0
v_mov_b32 v5, -1
v_mov_b32 v21, 0
v_mov_b32 v6, -1
v_mov_b32 v22, 0
v_mov_b32 v7, -1
v_mov_b32 v23, 0
s_mov_b32 s18, 74055680
s_lshl_b32 s3, s90, 13
s_add_u32 s3, s3, 73400320
buffer_store_dwordx4 v[20:23], v2, s[16:19], s3 offen sc1
buffer_store_dwordx4 v[20:23], v12, s[16:19], s3 offen sc1
s_mov_b32 s18, 0x10000000
s_mov_b32 s50, s90
s_add_u32 s50, s50, 128
s_lshr_b32 s3, s50, 7
s_add_u32 s3, s3, 2
s_bitcmp1_b32 s20, s3
s_cselect_b32 s3, 8192, 0
s_lshl_b32 s13, s50, 14
s_add_u32 s3, s3, s13
s_add_u32 s3, s3, 167772160
buffer_store_dwordx4 v[4:7], v2, s[16:19], s3 offen sc1
buffer_store_dwordx4 v[4:7], v12, s[16:19], s3 offen sc1
s_add_u32 s50, s50, 128
s_lshr_b32 s3, s50, 7
s_add_u32 s3, s3, 2
s_bitcmp1_b32 s20, s3
s_cselect_b32 s3, 8192, 0
s_lshl_b32 s13, s50, 14
s_add_u32 s3, s3, s13
s_add_u32 s3, s3, 167772160
buffer_store_dwordx4 v[4:7], v2, s[16:19], s3 offen sc1
buffer_store_dwordx4 v[4:7], v12, s[16:19], s3 offen sc1
s_add_u32 s50, s50, 128
s_lshr_b32 s3, s50, 7
s_add_u32 s3, s3, 2
s_bitcmp1_b32 s20, s3
s_cselect_b32 s3, 8192, 0
s_lshl_b32 s13, s50, 14
s_add_u32 s3, s3, s13
s_add_u32 s3, s3, 167772160
buffer_store_dwordx4 v[4:7], v2, s[16:19], s3 offen sc1
buffer_store_dwordx4 v[4:7], v12, s[16:19], s3 offen sc1
s_add_u32 s50, s50, 128
s_lshr_b32 s3, s50, 7
s_add_u32 s3, s3, 2
s_bitcmp1_b32 s20, s3
s_cselect_b32 s3, 8192, 0
s_lshl_b32 s13, s50, 14
s_add_u32 s3, s3, s13
s_add_u32 s3, s3, 167772160
buffer_store_dwordx4 v[4:7], v2, s[16:19], s3 offen sc1
buffer_store_dwordx4 v[4:7], v12, s[16:19], s3 offen sc1
s_add_u32 s50, s50, 128
s_lshr_b32 s3, s50, 7
s_add_u32 s3, s3, 2
s_bitcmp1_b32 s20, s3
s_cselect_b32 s3, 8192, 0
s_lshl_b32 s13, s50, 14
s_add_u32 s3, s3, s13
s_add_u32 s3, s3, 167772160
buffer_store_dwordx4 v[4:7], v2, s[16:19], s3 offen sc1
buffer_store_dwordx4 v[4:7], v12, s[16:19], s3 offen sc1
s_add_u32 s50, s50, 128
s_lshr_b32 s3, s50, 7
s_add_u32 s3, s3, 2
s_bitcmp1_b32 s20, s3
s_cselect_b32 s3, 8192, 0
s_lshl_b32 s13, s50, 14
s_add_u32 s3, s3, s13
s_add_u32 s3, s3, 167772160
buffer_store_dwordx4 v[4:7], v2, s[16:19], s3 offen sc1
buffer_store_dwordx4 v[4:7], v12, s[16:19], s3 offen sc1
s_add_u32 s50, s50, 128
s_lshr_b32 s3, s50, 7
s_add_u32 s3, s3, 2
s_bitcmp1_b32 s20, s3
s_cselect_b32 s3, 8192, 0
s_lshl_b32 s13, s50, 14
s_add_u32 s3, s3, s13
s_add_u32 s3, s3, 167772160
buffer_store_dwordx4 v[4:7], v2, s[16:19], s3 offen sc1
buffer_store_dwordx4 v[4:7], v12, s[16:19], s3 offen sc1
s_waitcnt vmcnt(0)
s_barrier
s_cmp_lg_u32 s12, 3
s_cbranch_scc1 L_sg_29
s_mov_b64 exec, 1
v_mov_b32 v16, 28
v_mov_b32 v17, 1
global_atomic_add v17, v16, v17, s[94:95] sc0
s_waitcnt vmcnt(0)
v_cmp_ne_u32 vcc, 127, v17
s_nop 0
s_cbranch_vccnz L_ar_30
v_mov_b32 v17, 1
global_store_dword v16, v17, s[94:95] offset:128 sc1
L_ar_30:
s_mov_b64 exec, -1
L_sg_29:
L_ln1_done:
s_load_dwordx4 s[4:7], s[0:1], 16
s_load_dwordx2 s[10:11], s[0:1], 32
v_and_b32 v1, 63, v0
s_and_b32 s14, s90, 31
s_lshr_b32 s40, s90, 5
s_add_u32 s3, s40, 2
s_sub_u32 s40, s40, 4
s_cmp_lt_u32 s90, 64
s_cselect_b32 s40, s3, s40
s_sub_u32 s3, s90, 64
s_lshr_b32 s13, s3, 4
s_and_b32 s15, s3, 15
s_add_u32 s15, s15, 32
s_cmp_lt_u32 s3, 64
s_cselect_b32 s40, s13, s40
s_cselect_b32 s14, s15, s14
s_waitcnt lgkmcnt(0)
s_lshr_b32 s41, s14, 4
s_and_b32 s42, s14, 15
s_cmp_eq_u32 s41, 1
s_cselect_b32 s6, s10, s6
s_cselect_b32 s7, s11, s7
s_cmp_eq_u32 s41, 2
s_cselect_b32 s6, s4, s6
s_cselect_b32 s7, s5, s7
s_lshl_b32 s3, s42, 9
s_lshl_b32 s17, s12, 7
s_add_u32 s3, s3, s17
s_add_u32 s6, s6, s3
s_addc_u32 s7, s7, 0
s_add_u32 s3, s40, 30
s_cmp_lt_u32 s40, 2
s_cselect_b32 s44, s40, s3
s_cselect_b32 s45, 32, 64
v_lshrrev_b32 v2, 3, v1
v_bfe_u32 v3, v1, 1, 2
v_bfe_u32 v4, v1, 4, 2
v_xor_b32 v3, v3, v4
v_mul_u32_u24 v2, 8192, v2
v_lshl_add_u32 v2, v3, 5, v2
v_and_b32 v3, 1, v1
v_lshl_add_u32 v2, v3, 4, v2
s_mul_i32 s20, s12, 36864
s_add_u32 s20, s20, 16384
v_lshrrev_b32 v3, 2, v1
v_bfe_u32 v8, v1, 3, 2
v_and_b32 v9, 3, v1
v_lshlrev_b32 v9, 3, v9
v_lshl_add_u32 v9, v3, 7, v9
v_add_u32 v9, s20, v9
v_xor_b32 v3, 0, v8
v_lshl_add_u32 v4, v3, 5, v9
v_xor_b32 v3, 1, v8
v_lshl_add_u32 v5, v3, 5, v9
v_xor_b32 v3, 2, v8
v_lshl_add_u32 v6, v3, 5, v9
v_xor_b32 v3, 3, v8
v_lshl_add_u32 v7, v3, 5, v9
s_add_u32 m0, s20, 0
s_nop 0
global_load_lds_dwordx4 v2, s[6:7]
s_add_u32 s6, s6, 65536
s_addc_u32 s7, s7, 0
s_add_u32 m0, s20, 1024
s_nop 0
global_load_lds_dwordx4 v2, s[6:7]
s_add_u32 s6, s6, 65536
s_addc_u32 s7, s7, 0
s_add_u32 m0, s20, 2048
s_nop 0
global_load_lds_dwordx4 v2, s[6:7]
s_add_u32 s6, s6, 65536
s_addc_u32 s7, s7, 0
s_add_u32 m0, s20, 3072
s_nop 0
global_load_lds_dwordx4 v2, s[6:7]
s_add_u32 s6, s6, 65536
s_addc_u32 s7, s7, 0
s_add_u32 m0, s20, 4096
s_nop 0
global_load_lds_dwordx4 v2, s[6:7]
s_add_u32 s6, s6, 65536
s_addc_u32 s7, s7, 0
s_add_u32 m0, s20, 5120
s_nop 0
global_load_lds_dwordx4 v2, s[6:7]
s_add_u32 s6, s6, 65536
s_addc_u32 s7, s7, 0
s_add_u32 m0, s20, 6144
s_nop 0
global_load_lds_dwordx4 v2, s[6:7]
s_add_u32 s6, s6, 65536
s_addc_u32 s7, s7, 0
s_add_u32 m0, s20, 7168
s_nop 0
global_load_lds_dwordx4 v2, s[6:7]
s_add_u32 s6, s6, 65536
s_addc_u32 s7, s7, 0
s_add_u32 m0, s20, 8192
s_nop 0
global_load_lds_dwordx4 v2, s[6:7]
s_add_u32 s6, s6, 65536
s_addc_u32 s7, s7, 0
s_add_u32 m0, s20, 9216
s_nop 0
global_load_lds_dwordx4 v2, s[6:7]
s_add_u32 s6, s6, 65536
s_addc_u32 s7, s7, 0
s_add_u32 m0, s20, 10240
s_nop 0
global_load_lds_dwordx4 v2, s[6:7]
s_add_u32 s6, s6, 65536
s_addc_u32 s7, s7, 0
s_add_u32 m0, s20, 11264
s_nop 0
global_load_lds_dwordx4 v2, s[6:7]
s_add_u32 s6, s6, 65536
s_addc_u32 s7, s7, 0
s_add_u32 m0, s20, 12288
s_nop 0
global_load_lds_dwordx4 v2, s[6:7]
s_add_u32 s6, s6, 65536
s_addc_u32 s7, s7, 0
s_add_u32 m0, s20, 13312
s_nop 0
global_load_lds_dwordx4 v2, s[6:7]
s_add_u32 s6, s6, 65536
s_addc_u32 s7, s7, 0
s_add_u32 m0, s20, 14336
s_nop 0
global_load_lds_dwordx4 v2, s[6:7]
s_add_u32 s6, s6, 65536
s_addc_u32 s7, s7, 0
s_add_u32 m0, s20, 15360
s_nop 0
global_load_lds_dwordx4 v2, s[6:7]
s_add_u32 s6, s6, 65536
s_addc_u32 s7, s7, 0
s_add_u32 m0, s20, 16384
s_nop 0
global_load_lds_dwordx4 v2, s[6:7]
s_add_u32 s6, s6, 65536
s_addc_u32 s7, s7, 0
s_add_u32 m0, s20, 17408
s_nop 0
global_load_lds_dwordx4 v2, s[6:7]
s_add_u32 s6, s6, 65536
s_addc_u32 s7, s7, 0
s_add_u32 m0, s20, 18432
s_nop 0
global_load_lds_dwordx4 v2, s[6:7]
s_add_u32 s6, s6, 65536
s_addc_u32 s7, s7, 0
s_add_u32 m0, s20, 19456
s_nop 0
global_load_lds_dwordx4 v2, s[6:7]
s_add_u32 s6, s6, 65536
s_addc_u32 s7, s7, 0
s_add_u32 m0, s20, 20480
s_nop 0
global_load_lds_dwordx4 v2, s[6:7]
s_add_u32 s6, s6, 65536
s_addc_u32 s7, s7, 0
s_add_u32 m0, s20, 21504
s_nop 0
global_load_lds_dwordx4 v2, s[6:7]
s_add_u32 s6, s6, 65536
s_addc_u32 s7, s7, 0
s_add_u32 m0, s20, 22528
s_nop 0
global_load_lds_dwordx4 v2, s[6:7]
s_add_u32 s6, s6, 65536
s_addc_u32 s7, s7, 0
s_add_u32 m0, s20, 23552
s_nop 0
global_load_lds_dwordx4 v2, s[6:7]
s_add_u32 s6, s6, 65536
s_addc_u32 s7, s7, 0
s_add_u32 m0, s20, 24576
s_nop 0
global_load_lds_dwordx4 v2, s[6:7]
s_add_u32 s6, s6, 65536
s_addc_u32 s7, s7, 0
s_add_u32 m0, s20, 25600
s_nop 0
global_load_lds_dwordx4 v2, s[6:7]
s_add_u32 s6, s6, 65536
s_addc_u32 s7, s7, 0
s_add_u32 m0, s20, 26624
s_nop 0
global_load_lds_dwordx4 v2, s[6:7]
s_add_u32 s6, s6, 65536
s_addc_u32 s7, s7, 0
s_add_u32 m0, s20, 27648
s_nop 0
global_load_lds_dwordx4 v2, s[6:7]
s_add_u32 s6, s6, 65536
s_addc_u32 s7, s7, 0
s_add_u32 m0, s20, 28672
s_nop 0
global_load_lds_dwordx4 v2, s[6:7]
s_add_u32 s6, s6, 65536
s_addc_u32 s7, s7, 0
s_add_u32 m0, s20, 29696
s_nop 0
global_load_lds_dwordx4 v2, s[6:7]
s_add_u32 s6, s6, 65536
s_addc_u32 s7, s7, 0
s_add_u32 m0, s20, 30720
s_nop 0
global_load_lds_dwordx4 v2, s[6:7]
s_add_u32 s6, s6, 65536
s_addc_u32 s7, s7, 0
s_add_u32 m0, s20, 31744
s_nop 0
global_load_lds_dwordx4 v2, s[6:7]
s_add_u32 s6, s6, 65536
s_addc_u32 s7, s7, 0
s_add_u32 m0, s20, 32768
s_nop 0
global_load_lds_dwordx4 v2, s[6:7]
s_add_u32 s6, s6, 65536
s_addc_u32 s7, s7, 0
s_add_u32 m0, s20, 33792
s_nop 0
global_load_lds_dwordx4 v2, s[6:7]
s_add_u32 s6, s6, 65536
s_addc_u32 s7, s7, 0
s_add_u32 m0, s20, 34816
s_nop 0
global_load_lds_dwordx4 v2, s[6:7]
s_add_u32 s6, s6, 65536
s_addc_u32 s7, s7, 0
s_add_u32 m0, s20, 35840
s_nop 0
global_load_lds_dwordx4 v2, s[6:7]
s_add_u32 s6, s6, 65536
s_addc_u32 s7, s7, 0
s_waitcnt vmcnt(32)
ds_read_b64_tr_b16 a[0:1], v4 offset:0
ds_read_b64_tr_b16 a[2:3], v4 offset:2048
ds_read_b64_tr_b16 a[80:81], v5 offset:0
ds_read_b64_tr_b16 a[82:83], v5 offset:2048
ds_read_b64_tr_b16 a[160:161], v6 offset:0
ds_read_b64_tr_b16 a[162:163], v6 offset:2048
ds_read_b64_tr_b16 a[240:241], v7 offset:0
ds_read_b64_tr_b16 a[242:243], v7 offset:2048
s_waitcnt vmcnt(28)
ds_read_b64_tr_b16 a[4:5], v4 offset:4096
ds_read_b64_tr_b16 a[6:7], v4 offset:6144
ds_read_b64_tr_b16 a[84:85], v5 offset:4096
ds_read_b64_tr_b16 a[86:87], v5 offset:6144
ds_read_b64_tr_b16 a[164:165], v6 offset:4096
ds_read_b64_tr_b16 a[166:167], v6 offset:6144
ds_read_b64_tr_b16 a[244:245], v7 offset:4096
ds_read_b64_tr_b16 a[246:247], v7 offset:6144
s_waitcnt lgkmcnt(8)
s_add_u32 m0, s20, 0
s_nop 0
global_load_lds_dwordx4 v2, s[6:7]
s_add_u32 s6, s6, 65536
s_addc_u32 s7, s7, 0
s_add_u32 m0, s20, 1024
s_nop 0
global_load_lds_dwordx4 v2, s[6:7]
s_add_u32 s6, s6, 65536
s_addc_u32 s7, s7, 0
s_add_u32 m0, s20, 2048
s_nop 0
global_load_lds_dwordx4 v2, s[6:7]
s_add_u32 s6, s6, 65536
s_addc_u32 s7, s7, 0
s_add_u32 m0, s20, 3072
s_nop 0
global_load_lds_dwordx4 v2, s[6:7]
s_add_u32 s6, s6, 65536
s_addc_u32 s7, s7, 0
s_waitcnt vmcnt(28)
ds_read_b64_tr_b16 a[8:9], v4 offset:8192
ds_read_b64_tr_b16 a[10:11], v4 offset:10240
ds_read_b64_tr_b16 a[88:89], v5 offset:8192
ds_read_b64_tr_b16 a[90:91], v5 offset:10240
ds_read_b64_tr_b16 a[168:169], v6 offset:8192
ds_read_b64_tr_b16 a[170:171], v6 offset:10240
ds_read_b64_tr_b16 a[248:249], v7 offset:8192
ds_read_b64_tr_b16 a[250:251], v7 offset:10240
s_waitcnt lgkmcnt(8)
s_add_u32 m0, s20, 4096
s_nop 0
global_load_lds_dwordx4 v2, s[6:7]
s_add_u32 s6, s6, 65536
s_addc_u32 s7, s7, 0
s_add_u32 m0, s20, 5120
s_nop 0
global_load_lds_dwordx4 v2, s[6:7]
s_add_u32 s6, s6, 65536
s_addc_u32 s7, s7, 0
s_add_u32 m0, s20, 6144
s_nop 0
global_load_lds_dwordx4 v2, s[6:7]
s_add_u32 s6, s6, 65536
s_addc_u32 s7, s7, 0
s_add_u32 m0, s20, 7168
s_nop 0
global_load_lds_dwordx4 v2, s[6:7]
s_add_u32 s6, s6, 65536
s_addc_u32 s7, s7, 0
s_waitcnt vmcnt(28)
ds_read_b64_tr_b16 a[12:13], v4 offset:12288
ds_read_b64_tr_b16 a[14:15], v4 offset:14336
ds_read_b64_tr_b16 a[92:93], v5 offset:12288
ds_read_b64_tr_b16 a[94:95], v5 offset:14336
ds_read_b64_tr_b16 a[172:173], v6 offset:12288
ds_read_b64_tr_b16 a[174:175], v6 offset:14336
ds_read_b64_tr_b16 a[252:253], v7 offset:12288
ds_read_b64_tr_b16 a[254:255], v7 offset:14336
s_waitcnt lgkmcnt(8)
s_add_u32 m0, s20, 8192
s_nop 0
global_load_lds_dwordx4 v2, s[6:7]
s_add_u32 s6, s6, 65536
s_addc_u32 s7, s7, 0
s_add_u32 m0, s20, 9216
s_nop 0
global_load_lds_dwordx4 v2, s[6:7]
s_add_u32 s6, s6, 65536
s_addc_u32 s7, s7, 0
s_add_u32 m0, s20, 10240
s_nop 0
global_load_lds_dwordx4 v2, s[6:7]
s_add_u32 s6, s6, 65536
s_addc_u32 s7, s7, 0
s_add_u32 m0, s20, 11264
s_nop 0
global_load_lds_dwordx4 v2, s[6:7]
s_add_u32 s6, s6, 65536
s_addc_u32 s7, s7, 0
s_waitcnt vmcnt(28)
ds_read_b64_tr_b16 a[16:17], v4 offset:16384
ds_read_b64_tr_b16 a[18:19], v4 offset:18432
ds_read_b64_tr_b16 a[96:97], v5 offset:16384
ds_read_b64_tr_b16 a[98:99], v5 offset:18432
ds_read_b64_tr_b16 a[176:177], v6 offset:16384
ds_read_b64_tr_b16 a[178:179], v6 offset:18432
ds_read_b64_tr_b16 v[192:193], v7 offset:16384
ds_read_b64_tr_b16 v[194:195], v7 offset:18432
s_waitcnt lgkmcnt(8)
s_add_u32 m0, s20, 12288
s_nop 0
global_load_lds_dwordx4 v2, s[6:7]
s_add_u32 s6, s6, 65536
s_addc_u32 s7, s7, 0
s_add_u32 m0, s20, 13312
s_nop 0
global_load_lds_dwordx4 v2, s[6:7]
s_add_u32 s6, s6, 65536
s_addc_u32 s7, s7, 0
s_add_u32 m0, s20, 14336
s_nop 0
global_load_lds_dwordx4 v2, s[6:7]
s_add_u32 s6, s6, 65536
s_addc_u32 s7, s7, 0
s_add_u32 m0, s20, 15360
s_nop 0
global_load_lds_dwordx4 v2, s[6:7]
s_add_u32 s6, s6, 65536
s_addc_u32 s7, s7, 0
s_waitcnt vmcnt(28)
ds_read_b64_tr_b16 a[20:21], v4 offset:20480
ds_read_b64_tr_b16 a[22:23], v4 offset:22528
ds_read_b64_tr_b16 a[100:101], v5 offset:20480
ds_read_b64_tr_b16 a[102:103], v5 offset:22528
ds_read_b64_tr_b16 a[180:181], v6 offset:20480
ds_read_b64_tr_b16 a[182:183], v6 offset:22528
ds_read_b64_tr_b16 v[196:197], v7 offset:20480
ds_read_b64_tr_b16 v[198:199], v7 offset:22528
s_waitcnt lgkmcnt(8)
s_add_u32 m0, s20, 16384
s_nop 0
global_load_lds_dwordx4 v2, s[6:7]
s_add_u32 s6, s6, 65536
s_addc_u32 s7, s7, 0
s_add_u32 m0, s20, 17408
s_nop 0
global_load_lds_dwordx4 v2, s[6:7]
s_add_u32 s6, s6, 65536
s_addc_u32 s7, s7, 0
s_add_u32 m0, s20, 18432
s_nop 0
global_load_lds_dwordx4 v2, s[6:7]
s_add_u32 s6, s6, 65536
s_addc_u32 s7, s7, 0
s_add_u32 m0, s20, 19456
s_nop 0
global_load_lds_dwordx4 v2, s[6:7]
s_add_u32 s6, s6, 65536
s_addc_u32 s7, s7, 0
s_waitcnt vmcnt(28)
ds_read_b64_tr_b16 a[24:25], v4 offset:24576
ds_read_b64_tr_b16 a[26:27], v4 offset:26624
ds_read_b64_tr_b16 a[104:105], v5 offset:24576
ds_read_b64_tr_b16 a[106:107], v5 offset:26624
ds_read_b64_tr_b16 a[184:185], v6 offset:24576
ds_read_b64_tr_b16 a[186:187], v6 offset:26624
ds_read_b64_tr_b16 v[200:201], v7 offset:24576
ds_read_b64_tr_b16 v[202:203], v7 offset:26624
s_waitcnt lgkmcnt(8)
s_add_u32 m0, s20, 20480
s_nop 0
global_load_lds_dwordx4 v2, s[6:7]
s_add_u32 s6, s6, 65536
s_addc_u32 s7, s7, 0
s_add_u32 m0, s20, 21504
s_nop 0
global_load_lds_dwordx4 v2, s[6:7]
s_add_u32 s6, s6, 65536
s_addc_u32 s7, s7, 0
s_add_u32 m0, s20, 22528
s_nop 0
global_load_lds_dwordx4 v2, s[6:7]
s_add_u32 s6, s6, 65536
s_addc_u32 s7, s7, 0
s_add_u32 m0, s20, 23552
s_nop 0
global_load_lds_dwordx4 v2, s[6:7]
s_add_u32 s6, s6, 65536
s_addc_u32 s7, s7, 0
s_waitcnt vmcnt(28)
ds_read_b64_tr_b16 a[28:29], v4 offset:28672
ds_read_b64_tr_b16 a[30:31], v4 offset:30720
ds_read_b64_tr_b16 a[108:109], v5 offset:28672
ds_read_b64_tr_b16 a[110:111], v5 offset:30720
ds_read_b64_tr_b16 a[188:189], v6 offset:28672
ds_read_b64_tr_b16 a[190:191], v6 offset:30720
ds_read_b64_tr_b16 v[204:205], v7 offset:28672
ds_read_b64_tr_b16 v[206:207], v7 offset:30720
s_waitcnt lgkmcnt(8)
s_add_u32 m0, s20, 24576
s_nop 0
global_load_lds_dwordx4 v2, s[6:7]
s_add_u32 s6, s6, 65536
s_addc_u32 s7, s7, 0
s_add_u32 m0, s20, 25600
s_nop 0
global_load_lds_dwordx4 v2, s[6:7]
s_add_u32 s6, s6, 65536
s_addc_u32 s7, s7, 0
s_add_u32 m0, s20, 26624
s_nop 0
global_load_lds_dwordx4 v2, s[6:7]
s_add_u32 s6, s6, 65536
s_addc_u32 s7, s7, 0
s_add_u32 m0, s20, 27648
s_nop 0
global_load_lds_dwordx4 v2, s[6:7]
s_add_u32 s6, s6, 65536
s_addc_u32 s7, s7, 0
s_waitcnt vmcnt(28)
ds_read_b64_tr_b16 a[32:33], v4 offset:32768
ds_read_b64_tr_b16 a[34:35], v4 offset:34816
ds_read_b64_tr_b16 a[112:113], v5 offset:32768
ds_read_b64_tr_b16 a[114:115], v5 offset:34816
ds_read_b64_tr_b16 a[192:193], v6 offset:32768
ds_read_b64_tr_b16 a[194:195], v6 offset:34816
ds_read_b64_tr_b16 v[208:209], v7 offset:32768
ds_read_b64_tr_b16 v[210:211], v7 offset:34816
s_waitcnt lgkmcnt(8)
s_add_u32 m0, s20, 28672
s_nop 0
global_load_lds_dwordx4 v2, s[6:7]
s_add_u32 s6, s6, 65536
s_addc_u32 s7, s7, 0
s_add_u32 m0, s20, 29696
s_nop 0
global_load_lds_dwordx4 v2, s[6:7]
s_add_u32 s6, s6, 65536
s_addc_u32 s7, s7, 0
s_add_u32 m0, s20, 30720
s_nop 0
global_load_lds_dwordx4 v2, s[6:7]
s_add_u32 s6, s6, 65536
s_addc_u32 s7, s7, 0
s_add_u32 m0, s20, 31744
s_nop 0
global_load_lds_dwordx4 v2, s[6:7]
s_add_u32 s6, s6, 65536
s_addc_u32 s7, s7, 0
s_waitcnt vmcnt(28)
ds_read_b64_tr_b16 a[36:37], v4 offset:0
ds_read_b64_tr_b16 a[38:39], v4 offset:2048
ds_read_b64_tr_b16 a[116:117], v5 offset:0
ds_read_b64_tr_b16 a[118:119], v5 offset:2048
ds_read_b64_tr_b16 a[196:197], v6 offset:0
ds_read_b64_tr_b16 a[198:199], v6 offset:2048
ds_read_b64_tr_b16 v[212:213], v7 offset:0
ds_read_b64_tr_b16 v[214:215], v7 offset:2048
s_waitcnt lgkmcnt(8)
s_add_u32 m0, s20, 32768
s_nop 0
global_load_lds_dwordx4 v2, s[6:7]
s_add_u32 s6, s6, 65536
s_addc_u32 s7, s7, 0
s_add_u32 m0, s20, 33792
s_nop 0
global_load_lds_dwordx4 v2, s[6:7]
s_add_u32 s6, s6, 65536
s_addc_u32 s7, s7, 0
s_add_u32 m0, s20, 34816
s_nop 0
global_load_lds_dwordx4 v2, s[6:7]
s_add_u32 s6, s6, 65536
s_addc_u32 s7, s7, 0
s_add_u32 m0, s20, 35840
s_nop 0
global_load_lds_dwordx4 v2, s[6:7]
s_add_u32 s6, s6, 65536
s_addc_u32 s7, s7, 0
s_waitcnt vmcnt(28)
ds_read_b64_tr_b16 a[40:41], v4 offset:4096
ds_read_b64_tr_b16 a[42:43], v4 offset:6144
ds_read_b64_tr_b16 a[120:121], v5 offset:4096
ds_read_b64_tr_b16 a[122:123], v5 offset:6144
ds_read_b64_tr_b16 a[200:201], v6 offset:4096
ds_read_b64_tr_b16 a[202:203], v6 offset:6144
ds_read_b64_tr_b16 v[216:217], v7 offset:4096
ds_read_b64_tr_b16 v[218:219], v7 offset:6144
s_waitcnt lgkmcnt(8)
s_add_u32 m0, s20, 0
s_nop 0
global_load_lds_dwordx4 v2, s[6:7]
s_add_u32 s6, s6, 65536
s_addc_u32 s7, s7, 0
s_add_u32 m0, s20, 1024
s_nop 0
global_load_lds_dwordx4 v2, s[6:7]
s_add_u32 s6, s6, 65536
s_addc_u32 s7, s7, 0
s_add_u32 m0, s20, 2048
s_nop 0
global_load_lds_dwordx4 v2, s[6:7]
s_add_u32 s6, s6, 65536
s_addc_u32 s7, s7, 0
s_add_u32 m0, s20, 3072
s_nop 0
global_load_lds_dwordx4 v2, s[6:7]
s_add_u32 s6, s6, 65536
s_addc_u32 s7, s7, 0
s_waitcnt vmcnt(28)
ds_read_b64_tr_b16 a[44:45], v4 offset:8192
ds_read_b64_tr_b16 a[46:47], v4 offset:10240
ds_read_b64_tr_b16 a[124:125], v5 offset:8192
ds_read_b64_tr_b16 a[126:127], v5 offset:10240
ds_read_b64_tr_b16 a[204:205], v6 offset:8192
ds_read_b64_tr_b16 a[206:207], v6 offset:10240
ds_read_b64_tr_b16 v[220:221], v7 offset:8192
ds_read_b64_tr_b16 v[222:223], v7 offset:10240
s_waitcnt lgkmcnt(8)
s_add_u32 m0, s20, 4096
s_nop 0
global_load_lds_dwordx4 v2, s[6:7]
s_add_u32 s6, s6, 65536
s_addc_u32 s7, s7, 0
s_add_u32 m0, s20, 5120
s_nop 0
global_load_lds_dwordx4 v2, s[6:7]
s_add_u32 s6, s6, 65536
s_addc_u32 s7, s7, 0
s_add_u32 m0, s20, 6144
s_nop 0
global_load_lds_dwordx4 v2, s[6:7]
s_add_u32 s6, s6, 65536
s_addc_u32 s7, s7, 0
s_add_u32 m0, s20, 7168
s_nop 0
global_load_lds_dwordx4 v2, s[6:7]
s_add_u32 s6, s6, 65536
s_addc_u32 s7, s7, 0
s_waitcnt vmcnt(28)
ds_read_b64_tr_b16 a[48:49], v4 offset:12288
ds_read_b64_tr_b16 a[50:51], v4 offset:14336
ds_read_b64_tr_b16 a[128:129], v5 offset:12288
ds_read_b64_tr_b16 a[130:131], v5 offset:14336
ds_read_b64_tr_b16 a[208:209], v6 offset:12288
ds_read_b64_tr_b16 a[210:211], v6 offset:14336
ds_read_b64_tr_b16 v[224:225], v7 offset:12288
ds_read_b64_tr_b16 v[226:227], v7 offset:14336
s_waitcnt vmcnt(24)
ds_read_b64_tr_b16 a[52:53], v4 offset:16384
ds_read_b64_tr_b16 a[54:55], v4 offset:18432
ds_read_b64_tr_b16 a[132:133], v5 offset:16384
ds_read_b64_tr_b16 a[134:135], v5 offset:18432
ds_read_b64_tr_b16 a[212:213], v6 offset:16384
ds_read_b64_tr_b16 a[214:215], v6 offset:18432
ds_read_b64_tr_b16 v[228:229], v7 offset:16384
ds_read_b64_tr_b16 v[230:231], v7 offset:18432
s_waitcnt vmcnt(20)
ds_read_b64_tr_b16 a[56:57], v4 offset:20480
ds_read_b64_tr_b16 a[58:59], v4 offset:22528
ds_read_b64_tr_b16 a[136:137], v5 offset:20480
ds_read_b64_tr_b16 a[138:139], v5 offset:22528
ds_read_b64_tr_b16 a[216:217], v6 offset:20480
ds_read_b64_tr_b16 a[218:219], v6 offset:22528
ds_read_b64_tr_b16 v[232:233], v7 offset:20480
ds_read_b64_tr_b16 v[234:235], v7 offset:22528
s_waitcnt vmcnt(16)
ds_read_b64_tr_b16 a[60:61], v4 offset:24576
ds_read_b64_tr_b16 a[62:63], v4 offset:26624
ds_read_b64_tr_b16 a[140:141], v5 offset:24576
ds_read_b64_tr_b16 a[142:143], v5 offset:26624
ds_read_b64_tr_b16 a[220:221], v6 offset:24576
ds_read_b64_tr_b16 a[222:223], v6 offset:26624
ds_read_b64_tr_b16 v[236:237], v7 offset:24576
ds_read_b64_tr_b16 v[238:239], v7 offset:26624
s_waitcnt vmcnt(12)
ds_read_b64_tr_b16 a[64:65], v4 offset:28672
ds_read_b64_tr_b16 a[66:67], v4 offset:30720
ds_read_b64_tr_b16 a[144:145], v5 offset:28672
ds_read_b64_tr_b16 a[146:147], v5 offset:30720
ds_read_b64_tr_b16 a[224:225], v6 offset:28672
ds_read_b64_tr_b16 a[226:227], v6 offset:30720
ds_read_b64_tr_b16 v[240:241], v7 offset:28672
ds_read_b64_tr_b16 v[242:243], v7 offset:30720
s_waitcnt vmcnt(8)
ds_read_b64_tr_b16 a[68:69], v4 offset:32768
ds_read_b64_tr_b16 a[70:71], v4 offset:34816
ds_read_b64_tr_b16 a[148:149], v5 offset:32768
ds_read_b64_tr_b16 a[150:151], v5 offset:34816
ds_read_b64_tr_b16 a[228:229], v6 offset:32768
ds_read_b64_tr_b16 a[230:231], v6 offset:34816
ds_read_b64_tr_b16 v[244:245], v7 offset:32768
ds_read_b64_tr_b16 v[246:247], v7 offset:34816
s_waitcnt vmcnt(4)
ds_read_b64_tr_b16 a[72:73], v4 offset:0
ds_read_b64_tr_b16 a[74:75], v4 offset:2048
ds_read_b64_tr_b16 a[152:153], v5 offset:0
ds_read_b64_tr_b16 a[154:155], v5 offset:2048
ds_read_b64_tr_b16 a[232:233], v6 offset:0
ds_read_b64_tr_b16 a[234:235], v6 offset:2048
ds_read_b64_tr_b16 v[248:249], v7 offset:0
ds_read_b64_tr_b16 v[250:251], v7 offset:2048
s_waitcnt vmcnt(0)
ds_read_b64_tr_b16 a[76:77], v4 offset:4096
ds_read_b64_tr_b16 a[78:79], v4 offset:6144
ds_read_b64_tr_b16 a[156:157], v5 offset:4096
ds_read_b64_tr_b16 a[158:159], v5 offset:6144
ds_read_b64_tr_b16 a[236:237], v6 offset:4096
ds_read_b64_tr_b16 a[238:239], v6 offset:6144
ds_read_b64_tr_b16 v[252:253], v7 offset:4096
ds_read_b64_tr_b16 v[254:255], v7 offset:6144
s_waitcnt lgkmcnt(0)
v_mov_b32 v11, 140
s_cmp_lg_u32 s12, 0
s_cbranch_scc1 L_wd_32
s_mov_b32 s96, 0x80000
L_wf_31:
global_load_dword v12, v11, s[94:95] sc1
s_waitcnt vmcnt(0)
v_cmp_gt_u32 vcc, 1, v12
s_nop 0
s_cbranch_vccz L_wd_32
s_sleep 2
s_sub_u32 s96, s96, 1
s_cbranch_scc0 L_wf_31
s_branch L_wabort
L_wd_32:
s_barrier
v_and_b32 v1, 63, v0
v_lshlrev_b32 v10, 4, v1
s_lshr_b32 s3, s12, 1
s_lshl_b32 s17, s42, 1
s_add_u32 s17, s17, s3
s_and_b32 s18, s12, 1
v_mov_b32 v2, 152
s_cmp_lg_u32 s12, 0
s_cbranch_scc1 L_wd_34
s_mov_b32 s96, 0x80000
L_wf_33:
global_load_dword v3, v2, s[94:95] sc1
s_waitcnt vmcnt(0)
v_cmp_gt_u32 vcc, 1, v3
s_nop 0
s_cbranch_vccz L_wd_34
s_sleep 3
s_sub_u32 s96, s96, 1
s_cbranch_scc0 L_wf_33
s_branch L_wabort
L_wd_34:
s_barrier
v_mov_b32 v2, 132
global_load_dword v3, v2, s[94:95] sc1
s_waitcnt vmcnt(0)
v_readfirstlane_b32 s46, v3
s_lshl_b32 s21, s17, 15
s_add_u32 s21, s21, 201326592
s_bitcmp1_b32 s46, 2
s_cselect_b32 s3, 8192, 0
s_lshl_b32 s28, s3, 1
s_sub_u32 s28, 2105344, s28
s_add_u32 s21, s21, s3
s_lshl_b32 s3, s18, 11
s_add_u32 s22, s21, s3
s_add_u32 s23, s22, s3
s_add_u32 s23, s23, 16384
s_lshl_b32 s24, s17, 13
s_add_u32 s24, s24, s3
s_add_u32 s24, s24, 33554432
s_mov_b32 s25, 0x100000
s_cmp_eq_u32 s41, 1
s_cselect_b32 s22, s23, s22
s_cmp_eq_u32 s41, 2
s_cselect_b32 s22, s24, s22
s_cselect_b32 s25, 262144, s25
s_cselect_b32 s28, 524288, s28
s_lshl_b32 s47, s25, 2
s_mul_i32 s3, s44, s25
s_add_u32 s3, s3, s22
s_add_u32 s26, s8, s3
s_addc_u32 s27, s9, 0
s_mul_i32 s3, s44, 40960
s_mul_i32 s29, s12, 10240
s_add_u32 s3, s3, s29
s_add_u32 s3, s3, 63963136
s_add_u32 s30, s8, s3
s_addc_u32 s31, s9, 0
s_mov_b32 s32, s44
s_mov_b32 s33, s29
s_mov_b32 s34, s44
v_add_u32 v11, 4096, v10
v_add_u32 v12, 8192, v10
s_lshl_b32 s3, s42, 7
s_lshl_b32 s13, s41, 4
s_add_u32 s3, s3, s13
s_lshl_b32 s13, s40, 2
s_add_u32 s3, s3, s13
s_add_u32 s3, s3, 68158464
v_mov_b32 v16, s3
v_mov_b32 v17, 0
s_cmp_eq_u32 s12, 0
s_cselect_b32 s43, 1, 0
s_lshr_b32 s3, s40, 1
s_lshl_b32 s3, s3, 8
s_add_u32 s3, s3, 68157568
v_mov_b32 v2, s3
s_cmp_lg_u32 s12, 0
s_cbranch_scc1 L_wd_36
s_mov_b32 s96, 0x80000
L_wf_35:
global_load_dword v3, v2, s[8:9] sc1
s_waitcnt vmcnt(0)
v_cmp_gt_u32 vcc, 1, v3
s_nop 0
s_cbranch_vccz L_wd_36
s_sleep 2
s_sub_u32 s96, s96, 1
s_cbranch_scc0 L_wf_35
s_branch L_wabort
L_wd_36:
s_barrier
s_mov_b32 s48, 0
s_barrier
s_add_u32 m0, s33, 0
s_nop 0
global_load_lds_dwordx4 v10, s[30:31] offset:0 sc1
global_load_lds_dwordx4 v10, s[30:31] offset:1024 sc1
global_load_lds_dwordx4 v10, s[30:31] offset:2048 sc1
global_load_lds_dwordx4 v10, s[30:31] offset:3072 sc1
s_add_u32 m0, s33, 4096
s_nop 0
global_load_lds_dwordx4 v11, s[30:31] offset:0 sc1
global_load_lds_dwordx4 v11, s[30:31] offset:1024 sc1
global_load_lds_dwordx4 v11, s[30:31] offset:2048 sc1
global_load_lds_dwordx4 v11, s[30:31] offset:3072 sc1
s_add_u32 m0, s33, 8192
s_nop 0
global_load_lds_dwordx4 v12, s[30:31] offset:0 sc1
global_load_lds_dwordx4 v12, s[30:31] offset:1024 sc1
s_add_u32 s32, s32, 2
s_cmp_lt_u32 s32, s45
s_cselect_b32 s3, 81920, 0
s_add_u32 s30, s30, s3
s_addc_u32 s31, s31, 0
s_add_u32 s33, s33, 40960
s_sub_u32 s3, s33, 122880
s_cmp_ge_u32 s33, 122880
s_cselect_b32 s33, s3, s33
s_add_u32 m0, s33, 0
s_nop 0
global_load_lds_dwordx4 v10, s[30:31] offset:0 sc1
global_load_lds_dwordx4 v10, s[30:31] offset:1024 sc1
global_load_lds_dwordx4 v10, s[30:31] offset:2048 sc1
global_load_lds_dwordx4 v10, s[30:31] offset:3072 sc1
s_add_u32 m0, s33, 4096
s_nop 0
global_load_lds_dwordx4 v11, s[30:31] offset:0 sc1
global_load_lds_dwordx4 v11, s[30:31] offset:1024 sc1
global_load_lds_dwordx4 v11, s[30:31] offset:2048 sc1
global_load_lds_dwordx4 v11, s[30:31] offset:3072 sc1
s_add_u32 m0, s33, 8192
s_nop 0
global_load_lds_dwordx4 v12, s[30:31] offset:0 sc1
global_load_lds_dwordx4 v12, s[30:31] offset:1024 sc1
s_add_u32 s32, s32, 2
s_cmp_lt_u32 s32, s45
s_cselect_b32 s3, 81920, 0
s_add_u32 s30, s30, s3
s_addc_u32 s31, s31, 0
s_add_u32 s33, s33, 40960
s_sub_u32 s3, s33, 122880
s_cmp_ge_u32 s33, 122880
s_cselect_b32 s33, s3, s33
s_waitcnt vmcnt(10)
s_barrier
v_mov_b32 v13, v10
s_mov_b32 s35, 0
s_cmp_eq_u32 s41, 1
s_cbranch_scc1 L_qkv_V
L_qkv_K:
ds_read_b128 v[96:99], v13 offset:0
ds_read_b128 v[100:103], v13 offset:20480
ds_read_b128 v[104:107], v13 offset:1024
ds_read_b128 v[108:111], v13 offset:21504
ds_read_b128 v[112:115], v13 offset:2048
ds_read_b128 v[116:119], v13 offset:22528
s_waitcnt lgkmcnt(4)
v_mfma_f32_16x16x32_bf16 v[128:131], a[0:3], v[96:99], 0
v_mfma_f32_16x16x32_bf16 v[144:147], a[0:3], v[100:103], 0
ds_read_b128 v[120:123], v13 offset:3072
ds_read_b128 v[124:127], v13 offset:23552
v_mfma_f32_16x16x32_bf16 v[132:135], a[80:83], v[96:99], 0
v_mfma_f32_16x16x32_bf16 v[148:151], a[80:83], v[100:103], 0
v_mfma_f32_16x16x32_bf16 v[136:139], a[160:163], v[96:99], 0
v_mfma_f32_16x16x32_bf16 v[152:155], a[160:163], v[100:103], 0
v_mfma_f32_16x16x32_bf16 v[140:143], a[240:243], v[96:99], 0
v_mfma_f32_16x16x32_bf16 v[156:159], a[240:243], v[100:103], 0
s_waitcnt lgkmcnt(4)
v_mfma_f32_16x16x32_bf16 v[128:131], a[4:7], v[104:107], v[128:131]
v_mfma_f32_16x16x32_bf16 v[144:147], a[4:7], v[108:111], v[144:147]
ds_read_b128 v[96:99], v13 offset:4096
ds_read_b128 v[100:103], v13 offset:24576
v_mfma_f32_16x16x32_bf16 v[132:135], a[84:87], v[104:107], v[132:135]
v_mfma_f32_16x16x32_bf16 v[148:151], a[84:87], v[108:111], v[148:151]
v_mfma_f32_16x16x32_bf16 v[136:139], a[164:167], v[104:107], v[136:139]
v_mfma_f32_16x16x32_bf16 v[152:155], a[164:167], v[108:111], v[152:155]
v_mfma_f32_16x16x32_bf16 v[140:143], a[244:247], v[104:107], v[140:143]
v_mfma_f32_16x16x32_bf16 v[156:159], a[244:247], v[108:111], v[156:159]
s_waitcnt lgkmcnt(4)
v_mfma_f32_16x16x32_bf16 v[128:131], a[8:11], v[112:115], v[128:131]
v_mfma_f32_16x16x32_bf16 v[144:147], a[8:11], v[116:119], v[144:147]
ds_read_b128 v[104:107], v13 offset:5120
ds_read_b128 v[108:111], v13 offset:25600
v_mfma_f32_16x16x32_bf16 v[132:135], a[88:91], v[112:115], v[132:135]
v_mfma_f32_16x16x32_bf16 v[148:151], a[88:91], v[116:119], v[148:151]
v_mfma_f32_16x16x32_bf16 v[136:139], a[168:171], v[112:115], v[136:139]
v_mfma_f32_16x16x32_bf16 v[152:155], a[168:171], v[116:119], v[152:155]
v_mfma_f32_16x16x32_bf16 v[140:143], a[248:251], v[112:115], v[140:143]
v_mfma_f32_16x16x32_bf16 v[156:159], a[248:251], v[116:119], v[156:159]
s_waitcnt lgkmcnt(4)
v_mfma_f32_16x16x32_bf16 v[128:131], a[12:15], v[120:123], v[128:131]
v_mfma_f32_16x16x32_bf16 v[144:147], a[12:15], v[124:127], v[144:147]
ds_read_b128 v[112:115], v13 offset:6144
ds_read_b128 v[116:119], v13 offset:26624
v_mfma_f32_16x16x32_bf16 v[132:135], a[92:95], v[120:123], v[132:135]
v_mfma_f32_16x16x32_bf16 v[148:151], a[92:95], v[124:127], v[148:151]
v_mfma_f32_16x16x32_bf16 v[136:139], a[172:175], v[120:123], v[136:139]
v_mfma_f32_16x16x32_bf16 v[152:155], a[172:175], v[124:127], v[152:155]
v_mfma_f32_16x16x32_bf16 v[140:143], a[252:255], v[120:123], v[140:143]
v_mfma_f32_16x16x32_bf16 v[156:159], a[252:255], v[124:127], v[156:159]
s_waitcnt lgkmcnt(4)
v_mfma_f32_16x16x32_bf16 v[128:131], a[16:19], v[96:99], v[128:131]
v_mfma_f32_16x16x32_bf16 v[144:147], a[16:19], v[100:103], v[144:147]
ds_read_b128 v[120:123], v13 offset:7168
ds_read_b128 v[124:127], v13 offset:27648
v_mfma_f32_16x16x32_bf16 v[132:135], a[96:99], v[96:99], v[132:135]
v_mfma_f32_16x16x32_bf16 v[148:151], a[96:99], v[100:103], v[148:151]
v_mfma_f32_16x16x32_bf16 v[136:139], a[176:179], v[96:99], v[136:139]
v_mfma_f32_16x16x32_bf16 v[152:155], a[176:179], v[100:103], v[152:155]
v_mfma_f32_16x16x32_bf16 v[140:143], v[192:195], v[96:99], v[140:143]
v_mfma_f32_16x16x32_bf16 v[156:159], v[192:195], v[100:103], v[156:159]
s_waitcnt lgkmcnt(4)
v_mfma_f32_16x16x32_bf16 v[128:131], a[20:23], v[104:107], v[128:131]
v_mfma_f32_16x16x32_bf16 v[144:147], a[20:23], v[108:111], v[144:147]
ds_read_b128 v[96:99], v13 offset:8192
ds_read_b128 v[100:103], v13 offset:28672
v_mfma_f32_16x16x32_bf16 v[132:135], a[100:103], v[104:107], v[132:135]
v_mfma_f32_16x16x32_bf16 v[148:151], a[100:103], v[108:111], v[148:151]
v_mfma_f32_16x16x32_bf16 v[136:139], a[180:183], v[104:107], v[136:139]
v_mfma_f32_16x16x32_bf16 v[152:155], a[180:183], v[108:111], v[152:155]
v_mfma_f32_16x16x32_bf16 v[140:143], v[196:199], v[104:107], v[140:143]
v_mfma_f32_16x16x32_bf16 v[156:159], v[196:199], v[108:111], v[156:159]
s_waitcnt lgkmcnt(4)
v_mfma_f32_16x16x32_bf16 v[128:131], a[24:27], v[112:115], v[128:131]
v_mfma_f32_16x16x32_bf16 v[144:147], a[24:27], v[116:119], v[144:147]
ds_read_b128 v[104:107], v13 offset:9216
ds_read_b128 v[108:111], v13 offset:29696
v_mfma_f32_16x16x32_bf16 v[132:135], a[104:107], v[112:115], v[132:135]
v_mfma_f32_16x16x32_bf16 v[148:151], a[104:107], v[116:119], v[148:151]
v_mfma_f32_16x16x32_bf16 v[136:139], a[184:187], v[112:115], v[136:139]
v_mfma_f32_16x16x32_bf16 v[152:155], a[184:187], v[116:119], v[152:155]
v_mfma_f32_16x16x32_bf16 v[140:143], v[200:203], v[112:115], v[140:143]
v_mfma_f32_16x16x32_bf16 v[156:159], v[200:203], v[116:119], v[156:159]
s_waitcnt lgkmcnt(4)
v_mfma_f32_16x16x32_bf16 v[128:131], a[28:31], v[120:123], v[128:131]
v_mfma_f32_16x16x32_bf16 v[144:147], a[28:31], v[124:127], v[144:147]
ds_read_b128 v[112:115], v13 offset:10240
ds_read_b128 v[116:119], v13 offset:30720
v_mfma_f32_16x16x32_bf16 v[132:135], a[108:111], v[120:123], v[132:135]
v_mfma_f32_16x16x32_bf16 v[148:151], a[108:111], v[124:127], v[148:151]
v_mfma_f32_16x16x32_bf16 v[136:139], a[188:191], v[120:123], v[136:139]
v_mfma_f32_16x16x32_bf16 v[152:155], a[188:191], v[124:127], v[152:155]
v_mfma_f32_16x16x32_bf16 v[140:143], v[204:207], v[120:123], v[140:143]
v_mfma_f32_16x16x32_bf16 v[156:159], v[204:207], v[124:127], v[156:159]
s_waitcnt lgkmcnt(4)
v_mfma_f32_16x16x32_bf16 v[128:131], a[32:35], v[96:99], v[128:131]
v_mfma_f32_16x16x32_bf16 v[144:147], a[32:35], v[100:103], v[144:147]
ds_read_b128 v[120:123], v13 offset:11264
ds_read_b128 v[124:127], v13 offset:31744
v_mfma_f32_16x16x32_bf16 v[132:135], a[112:115], v[96:99], v[132:135]
v_mfma_f32_16x16x32_bf16 v[148:151], a[112:115], v[100:103], v[148:151]
v_mfma_f32_16x16x32_bf16 v[136:139], a[192:195], v[96:99], v[136:139]
v_mfma_f32_16x16x32_bf16 v[152:155], a[192:195], v[100:103], v[152:155]
v_mfma_f32_16x16x32_bf16 v[140:143], v[208:211], v[96:99], v[140:143]
v_mfma_f32_16x16x32_bf16 v[156:159], v[208:211], v[100:103], v[156:159]
s_waitcnt lgkmcnt(4)
v_mfma_f32_16x16x32_bf16 v[128:131], a[36:39], v[104:107], v[128:131]
v_mfma_f32_16x16x32_bf16 v[144:147], a[36:39], v[108:111], v[144:147]
ds_read_b128 v[96:99], v13 offset:12288
ds_read_b128 v[100:103], v13 offset:32768
v_mfma_f32_16x16x32_bf16 v[132:135], a[116:119], v[104:107], v[132:135]
v_mfma_f32_16x16x32_bf16 v[148:151], a[116:119], v[108:111], v[148:151]
v_mfma_f32_16x16x32_bf16 v[136:139], a[196:199], v[104:107], v[136:139]
v_mfma_f32_16x16x32_bf16 v[152:155], a[196:199], v[108:111], v[152:155]
v_mfma_f32_16x16x32_bf16 v[140:143], v[212:215], v[104:107], v[140:143]
v_mfma_f32_16x16x32_bf16 v[156:159], v[212:215], v[108:111], v[156:159]
s_waitcnt lgkmcnt(4)
v_mfma_f32_16x16x32_bf16 v[128:131], a[40:43], v[112:115], v[128:131]
v_mfma_f32_16x16x32_bf16 v[144:147], a[40:43], v[116:119], v[144:147]
ds_read_b128 v[104:107], v13 offset:13312
ds_read_b128 v[108:111], v13 offset:33792
v_mfma_f32_16x16x32_bf16 v[132:135], a[120:123], v[112:115], v[132:135]
v_mfma_f32_16x16x32_bf16 v[148:151], a[120:123], v[116:119], v[148:151]
v_mfma_f32_16x16x32_bf16 v[136:139], a[200:203], v[112:115], v[136:139]
v_mfma_f32_16x16x32_bf16 v[152:155], a[200:203], v[116:119], v[152:155]
v_mfma_f32_16x16x32_bf16 v[140:143], v[216:219], v[112:115], v[140:143]
v_mfma_f32_16x16x32_bf16 v[156:159], v[216:219], v[116:119], v[156:159]
s_waitcnt lgkmcnt(4)
v_mfma_f32_16x16x32_bf16 v[128:131], a[44:47], v[120:123], v[128:131]
v_mfma_f32_16x16x32_bf16 v[144:147], a[44:47], v[124:127], v[144:147]
ds_read_b128 v[112:115], v13 offset:14336
ds_read_b128 v[116:119], v13 offset:34816
v_mfma_f32_16x16x32_bf16 v[132:135], a[124:127], v[120:123], v[132:135]
v_mfma_f32_16x16x32_bf16 v[148:151], a[124:127], v[124:127], v[148:151]
v_mfma_f32_16x16x32_bf16 v[136:139], a[204:207], v[120:123], v[136:139]
v_mfma_f32_16x16x32_bf16 v[152:155], a[204:207], v[124:127], v[152:155]
v_mfma_f32_16x16x32_bf16 v[140:143], v[220:223], v[120:123], v[140:143]
v_mfma_f32_16x16x32_bf16 v[156:159], v[220:223], v[124:127], v[156:159]
s_waitcnt lgkmcnt(4)
v_mfma_f32_16x16x32_bf16 v[128:131], a[48:51], v[96:99], v[128:131]
v_mfma_f32_16x16x32_bf16 v[144:147], a[48:51], v[100:103], v[144:147]
ds_read_b128 v[120:123], v13 offset:15360
ds_read_b128 v[124:127], v13 offset:35840
v_mfma_f32_16x16x32_bf16 v[132:135], a[128:131], v[96:99], v[132:135]
v_mfma_f32_16x16x32_bf16 v[148:151], a[128:131], v[100:103], v[148:151]
v_mfma_f32_16x16x32_bf16 v[136:139], a[208:211], v[96:99], v[136:139]
v_mfma_f32_16x16x32_bf16 v[152:155], a[208:211], v[100:103], v[152:155]
v_mfma_f32_16x16x32_bf16 v[140:143], v[224:227], v[96:99], v[140:143]
v_mfma_f32_16x16x32_bf16 v[156:159], v[224:227], v[100:103], v[156:159]
s_waitcnt vmcnt(0)
s_barrier
s_add_u32 s35, s35, 40960
s_cmp_ge_u32 s35, 122880
s_cselect_b32 s35, 0, s35
v_add_u32 v15, s35, v10
s_waitcnt lgkmcnt(4)
v_mfma_f32_16x16x32_bf16 v[128:131], a[52:55], v[104:107], v[128:131]
v_mfma_f32_16x16x32_bf16 v[144:147], a[52:55], v[108:111], v[144:147]
ds_read_b128 v[96:99], v13 offset:16384
ds_read_b128 v[100:103], v13 offset:36864
v_mfma_f32_16x16x32_bf16 v[132:135], a[132:135], v[104:107], v[132:135]
v_mfma_f32_16x16x32_bf16 v[148:151], a[132:135], v[108:111], v[148:151]
s_add_u32 m0, s33, 0
s_nop 0
global_load_lds_dwordx4 v10, s[30:31] offset:0 sc1
v_mfma_f32_16x16x32_bf16 v[136:139], a[212:215], v[104:107], v[136:139]
v_mfma_f32_16x16x32_bf16 v[152:155], a[212:215], v[108:111], v[152:155]
v_mfma_f32_16x16x32_bf16 v[140:143], v[228:231], v[104:107], v[140:143]
v_mfma_f32_16x16x32_bf16 v[156:159], v[228:231], v[108:111], v[156:159]
global_load_lds_dwordx4 v10, s[30:31] offset:1024 sc1
s_waitcnt lgkmcnt(4)
v_mfma_f32_16x16x32_bf16 v[128:131], a[56:59], v[112:115], v[128:131]
v_mfma_f32_16x16x32_bf16 v[144:147], a[56:59], v[116:119], v[144:147]
ds_read_b128 v[104:107], v13 offset:17408
ds_read_b128 v[108:111], v13 offset:37888
v_mfma_f32_16x16x32_bf16 v[132:135], a[136:139], v[112:115], v[132:135]
v_mfma_f32_16x16x32_bf16 v[148:151], a[136:139], v[116:119], v[148:151]
global_load_lds_dwordx4 v10, s[30:31] offset:2048 sc1
v_mfma_f32_16x16x32_bf16 v[136:139], a[216:219], v[112:115], v[136:139]
v_mfma_f32_16x16x32_bf16 v[152:155], a[216:219], v[116:119], v[152:155]
v_mfma_f32_16x16x32_bf16 v[140:143], v[232:235], v[112:115], v[140:143]
v_mfma_f32_16x16x32_bf16 v[156:159], v[232:235], v[116:119], v[156:159]
global_load_lds_dwordx4 v10, s[30:31] offset:3072 sc1
s_waitcnt lgkmcnt(4)
v_mfma_f32_16x16x32_bf16 v[128:131], a[60:63], v[120:123], v[128:131]
v_mfma_f32_16x16x32_bf16 v[144:147], a[60:63], v[124:127], v[144:147]
ds_read_b128 v[112:115], v13 offset:18432
ds_read_b128 v[116:119], v13 offset:38912
v_mfma_f32_16x16x32_bf16 v[132:135], a[140:143], v[120:123], v[132:135]
v_mfma_f32_16x16x32_bf16 v[148:151], a[140:143], v[124:127], v[148:151]
s_add_u32 m0, s33, 4096
s_nop 0
global_load_lds_dwordx4 v11, s[30:31] offset:0 sc1
v_mfma_f32_16x16x32_bf16 v[136:139], a[220:223], v[120:123], v[136:139]
v_mfma_f32_16x16x32_bf16 v[152:155], a[220:223], v[124:127], v[152:155]
v_mfma_f32_16x16x32_bf16 v[140:143], v[236:239], v[120:123], v[140:143]
v_mfma_f32_16x16x32_bf16 v[156:159], v[236:239], v[124:127], v[156:159]
global_load_lds_dwordx4 v11, s[30:31] offset:1024 sc1
s_waitcnt lgkmcnt(4)
v_mfma_f32_16x16x32_bf16 v[128:131], a[64:67], v[96:99], v[128:131]
v_mfma_f32_16x16x32_bf16 v[144:147], a[64:67], v[100:103], v[144:147]
ds_read_b128 v[120:123], v13 offset:19456
ds_read_b128 v[124:127], v13 offset:39936
v_mfma_f32_16x16x32_bf16 v[132:135], a[144:147], v[96:99], v[132:135]
v_mfma_f32_16x16x32_bf16 v[148:151], a[144:147], v[100:103], v[148:151]
global_load_lds_dwordx4 v11, s[30:31] offset:2048 sc1
v_mfma_f32_16x16x32_bf16 v[136:139], a[224:227], v[96:99], v[136:139]
v_mfma_f32_16x16x32_bf16 v[152:155], a[224:227], v[100:103], v[152:155]
v_mfma_f32_16x16x32_bf16 v[140:143], v[240:243], v[96:99], v[140:143]
v_mfma_f32_16x16x32_bf16 v[156:159], v[240:243], v[100:103], v[156:159]
global_load_lds_dwordx4 v11, s[30:31] offset:3072 sc1
s_waitcnt lgkmcnt(4)
v_mfma_f32_16x16x32_bf16 v[128:131], a[68:71], v[104:107], v[128:131]
v_mfma_f32_16x16x32_bf16 v[144:147], a[68:71], v[108:111], v[144:147]
ds_read_b128 v[96:99], v15 offset:0
ds_read_b128 v[100:103], v15 offset:20480
v_mfma_f32_16x16x32_bf16 v[132:135], a[148:151], v[104:107], v[132:135]
v_mfma_f32_16x16x32_bf16 v[148:151], a[148:151], v[108:111], v[148:151]
s_add_u32 m0, s33, 8192
s_nop 0
global_load_lds_dwordx4 v12, s[30:31] offset:0 sc1
v_mfma_f32_16x16x32_bf16 v[136:139], a[228:231], v[104:107], v[136:139]
v_mfma_f32_16x16x32_bf16 v[152:155], a[228:231], v[108:111], v[152:155]
v_mfma_f32_16x16x32_bf16 v[140:143], v[244:247], v[104:107], v[140:143]
v_mfma_f32_16x16x32_bf16 v[156:159], v[244:247], v[108:111], v[156:159]
global_load_lds_dwordx4 v12, s[30:31] offset:1024 sc1
s_waitcnt lgkmcnt(4)
v_mfma_f32_16x16x32_bf16 v[128:131], a[72:75], v[112:115], v[128:131]
v_mfma_f32_16x16x32_bf16 v[144:147], a[72:75], v[116:119], v[144:147]
ds_read_b128 v[104:107], v15 offset:1024
ds_read_b128 v[108:111], v15 offset:21504
v_mfma_f32_16x16x32_bf16 v[132:135], a[152:155], v[112:115], v[132:135]
v_mfma_f32_16x16x32_bf16 v[148:151], a[152:155], v[116:119], v[148:151]
s_add_u32 s32, s32, 2
s_cmp_lt_u32 s32, s45
s_cselect_b32 s3, 81920, 0
s_add_u32 s30, s30, s3
s_addc_u32 s31, s31, 0
s_add_u32 s33, s33, 40960
s_sub_u32 s3, s33, 122880
s_cmp_ge_u32 s33, 122880
s_cselect_b32 s33, s3, s33
v_mfma_f32_16x16x32_bf16 v[136:139], a[232:235], v[112:115], v[136:139]
v_mfma_f32_16x16x32_bf16 v[152:155], a[232:235], v[116:119], v[152:155]
v_mfma_f32_16x16x32_bf16 v[140:143], v[248:251], v[112:115], v[140:143]
v_mfma_f32_16x16x32_bf16 v[156:159], v[248:251], v[116:119], v[156:159]
s_waitcnt lgkmcnt(4)
v_mfma_f32_16x16x32_bf16 v[128:131], a[76:79], v[120:123], v[128:131]
v_mfma_f32_16x16x32_bf16 v[144:147], a[76:79], v[124:127], v[144:147]
ds_read_b128 v[112:115], v15 offset:2048
ds_read_b128 v[116:119], v15 offset:22528
v_mfma_f32_16x16x32_bf16 v[132:135], a[156:159], v[120:123], v[132:135]
v_mfma_f32_16x16x32_bf16 v[148:151], a[156:159], v[124:127], v[148:151]
v_mfma_f32_16x16x32_bf16 v[136:139], a[236:239], v[120:123], v[136:139]
v_mfma_f32_16x16x32_bf16 v[152:155], a[236:239], v[124:127], v[152:155]
v_mfma_f32_16x16x32_bf16 v[140:143], v[252:255], v[120:123], v[140:143]
v_mfma_f32_16x16x32_bf16 v[156:159], v[252:255], v[124:127], v[156:159]
v_mov_b32 v13, v15
s_add_u32 s34, s34, 2
s_cmp_ge_u32 s34, s45
s_cmp_ge_u32 s40, 2
s_cbranch_scc1 L_qkv_K_loop
s_nop 7
v_cvt_pk_bf16_f32 v64, v128, v129
v_cvt_pk_bf16_f32 v65, v130, v131
v_cvt_pk_bf16_f32 v66, v132, v133
v_cvt_pk_bf16_f32 v67, v134, v135
global_store_dwordx4 v10, v[64:67], s[26:27] offset:0 sc1
v_cvt_pk_bf16_f32 v68, v136, v137
v_cvt_pk_bf16_f32 v69, v138, v139
v_cvt_pk_bf16_f32 v70, v140, v141
v_cvt_pk_bf16_f32 v71, v142, v143
global_store_dwordx4 v10, v[68:71], s[26:27] offset:1024 sc1
v_cvt_pk_bf16_f32 v72, v144, v145
v_cvt_pk_bf16_f32 v73, v146, v147
v_cvt_pk_bf16_f32 v74, v148, v149
v_cvt_pk_bf16_f32 v75, v150, v151
global_store_dwordx4 v11, v[72:75], s[26:27] offset:0 sc1
v_cvt_pk_bf16_f32 v76, v152, v153
v_cvt_pk_bf16_f32 v77, v154, v155
v_cvt_pk_bf16_f32 v78, v156, v157
v_cvt_pk_bf16_f32 v79, v158, v159
global_store_dwordx4 v11, v[76:79], s[26:27] offset:1024 sc1
s_waitcnt vmcnt(0)
s_barrier
s_cmp_eq_u32 s43, 0
s_cbranch_scc1 L_pg_37
v_mov_b32 v17, 1
s_mov_b64 exec, 1
global_store_dword v16, v17, s[8:9] sc1
s_mov_b64 exec, -1
L_pg_37:
L_qkv_K_loop:
s_waitcnt lgkmcnt(4)
v_mfma_f32_16x16x32_bf16 v[160:163], a[0:3], v[96:99], 0
v_mfma_f32_16x16x32_bf16 v[176:179], a[0:3], v[100:103], 0
ds_read_b128 v[120:123], v13 offset:3072
ds_read_b128 v[124:127], v13 offset:23552
v_mfma_f32_16x16x32_bf16 v[164:167], a[80:83], v[96:99], 0
v_mfma_f32_16x16x32_bf16 v[180:183], a[80:83], v[100:103], 0
v_mfma_f32_16x16x32_bf16 v[168:171], a[160:163], v[96:99], 0
v_mfma_f32_16x16x32_bf16 v[184:187], a[160:163], v[100:103], 0
v_mfma_f32_16x16x32_bf16 v[172:175], a[240:243], v[96:99], 0
v_mfma_f32_16x16x32_bf16 v[188:191], a[240:243], v[100:103], 0
s_waitcnt lgkmcnt(4)
v_mfma_f32_16x16x32_bf16 v[160:163], a[4:7], v[104:107], v[160:163]
v_cvt_pk_bf16_f32 v64, v128, v129
v_mfma_f32_16x16x32_bf16 v[176:179], a[4:7], v[108:111], v[176:179]
v_cvt_pk_bf16_f32 v65, v130, v131
ds_read_b128 v[96:99], v13 offset:4096
ds_read_b128 v[100:103], v13 offset:24576
v_mfma_f32_16x16x32_bf16 v[164:167], a[84:87], v[104:107], v[164:167]
v_cvt_pk_bf16_f32 v66, v132, v133
v_mfma_f32_16x16x32_bf16 v[180:183], a[84:87], v[108:111], v[180:183]
v_cvt_pk_bf16_f32 v67, v134, v135
v_mfma_f32_16x16x32_bf16 v[168:171], a[164:167], v[104:107], v[168:171]
global_store_dwordx4 v10, v[64:67], s[26:27] offset:0 sc1
v_mfma_f32_16x16x32_bf16 v[184:187], a[164:167], v[108:111], v[184:187]
v_cvt_pk_bf16_f32 v68, v136, v137
v_mfma_f32_16x16x32_bf16 v[172:175], a[244:247], v[104:107], v[172:175]
v_cvt_pk_bf16_f32 v69, v138, v139
v_mfma_f32_16x16x32_bf16 v[188:191], a[244:247], v[108:111], v[188:191]
v_cvt_pk_bf16_f32 v70, v140, v141
s_waitcnt lgkmcnt(4)
v_mfma_f32_16x16x32_bf16 v[160:163], a[8:11], v[112:115], v[160:163]
v_cvt_pk_bf16_f32 v71, v142, v143
v_mfma_f32_16x16x32_bf16 v[176:179], a[8:11], v[116:119], v[176:179]
global_store_dwordx4 v10, v[68:71], s[26:27] offset:1024 sc1
ds_read_b128 v[104:107], v13 offset:5120
ds_read_b128 v[108:111], v13 offset:25600
v_mfma_f32_16x16x32_bf16 v[164:167], a[88:91], v[112:115], v[164:167]
v_cvt_pk_bf16_f32 v72, v144, v145
v_mfma_f32_16x16x32_bf16 v[180:183], a[88:91], v[116:119], v[180:183]
v_cvt_pk_bf16_f32 v73, v146, v147
v_mfma_f32_16x16x32_bf16 v[168:171], a[168:171], v[112:115], v[168:171]
v_cvt_pk_bf16_f32 v74, v148, v149
v_mfma_f32_16x16x32_bf16 v[184:187], a[168:171], v[116:119], v[184:187]
v_cvt_pk_bf16_f32 v75, v150, v151
v_mfma_f32_16x16x32_bf16 v[172:175], a[248:251], v[112:115], v[172:175]
global_store_dwordx4 v11, v[72:75], s[26:27] offset:0 sc1
v_mfma_f32_16x16x32_bf16 v[188:191], a[248:251], v[116:119], v[188:191]
v_cvt_pk_bf16_f32 v76, v152, v153
s_waitcnt lgkmcnt(4)
v_mfma_f32_16x16x32_bf16 v[160:163], a[12:15], v[120:123], v[160:163]
v_cvt_pk_bf16_f32 v77, v154, v155
v_mfma_f32_16x16x32_bf16 v[176:179], a[12:15], v[124:127], v[176:179]
v_cvt_pk_bf16_f32 v78, v156, v157
ds_read_b128 v[112:115], v13 offset:6144
ds_read_b128 v[116:119], v13 offset:26624
v_mfma_f32_16x16x32_bf16 v[164:167], a[92:95], v[120:123], v[164:167]
v_cvt_pk_bf16_f32 v79, v158, v159
v_mfma_f32_16x16x32_bf16 v[180:183], a[92:95], v[124:127], v[180:183]
global_store_dwordx4 v11, v[76:79], s[26:27] offset:1024 sc1
v_mfma_f32_16x16x32_bf16 v[168:171], a[172:175], v[120:123], v[168:171]
s_add_u32 s26, s26, s28
s_addc_u32 s27, s27, 0
s_sub_u32 s28, s47, s28
v_mfma_f32_16x16x32_bf16 v[184:187], a[172:175], v[124:127], v[184:187]
v_mfma_f32_16x16x32_bf16 v[172:175], a[252:255], v[120:123], v[172:175]
v_mfma_f32_16x16x32_bf16 v[188:191], a[252:255], v[124:127], v[188:191]
s_waitcnt lgkmcnt(4)
v_mfma_f32_16x16x32_bf16 v[160:163], a[16:19], v[96:99], v[160:163]
v_mfma_f32_16x16x32_bf16 v[176:179], a[16:19], v[100:103], v[176:179]
ds_read_b128 v[120:123], v13 offset:7168
ds_read_b128 v[124:127], v13 offset:27648
v_mfma_f32_16x16x32_bf16 v[164:167], a[96:99], v[96:99], v[164:167]
v_mfma_f32_16x16x32_bf16 v[180:183], a[96:99], v[100:103], v[180:183]
v_mfma_f32_16x16x32_bf16 v[168:171], a[176:179], v[96:99], v[168:171]
v_mfma_f32_16x16x32_bf16 v[184:187], a[176:179], v[100:103], v[184:187]
v_mfma_f32_16x16x32_bf16 v[172:175], v[192:195], v[96:99], v[172:175]
v_mfma_f32_16x16x32_bf16 v[188:191], v[192:195], v[100:103], v[188:191]
s_waitcnt lgkmcnt(4)
v_mfma_f32_16x16x32_bf16 v[160:163], a[20:23], v[104:107], v[160:163]
v_mfma_f32_16x16x32_bf16 v[176:179], a[20:23], v[108:111], v[176:179]
ds_read_b128 v[96:99], v13 offset:8192
ds_read_b128 v[100:103], v13 offset:28672
v_mfma_f32_16x16x32_bf16 v[164:167], a[100:103], v[104:107], v[164:167]
v_mfma_f32_16x16x32_bf16 v[180:183], a[100:103], v[108:111], v[180:183]
v_mfma_f32_16x16x32_bf16 v[168:171], a[180:183], v[104:107], v[168:171]
v_mfma_f32_16x16x32_bf16 v[184:187], a[180:183], v[108:111], v[184:187]
v_mfma_f32_16x16x32_bf16 v[172:175], v[196:199], v[104:107], v[172:175]
v_mfma_f32_16x16x32_bf16 v[188:191], v[196:199], v[108:111], v[188:191]
s_waitcnt lgkmcnt(4)
v_mfma_f32_16x16x32_bf16 v[160:163], a[24:27], v[112:115], v[160:163]
v_mfma_f32_16x16x32_bf16 v[176:179], a[24:27], v[116:119], v[176:179]
ds_read_b128 v[104:107], v13 offset:9216
ds_read_b128 v[108:111], v13 offset:29696
v_mfma_f32_16x16x32_bf16 v[164:167], a[104:107], v[112:115], v[164:167]
v_mfma_f32_16x16x32_bf16 v[180:183], a[104:107], v[116:119], v[180:183]
v_mfma_f32_16x16x32_bf16 v[168:171], a[184:187], v[112:115], v[168:171]
v_mfma_f32_16x16x32_bf16 v[184:187], a[184:187], v[116:119], v[184:187]
v_mfma_f32_16x16x32_bf16 v[172:175], v[200:203], v[112:115], v[172:175]
v_mfma_f32_16x16x32_bf16 v[188:191], v[200:203], v[116:119], v[188:191]
s_waitcnt lgkmcnt(4)
v_mfma_f32_16x16x32_bf16 v[160:163], a[28:31], v[120:123], v[160:163]
v_mfma_f32_16x16x32_bf16 v[176:179], a[28:31], v[124:127], v[176:179]
ds_read_b128 v[112:115], v13 offset:10240
ds_read_b128 v[116:119], v13 offset:30720
v_mfma_f32_16x16x32_bf16 v[164:167], a[108:111], v[120:123], v[164:167]
v_mfma_f32_16x16x32_bf16 v[180:183], a[108:111], v[124:127], v[180:183]
v_mfma_f32_16x16x32_bf16 v[168:171], a[188:191], v[120:123], v[168:171]
v_mfma_f32_16x16x32_bf16 v[184:187], a[188:191], v[124:127], v[184:187]
v_mfma_f32_16x16x32_bf16 v[172:175], v[204:207], v[120:123], v[172:175]
v_mfma_f32_16x16x32_bf16 v[188:191], v[204:207], v[124:127], v[188:191]
s_waitcnt lgkmcnt(4)
v_mfma_f32_16x16x32_bf16 v[160:163], a[32:35], v[96:99], v[160:163]
v_mfma_f32_16x16x32_bf16 v[176:179], a[32:35], v[100:103], v[176:179]
ds_read_b128 v[120:123], v13 offset:11264
ds_read_b128 v[124:127], v13 offset:31744
v_mfma_f32_16x16x32_bf16 v[164:167], a[112:115], v[96:99], v[164:167]
v_mfma_f32_16x16x32_bf16 v[180:183], a[112:115], v[100:103], v[180:183]
v_mfma_f32_16x16x32_bf16 v[168:171], a[192:195], v[96:99], v[168:171]
v_mfma_f32_16x16x32_bf16 v[184:187], a[192:195], v[100:103], v[184:187]
v_mfma_f32_16x16x32_bf16 v[172:175], v[208:211], v[96:99], v[172:175]
v_mfma_f32_16x16x32_bf16 v[188:191], v[208:211], v[100:103], v[188:191]
s_waitcnt lgkmcnt(4)
v_mfma_f32_16x16x32_bf16 v[160:163], a[36:39], v[104:107], v[160:163]
v_mfma_f32_16x16x32_bf16 v[176:179], a[36:39], v[108:111], v[176:179]
ds_read_b128 v[96:99], v13 offset:12288
ds_read_b128 v[100:103], v13 offset:32768
v_mfma_f32_16x16x32_bf16 v[164:167], a[116:119], v[104:107], v[164:167]
v_mfma_f32_16x16x32_bf16 v[180:183], a[116:119], v[108:111], v[180:183]
v_mfma_f32_16x16x32_bf16 v[168:171], a[196:199], v[104:107], v[168:171]
v_mfma_f32_16x16x32_bf16 v[184:187], a[196:199], v[108:111], v[184:187]
v_mfma_f32_16x16x32_bf16 v[172:175], v[212:215], v[104:107], v[172:175]
v_mfma_f32_16x16x32_bf16 v[188:191], v[212:215], v[108:111], v[188:191]
s_waitcnt lgkmcnt(4)
v_mfma_f32_16x16x32_bf16 v[160:163], a[40:43], v[112:115], v[160:163]
v_mfma_f32_16x16x32_bf16 v[176:179], a[40:43], v[116:119], v[176:179]
ds_read_b128 v[104:107], v13 offset:13312
ds_read_b128 v[108:111], v13 offset:33792
v_mfma_f32_16x16x32_bf16 v[164:167], a[120:123], v[112:115], v[164:167]
v_mfma_f32_16x16x32_bf16 v[180:183], a[120:123], v[116:119], v[180:183]
v_mfma_f32_16x16x32_bf16 v[168:171], a[200:203], v[112:115], v[168:171]
v_mfma_f32_16x16x32_bf16 v[184:187], a[200:203], v[116:119], v[184:187]
v_mfma_f32_16x16x32_bf16 v[172:175], v[216:219], v[112:115], v[172:175]
v_mfma_f32_16x16x32_bf16 v[188:191], v[216:219], v[116:119], v[188:191]
s_waitcnt lgkmcnt(4)
v_mfma_f32_16x16x32_bf16 v[160:163], a[44:47], v[120:123], v[160:163]
v_mfma_f32_16x16x32_bf16 v[176:179], a[44:47], v[124:127], v[176:179]
ds_read_b128 v[112:115], v13 offset:14336
ds_read_b128 v[116:119], v13 offset:34816
v_mfma_f32_16x16x32_bf16 v[164:167], a[124:127], v[120:123], v[164:167]
v_mfma_f32_16x16x32_bf16 v[180:183], a[124:127], v[124:127], v[180:183]
v_mfma_f32_16x16x32_bf16 v[168:171], a[204:207], v[120:123], v[168:171]
v_mfma_f32_16x16x32_bf16 v[184:187], a[204:207], v[124:127], v[184:187]
v_mfma_f32_16x16x32_bf16 v[172:175], v[220:223], v[120:123], v[172:175]
v_mfma_f32_16x16x32_bf16 v[188:191], v[220:223], v[124:127], v[188:191]
s_waitcnt lgkmcnt(4)
v_mfma_f32_16x16x32_bf16 v[160:163], a[48:51], v[96:99], v[160:163]
v_mfma_f32_16x16x32_bf16 v[176:179], a[48:51], v[100:103], v[176:179]
ds_read_b128 v[120:123], v13 offset:15360
ds_read_b128 v[124:127], v13 offset:35840
v_mfma_f32_16x16x32_bf16 v[164:167], a[128:131], v[96:99], v[164:167]
v_mfma_f32_16x16x32_bf16 v[180:183], a[128:131], v[100:103], v[180:183]
v_mfma_f32_16x16x32_bf16 v[168:171], a[208:211], v[96:99], v[168:171]
v_mfma_f32_16x16x32_bf16 v[184:187], a[208:211], v[100:103], v[184:187]
v_mfma_f32_16x16x32_bf16 v[172:175], v[224:227], v[96:99], v[172:175]
v_mfma_f32_16x16x32_bf16 v[188:191], v[224:227], v[100:103], v[188:191]
s_mov_b32 s49, s48
s_add_u32 s48, s48, 1
s_cmp_gt_u32 s48, 2
s_cbranch_scc1 L_lax_38
s_waitcnt vmcnt(0)
s_mov_b32 s49, s48
L_lax_38:
s_waitcnt vmcnt(4)
s_barrier
s_cmp_eq_u32 s43, 0
s_cbranch_scc1 L_pg_39
v_mov_b32 v17, s49
s_mov_b64 exec, 1
global_store_dword v16, v17, s[8:9] sc1
s_mov_b64 exec, -1
L_pg_39:
s_add_u32 s35, s35, 40960
s_cmp_ge_u32 s35, 122880
s_cselect_b32 s35, 0, s35
v_add_u32 v15, s35, v10
s_waitcnt lgkmcnt(4)
v_mfma_f32_16x16x32_bf16 v[160:163], a[52:55], v[104:107], v[160:163]
v_mfma_f32_16x16x32_bf16 v[176:179], a[52:55], v[108:111], v[176:179]
ds_read_b128 v[96:99], v13 offset:16384
ds_read_b128 v[100:103], v13 offset:36864
v_mfma_f32_16x16x32_bf16 v[164:167], a[132:135], v[104:107], v[164:167]
v_mfma_f32_16x16x32_bf16 v[180:183], a[132:135], v[108:111], v[180:183]
s_add_u32 m0, s33, 0
s_nop 0
global_load_lds_dwordx4 v10, s[30:31] offset:0 sc1
v_mfma_f32_16x16x32_bf16 v[168:171], a[212:215], v[104:107], v[168:171]
v_mfma_f32_16x16x32_bf16 v[184:187], a[212:215], v[108:111], v[184:187]
v_mfma_f32_16x16x32_bf16 v[172:175], v[228:231], v[104:107], v[172:175]
v_mfma_f32_16x16x32_bf16 v[188:191], v[228:231], v[108:111], v[188:191]
global_load_lds_dwordx4 v10, s[30:31] offset:1024 sc1
s_waitcnt lgkmcnt(4)
v_mfma_f32_16x16x32_bf16 v[160:163], a[56:59], v[112:115], v[160:163]
v_mfma_f32_16x16x32_bf16 v[176:179], a[56:59], v[116:119], v[176:179]
ds_read_b128 v[104:107], v13 offset:17408
ds_read_b128 v[108:111], v13 offset:37888
v_mfma_f32_16x16x32_bf16 v[164:167], a[136:139], v[112:115], v[164:167]
v_mfma_f32_16x16x32_bf16 v[180:183], a[136:139], v[116:119], v[180:183]
global_load_lds_dwordx4 v10, s[30:31] offset:2048 sc1
v_mfma_f32_16x16x32_bf16 v[168:171], a[216:219], v[112:115], v[168:171]
v_mfma_f32_16x16x32_bf16 v[184:187], a[216:219], v[116:119], v[184:187]
v_mfma_f32_16x16x32_bf16 v[172:175], v[232:235], v[112:115], v[172:175]
v_mfma_f32_16x16x32_bf16 v[188:191], v[232:235], v[116:119], v[188:191]
global_load_lds_dwordx4 v10, s[30:31] offset:3072 sc1
s_waitcnt lgkmcnt(4)
v_mfma_f32_16x16x32_bf16 v[160:163], a[60:63], v[120:123], v[160:163]
v_mfma_f32_16x16x32_bf16 v[176:179], a[60:63], v[124:127], v[176:179]
ds_read_b128 v[112:115], v13 offset:18432
ds_read_b128 v[116:119], v13 offset:38912
v_mfma_f32_16x16x32_bf16 v[164:167], a[140:143], v[120:123], v[164:167]
v_mfma_f32_16x16x32_bf16 v[180:183], a[140:143], v[124:127], v[180:183]
s_add_u32 m0, s33, 4096
s_nop 0
global_load_lds_dwordx4 v11, s[30:31] offset:0 sc1
v_mfma_f32_16x16x32_bf16 v[168:171], a[220:223], v[120:123], v[168:171]
v_mfma_f32_16x16x32_bf16 v[184:187], a[220:223], v[124:127], v[184:187]
v_mfma_f32_16x16x32_bf16 v[172:175], v[236:239], v[120:123], v[172:175]
v_mfma_f32_16x16x32_bf16 v[188:191], v[236:239], v[124:127], v[188:191]
global_load_lds_dwordx4 v11, s[30:31] offset:1024 sc1
s_waitcnt lgkmcnt(4)
v_mfma_f32_16x16x32_bf16 v[160:163], a[64:67], v[96:99], v[160:163]
v_mfma_f32_16x16x32_bf16 v[176:179], a[64:67], v[100:103], v[176:179]
ds_read_b128 v[120:123], v13 offset:19456
ds_read_b128 v[124:127], v13 offset:39936
v_mfma_f32_16x16x32_bf16 v[164:167], a[144:147], v[96:99], v[164:167]
v_mfma_f32_16x16x32_bf16 v[180:183], a[144:147], v[100:103], v[180:183]
global_load_lds_dwordx4 v11, s[30:31] offset:2048 sc1
v_mfma_f32_16x16x32_bf16 v[168:171], a[224:227], v[96:99], v[168:171]
v_mfma_f32_16x16x32_bf16 v[184:187], a[224:227], v[100:103], v[184:187]
v_mfma_f32_16x16x32_bf16 v[172:175], v[240:243], v[96:99], v[172:175]
v_mfma_f32_16x16x32_bf16 v[188:191], v[240:243], v[100:103], v[188:191]
global_load_lds_dwordx4 v11, s[30:31] offset:3072 sc1
s_waitcnt lgkmcnt(4)
v_mfma_f32_16x16x32_bf16 v[160:163], a[68:71], v[104:107], v[160:163]
v_mfma_f32_16x16x32_bf16 v[176:179], a[68:71], v[108:111], v[176:179]
ds_read_b128 v[96:99], v15 offset:0
ds_read_b128 v[100:103], v15 offset:20480
v_mfma_f32_16x16x32_bf16 v[164:167], a[148:151], v[104:107], v[164:167]
v_mfma_f32_16x16x32_bf16 v[180:183], a[148:151], v[108:111], v[180:183]
s_add_u32 m0, s33, 8192
s_nop 0
global_load_lds_dwordx4 v12, s[30:31] offset:0 sc1
v_mfma_f32_16x16x32_bf16 v[168:171], a[228:231], v[104:107], v[168:171]
v_mfma_f32_16x16x32_bf16 v[184:187], a[228:231], v[108:111], v[184:187]
v_mfma_f32_16x16x32_bf16 v[172:175], v[244:247], v[104:107], v[172:175]
v_mfma_f32_16x16x32_bf16 v[188:191], v[244:247], v[108:111], v[188:191]
global_load_lds_dwordx4 v12, s[30:31] offset:1024 sc1
s_waitcnt lgkmcnt(4)
v_mfma_f32_16x16x32_bf16 v[160:163], a[72:75], v[112:115], v[160:163]
v_mfma_f32_16x16x32_bf16 v[176:179], a[72:75], v[116:119], v[176:179]
ds_read_b128 v[104:107], v15 offset:1024
ds_read_b128 v[108:111], v15 offset:21504
v_mfma_f32_16x16x32_bf16 v[164:167], a[152:155], v[112:115], v[164:167]
v_mfma_f32_16x16x32_bf16 v[180:183], a[152:155], v[116:119], v[180:183]
s_add_u32 s32, s32, 2
s_cmp_lt_u32 s32, s45
s_cselect_b32 s3, 81920, 0
s_add_u32 s30, s30, s3
s_addc_u32 s31, s31, 0
s_add_u32 s33, s33, 40960
s_sub_u32 s3, s33, 122880
s_cmp_ge_u32 s33, 122880
s_cselect_b32 s33, s3, s33
v_mfma_f32_16x16x32_bf16 v[168:171], a[232:235], v[112:115], v[168:171]
v_mfma_f32_16x16x32_bf16 v[184:187], a[232:235], v[116:119], v[184:187]
v_mfma_f32_16x16x32_bf16 v[172:175], v[248:251], v[112:115], v[172:175]
v_mfma_f32_16x16x32_bf16 v[188:191], v[248:251], v[116:119], v[188:191]
s_waitcnt lgkmcnt(4)
v_mfma_f32_16x16x32_bf16 v[160:163], a[76:79], v[120:123], v[160:163]
v_mfma_f32_16x16x32_bf16 v[176:179], a[76:79], v[124:127], v[176:179]
ds_read_b128 v[112:115], v15 offset:2048
ds_read_b128 v[116:119], v15 offset:22528
v_mfma_f32_16x16x32_bf16 v[164:167], a[156:159], v[120:123], v[164:167]
v_mfma_f32_16x16x32_bf16 v[180:183], a[156:159], v[124:127], v[180:183]
v_mfma_f32_16x16x32_bf16 v[168:171], a[236:239], v[120:123], v[168:171]
v_mfma_f32_16x16x32_bf16 v[184:187], a[236:239], v[124:127], v[184:187]
v_mfma_f32_16x16x32_bf16 v[172:175], v[252:255], v[120:123], v[172:175]
v_mfma_f32_16x16x32_bf16 v[188:191], v[252:255], v[124:127], v[188:191]
v_mov_b32 v13, v15
s_add_u32 s34, s34, 2
s_cmp_ge_u32 s34, s45
s_cbranch_scc1 L_qkv_K_fin
s_waitcnt lgkmcnt(4)
v_mfma_f32_16x16x32_bf16 v[128:131], a[0:3], v[96:99], 0
v_mfma_f32_16x16x32_bf16 v[144:147], a[0:3], v[100:103], 0
ds_read_b128 v[120:123], v13 offset:3072
ds_read_b128 v[124:127], v13 offset:23552
v_mfma_f32_16x16x32_bf16 v[132:135], a[80:83], v[96:99], 0
v_mfma_f32_16x16x32_bf16 v[148:151], a[80:83], v[100:103], 0
v_mfma_f32_16x16x32_bf16 v[136:139], a[160:163], v[96:99], 0
v_mfma_f32_16x16x32_bf16 v[152:155], a[160:163], v[100:103], 0
v_mfma_f32_16x16x32_bf16 v[140:143], a[240:243], v[96:99], 0
v_mfma_f32_16x16x32_bf16 v[156:159], a[240:243], v[100:103], 0
s_waitcnt lgkmcnt(4)
v_mfma_f32_16x16x32_bf16 v[128:131], a[4:7], v[104:107], v[128:131]
v_cvt_pk_bf16_f32 v64, v160, v161
v_mfma_f32_16x16x32_bf16 v[144:147], a[4:7], v[108:111], v[144:147]
v_cvt_pk_bf16_f32 v65, v162, v163
ds_read_b128 v[96:99], v13 offset:4096
ds_read_b128 v[100:103], v13 offset:24576
v_mfma_f32_16x16x32_bf16 v[132:135], a[84:87], v[104:107], v[132:135]
v_cvt_pk_bf16_f32 v66, v164, v165
v_mfma_f32_16x16x32_bf16 v[148:151], a[84:87], v[108:111], v[148:151]
v_cvt_pk_bf16_f32 v67, v166, v167
v_mfma_f32_16x16x32_bf16 v[136:139], a[164:167], v[104:107], v[136:139]
global_store_dwordx4 v10, v[64:67], s[26:27] offset:0 sc1
v_mfma_f32_16x16x32_bf16 v[152:155], a[164:167], v[108:111], v[152:155]
v_cvt_pk_bf16_f32 v68, v168, v169
v_mfma_f32_16x16x32_bf16 v[140:143], a[244:247], v[104:107], v[140:143]
v_cvt_pk_bf16_f32 v69, v170, v171
v_mfma_f32_16x16x32_bf16 v[156:159], a[244:247], v[108:111], v[156:159]
v_cvt_pk_bf16_f32 v70, v172, v173
s_waitcnt lgkmcnt(4)
v_mfma_f32_16x16x32_bf16 v[128:131], a[8:11], v[112:115], v[128:131]
v_cvt_pk_bf16_f32 v71, v174, v175
v_mfma_f32_16x16x32_bf16 v[144:147], a[8:11], v[116:119], v[144:147]
global_store_dwordx4 v10, v[68:71], s[26:27] offset:1024 sc1
ds_read_b128 v[104:107], v13 offset:5120
ds_read_b128 v[108:111], v13 offset:25600
v_mfma_f32_16x16x32_bf16 v[132:135], a[88:91], v[112:115], v[132:135]
v_cvt_pk_bf16_f32 v72, v176, v177
v_mfma_f32_16x16x32_bf16 v[148:151], a[88:91], v[116:119], v[148:151]
v_cvt_pk_bf16_f32 v73, v178, v179
v_mfma_f32_16x16x32_bf16 v[136:139], a[168:171], v[112:115], v[136:139]
v_cvt_pk_bf16_f32 v74, v180, v181
v_mfma_f32_16x16x32_bf16 v[152:155], a[168:171], v[116:119], v[152:155]
v_cvt_pk_bf16_f32 v75, v182, v183
v_mfma_f32_16x16x32_bf16 v[140:143], a[248:251], v[112:115], v[140:143]
global_store_dwordx4 v11, v[72:75], s[26:27] offset:0 sc1
v_mfma_f32_16x16x32_bf16 v[156:159], a[248:251], v[116:119], v[156:159]
v_cvt_pk_bf16_f32 v76, v184, v185
s_waitcnt lgkmcnt(4)
v_mfma_f32_16x16x32_bf16 v[128:131], a[12:15], v[120:123], v[128:131]
v_cvt_pk_bf16_f32 v77, v186, v187
v_mfma_f32_16x16x32_bf16 v[144:147], a[12:15], v[124:127], v[144:147]
v_cvt_pk_bf16_f32 v78, v188, v189
ds_read_b128 v[112:115], v13 offset:6144
ds_read_b128 v[116:119], v13 offset:26624
v_mfma_f32_16x16x32_bf16 v[132:135], a[92:95], v[120:123], v[132:135]
v_cvt_pk_bf16_f32 v79, v190, v191
v_mfma_f32_16x16x32_bf16 v[148:151], a[92:95], v[124:127], v[148:151]
global_store_dwordx4 v11, v[76:79], s[26:27] offset:1024 sc1
v_mfma_f32_16x16x32_bf16 v[136:139], a[172:175], v[120:123], v[136:139]
s_add_u32 s26, s26, s28
s_addc_u32 s27, s27, 0
s_sub_u32 s28, s47, s28
v_mfma_f32_16x16x32_bf16 v[152:155], a[172:175], v[124:127], v[152:155]
v_mfma_f32_16x16x32_bf16 v[140:143], a[252:255], v[120:123], v[140:143]
v_mfma_f32_16x16x32_bf16 v[156:159], a[252:255], v[124:127], v[156:159]
s_waitcnt lgkmcnt(4)
v_mfma_f32_16x16x32_bf16 v[128:131], a[16:19], v[96:99], v[128:131]
v_mfma_f32_16x16x32_bf16 v[144:147], a[16:19], v[100:103], v[144:147]
ds_read_b128 v[120:123], v13 offset:7168
ds_read_b128 v[124:127], v13 offset:27648
v_mfma_f32_16x16x32_bf16 v[132:135], a[96:99], v[96:99], v[132:135]
v_mfma_f32_16x16x32_bf16 v[148:151], a[96:99], v[100:103], v[148:151]
v_mfma_f32_16x16x32_bf16 v[136:139], a[176:179], v[96:99], v[136:139]
v_mfma_f32_16x16x32_bf16 v[152:155], a[176:179], v[100:103], v[152:155]
v_mfma_f32_16x16x32_bf16 v[140:143], v[192:195], v[96:99], v[140:143]
v_mfma_f32_16x16x32_bf16 v[156:159], v[192:195], v[100:103], v[156:159]
s_waitcnt lgkmcnt(4)
v_mfma_f32_16x16x32_bf16 v[128:131], a[20:23], v[104:107], v[128:131]
v_mfma_f32_16x16x32_bf16 v[144:147], a[20:23], v[108:111], v[144:147]
ds_read_b128 v[96:99], v13 offset:8192
ds_read_b128 v[100:103], v13 offset:28672
v_mfma_f32_16x16x32_bf16 v[132:135], a[100:103], v[104:107], v[132:135]
v_mfma_f32_16x16x32_bf16 v[148:151], a[100:103], v[108:111], v[148:151]
v_mfma_f32_16x16x32_bf16 v[136:139], a[180:183], v[104:107], v[136:139]
v_mfma_f32_16x16x32_bf16 v[152:155], a[180:183], v[108:111], v[152:155]
v_mfma_f32_16x16x32_bf16 v[140:143], v[196:199], v[104:107], v[140:143]
v_mfma_f32_16x16x32_bf16 v[156:159], v[196:199], v[108:111], v[156:159]
s_waitcnt lgkmcnt(4)
v_mfma_f32_16x16x32_bf16 v[128:131], a[24:27], v[112:115], v[128:131]
v_mfma_f32_16x16x32_bf16 v[144:147], a[24:27], v[116:119], v[144:147]
ds_read_b128 v[104:107], v13 offset:9216
ds_read_b128 v[108:111], v13 offset:29696
v_mfma_f32_16x16x32_bf16 v[132:135], a[104:107], v[112:115], v[132:135]
v_mfma_f32_16x16x32_bf16 v[148:151], a[104:107], v[116:119], v[148:151]
v_mfma_f32_16x16x32_bf16 v[136:139], a[184:187], v[112:115], v[136:139]
v_mfma_f32_16x16x32_bf16 v[152:155], a[184:187], v[116:119], v[152:155]
v_mfma_f32_16x16x32_bf16 v[140:143], v[200:203], v[112:115], v[140:143]
v_mfma_f32_16x16x32_bf16 v[156:159], v[200:203], v[116:119], v[156:159]
s_waitcnt lgkmcnt(4)
v_mfma_f32_16x16x32_bf16 v[128:131], a[28:31], v[120:123], v[128:131]
v_mfma_f32_16x16x32_bf16 v[144:147], a[28:31], v[124:127], v[144:147]
ds_read_b128 v[112:115], v13 offset:10240
ds_read_b128 v[116:119], v13 offset:30720
v_mfma_f32_16x16x32_bf16 v[132:135], a[108:111], v[120:123], v[132:135]
v_mfma_f32_16x16x32_bf16 v[148:151], a[108:111], v[124:127], v[148:151]
v_mfma_f32_16x16x32_bf16 v[136:139], a[188:191], v[120:123], v[136:139]
v_mfma_f32_16x16x32_bf16 v[152:155], a[188:191], v[124:127], v[152:155]
v_mfma_f32_16x16x32_bf16 v[140:143], v[204:207], v[120:123], v[140:143]
v_mfma_f32_16x16x32_bf16 v[156:159], v[204:207], v[124:127], v[156:159]
s_waitcnt lgkmcnt(4)
v_mfma_f32_16x16x32_bf16 v[128:131], a[32:35], v[96:99], v[128:131]
v_mfma_f32_16x16x32_bf16 v[144:147], a[32:35], v[100:103], v[144:147]
ds_read_b128 v[120:123], v13 offset:11264
ds_read_b128 v[124:127], v13 offset:31744
v_mfma_f32_16x16x32_bf16 v[132:135], a[112:115], v[96:99], v[132:135]
v_mfma_f32_16x16x32_bf16 v[148:151], a[112:115], v[100:103], v[148:151]
v_mfma_f32_16x16x32_bf16 v[136:139], a[192:195], v[96:99], v[136:139]
v_mfma_f32_16x16x32_bf16 v[152:155], a[192:195], v[100:103], v[152:155]
v_mfma_f32_16x16x32_bf16 v[140:143], v[208:211], v[96:99], v[140:143]
v_mfma_f32_16x16x32_bf16 v[156:159], v[208:211], v[100:103], v[156:159]
s_waitcnt lgkmcnt(4)
v_mfma_f32_16x16x32_bf16 v[128:131], a[36:39], v[104:107], v[128:131]
v_mfma_f32_16x16x32_bf16 v[144:147], a[36:39], v[108:111], v[144:147]
ds_read_b128 v[96:99], v13 offset:12288
ds_read_b128 v[100:103], v13 offset:32768
v_mfma_f32_16x16x32_bf16 v[132:135], a[116:119], v[104:107], v[132:135]
v_mfma_f32_16x16x32_bf16 v[148:151], a[116:119], v[108:111], v[148:151]
v_mfma_f32_16x16x32_bf16 v[136:139], a[196:199], v[104:107], v[136:139]
v_mfma_f32_16x16x32_bf16 v[152:155], a[196:199], v[108:111], v[152:155]
v_mfma_f32_16x16x32_bf16 v[140:143], v[212:215], v[104:107], v[140:143]
v_mfma_f32_16x16x32_bf16 v[156:159], v[212:215], v[108:111], v[156:159]
s_waitcnt lgkmcnt(4)
v_mfma_f32_16x16x32_bf16 v[128:131], a[40:43], v[112:115], v[128:131]
v_mfma_f32_16x16x32_bf16 v[144:147], a[40:43], v[116:119], v[144:147]
ds_read_b128 v[104:107], v13 offset:13312
ds_read_b128 v[108:111], v13 offset:33792
v_mfma_f32_16x16x32_bf16 v[132:135], a[120:123], v[112:115], v[132:135]
v_mfma_f32_16x16x32_bf16 v[148:151], a[120:123], v[116:119], v[148:151]
v_mfma_f32_16x16x32_bf16 v[136:139], a[200:203], v[112:115], v[136:139]
v_mfma_f32_16x16x32_bf16 v[152:155], a[200:203], v[116:119], v[152:155]
v_mfma_f32_16x16x32_bf16 v[140:143], v[216:219], v[112:115], v[140:143]
v_mfma_f32_16x16x32_bf16 v[156:159], v[216:219], v[116:119], v[156:159]
s_waitcnt lgkmcnt(4)
v_mfma_f32_16x16x32_bf16 v[128:131], a[44:47], v[120:123], v[128:131]
v_mfma_f32_16x16x32_bf16 v[144:147], a[44:47], v[124:127], v[144:147]
ds_read_b128 v[112:115], v13 offset:14336
ds_read_b128 v[116:119], v13 offset:34816
v_mfma_f32_16x16x32_bf16 v[132:135], a[124:127], v[120:123], v[132:135]
v_mfma_f32_16x16x32_bf16 v[148:151], a[124:127], v[124:127], v[148:151]
v_mfma_f32_16x16x32_bf16 v[136:139], a[204:207], v[120:123], v[136:139]
v_mfma_f32_16x16x32_bf16 v[152:155], a[204:207], v[124:127], v[152:155]
v_mfma_f32_16x16x32_bf16 v[140:143], v[220:223], v[120:123], v[140:143]
v_mfma_f32_16x16x32_bf16 v[156:159], v[220:223], v[124:127], v[156:159]
s_waitcnt lgkmcnt(4)
v_mfma_f32_16x16x32_bf16 v[128:131], a[48:51], v[96:99], v[128:131]
v_mfma_f32_16x16x32_bf16 v[144:147], a[48:51], v[100:103], v[144:147]
ds_read_b128 v[120:123], v13 offset:15360
ds_read_b128 v[124:127], v13 offset:35840
v_mfma_f32_16x16x32_bf16 v[132:135], a[128:131], v[96:99], v[132:135]
v_mfma_f32_16x16x32_bf16 v[148:151], a[128:131], v[100:103], v[148:151]
v_mfma_f32_16x16x32_bf16 v[136:139], a[208:211], v[96:99], v[136:139]
v_mfma_f32_16x16x32_bf16 v[152:155], a[208:211], v[100:103], v[152:155]
v_mfma_f32_16x16x32_bf16 v[140:143], v[224:227], v[96:99], v[140:143]
v_mfma_f32_16x16x32_bf16 v[156:159], v[224:227], v[100:103], v[156:159]
s_mov_b32 s49, s48
s_add_u32 s48, s48, 1
s_cmp_gt_u32 s48, 2
s_cbranch_scc1 L_lax_40
s_waitcnt vmcnt(0)
s_mov_b32 s49, s48
L_lax_40:
s_waitcnt vmcnt(4)
s_cmp_lg_u32 s48, 4
s_cbranch_scc1 L_fb_41
v_mov_b32 v18, 156
s_mov_b32 s96, 0x80000
L_wf_42:
global_load_dword v19, v18, s[94:95] sc1
s_waitcnt vmcnt(0)
v_cmp_gt_u32 vcc, 1, v19
s_nop 0
s_cbranch_vccz L_wd_43
s_sleep 3
s_sub_u32 s96, s96, 1
s_cbranch_scc0 L_wf_42
s_branch L_wabort
L_wd_43:
L_fb_41:
s_barrier
s_cmp_eq_u32 s43, 0
s_cbranch_scc1 L_pg_44
v_mov_b32 v17, s49
s_mov_b64 exec, 1
global_store_dword v16, v17, s[8:9] sc1
s_mov_b64 exec, -1
L_pg_44:
s_add_u32 s35, s35, 40960
s_cmp_ge_u32 s35, 122880
s_cselect_b32 s35, 0, s35
v_add_u32 v15, s35, v10
s_waitcnt lgkmcnt(4)
v_mfma_f32_16x16x32_bf16 v[128:131], a[52:55], v[104:107], v[128:131]
v_mfma_f32_16x16x32_bf16 v[144:147], a[52:55], v[108:111], v[144:147]
ds_read_b128 v[96:99], v13 offset:16384
ds_read_b128 v[100:103], v13 offset:36864
v_mfma_f32_16x16x32_bf16 v[132:135], a[132:135], v[104:107], v[132:135]
v_mfma_f32_16x16x32_bf16 v[148:151], a[132:135], v[108:111], v[148:151]
s_add_u32 m0, s33, 0
s_nop 0
global_load_lds_dwordx4 v10, s[30:31] offset:0 sc1
v_mfma_f32_16x16x32_bf16 v[136:139], a[212:215], v[104:107], v[136:139]
v_mfma_f32_16x16x32_bf16 v[152:155], a[212:215], v[108:111], v[152:155]
v_mfma_f32_16x16x32_bf16 v[140:143], v[228:231], v[104:107], v[140:143]
v_mfma_f32_16x16x32_bf16 v[156:159], v[228:231], v[108:111], v[156:159]
global_load_lds_dwordx4 v10, s[30:31] offset:1024 sc1
s_waitcnt lgkmcnt(4)
v_mfma_f32_16x16x32_bf16 v[128:131], a[56:59], v[112:115], v[128:131]
v_mfma_f32_16x16x32_bf16 v[144:147], a[56:59], v[116:119], v[144:147]
ds_read_b128 v[104:107], v13 offset:17408
ds_read_b128 v[108:111], v13 offset:37888
v_mfma_f32_16x16x32_bf16 v[132:135], a[136:139], v[112:115], v[132:135]
v_mfma_f32_16x16x32_bf16 v[148:151], a[136:139], v[116:119], v[148:151]
global_load_lds_dwordx4 v10, s[30:31] offset:2048 sc1
v_mfma_f32_16x16x32_bf16 v[136:139], a[216:219], v[112:115], v[136:139]
v_mfma_f32_16x16x32_bf16 v[152:155], a[216:219], v[116:119], v[152:155]
v_mfma_f32_16x16x32_bf16 v[140:143], v[232:235], v[112:115], v[140:143]
v_mfma_f32_16x16x32_bf16 v[156:159], v[232:235], v[116:119], v[156:159]
global_load_lds_dwordx4 v10, s[30:31] offset:3072 sc1
s_waitcnt lgkmcnt(4)
v_mfma_f32_16x16x32_bf16 v[128:131], a[60:63], v[120:123], v[128:131]
v_mfma_f32_16x16x32_bf16 v[144:147], a[60:63], v[124:127], v[144:147]
ds_read_b128 v[112:115], v13 offset:18432
ds_read_b128 v[116:119], v13 offset:38912
v_mfma_f32_16x16x32_bf16 v[132:135], a[140:143], v[120:123], v[132:135]
v_mfma_f32_16x16x32_bf16 v[148:151], a[140:143], v[124:127], v[148:151]
s_add_u32 m0, s33, 4096
s_nop 0
global_load_lds_dwordx4 v11, s[30:31] offset:0 sc1
v_mfma_f32_16x16x32_bf16 v[136:139], a[220:223], v[120:123], v[136:139]
v_mfma_f32_16x16x32_bf16 v[152:155], a[220:223], v[124:127], v[152:155]
v_mfma_f32_16x16x32_bf16 v[140:143], v[236:239], v[120:123], v[140:143]
v_mfma_f32_16x16x32_bf16 v[156:159], v[236:239], v[124:127], v[156:159]
global_load_lds_dwordx4 v11, s[30:31] offset:1024 sc1
s_waitcnt lgkmcnt(4)
v_mfma_f32_16x16x32_bf16 v[128:131], a[64:67], v[96:99], v[128:131]
v_mfma_f32_16x16x32_bf16 v[144:147], a[64:67], v[100:103], v[144:147]
ds_read_b128 v[120:123], v13 offset:19456
ds_read_b128 v[124:127], v13 offset:39936
v_mfma_f32_16x16x32_bf16 v[132:135], a[144:147], v[96:99], v[132:135]
v_mfma_f32_16x16x32_bf16 v[148:151], a[144:147], v[100:103], v[148:151]
global_load_lds_dwordx4 v11, s[30:31] offset:2048 sc1
v_mfma_f32_16x16x32_bf16 v[136:139], a[224:227], v[96:99], v[136:139]
v_mfma_f32_16x16x32_bf16 v[152:155], a[224:227], v[100:103], v[152:155]
v_mfma_f32_16x16x32_bf16 v[140:143], v[240:243], v[96:99], v[140:143]
v_mfma_f32_16x16x32_bf16 v[156:159], v[240:243], v[100:103], v[156:159]
global_load_lds_dwordx4 v11, s[30:31] offset:3072 sc1
s_waitcnt lgkmcnt(4)
v_mfma_f32_16x16x32_bf16 v[128:131], a[68:71], v[104:107], v[128:131]
v_mfma_f32_16x16x32_bf16 v[144:147], a[68:71], v[108:111], v[144:147]
ds_read_b128 v[96:99], v15 offset:0
ds_read_b128 v[100:103], v15 offset:20480
v_mfma_f32_16x16x32_bf16 v[132:135], a[148:151], v[104:107], v[132:135]
v_mfma_f32_16x16x32_bf16 v[148:151], a[148:151], v[108:111], v[148:151]
s_add_u32 m0, s33, 8192
s_nop 0
global_load_lds_dwordx4 v12, s[30:31] offset:0 sc1
v_mfma_f32_16x16x32_bf16 v[136:139], a[228:231], v[104:107], v[136:139]
v_mfma_f32_16x16x32_bf16 v[152:155], a[228:231], v[108:111], v[152:155]
v_mfma_f32_16x16x32_bf16 v[140:143], v[244:247], v[104:107], v[140:143]
v_mfma_f32_16x16x32_bf16 v[156:159], v[244:247], v[108:111], v[156:159]
global_load_lds_dwordx4 v12, s[30:31] offset:1024 sc1
s_waitcnt lgkmcnt(4)
v_mfma_f32_16x16x32_bf16 v[128:131], a[72:75], v[112:115], v[128:131]
v_mfma_f32_16x16x32_bf16 v[144:147], a[72:75], v[116:119], v[144:147]
ds_read_b128 v[104:107], v15 offset:1024
ds_read_b128 v[108:111], v15 offset:21504
v_mfma_f32_16x16x32_bf16 v[132:135], a[152:155], v[112:115], v[132:135]
v_mfma_f32_16x16x32_bf16 v[148:151], a[152:155], v[116:119], v[148:151]
s_add_u32 s32, s32, 2
s_cmp_lt_u32 s32, s45
s_cselect_b32 s3, 81920, 0
s_add_u32 s30, s30, s3
s_addc_u32 s31, s31, 0
s_add_u32 s33, s33, 40960
s_sub_u32 s3, s33, 122880
s_cmp_ge_u32 s33, 122880
s_cselect_b32 s33, s3, s33
v_mfma_f32_16x16x32_bf16 v[136:139], a[232:235], v[112:115], v[136:139]
v_mfma_f32_16x16x32_bf16 v[152:155], a[232:235], v[116:119], v[152:155]
v_mfma_f32_16x16x32_bf16 v[140:143], v[248:251], v[112:115], v[140:143]
v_mfma_f32_16x16x32_bf16 v[156:159], v[248:251], v[116:119], v[156:159]
s_waitcnt lgkmcnt(4)
v_mfma_f32_16x16x32_bf16 v[128:131], a[76:79], v[120:123], v[128:131]
v_mfma_f32_16x16x32_bf16 v[144:147], a[76:79], v[124:127], v[144:147]
ds_read_b128 v[112:115], v15 offset:2048
ds_read_b128 v[116:119], v15 offset:22528
v_mfma_f32_16x16x32_bf16 v[132:135], a[156:159], v[120:123], v[132:135]
v_mfma_f32_16x16x32_bf16 v[148:151], a[156:159], v[124:127], v[148:151]
v_mfma_f32_16x16x32_bf16 v[136:139], a[236:239], v[120:123], v[136:139]
v_mfma_f32_16x16x32_bf16 v[152:155], a[236:239], v[124:127], v[152:155]
v_mfma_f32_16x16x32_bf16 v[140:143], v[252:255], v[120:123], v[140:143]
v_mfma_f32_16x16x32_bf16 v[156:159], v[252:255], v[124:127], v[156:159]
v_mov_b32 v13, v15
s_add_u32 s34, s34, 2
s_cmp_ge_u32 s34, s45
s_branch L_qkv_K_loop
L_qkv_K_fin:
s_nop 7
v_cvt_pk_bf16_f32 v64, v160, v161
v_cvt_pk_bf16_f32 v65, v162, v163
v_cvt_pk_bf16_f32 v66, v164, v165
v_cvt_pk_bf16_f32 v67, v166, v167
global_store_dwordx4 v10, v[64:67], s[26:27] offset:0 sc1
v_cvt_pk_bf16_f32 v68, v168, v169
v_cvt_pk_bf16_f32 v69, v170, v171
v_cvt_pk_bf16_f32 v70, v172, v173
v_cvt_pk_bf16_f32 v71, v174, v175
global_store_dwordx4 v10, v[68:71], s[26:27] offset:1024 sc1
v_cvt_pk_bf16_f32 v72, v176, v177
v_cvt_pk_bf16_f32 v73, v178, v179
v_cvt_pk_bf16_f32 v74, v180, v181
v_cvt_pk_bf16_f32 v75, v182, v183
global_store_dwordx4 v11, v[72:75], s[26:27] offset:0 sc1
v_cvt_pk_bf16_f32 v76, v184, v185
v_cvt_pk_bf16_f32 v77, v186, v187
v_cvt_pk_bf16_f32 v78, v188, v189
v_cvt_pk_bf16_f32 v79, v190, v191
global_store_dwordx4 v11, v[76:79], s[26:27] offset:1024 sc1
s_add_u32 s26, s26, s28
s_addc_u32 s27, s27, 0
s_sub_u32 s28, s47, s28
s_waitcnt vmcnt(0) lgkmcnt(0)
s_barrier
s_cmp_eq_u32 s43, 0
s_cbranch_scc1 L_pg_45
v_mov_b32 v17, 16
s_mov_b64 exec, 1
global_store_dword v16, v17, s[8:9] sc1
s_mov_b64 exec, -1
L_pg_45:
s_branch L_post
L_qkv_V:
ds_read_b128 v[96:99], v13 offset:0
ds_read_b128 v[100:103], v13 offset:20480
ds_read_b128 v[104:107], v13 offset:1024
ds_read_b128 v[108:111], v13 offset:21504
ds_read_b128 v[112:115], v13 offset:2048
ds_read_b128 v[116:119], v13 offset:22528
s_waitcnt lgkmcnt(4)
v_mfma_f32_16x16x32_bf16 v[128:131], v[96:99], a[0:3], 0
v_mfma_f32_16x16x32_bf16 v[144:147], v[100:103], a[0:3], 0
ds_read_b128 v[120:123], v13 offset:3072
ds_read_b128 v[124:127], v13 offset:23552
v_mfma_f32_16x16x32_bf16 v[132:135], v[96:99], a[80:83], 0
v_mfma_f32_16x16x32_bf16 v[148:151], v[100:103], a[80:83], 0
v_mfma_f32_16x16x32_bf16 v[136:139], v[96:99], a[160:163], 0
v_mfma_f32_16x16x32_bf16 v[152:155], v[100:103], a[160:163], 0
v_mfma_f32_16x16x32_bf16 v[140:143], v[96:99], a[240:243], 0
v_mfma_f32_16x16x32_bf16 v[156:159], v[100:103], a[240:243], 0
s_waitcnt lgkmcnt(4)
v_mfma_f32_16x16x32_bf16 v[128:131], v[104:107], a[4:7], v[128:131]
v_mfma_f32_16x16x32_bf16 v[144:147], v[108:111], a[4:7], v[144:147]
ds_read_b128 v[96:99], v13 offset:4096
ds_read_b128 v[100:103], v13 offset:24576
v_mfma_f32_16x16x32_bf16 v[132:135], v[104:107], a[84:87], v[132:135]
v_mfma_f32_16x16x32_bf16 v[148:151], v[108:111], a[84:87], v[148:151]
v_mfma_f32_16x16x32_bf16 v[136:139], v[104:107], a[164:167], v[136:139]
v_mfma_f32_16x16x32_bf16 v[152:155], v[108:111], a[164:167], v[152:155]
v_mfma_f32_16x16x32_bf16 v[140:143], v[104:107], a[244:247], v[140:143]
v_mfma_f32_16x16x32_bf16 v[156:159], v[108:111], a[244:247], v[156:159]
s_waitcnt lgkmcnt(4)
v_mfma_f32_16x16x32_bf16 v[128:131], v[112:115], a[8:11], v[128:131]
v_mfma_f32_16x16x32_bf16 v[144:147], v[116:119], a[8:11], v[144:147]
ds_read_b128 v[104:107], v13 offset:5120
ds_read_b128 v[108:111], v13 offset:25600
v_mfma_f32_16x16x32_bf16 v[132:135], v[112:115], a[88:91], v[132:135]
v_mfma_f32_16x16x32_bf16 v[148:151], v[116:119], a[88:91], v[148:151]
v_mfma_f32_16x16x32_bf16 v[136:139], v[112:115], a[168:171], v[136:139]
v_mfma_f32_16x16x32_bf16 v[152:155], v[116:119], a[168:171], v[152:155]
v_mfma_f32_16x16x32_bf16 v[140:143], v[112:115], a[248:251], v[140:143]
v_mfma_f32_16x16x32_bf16 v[156:159], v[116:119], a[248:251], v[156:159]
s_waitcnt lgkmcnt(4)
v_mfma_f32_16x16x32_bf16 v[128:131], v[120:123], a[12:15], v[128:131]
v_mfma_f32_16x16x32_bf16 v[144:147], v[124:127], a[12:15], v[144:147]
ds_read_b128 v[112:115], v13 offset:6144
ds_read_b128 v[116:119], v13 offset:26624
v_mfma_f32_16x16x32_bf16 v[132:135], v[120:123], a[92:95], v[132:135]
v_mfma_f32_16x16x32_bf16 v[148:151], v[124:127], a[92:95], v[148:151]
v_mfma_f32_16x16x32_bf16 v[136:139], v[120:123], a[172:175], v[136:139]
v_mfma_f32_16x16x32_bf16 v[152:155], v[124:127], a[172:175], v[152:155]
v_mfma_f32_16x16x32_bf16 v[140:143], v[120:123], a[252:255], v[140:143]
v_mfma_f32_16x16x32_bf16 v[156:159], v[124:127], a[252:255], v[156:159]
s_waitcnt lgkmcnt(4)
v_mfma_f32_16x16x32_bf16 v[128:131], v[96:99], a[16:19], v[128:131]
v_mfma_f32_16x16x32_bf16 v[144:147], v[100:103], a[16:19], v[144:147]
ds_read_b128 v[120:123], v13 offset:7168
ds_read_b128 v[124:127], v13 offset:27648
v_mfma_f32_16x16x32_bf16 v[132:135], v[96:99], a[96:99], v[132:135]
v_mfma_f32_16x16x32_bf16 v[148:151], v[100:103], a[96:99], v[148:151]
v_mfma_f32_16x16x32_bf16 v[136:139], v[96:99], a[176:179], v[136:139]
v_mfma_f32_16x16x32_bf16 v[152:155], v[100:103], a[176:179], v[152:155]
v_mfma_f32_16x16x32_bf16 v[140:143], v[96:99], v[192:195], v[140:143]
v_mfma_f32_16x16x32_bf16 v[156:159], v[100:103], v[192:195], v[156:159]
s_waitcnt lgkmcnt(4)
v_mfma_f32_16x16x32_bf16 v[128:131], v[104:107], a[20:23], v[128:131]
v_mfma_f32_16x16x32_bf16 v[144:147], v[108:111], a[20:23], v[144:147]
ds_read_b128 v[96:99], v13 offset:8192
ds_read_b128 v[100:103], v13 offset:28672
v_mfma_f32_16x16x32_bf16 v[132:135], v[104:107], a[100:103], v[132:135]
v_mfma_f32_16x16x32_bf16 v[148:151], v[108:111], a[100:103], v[148:151]
v_mfma_f32_16x16x32_bf16 v[136:139], v[104:107], a[180:183], v[136:139]
v_mfma_f32_16x16x32_bf16 v[152:155], v[108:111], a[180:183], v[152:155]
v_mfma_f32_16x16x32_bf16 v[140:143], v[104:107], v[196:199], v[140:143]
v_mfma_f32_16x16x32_bf16 v[156:159], v[108:111], v[196:199], v[156:159]
s_waitcnt lgkmcnt(4)
v_mfma_f32_16x16x32_bf16 v[128:131], v[112:115], a[24:27], v[128:131]
v_mfma_f32_16x16x32_bf16 v[144:147], v[116:119], a[24:27], v[144:147]
ds_read_b128 v[104:107], v13 offset:9216
ds_read_b128 v[108:111], v13 offset:29696
v_mfma_f32_16x16x32_bf16 v[132:135], v[112:115], a[104:107], v[132:135]
v_mfma_f32_16x16x32_bf16 v[148:151], v[116:119], a[104:107], v[148:151]
v_mfma_f32_16x16x32_bf16 v[136:139], v[112:115], a[184:187], v[136:139]
v_mfma_f32_16x16x32_bf16 v[152:155], v[116:119], a[184:187], v[152:155]
v_mfma_f32_16x16x32_bf16 v[140:143], v[112:115], v[200:203], v[140:143]
v_mfma_f32_16x16x32_bf16 v[156:159], v[116:119], v[200:203], v[156:159]
s_waitcnt lgkmcnt(4)
v_mfma_f32_16x16x32_bf16 v[128:131], v[120:123], a[28:31], v[128:131]
v_mfma_f32_16x16x32_bf16 v[144:147], v[124:127], a[28:31], v[144:147]
ds_read_b128 v[112:115], v13 offset:10240
ds_read_b128 v[116:119], v13 offset:30720
v_mfma_f32_16x16x32_bf16 v[132:135], v[120:123], a[108:111], v[132:135]
v_mfma_f32_16x16x32_bf16 v[148:151], v[124:127], a[108:111], v[148:151]
v_mfma_f32_16x16x32_bf16 v[136:139], v[120:123], a[188:191], v[136:139]
v_mfma_f32_16x16x32_bf16 v[152:155], v[124:127], a[188:191], v[152:155]
v_mfma_f32_16x16x32_bf16 v[140:143], v[120:123], v[204:207], v[140:143]
v_mfma_f32_16x16x32_bf16 v[156:159], v[124:127], v[204:207], v[156:159]
s_waitcnt lgkmcnt(4)
v_mfma_f32_16x16x32_bf16 v[128:131], v[96:99], a[32:35], v[128:131]
v_mfma_f32_16x16x32_bf16 v[144:147], v[100:103], a[32:35], v[144:147]
ds_read_b128 v[120:123], v13 offset:11264
ds_read_b128 v[124:127], v13 offset:31744
v_mfma_f32_16x16x32_bf16 v[132:135], v[96:99], a[112:115], v[132:135]
v_mfma_f32_16x16x32_bf16 v[148:151], v[100:103], a[112:115], v[148:151]
v_mfma_f32_16x16x32_bf16 v[136:139], v[96:99], a[192:195], v[136:139]
v_mfma_f32_16x16x32_bf16 v[152:155], v[100:103], a[192:195], v[152:155]
v_mfma_f32_16x16x32_bf16 v[140:143], v[96:99], v[208:211], v[140:143]
v_mfma_f32_16x16x32_bf16 v[156:159], v[100:103], v[208:211], v[156:159]
s_waitcnt lgkmcnt(4)
v_mfma_f32_16x16x32_bf16 v[128:131], v[104:107], a[36:39], v[128:131]
v_mfma_f32_16x16x32_bf16 v[144:147], v[108:111], a[36:39], v[144:147]
ds_read_b128 v[96:99], v13 offset:12288
ds_read_b128 v[100:103], v13 offset:32768
v_mfma_f32_16x16x32_bf16 v[132:135], v[104:107], a[116:119], v[132:135]
v_mfma_f32_16x16x32_bf16 v[148:151], v[108:111], a[116:119], v[148:151]
v_mfma_f32_16x16x32_bf16 v[136:139], v[104:107], a[196:199], v[136:139]
v_mfma_f32_16x16x32_bf16 v[152:155], v[108:111], a[196:199], v[152:155]
v_mfma_f32_16x16x32_bf16 v[140:143], v[104:107], v[212:215], v[140:143]
v_mfma_f32_16x16x32_bf16 v[156:159], v[108:111], v[212:215], v[156:159]
s_waitcnt lgkmcnt(4)
v_mfma_f32_16x16x32_bf16 v[128:131], v[112:115], a[40:43], v[128:131]
v_mfma_f32_16x16x32_bf16 v[144:147], v[116:119], a[40:43], v[144:147]
ds_read_b128 v[104:107], v13 offset:13312
ds_read_b128 v[108:111], v13 offset:33792
v_mfma_f32_16x16x32_bf16 v[132:135], v[112:115], a[120:123], v[132:135]
v_mfma_f32_16x16x32_bf16 v[148:151], v[116:119], a[120:123], v[148:151]
v_mfma_f32_16x16x32_bf16 v[136:139], v[112:115], a[200:203], v[136:139]
v_mfma_f32_16x16x32_bf16 v[152:155], v[116:119], a[200:203], v[152:155]
v_mfma_f32_16x16x32_bf16 v[140:143], v[112:115], v[216:219], v[140:143]
v_mfma_f32_16x16x32_bf16 v[156:159], v[116:119], v[216:219], v[156:159]
s_waitcnt lgkmcnt(4)
v_mfma_f32_16x16x32_bf16 v[128:131], v[120:123], a[44:47], v[128:131]
v_mfma_f32_16x16x32_bf16 v[144:147], v[124:127], a[44:47], v[144:147]
ds_read_b128 v[112:115], v13 offset:14336
ds_read_b128 v[116:119], v13 offset:34816
v_mfma_f32_16x16x32_bf16 v[132:135], v[120:123], a[124:127], v[132:135]
v_mfma_f32_16x16x32_bf16 v[148:151], v[124:127], a[124:127], v[148:151]
v_mfma_f32_16x16x32_bf16 v[136:139], v[120:123], a[204:207], v[136:139]
v_mfma_f32_16x16x32_bf16 v[152:155], v[124:127], a[204:207], v[152:155]
v_mfma_f32_16x16x32_bf16 v[140:143], v[120:123], v[220:223], v[140:143]
v_mfma_f32_16x16x32_bf16 v[156:159], v[124:127], v[220:223], v[156:159]
s_waitcnt lgkmcnt(4)
v_mfma_f32_16x16x32_bf16 v[128:131], v[96:99], a[48:51], v[128:131]
v_mfma_f32_16x16x32_bf16 v[144:147], v[100:103], a[48:51], v[144:147]
ds_read_b128 v[120:123], v13 offset:15360
ds_read_b128 v[124:127], v13 offset:35840
v_mfma_f32_16x16x32_bf16 v[132:135], v[96:99], a[128:131], v[132:135]
v_mfma_f32_16x16x32_bf16 v[148:151], v[100:103], a[128:131], v[148:151]
v_mfma_f32_16x16x32_bf16 v[136:139], v[96:99], a[208:211], v[136:139]
v_mfma_f32_16x16x32_bf16 v[152:155], v[100:103], a[208:211], v[152:155]
v_mfma_f32_16x16x32_bf16 v[140:143], v[96:99], v[224:227], v[140:143]
v_mfma_f32_16x16x32_bf16 v[156:159], v[100:103], v[224:227], v[156:159]
s_waitcnt vmcnt(0)
s_barrier
s_add_u32 s35, s35, 40960
s_cmp_ge_u32 s35, 122880
s_cselect_b32 s35, 0, s35
v_add_u32 v15, s35, v10
s_waitcnt lgkmcnt(4)
v_mfma_f32_16x16x32_bf16 v[128:131], v[104:107], a[52:55], v[128:131]
v_mfma_f32_16x16x32_bf16 v[144:147], v[108:111], a[52:55], v[144:147]
ds_read_b128 v[96:99], v13 offset:16384
ds_read_b128 v[100:103], v13 offset:36864
v_mfma_f32_16x16x32_bf16 v[132:135], v[104:107], a[132:135], v[132:135]
v_mfma_f32_16x16x32_bf16 v[148:151], v[108:111], a[132:135], v[148:151]
s_add_u32 m0, s33, 0
s_nop 0
global_load_lds_dwordx4 v10, s[30:31] offset:0 sc1
v_mfma_f32_16x16x32_bf16 v[136:139], v[104:107], a[212:215], v[136:139]
v_mfma_f32_16x16x32_bf16 v[152:155], v[108:111], a[212:215], v[152:155]
v_mfma_f32_16x16x32_bf16 v[140:143], v[104:107], v[228:231], v[140:143]
v_mfma_f32_16x16x32_bf16 v[156:159], v[108:111], v[228:231], v[156:159]
global_load_lds_dwordx4 v10, s[30:31] offset:1024 sc1
s_waitcnt lgkmcnt(4)
v_mfma_f32_16x16x32_bf16 v[128:131], v[112:115], a[56:59], v[128:131]
v_mfma_f32_16x16x32_bf16 v[144:147], v[116:119], a[56:59], v[144:147]
ds_read_b128 v[104:107], v13 offset:17408
ds_read_b128 v[108:111], v13 offset:37888
v_mfma_f32_16x16x32_bf16 v[132:135], v[112:115], a[136:139], v[132:135]
v_mfma_f32_16x16x32_bf16 v[148:151], v[116:119], a[136:139], v[148:151]
global_load_lds_dwordx4 v10, s[30:31] offset:2048 sc1
v_mfma_f32_16x16x32_bf16 v[136:139], v[112:115], a[216:219], v[136:139]
v_mfma_f32_16x16x32_bf16 v[152:155], v[116:119], a[216:219], v[152:155]
v_mfma_f32_16x16x32_bf16 v[140:143], v[112:115], v[232:235], v[140:143]
v_mfma_f32_16x16x32_bf16 v[156:159], v[116:119], v[232:235], v[156:159]
global_load_lds_dwordx4 v10, s[30:31] offset:3072 sc1
s_waitcnt lgkmcnt(4)
v_mfma_f32_16x16x32_bf16 v[128:131], v[120:123], a[60:63], v[128:131]
v_mfma_f32_16x16x32_bf16 v[144:147], v[124:127], a[60:63], v[144:147]
ds_read_b128 v[112:115], v13 offset:18432
ds_read_b128 v[116:119], v13 offset:38912
v_mfma_f32_16x16x32_bf16 v[132:135], v[120:123], a[140:143], v[132:135]
v_mfma_f32_16x16x32_bf16 v[148:151], v[124:127], a[140:143], v[148:151]
s_add_u32 m0, s33, 4096
s_nop 0
global_load_lds_dwordx4 v11, s[30:31] offset:0 sc1
v_mfma_f32_16x16x32_bf16 v[136:139], v[120:123], a[220:223], v[136:139]
v_mfma_f32_16x16x32_bf16 v[152:155], v[124:127], a[220:223], v[152:155]
v_mfma_f32_16x16x32_bf16 v[140:143], v[120:123], v[236:239], v[140:143]
v_mfma_f32_16x16x32_bf16 v[156:159], v[124:127], v[236:239], v[156:159]
global_load_lds_dwordx4 v11, s[30:31] offset:1024 sc1
s_waitcnt lgkmcnt(4)
v_mfma_f32_16x16x32_bf16 v[128:131], v[96:99], a[64:67], v[128:131]
v_mfma_f32_16x16x32_bf16 v[144:147], v[100:103], a[64:67], v[144:147]
ds_read_b128 v[120:123], v13 offset:19456
ds_read_b128 v[124:127], v13 offset:39936
v_mfma_f32_16x16x32_bf16 v[132:135], v[96:99], a[144:147], v[132:135]
v_mfma_f32_16x16x32_bf16 v[148:151], v[100:103], a[144:147], v[148:151]
global_load_lds_dwordx4 v11, s[30:31] offset:2048 sc1
v_mfma_f32_16x16x32_bf16 v[136:139], v[96:99], a[224:227], v[136:139]
v_mfma_f32_16x16x32_bf16 v[152:155], v[100:103], a[224:227], v[152:155]
v_mfma_f32_16x16x32_bf16 v[140:143], v[96:99], v[240:243], v[140:143]
v_mfma_f32_16x16x32_bf16 v[156:159], v[100:103], v[240:243], v[156:159]
global_load_lds_dwordx4 v11, s[30:31] offset:3072 sc1
s_waitcnt lgkmcnt(4)
v_mfma_f32_16x16x32_bf16 v[128:131], v[104:107], a[68:71], v[128:131]
v_mfma_f32_16x16x32_bf16 v[144:147], v[108:111], a[68:71], v[144:147]
ds_read_b128 v[96:99], v15 offset:0
ds_read_b128 v[100:103], v15 offset:20480
v_mfma_f32_16x16x32_bf16 v[132:135], v[104:107], a[148:151], v[132:135]
v_mfma_f32_16x16x32_bf16 v[148:151], v[108:111], a[148:151], v[148:151]
s_add_u32 m0, s33, 8192
s_nop 0
global_load_lds_dwordx4 v12, s[30:31] offset:0 sc1
v_mfma_f32_16x16x32_bf16 v[136:139], v[104:107], a[228:231], v[136:139]
v_mfma_f32_16x16x32_bf16 v[152:155], v[108:111], a[228:231], v[152:155]
v_mfma_f32_16x16x32_bf16 v[140:143], v[104:107], v[244:247], v[140:143]
v_mfma_f32_16x16x32_bf16 v[156:159], v[108:111], v[244:247], v[156:159]
global_load_lds_dwordx4 v12, s[30:31] offset:1024 sc1
s_waitcnt lgkmcnt(4)
v_mfma_f32_16x16x32_bf16 v[128:131], v[112:115], a[72:75], v[128:131]
v_mfma_f32_16x16x32_bf16 v[144:147], v[116:119], a[72:75], v[144:147]
ds_read_b128 v[104:107], v15 offset:1024
ds_read_b128 v[108:111], v15 offset:21504
v_mfma_f32_16x16x32_bf16 v[132:135], v[112:115], a[152:155], v[132:135]
v_mfma_f32_16x16x32_bf16 v[148:151], v[116:119], a[152:155], v[148:151]
s_add_u32 s32, s32, 2
s_cmp_lt_u32 s32, s45
s_cselect_b32 s3, 81920, 0
s_add_u32 s30, s30, s3
s_addc_u32 s31, s31, 0
s_add_u32 s33, s33, 40960
s_sub_u32 s3, s33, 122880
s_cmp_ge_u32 s33, 122880
s_cselect_b32 s33, s3, s33
v_mfma_f32_16x16x32_bf16 v[136:139], v[112:115], a[232:235], v[136:139]
v_mfma_f32_16x16x32_bf16 v[152:155], v[116:119], a[232:235], v[152:155]
v_mfma_f32_16x16x32_bf16 v[140:143], v[112:115], v[248:251], v[140:143]
v_mfma_f32_16x16x32_bf16 v[156:159], v[116:119], v[248:251], v[156:159]
s_waitcnt lgkmcnt(4)
v_mfma_f32_16x16x32_bf16 v[128:131], v[120:123], a[76:79], v[128:131]
v_mfma_f32_16x16x32_bf16 v[144:147], v[124:127], a[76:79], v[144:147]
ds_read_b128 v[112:115], v15 offset:2048
ds_read_b128 v[116:119], v15 offset:22528
v_mfma_f32_16x16x32_bf16 v[132:135], v[120:123], a[156:159], v[132:135]
v_mfma_f32_16x16x32_bf16 v[148:151], v[124:127], a[156:159], v[148:151]
v_mfma_f32_16x16x32_bf16 v[136:139], v[120:123], a[236:239], v[136:139]
v_mfma_f32_16x16x32_bf16 v[152:155], v[124:127], a[236:239], v[152:155]
v_mfma_f32_16x16x32_bf16 v[140:143], v[120:123], v[252:255], v[140:143]
v_mfma_f32_16x16x32_bf16 v[156:159], v[124:127], v[252:255], v[156:159]
v_mov_b32 v13, v15
s_add_u32 s34, s34, 2
s_cmp_ge_u32 s34, s45
s_cmp_ge_u32 s40, 2
s_cbranch_scc1 L_qkv_V_loop
s_nop 7
v_cvt_pk_bf16_f32 v64, v128, v129
v_cvt_pk_bf16_f32 v65, v130, v131
v_cvt_pk_bf16_f32 v66, v144, v145
v_cvt_pk_bf16_f32 v67, v146, v147
global_store_dwordx4 v10, v[64:67], s[26:27] offset:0 sc1
v_cvt_pk_bf16_f32 v68, v132, v133
v_cvt_pk_bf16_f32 v69, v134, v135
v_cvt_pk_bf16_f32 v70, v148, v149
v_cvt_pk_bf16_f32 v71, v150, v151
global_store_dwordx4 v10, v[68:71], s[26:27] offset:1024 sc1
v_cvt_pk_bf16_f32 v72, v136, v137
v_cvt_pk_bf16_f32 v73, v138, v139
v_cvt_pk_bf16_f32 v74, v152, v153
v_cvt_pk_bf16_f32 v75, v154, v155
global_store_dwordx4 v10, v[72:75], s[26:27] offset:2048 sc1
v_cvt_pk_bf16_f32 v76, v140, v141
v_cvt_pk_bf16_f32 v77, v142, v143
v_cvt_pk_bf16_f32 v78, v156, v157
v_cvt_pk_bf16_f32 v79, v158, v159
global_store_dwordx4 v10, v[76:79], s[26:27] offset:3072 sc1
s_waitcnt vmcnt(0)
s_barrier
s_cmp_eq_u32 s43, 0
s_cbranch_scc1 L_pg_46
v_mov_b32 v17, 1
s_mov_b64 exec, 1
global_store_dword v16, v17, s[8:9] sc1
s_mov_b64 exec, -1
L_pg_46:
L_qkv_V_loop:
s_waitcnt lgkmcnt(4)
v_mfma_f32_16x16x32_bf16 v[160:163], v[96:99], a[0:3], 0
v_mfma_f32_16x16x32_bf16 v[176:179], v[100:103], a[0:3], 0
ds_read_b128 v[120:123], v13 offset:3072
ds_read_b128 v[124:127], v13 offset:23552
v_mfma_f32_16x16x32_bf16 v[164:167], v[96:99], a[80:83], 0
v_mfma_f32_16x16x32_bf16 v[180:183], v[100:103], a[80:83], 0
v_mfma_f32_16x16x32_bf16 v[168:171], v[96:99], a[160:163], 0
v_mfma_f32_16x16x32_bf16 v[184:187], v[100:103], a[160:163], 0
v_mfma_f32_16x16x32_bf16 v[172:175], v[96:99], a[240:243], 0
v_mfma_f32_16x16x32_bf16 v[188:191], v[100:103], a[240:243], 0
s_waitcnt lgkmcnt(4)
v_mfma_f32_16x16x32_bf16 v[160:163], v[104:107], a[4:7], v[160:163]
v_cvt_pk_bf16_f32 v64, v128, v129
v_mfma_f32_16x16x32_bf16 v[176:179], v[108:111], a[4:7], v[176:179]
v_cvt_pk_bf16_f32 v65, v130, v131
ds_read_b128 v[96:99], v13 offset:4096
ds_read_b128 v[100:103], v13 offset:24576
v_mfma_f32_16x16x32_bf16 v[164:167], v[104:107], a[84:87], v[164:167]
v_cvt_pk_bf16_f32 v66, v144, v145
v_mfma_f32_16x16x32_bf16 v[180:183], v[108:111], a[84:87], v[180:183]
v_cvt_pk_bf16_f32 v67, v146, v147
v_mfma_f32_16x16x32_bf16 v[168:171], v[104:107], a[164:167], v[168:171]
global_store_dwordx4 v10, v[64:67], s[26:27] offset:0 sc1
v_mfma_f32_16x16x32_bf16 v[184:187], v[108:111], a[164:167], v[184:187]
v_cvt_pk_bf16_f32 v68, v132, v133
v_mfma_f32_16x16x32_bf16 v[172:175], v[104:107], a[244:247], v[172:175]
v_cvt_pk_bf16_f32 v69, v134, v135
v_mfma_f32_16x16x32_bf16 v[188:191], v[108:111], a[244:247], v[188:191]
v_cvt_pk_bf16_f32 v70, v148, v149
s_waitcnt lgkmcnt(4)
v_mfma_f32_16x16x32_bf16 v[160:163], v[112:115], a[8:11], v[160:163]
v_cvt_pk_bf16_f32 v71, v150, v151
v_mfma_f32_16x16x32_bf16 v[176:179], v[116:119], a[8:11], v[176:179]
global_store_dwordx4 v10, v[68:71], s[26:27] offset:1024 sc1
ds_read_b128 v[104:107], v13 offset:5120
ds_read_b128 v[108:111], v13 offset:25600
v_mfma_f32_16x16x32_bf16 v[164:167], v[112:115], a[88:91], v[164:167]
v_cvt_pk_bf16_f32 v72, v136, v137
v_mfma_f32_16x16x32_bf16 v[180:183], v[116:119], a[88:91], v[180:183]
v_cvt_pk_bf16_f32 v73, v138, v139
v_mfma_f32_16x16x32_bf16 v[168:171], v[112:115], a[168:171], v[168:171]
v_cvt_pk_bf16_f32 v74, v152, v153
v_mfma_f32_16x16x32_bf16 v[184:187], v[116:119], a[168:171], v[184:187]
v_cvt_pk_bf16_f32 v75, v154, v155
v_mfma_f32_16x16x32_bf16 v[172:175], v[112:115], a[248:251], v[172:175]
global_store_dwordx4 v10, v[72:75], s[26:27] offset:2048 sc1
v_mfma_f32_16x16x32_bf16 v[188:191], v[116:119], a[248:251], v[188:191]
v_cvt_pk_bf16_f32 v76, v140, v141
s_waitcnt lgkmcnt(4)
v_mfma_f32_16x16x32_bf16 v[160:163], v[120:123], a[12:15], v[160:163]
v_cvt_pk_bf16_f32 v77, v142, v143
v_mfma_f32_16x16x32_bf16 v[176:179], v[124:127], a[12:15], v[176:179]
v_cvt_pk_bf16_f32 v78, v156, v157
ds_read_b128 v[112:115], v13 offset:6144
ds_read_b128 v[116:119], v13 offset:26624
v_mfma_f32_16x16x32_bf16 v[164:167], v[120:123], a[92:95], v[164:167]
v_cvt_pk_bf16_f32 v79, v158, v159
v_mfma_f32_16x16x32_bf16 v[180:183], v[124:127], a[92:95], v[180:183]
global_store_dwordx4 v10, v[76:79], s[26:27] offset:3072 sc1
v_mfma_f32_16x16x32_bf16 v[168:171], v[120:123], a[172:175], v[168:171]
s_add_u32 s26, s26, s28
s_addc_u32 s27, s27, 0
s_sub_u32 s28, s47, s28
v_mfma_f32_16x16x32_bf16 v[184:187], v[124:127], a[172:175], v[184:187]
v_mfma_f32_16x16x32_bf16 v[172:175], v[120:123], a[252:255], v[172:175]
v_mfma_f32_16x16x32_bf16 v[188:191], v[124:127], a[252:255], v[188:191]
s_waitcnt lgkmcnt(4)
v_mfma_f32_16x16x32_bf16 v[160:163], v[96:99], a[16:19], v[160:163]
v_mfma_f32_16x16x32_bf16 v[176:179], v[100:103], a[16:19], v[176:179]
ds_read_b128 v[120:123], v13 offset:7168
ds_read_b128 v[124:127], v13 offset:27648
v_mfma_f32_16x16x32_bf16 v[164:167], v[96:99], a[96:99], v[164:167]
v_mfma_f32_16x16x32_bf16 v[180:183], v[100:103], a[96:99], v[180:183]
v_mfma_f32_16x16x32_bf16 v[168:171], v[96:99], a[176:179], v[168:171]
v_mfma_f32_16x16x32_bf16 v[184:187], v[100:103], a[176:179], v[184:187]
v_mfma_f32_16x16x32_bf16 v[172:175], v[96:99], v[192:195], v[172:175]
v_mfma_f32_16x16x32_bf16 v[188:191], v[100:103], v[192:195], v[188:191]
s_waitcnt lgkmcnt(4)
v_mfma_f32_16x16x32_bf16 v[160:163], v[104:107], a[20:23], v[160:163]
v_mfma_f32_16x16x32_bf16 v[176:179], v[108:111], a[20:23], v[176:179]
ds_read_b128 v[96:99], v13 offset:8192
ds_read_b128 v[100:103], v13 offset:28672
v_mfma_f32_16x16x32_bf16 v[164:167], v[104:107], a[100:103], v[164:167]
v_mfma_f32_16x16x32_bf16 v[180:183], v[108:111], a[100:103], v[180:183]
v_mfma_f32_16x16x32_bf16 v[168:171], v[104:107], a[180:183], v[168:171]
v_mfma_f32_16x16x32_bf16 v[184:187], v[108:111], a[180:183], v[184:187]
v_mfma_f32_16x16x32_bf16 v[172:175], v[104:107], v[196:199], v[172:175]
v_mfma_f32_16x16x32_bf16 v[188:191], v[108:111], v[196:199], v[188:191]
s_waitcnt lgkmcnt(4)
v_mfma_f32_16x16x32_bf16 v[160:163], v[112:115], a[24:27], v[160:163]
v_mfma_f32_16x16x32_bf16 v[176:179], v[116:119], a[24:27], v[176:179]
ds_read_b128 v[104:107], v13 offset:9216
ds_read_b128 v[108:111], v13 offset:29696
v_mfma_f32_16x16x32_bf16 v[164:167], v[112:115], a[104:107], v[164:167]
v_mfma_f32_16x16x32_bf16 v[180:183], v[116:119], a[104:107], v[180:183]
v_mfma_f32_16x16x32_bf16 v[168:171], v[112:115], a[184:187], v[168:171]
v_mfma_f32_16x16x32_bf16 v[184:187], v[116:119], a[184:187], v[184:187]
v_mfma_f32_16x16x32_bf16 v[172:175], v[112:115], v[200:203], v[172:175]
v_mfma_f32_16x16x32_bf16 v[188:191], v[116:119], v[200:203], v[188:191]
s_waitcnt lgkmcnt(4)
v_mfma_f32_16x16x32_bf16 v[160:163], v[120:123], a[28:31], v[160:163]
v_mfma_f32_16x16x32_bf16 v[176:179], v[124:127], a[28:31], v[176:179]
ds_read_b128 v[112:115], v13 offset:10240
ds_read_b128 v[116:119], v13 offset:30720
v_mfma_f32_16x16x32_bf16 v[164:167], v[120:123], a[108:111], v[164:167]
v_mfma_f32_16x16x32_bf16 v[180:183], v[124:127], a[108:111], v[180:183]
v_mfma_f32_16x16x32_bf16 v[168:171], v[120:123], a[188:191], v[168:171]
v_mfma_f32_16x16x32_bf16 v[184:187], v[124:127], a[188:191], v[184:187]
v_mfma_f32_16x16x32_bf16 v[172:175], v[120:123], v[204:207], v[172:175]
v_mfma_f32_16x16x32_bf16 v[188:191], v[124:127], v[204:207], v[188:191]
s_waitcnt lgkmcnt(4)
v_mfma_f32_16x16x32_bf16 v[160:163], v[96:99], a[32:35], v[160:163]
v_mfma_f32_16x16x32_bf16 v[176:179], v[100:103], a[32:35], v[176:179]
ds_read_b128 v[120:123], v13 offset:11264
ds_read_b128 v[124:127], v13 offset:31744
v_mfma_f32_16x16x32_bf16 v[164:167], v[96:99], a[112:115], v[164:167]
v_mfma_f32_16x16x32_bf16 v[180:183], v[100:103], a[112:115], v[180:183]
v_mfma_f32_16x16x32_bf16 v[168:171], v[96:99], a[192:195], v[168:171]
v_mfma_f32_16x16x32_bf16 v[184:187], v[100:103], a[192:195], v[184:187]
v_mfma_f32_16x16x32_bf16 v[172:175], v[96:99], v[208:211], v[172:175]
v_mfma_f32_16x16x32_bf16 v[188:191], v[100:103], v[208:211], v[188:191]
s_waitcnt lgkmcnt(4)
v_mfma_f32_16x16x32_bf16 v[160:163], v[104:107], a[36:39], v[160:163]
v_mfma_f32_16x16x32_bf16 v[176:179], v[108:111], a[36:39], v[176:179]
ds_read_b128 v[96:99], v13 offset:12288
ds_read_b128 v[100:103], v13 offset:32768
v_mfma_f32_16x16x32_bf16 v[164:167], v[104:107], a[116:119], v[164:167]
v_mfma_f32_16x16x32_bf16 v[180:183], v[108:111], a[116:119], v[180:183]
v_mfma_f32_16x16x32_bf16 v[168:171], v[104:107], a[196:199], v[168:171]
v_mfma_f32_16x16x32_bf16 v[184:187], v[108:111], a[196:199], v[184:187]
v_mfma_f32_16x16x32_bf16 v[172:175], v[104:107], v[212:215], v[172:175]
v_mfma_f32_16x16x32_bf16 v[188:191], v[108:111], v[212:215], v[188:191]
s_waitcnt lgkmcnt(4)
v_mfma_f32_16x16x32_bf16 v[160:163], v[112:115], a[40:43], v[160:163]
v_mfma_f32_16x16x32_bf16 v[176:179], v[116:119], a[40:43], v[176:179]
ds_read_b128 v[104:107], v13 offset:13312
ds_read_b128 v[108:111], v13 offset:33792
v_mfma_f32_16x16x32_bf16 v[164:167], v[112:115], a[120:123], v[164:167]
v_mfma_f32_16x16x32_bf16 v[180:183], v[116:119], a[120:123], v[180:183]
v_mfma_f32_16x16x32_bf16 v[168:171], v[112:115], a[200:203], v[168:171]
v_mfma_f32_16x16x32_bf16 v[184:187], v[116:119], a[200:203], v[184:187]
v_mfma_f32_16x16x32_bf16 v[172:175], v[112:115], v[216:219], v[172:175]
v_mfma_f32_16x16x32_bf16 v[188:191], v[116:119], v[216:219], v[188:191]
s_waitcnt lgkmcnt(4)
v_mfma_f32_16x16x32_bf16 v[160:163], v[120:123], a[44:47], v[160:163]
v_mfma_f32_16x16x32_bf16 v[176:179], v[124:127], a[44:47], v[176:179]
ds_read_b128 v[112:115], v13 offset:14336
ds_read_b128 v[116:119], v13 offset:34816
v_mfma_f32_16x16x32_bf16 v[164:167], v[120:123], a[124:127], v[164:167]
v_mfma_f32_16x16x32_bf16 v[180:183], v[124:127], a[124:127], v[180:183]
v_mfma_f32_16x16x32_bf16 v[168:171], v[120:123], a[204:207], v[168:171]
v_mfma_f32_16x16x32_bf16 v[184:187], v[124:127], a[204:207], v[184:187]
v_mfma_f32_16x16x32_bf16 v[172:175], v[120:123], v[220:223], v[172:175]
v_mfma_f32_16x16x32_bf16 v[188:191], v[124:127], v[220:223], v[188:191]
s_waitcnt lgkmcnt(4)
v_mfma_f32_16x16x32_bf16 v[160:163], v[96:99], a[48:51], v[160:163]
v_mfma_f32_16x16x32_bf16 v[176:179], v[100:103], a[48:51], v[176:179]
ds_read_b128 v[120:123], v13 offset:15360
ds_read_b128 v[124:127], v13 offset:35840
v_mfma_f32_16x16x32_bf16 v[164:167], v[96:99], a[128:131], v[164:167]
v_mfma_f32_16x16x32_bf16 v[180:183], v[100:103], a[128:131], v[180:183]
v_mfma_f32_16x16x32_bf16 v[168:171], v[96:99], a[208:211], v[168:171]
v_mfma_f32_16x16x32_bf16 v[184:187], v[100:103], a[208:211], v[184:187]
v_mfma_f32_16x16x32_bf16 v[172:175], v[96:99], v[224:227], v[172:175]
v_mfma_f32_16x16x32_bf16 v[188:191], v[100:103], v[224:227], v[188:191]
s_mov_b32 s49, s48
s_add_u32 s48, s48, 1
s_cmp_gt_u32 s48, 2
s_cbranch_scc1 L_lax_47
s_waitcnt vmcnt(0)
s_mov_b32 s49, s48
L_lax_47:
s_waitcnt vmcnt(4)
s_barrier
s_cmp_eq_u32 s43, 0
s_cbranch_scc1 L_pg_48
v_mov_b32 v17, s49
s_mov_b64 exec, 1
global_store_dword v16, v17, s[8:9] sc1
s_mov_b64 exec, -1
L_pg_48:
s_add_u32 s35, s35, 40960
s_cmp_ge_u32 s35, 122880
s_cselect_b32 s35, 0, s35
v_add_u32 v15, s35, v10
s_waitcnt lgkmcnt(4)
v_mfma_f32_16x16x32_bf16 v[160:163], v[104:107], a[52:55], v[160:163]
v_mfma_f32_16x16x32_bf16 v[176:179], v[108:111], a[52:55], v[176:179]
ds_read_b128 v[96:99], v13 offset:16384
ds_read_b128 v[100:103], v13 offset:36864
v_mfma_f32_16x16x32_bf16 v[164:167], v[104:107], a[132:135], v[164:167]
v_mfma_f32_16x16x32_bf16 v[180:183], v[108:111], a[132:135], v[180:183]
s_add_u32 m0, s33, 0
s_nop 0
global_load_lds_dwordx4 v10, s[30:31] offset:0 sc1
v_mfma_f32_16x16x32_bf16 v[168:171], v[104:107], a[212:215], v[168:171]
v_mfma_f32_16x16x32_bf16 v[184:187], v[108:111], a[212:215], v[184:187]
v_mfma_f32_16x16x32_bf16 v[172:175], v[104:107], v[228:231], v[172:175]
v_mfma_f32_16x16x32_bf16 v[188:191], v[108:111], v[228:231], v[188:191]
global_load_lds_dwordx4 v10, s[30:31] offset:1024 sc1
s_waitcnt lgkmcnt(4)
v_mfma_f32_16x16x32_bf16 v[160:163], v[112:115], a[56:59], v[160:163]
v_mfma_f32_16x16x32_bf16 v[176:179], v[116:119], a[56:59], v[176:179]
ds_read_b128 v[104:107], v13 offset:17408
ds_read_b128 v[108:111], v13 offset:37888
v_mfma_f32_16x16x32_bf16 v[164:167], v[112:115], a[136:139], v[164:167]
v_mfma_f32_16x16x32_bf16 v[180:183], v[116:119], a[136:139], v[180:183]
global_load_lds_dwordx4 v10, s[30:31] offset:2048 sc1
v_mfma_f32_16x16x32_bf16 v[168:171], v[112:115], a[216:219], v[168:171]
v_mfma_f32_16x16x32_bf16 v[184:187], v[116:119], a[216:219], v[184:187]
v_mfma_f32_16x16x32_bf16 v[172:175], v[112:115], v[232:235], v[172:175]
v_mfma_f32_16x16x32_bf16 v[188:191], v[116:119], v[232:235], v[188:191]
global_load_lds_dwordx4 v10, s[30:31] offset:3072 sc1
s_waitcnt lgkmcnt(4)
v_mfma_f32_16x16x32_bf16 v[160:163], v[120:123], a[60:63], v[160:163]
v_mfma_f32_16x16x32_bf16 v[176:179], v[124:127], a[60:63], v[176:179]
ds_read_b128 v[112:115], v13 offset:18432
ds_read_b128 v[116:119], v13 offset:38912
v_mfma_f32_16x16x32_bf16 v[164:167], v[120:123], a[140:143], v[164:167]
v_mfma_f32_16x16x32_bf16 v[180:183], v[124:127], a[140:143], v[180:183]
s_add_u32 m0, s33, 4096
s_nop 0
global_load_lds_dwordx4 v11, s[30:31] offset:0 sc1
v_mfma_f32_16x16x32_bf16 v[168:171], v[120:123], a[220:223], v[168:171]
v_mfma_f32_16x16x32_bf16 v[184:187], v[124:127], a[220:223], v[184:187]
v_mfma_f32_16x16x32_bf16 v[172:175], v[120:123], v[236:239], v[172:175]
v_mfma_f32_16x16x32_bf16 v[188:191], v[124:127], v[236:239], v[188:191]
global_load_lds_dwordx4 v11, s[30:31] offset:1024 sc1
s_waitcnt lgkmcnt(4)
v_mfma_f32_16x16x32_bf16 v[160:163], v[96:99], a[64:67], v[160:163]
v_mfma_f32_16x16x32_bf16 v[176:179], v[100:103], a[64:67], v[176:179]
ds_read_b128 v[120:123], v13 offset:19456
ds_read_b128 v[124:127], v13 offset:39936
v_mfma_f32_16x16x32_bf16 v[164:167], v[96:99], a[144:147], v[164:167]
v_mfma_f32_16x16x32_bf16 v[180:183], v[100:103], a[144:147], v[180:183]
global_load_lds_dwordx4 v11, s[30:31] offset:2048 sc1
v_mfma_f32_16x16x32_bf16 v[168:171], v[96:99], a[224:227], v[168:171]
v_mfma_f32_16x16x32_bf16 v[184:187], v[100:103], a[224:227], v[184:187]
v_mfma_f32_16x16x32_bf16 v[172:175], v[96:99], v[240:243], v[172:175]
v_mfma_f32_16x16x32_bf16 v[188:191], v[100:103], v[240:243], v[188:191]
global_load_lds_dwordx4 v11, s[30:31] offset:3072 sc1
s_waitcnt lgkmcnt(4)
v_mfma_f32_16x16x32_bf16 v[160:163], v[104:107], a[68:71], v[160:163]
v_mfma_f32_16x16x32_bf16 v[176:179], v[108:111], a[68:71], v[176:179]
ds_read_b128 v[96:99], v15 offset:0
ds_read_b128 v[100:103], v15 offset:20480
v_mfma_f32_16x16x32_bf16 v[164:167], v[104:107], a[148:151], v[164:167]
v_mfma_f32_16x16x32_bf16 v[180:183], v[108:111], a[148:151], v[180:183]
s_add_u32 m0, s33, 8192
s_nop 0
global_load_lds_dwordx4 v12, s[30:31] offset:0 sc1
v_mfma_f32_16x16x32_bf16 v[168:171], v[104:107], a[228:231], v[168:171]
v_mfma_f32_16x16x32_bf16 v[184:187], v[108:111], a[228:231], v[184:187]
v_mfma_f32_16x16x32_bf16 v[172:175], v[104:107], v[244:247], v[172:175]
v_mfma_f32_16x16x32_bf16 v[188:191], v[108:111], v[244:247], v[188:191]
global_load_lds_dwordx4 v12, s[30:31] offset:1024 sc1
s_waitcnt lgkmcnt(4)
v_mfma_f32_16x16x32_bf16 v[160:163], v[112:115], a[72:75], v[160:163]
v_mfma_f32_16x16x32_bf16 v[176:179], v[116:119], a[72:75], v[176:179]
ds_read_b128 v[104:107], v15 offset:1024
ds_read_b128 v[108:111], v15 offset:21504
v_mfma_f32_16x16x32_bf16 v[164:167], v[112:115], a[152:155], v[164:167]
v_mfma_f32_16x16x32_bf16 v[180:183], v[116:119], a[152:155], v[180:183]
s_add_u32 s32, s32, 2
s_cmp_lt_u32 s32, s45
s_cselect_b32 s3, 81920, 0
s_add_u32 s30, s30, s3
s_addc_u32 s31, s31, 0
s_add_u32 s33, s33, 40960
s_sub_u32 s3, s33, 122880
s_cmp_ge_u32 s33, 122880
s_cselect_b32 s33, s3, s33
v_mfma_f32_16x16x32_bf16 v[168:171], v[112:115], a[232:235], v[168:171]
v_mfma_f32_16x16x32_bf16 v[184:187], v[116:119], a[232:235], v[184:187]
v_mfma_f32_16x16x32_bf16 v[172:175], v[112:115], v[248:251], v[172:175]
v_mfma_f32_16x16x32_bf16 v[188:191], v[116:119], v[248:251], v[188:191]
s_waitcnt lgkmcnt(4)
v_mfma_f32_16x16x32_bf16 v[160:163], v[120:123], a[76:79], v[160:163]
v_mfma_f32_16x16x32_bf16 v[176:179], v[124:127], a[76:79], v[176:179]
ds_read_b128 v[112:115], v15 offset:2048
ds_read_b128 v[116:119], v15 offset:22528
v_mfma_f32_16x16x32_bf16 v[164:167], v[120:123], a[156:159], v[164:167]
v_mfma_f32_16x16x32_bf16 v[180:183], v[124:127], a[156:159], v[180:183]
v_mfma_f32_16x16x32_bf16 v[168:171], v[120:123], a[236:239], v[168:171]
v_mfma_f32_16x16x32_bf16 v[184:187], v[124:127], a[236:239], v[184:187]
v_mfma_f32_16x16x32_bf16 v[172:175], v[120:123], v[252:255], v[172:175]
v_mfma_f32_16x16x32_bf16 v[188:191], v[124:127], v[252:255], v[188:191]
v_mov_b32 v13, v15
s_add_u32 s34, s34, 2
s_cmp_ge_u32 s34, s45
s_cbranch_scc1 L_qkv_V_fin
s_waitcnt lgkmcnt(4)
v_mfma_f32_16x16x32_bf16 v[128:131], v[96:99], a[0:3], 0
v_mfma_f32_16x16x32_bf16 v[144:147], v[100:103], a[0:3], 0
ds_read_b128 v[120:123], v13 offset:3072
ds_read_b128 v[124:127], v13 offset:23552
v_mfma_f32_16x16x32_bf16 v[132:135], v[96:99], a[80:83], 0
v_mfma_f32_16x16x32_bf16 v[148:151], v[100:103], a[80:83], 0
v_mfma_f32_16x16x32_bf16 v[136:139], v[96:99], a[160:163], 0
v_mfma_f32_16x16x32_bf16 v[152:155], v[100:103], a[160:163], 0
v_mfma_f32_16x16x32_bf16 v[140:143], v[96:99], a[240:243], 0
v_mfma_f32_16x16x32_bf16 v[156:159], v[100:103], a[240:243], 0
s_waitcnt lgkmcnt(4)
v_mfma_f32_16x16x32_bf16 v[128:131], v[104:107], a[4:7], v[128:131]
v_cvt_pk_bf16_f32 v64, v160, v161
v_mfma_f32_16x16x32_bf16 v[144:147], v[108:111], a[4:7], v[144:147]
v_cvt_pk_bf16_f32 v65, v162, v163
ds_read_b128 v[96:99], v13 offset:4096
ds_read_b128 v[100:103], v13 offset:24576
v_mfma_f32_16x16x32_bf16 v[132:135], v[104:107], a[84:87], v[132:135]
v_cvt_pk_bf16_f32 v66, v176, v177
v_mfma_f32_16x16x32_bf16 v[148:151], v[108:111], a[84:87], v[148:151]
v_cvt_pk_bf16_f32 v67, v178, v179
v_mfma_f32_16x16x32_bf16 v[136:139], v[104:107], a[164:167], v[136:139]
global_store_dwordx4 v10, v[64:67], s[26:27] offset:0 sc1
v_mfma_f32_16x16x32_bf16 v[152:155], v[108:111], a[164:167], v[152:155]
v_cvt_pk_bf16_f32 v68, v164, v165
v_mfma_f32_16x16x32_bf16 v[140:143], v[104:107], a[244:247], v[140:143]
v_cvt_pk_bf16_f32 v69, v166, v167
v_mfma_f32_16x16x32_bf16 v[156:159], v[108:111], a[244:247], v[156:159]
v_cvt_pk_bf16_f32 v70, v180, v181
s_waitcnt lgkmcnt(4)
v_mfma_f32_16x16x32_bf16 v[128:131], v[112:115], a[8:11], v[128:131]
v_cvt_pk_bf16_f32 v71, v182, v183
v_mfma_f32_16x16x32_bf16 v[144:147], v[116:119], a[8:11], v[144:147]
global_store_dwordx4 v10, v[68:71], s[26:27] offset:1024 sc1
ds_read_b128 v[104:107], v13 offset:5120
ds_read_b128 v[108:111], v13 offset:25600
v_mfma_f32_16x16x32_bf16 v[132:135], v[112:115], a[88:91], v[132:135]
v_cvt_pk_bf16_f32 v72, v168, v169
v_mfma_f32_16x16x32_bf16 v[148:151], v[116:119], a[88:91], v[148:151]
v_cvt_pk_bf16_f32 v73, v170, v171
v_mfma_f32_16x16x32_bf16 v[136:139], v[112:115], a[168:171], v[136:139]
v_cvt_pk_bf16_f32 v74, v184, v185
v_mfma_f32_16x16x32_bf16 v[152:155], v[116:119], a[168:171], v[152:155]
v_cvt_pk_bf16_f32 v75, v186, v187
v_mfma_f32_16x16x32_bf16 v[140:143], v[112:115], a[248:251], v[140:143]
global_store_dwordx4 v10, v[72:75], s[26:27] offset:2048 sc1
v_mfma_f32_16x16x32_bf16 v[156:159], v[116:119], a[248:251], v[156:159]
v_cvt_pk_bf16_f32 v76, v172, v173
s_waitcnt lgkmcnt(4)
v_mfma_f32_16x16x32_bf16 v[128:131], v[120:123], a[12:15], v[128:131]
v_cvt_pk_bf16_f32 v77, v174, v175
v_mfma_f32_16x16x32_bf16 v[144:147], v[124:127], a[12:15], v[144:147]
v_cvt_pk_bf16_f32 v78, v188, v189
ds_read_b128 v[112:115], v13 offset:6144
ds_read_b128 v[116:119], v13 offset:26624
v_mfma_f32_16x16x32_bf16 v[132:135], v[120:123], a[92:95], v[132:135]
v_cvt_pk_bf16_f32 v79, v190, v191
v_mfma_f32_16x16x32_bf16 v[148:151], v[124:127], a[92:95], v[148:151]
global_store_dwordx4 v10, v[76:79], s[26:27] offset:3072 sc1
v_mfma_f32_16x16x32_bf16 v[136:139], v[120:123], a[172:175], v[136:139]
s_add_u32 s26, s26, s28
s_addc_u32 s27, s27, 0
s_sub_u32 s28, s47, s28
v_mfma_f32_16x16x32_bf16 v[152:155], v[124:127], a[172:175], v[152:155]
v_mfma_f32_16x16x32_bf16 v[140:143], v[120:123], a[252:255], v[140:143]
v_mfma_f32_16x16x32_bf16 v[156:159], v[124:127], a[252:255], v[156:159]
s_waitcnt lgkmcnt(4)
v_mfma_f32_16x16x32_bf16 v[128:131], v[96:99], a[16:19], v[128:131]
v_mfma_f32_16x16x32_bf16 v[144:147], v[100:103], a[16:19], v[144:147]
ds_read_b128 v[120:123], v13 offset:7168
ds_read_b128 v[124:127], v13 offset:27648
v_mfma_f32_16x16x32_bf16 v[132:135], v[96:99], a[96:99], v[132:135]
v_mfma_f32_16x16x32_bf16 v[148:151], v[100:103], a[96:99], v[148:151]
v_mfma_f32_16x16x32_bf16 v[136:139], v[96:99], a[176:179], v[136:139]
v_mfma_f32_16x16x32_bf16 v[152:155], v[100:103], a[176:179], v[152:155]
v_mfma_f32_16x16x32_bf16 v[140:143], v[96:99], v[192:195], v[140:143]
v_mfma_f32_16x16x32_bf16 v[156:159], v[100:103], v[192:195], v[156:159]
s_waitcnt lgkmcnt(4)
v_mfma_f32_16x16x32_bf16 v[128:131], v[104:107], a[20:23], v[128:131]
v_mfma_f32_16x16x32_bf16 v[144:147], v[108:111], a[20:23], v[144:147]
ds_read_b128 v[96:99], v13 offset:8192
ds_read_b128 v[100:103], v13 offset:28672
v_mfma_f32_16x16x32_bf16 v[132:135], v[104:107], a[100:103], v[132:135]
v_mfma_f32_16x16x32_bf16 v[148:151], v[108:111], a[100:103], v[148:151]
v_mfma_f32_16x16x32_bf16 v[136:139], v[104:107], a[180:183], v[136:139]
v_mfma_f32_16x16x32_bf16 v[152:155], v[108:111], a[180:183], v[152:155]
v_mfma_f32_16x16x32_bf16 v[140:143], v[104:107], v[196:199], v[140:143]
v_mfma_f32_16x16x32_bf16 v[156:159], v[108:111], v[196:199], v[156:159]
s_waitcnt lgkmcnt(4)
v_mfma_f32_16x16x32_bf16 v[128:131], v[112:115], a[24:27], v[128:131]
v_mfma_f32_16x16x32_bf16 v[144:147], v[116:119], a[24:27], v[144:147]
ds_read_b128 v[104:107], v13 offset:9216
ds_read_b128 v[108:111], v13 offset:29696
v_mfma_f32_16x16x32_bf16 v[132:135], v[112:115], a[104:107], v[132:135]
v_mfma_f32_16x16x32_bf16 v[148:151], v[116:119], a[104:107], v[148:151]
v_mfma_f32_16x16x32_bf16 v[136:139], v[112:115], a[184:187], v[136:139]
v_mfma_f32_16x16x32_bf16 v[152:155], v[116:119], a[184:187], v[152:155]
v_mfma_f32_16x16x32_bf16 v[140:143], v[112:115], v[200:203], v[140:143]
v_mfma_f32_16x16x32_bf16 v[156:159], v[116:119], v[200:203], v[156:159]
s_waitcnt lgkmcnt(4)
v_mfma_f32_16x16x32_bf16 v[128:131], v[120:123], a[28:31], v[128:131]
v_mfma_f32_16x16x32_bf16 v[144:147], v[124:127], a[28:31], v[144:147]
ds_read_b128 v[112:115], v13 offset:10240
ds_read_b128 v[116:119], v13 offset:30720
v_mfma_f32_16x16x32_bf16 v[132:135], v[120:123], a[108:111], v[132:135]
v_mfma_f32_16x16x32_bf16 v[148:151], v[124:127], a[108:111], v[148:151]
v_mfma_f32_16x16x32_bf16 v[136:139], v[120:123], a[188:191], v[136:139]
v_mfma_f32_16x16x32_bf16 v[152:155], v[124:127], a[188:191], v[152:155]
v_mfma_f32_16x16x32_bf16 v[140:143], v[120:123], v[204:207], v[140:143]
v_mfma_f32_16x16x32_bf16 v[156:159], v[124:127], v[204:207], v[156:159]
s_waitcnt lgkmcnt(4)
v_mfma_f32_16x16x32_bf16 v[128:131], v[96:99], a[32:35], v[128:131]
v_mfma_f32_16x16x32_bf16 v[144:147], v[100:103], a[32:35], v[144:147]
ds_read_b128 v[120:123], v13 offset:11264
ds_read_b128 v[124:127], v13 offset:31744
v_mfma_f32_16x16x32_bf16 v[132:135], v[96:99], a[112:115], v[132:135]
v_mfma_f32_16x16x32_bf16 v[148:151], v[100:103], a[112:115], v[148:151]
v_mfma_f32_16x16x32_bf16 v[136:139], v[96:99], a[192:195], v[136:139]
v_mfma_f32_16x16x32_bf16 v[152:155], v[100:103], a[192:195], v[152:155]
v_mfma_f32_16x16x32_bf16 v[140:143], v[96:99], v[208:211], v[140:143]
v_mfma_f32_16x16x32_bf16 v[156:159], v[100:103], v[208:211], v[156:159]
s_waitcnt lgkmcnt(4)
v_mfma_f32_16x16x32_bf16 v[128:131], v[104:107], a[36:39], v[128:131]
v_mfma_f32_16x16x32_bf16 v[144:147], v[108:111], a[36:39], v[144:147]
ds_read_b128 v[96:99], v13 offset:12288
ds_read_b128 v[100:103], v13 offset:32768
v_mfma_f32_16x16x32_bf16 v[132:135], v[104:107], a[116:119], v[132:135]
v_mfma_f32_16x16x32_bf16 v[148:151], v[108:111], a[116:119], v[148:151]
v_mfma_f32_16x16x32_bf16 v[136:139], v[104:107], a[196:199], v[136:139]
v_mfma_f32_16x16x32_bf16 v[152:155], v[108:111], a[196:199], v[152:155]
v_mfma_f32_16x16x32_bf16 v[140:143], v[104:107], v[212:215], v[140:143]
v_mfma_f32_16x16x32_bf16 v[156:159], v[108:111], v[212:215], v[156:159]
s_waitcnt lgkmcnt(4)
v_mfma_f32_16x16x32_bf16 v[128:131], v[112:115], a[40:43], v[128:131]
v_mfma_f32_16x16x32_bf16 v[144:147], v[116:119], a[40:43], v[144:147]
ds_read_b128 v[104:107], v13 offset:13312
ds_read_b128 v[108:111], v13 offset:33792
v_mfma_f32_16x16x32_bf16 v[132:135], v[112:115], a[120:123], v[132:135]
v_mfma_f32_16x16x32_bf16 v[148:151], v[116:119], a[120:123], v[148:151]
v_mfma_f32_16x16x32_bf16 v[136:139], v[112:115], a[200:203], v[136:139]
v_mfma_f32_16x16x32_bf16 v[152:155], v[116:119], a[200:203], v[152:155]
v_mfma_f32_16x16x32_bf16 v[140:143], v[112:115], v[216:219], v[140:143]
v_mfma_f32_16x16x32_bf16 v[156:159], v[116:119], v[216:219], v[156:159]
s_waitcnt lgkmcnt(4)
v_mfma_f32_16x16x32_bf16 v[128:131], v[120:123], a[44:47], v[128:131]
v_mfma_f32_16x16x32_bf16 v[144:147], v[124:127], a[44:47], v[144:147]
ds_read_b128 v[112:115], v13 offset:14336
ds_read_b128 v[116:119], v13 offset:34816
v_mfma_f32_16x16x32_bf16 v[132:135], v[120:123], a[124:127], v[132:135]
v_mfma_f32_16x16x32_bf16 v[148:151], v[124:127], a[124:127], v[148:151]
v_mfma_f32_16x16x32_bf16 v[136:139], v[120:123], a[204:207], v[136:139]
v_mfma_f32_16x16x32_bf16 v[152:155], v[124:127], a[204:207], v[152:155]
v_mfma_f32_16x16x32_bf16 v[140:143], v[120:123], v[220:223], v[140:143]
v_mfma_f32_16x16x32_bf16 v[156:159], v[124:127], v[220:223], v[156:159]
s_waitcnt lgkmcnt(4)
v_mfma_f32_16x16x32_bf16 v[128:131], v[96:99], a[48:51], v[128:131]
v_mfma_f32_16x16x32_bf16 v[144:147], v[100:103], a[48:51], v[144:147]
ds_read_b128 v[120:123], v13 offset:15360
ds_read_b128 v[124:127], v13 offset:35840
v_mfma_f32_16x16x32_bf16 v[132:135], v[96:99], a[128:131], v[132:135]
v_mfma_f32_16x16x32_bf16 v[148:151], v[100:103], a[128:131], v[148:151]
v_mfma_f32_16x16x32_bf16 v[136:139], v[96:99], a[208:211], v[136:139]
v_mfma_f32_16x16x32_bf16 v[152:155], v[100:103], a[208:211], v[152:155]
v_mfma_f32_16x16x32_bf16 v[140:143], v[96:99], v[224:227], v[140:143]
v_mfma_f32_16x16x32_bf16 v[156:159], v[100:103], v[224:227], v[156:159]
s_mov_b32 s49, s48
s_add_u32 s48, s48, 1
s_cmp_gt_u32 s48, 2
s_cbranch_scc1 L_lax_49
s_waitcnt vmcnt(0)
s_mov_b32 s49, s48
L_lax_49:
s_waitcnt vmcnt(4)
s_cmp_lg_u32 s48, 4
s_cbranch_scc1 L_fb_50
v_mov_b32 v18, 156
s_mov_b32 s96, 0x80000
L_wf_51:
global_load_dword v19, v18, s[94:95] sc1
s_waitcnt vmcnt(0)
v_cmp_gt_u32 vcc, 1, v19
s_nop 0
s_cbranch_vccz L_wd_52
s_sleep 3
s_sub_u32 s96, s96, 1
s_cbranch_scc0 L_wf_51
s_branch L_wabort
L_wd_52:
L_fb_50:
s_barrier
s_cmp_eq_u32 s43, 0
s_cbranch_scc1 L_pg_53
v_mov_b32 v17, s49
s_mov_b64 exec, 1
global_store_dword v16, v17, s[8:9] sc1
s_mov_b64 exec, -1
L_pg_53:
s_add_u32 s35, s35, 40960
s_cmp_ge_u32 s35, 122880
s_cselect_b32 s35, 0, s35
v_add_u32 v15, s35, v10
s_waitcnt lgkmcnt(4)
v_mfma_f32_16x16x32_bf16 v[128:131], v[104:107], a[52:55], v[128:131]
v_mfma_f32_16x16x32_bf16 v[144:147], v[108:111], a[52:55], v[144:147]
ds_read_b128 v[96:99], v13 offset:16384
ds_read_b128 v[100:103], v13 offset:36864
v_mfma_f32_16x16x32_bf16 v[132:135], v[104:107], a[132:135], v[132:135]
v_mfma_f32_16x16x32_bf16 v[148:151], v[108:111], a[132:135], v[148:151]
s_add_u32 m0, s33, 0
s_nop 0
global_load_lds_dwordx4 v10, s[30:31] offset:0 sc1
v_mfma_f32_16x16x32_bf16 v[136:139], v[104:107], a[212:215], v[136:139]
v_mfma_f32_16x16x32_bf16 v[152:155], v[108:111], a[212:215], v[152:155]
v_mfma_f32_16x16x32_bf16 v[140:143], v[104:107], v[228:231], v[140:143]
v_mfma_f32_16x16x32_bf16 v[156:159], v[108:111], v[228:231], v[156:159]
global_load_lds_dwordx4 v10, s[30:31] offset:1024 sc1
s_waitcnt lgkmcnt(4)
v_mfma_f32_16x16x32_bf16 v[128:131], v[112:115], a[56:59], v[128:131]
v_mfma_f32_16x16x32_bf16 v[144:147], v[116:119], a[56:59], v[144:147]
ds_read_b128 v[104:107], v13 offset:17408
ds_read_b128 v[108:111], v13 offset:37888
v_mfma_f32_16x16x32_bf16 v[132:135], v[112:115], a[136:139], v[132:135]
v_mfma_f32_16x16x32_bf16 v[148:151], v[116:119], a[136:139], v[148:151]
global_load_lds_dwordx4 v10, s[30:31] offset:2048 sc1
v_mfma_f32_16x16x32_bf16 v[136:139], v[112:115], a[216:219], v[136:139]
v_mfma_f32_16x16x32_bf16 v[152:155], v[116:119], a[216:219], v[152:155]
v_mfma_f32_16x16x32_bf16 v[140:143], v[112:115], v[232:235], v[140:143]
v_mfma_f32_16x16x32_bf16 v[156:159], v[116:119], v[232:235], v[156:159]
global_load_lds_dwordx4 v10, s[30:31] offset:3072 sc1
s_waitcnt lgkmcnt(4)
v_mfma_f32_16x16x32_bf16 v[128:131], v[120:123], a[60:63], v[128:131]
v_mfma_f32_16x16x32_bf16 v[144:147], v[124:127], a[60:63], v[144:147]
ds_read_b128 v[112:115], v13 offset:18432
ds_read_b128 v[116:119], v13 offset:38912
v_mfma_f32_16x16x32_bf16 v[132:135], v[120:123], a[140:143], v[132:135]
v_mfma_f32_16x16x32_bf16 v[148:151], v[124:127], a[140:143], v[148:151]
s_add_u32 m0, s33, 4096
s_nop 0
global_load_lds_dwordx4 v11, s[30:31] offset:0 sc1
v_mfma_f32_16x16x32_bf16 v[136:139], v[120:123], a[220:223], v[136:139]
v_mfma_f32_16x16x32_bf16 v[152:155], v[124:127], a[220:223], v[152:155]
v_mfma_f32_16x16x32_bf16 v[140:143], v[120:123], v[236:239], v[140:143]
v_mfma_f32_16x16x32_bf16 v[156:159], v[124:127], v[236:239], v[156:159]
global_load_lds_dwordx4 v11, s[30:31] offset:1024 sc1
s_waitcnt lgkmcnt(4)
v_mfma_f32_16x16x32_bf16 v[128:131], v[96:99], a[64:67], v[128:131]
v_mfma_f32_16x16x32_bf16 v[144:147], v[100:103], a[64:67], v[144:147]
ds_read_b128 v[120:123], v13 offset:19456
ds_read_b128 v[124:127], v13 offset:39936
v_mfma_f32_16x16x32_bf16 v[132:135], v[96:99], a[144:147], v[132:135]
v_mfma_f32_16x16x32_bf16 v[148:151], v[100:103], a[144:147], v[148:151]
global_load_lds_dwordx4 v11, s[30:31] offset:2048 sc1
v_mfma_f32_16x16x32_bf16 v[136:139], v[96:99], a[224:227], v[136:139]
v_mfma_f32_16x16x32_bf16 v[152:155], v[100:103], a[224:227], v[152:155]
v_mfma_f32_16x16x32_bf16 v[140:143], v[96:99], v[240:243], v[140:143]
v_mfma_f32_16x16x32_bf16 v[156:159], v[100:103], v[240:243], v[156:159]
global_load_lds_dwordx4 v11, s[30:31] offset:3072 sc1
s_waitcnt lgkmcnt(4)
v_mfma_f32_16x16x32_bf16 v[128:131], v[104:107], a[68:71], v[128:131]
v_mfma_f32_16x16x32_bf16 v[144:147], v[108:111], a[68:71], v[144:147]
ds_read_b128 v[96:99], v15 offset:0
ds_read_b128 v[100:103], v15 offset:20480
v_mfma_f32_16x16x32_bf16 v[132:135], v[104:107], a[148:151], v[132:135]
v_mfma_f32_16x16x32_bf16 v[148:151], v[108:111], a[148:151], v[148:151]
s_add_u32 m0, s33, 8192
s_nop 0
global_load_lds_dwordx4 v12, s[30:31] offset:0 sc1
v_mfma_f32_16x16x32_bf16 v[136:139], v[104:107], a[228:231], v[136:139]
v_mfma_f32_16x16x32_bf16 v[152:155], v[108:111], a[228:231], v[152:155]
v_mfma_f32_16x16x32_bf16 v[140:143], v[104:107], v[244:247], v[140:143]
v_mfma_f32_16x16x32_bf16 v[156:159], v[108:111], v[244:247], v[156:159]
global_load_lds_dwordx4 v12, s[30:31] offset:1024 sc1
s_waitcnt lgkmcnt(4)
v_mfma_f32_16x16x32_bf16 v[128:131], v[112:115], a[72:75], v[128:131]
v_mfma_f32_16x16x32_bf16 v[144:147], v[116:119], a[72:75], v[144:147]
ds_read_b128 v[104:107], v15 offset:1024
ds_read_b128 v[108:111], v15 offset:21504
v_mfma_f32_16x16x32_bf16 v[132:135], v[112:115], a[152:155], v[132:135]
v_mfma_f32_16x16x32_bf16 v[148:151], v[116:119], a[152:155], v[148:151]
s_add_u32 s32, s32, 2
s_cmp_lt_u32 s32, s45
s_cselect_b32 s3, 81920, 0
s_add_u32 s30, s30, s3
s_addc_u32 s31, s31, 0
s_add_u32 s33, s33, 40960
s_sub_u32 s3, s33, 122880
s_cmp_ge_u32 s33, 122880
s_cselect_b32 s33, s3, s33
v_mfma_f32_16x16x32_bf16 v[136:139], v[112:115], a[232:235], v[136:139]
v_mfma_f32_16x16x32_bf16 v[152:155], v[116:119], a[232:235], v[152:155]
v_mfma_f32_16x16x32_bf16 v[140:143], v[112:115], v[248:251], v[140:143]
v_mfma_f32_16x16x32_bf16 v[156:159], v[116:119], v[248:251], v[156:159]
s_waitcnt lgkmcnt(4)
v_mfma_f32_16x16x32_bf16 v[128:131], v[120:123], a[76:79], v[128:131]
v_mfma_f32_16x16x32_bf16 v[144:147], v[124:127], a[76:79], v[144:147]
ds_read_b128 v[112:115], v15 offset:2048
ds_read_b128 v[116:119], v15 offset:22528
v_mfma_f32_16x16x32_bf16 v[132:135], v[120:123], a[156:159], v[132:135]
v_mfma_f32_16x16x32_bf16 v[148:151], v[124:127], a[156:159], v[148:151]
v_mfma_f32_16x16x32_bf16 v[136:139], v[120:123], a[236:239], v[136:139]
v_mfma_f32_16x16x32_bf16 v[152:155], v[124:127], a[236:239], v[152:155]
v_mfma_f32_16x16x32_bf16 v[140:143], v[120:123], v[252:255], v[140:143]
v_mfma_f32_16x16x32_bf16 v[156:159], v[124:127], v[252:255], v[156:159]
v_mov_b32 v13, v15
s_add_u32 s34, s34, 2
s_cmp_ge_u32 s34, s45
s_branch L_qkv_V_loop
L_qkv_V_fin:
s_nop 7
v_cvt_pk_bf16_f32 v64, v160, v161
v_cvt_pk_bf16_f32 v65, v162, v163
v_cvt_pk_bf16_f32 v66, v176, v177
v_cvt_pk_bf16_f32 v67, v178, v179
global_store_dwordx4 v10, v[64:67], s[26:27] offset:0 sc1
v_cvt_pk_bf16_f32 v68, v164, v165
v_cvt_pk_bf16_f32 v69, v166, v167
v_cvt_pk_bf16_f32 v70, v180, v181
v_cvt_pk_bf16_f32 v71, v182, v183
global_store_dwordx4 v10, v[68:71], s[26:27] offset:1024 sc1
v_cvt_pk_bf16_f32 v72, v168, v169
v_cvt_pk_bf16_f32 v73, v170, v171
v_cvt_pk_bf16_f32 v74, v184, v185
v_cvt_pk_bf16_f32 v75, v186, v187
global_store_dwordx4 v10, v[72:75], s[26:27] offset:2048 sc1
v_cvt_pk_bf16_f32 v76, v172, v173
v_cvt_pk_bf16_f32 v77, v174, v175
v_cvt_pk_bf16_f32 v78, v188, v189
v_cvt_pk_bf16_f32 v79, v190, v191
global_store_dwordx4 v10, v[76:79], s[26:27] offset:3072 sc1
s_add_u32 s26, s26, s28
s_addc_u32 s27, s27, 0
s_sub_u32 s28, s47, s28
s_waitcnt vmcnt(0) lgkmcnt(0)
s_barrier
s_cmp_eq_u32 s43, 0
s_cbranch_scc1 L_pg_54
v_mov_b32 v17, 16
s_mov_b64 exec, 1
global_store_dword v16, v17, s[8:9] sc1
s_mov_b64 exec, -1
L_pg_54:
s_branch L_post
L_wabort:
s_waitcnt vmcnt(0)
v_mov_b32 v2, 192
v_mov_b32 v3, 1
s_mov_b64 exec, 1
global_atomic_add v2, v3, s[94:95]
s_endpgm
L_post:
s_sub_u32 s40, s90, 0
s_cmp_lt_u32 s40, 32
s_cbranch_scc1 L_st_at
s_sub_u32 s40, s90, 32
s_cmp_lt_u32 s40, 64
s_cbranch_scc1 L_st_op
s_sub_u32 s40, s90, 96
s_cmp_lt_u32 s40, 24
s_cbranch_scc1 L_st_f2
s_sub_u32 s40, s90, 120
s_cmp_lt_u32 s40, 56
s_cbranch_scc1 L_st_f1
s_sub_u32 s40, s90, 176
s_cmp_lt_u32 s40, 16
s_cbranch_scc1 L_st_ln
s_endpgm
L_st_at:
v_and_b32 v1, 63, v0
s_and_b32 s41, s40, 7
s_lshl_b32 s41, s41, 2
s_add_u32 s41, s41, s12
s_lshr_b32 s42, s40, 3
v_lshlrev_b32 v2, 4, v1
v_lshrrev_b32 v3, 4, v1
v_and_b32 v4, 15, v1
v_lshrrev_b32 v5, 2, v4
v_and_b32 v6, 1, v4
v_lshl_add_u32 v5, v5, 1, v6
v_lshlrev_b32 v5, 4, v5
v_lshl_add_u32 v5, v3, 7, v5
v_lshlrev_b32 v6, 2, v1
v_mov_b32 v10, 132
global_load_dword v11, v10, s[94:95] sc1
s_waitcnt vmcnt(0)
v_readfirstlane_b32 s44, v11
v_lshlrev_b32 v7, 2, v3
v_add_u32 v8, 0, v7
v_cmp_gt_u32 s[30:31], v8, v4
v_add_u32 v8, 1, v7
v_cmp_gt_u32 s[32:33], v8, v4
v_add_u32 v8, 2, v7
v_cmp_gt_u32 s[34:35], v8, v4
v_add_u32 v8, 3, v7
v_cmp_gt_u32 s[36:37], v8, v4
s_mov_b32 s28, 0x3fb8aa3b
s_mov_b32 s29, 0x3db504f3
s_lshr_b32 s3, s41, 1
s_lshl_b32 s3, s3, 7
s_add_u32 s3, s3, 68158464
v_min_u32 v8, 11, v1
v_lshlrev_b32 v8, 2, v8
v_add_u32 v8, s3, v8
s_mov_b32 s96, 0x80000
L_wf_55:
global_load_dword v10, v8, s[8:9] sc1
s_waitcnt vmcnt(0)
v_cmp_gt_u32 vcc, 16, v10
s_nop 0
s_cbranch_vccz L_wd_56
s_sleep 8
s_sub_u32 s96, s96, 1
s_cbranch_scc0 L_wf_55
s_branch L_wabort
L_wd_56:
v_mov_b32 v9, 0xfe000000
v_mov_b64 v[160:161], 0
v_mov_b64 v[162:163], 0
v_mov_b64 v[164:165], 0
v_mov_b64 v[166:167], 0
v_mov_b64 v[168:169], 0
v_mov_b64 v[170:171], 0
v_mov_b64 v[172:173], 0
v_mov_b64 v[174:175], 0
v_mov_b64 v[176:177], 0
v_mov_b64 v[178:179], 0
v_mov_b64 v[154:155], 0
v_mov_b32 v180, 0x3f803f80
v_mov_b32 v181, 0x3f803f80
v_mov_b32 v182, 0x3f803f80
v_mov_b32 v183, 0x3f803f80
L_at_loop:
s_lshl_b32 s13, s42, 5
s_add_u32 s13, s13, s41
s_lshl_b32 s3, s42, 1
s_xor_b32 s3, s3, s44
s_and_b32 s3, s3, 4
s_lshl_b32 s22, s3, 11
s_lshl_b32 s3, s13, 15
s_add_u32 s3, s3, s22
s_add_u32 s3, s3, 201330688
s_add_u32 s14, s8, s3
s_addc_u32 s15, s9, 0
s_add_u32 s16, s14, 16384
s_addc_u32 s17, s15, 0
s_lshl_b32 s3, s13, 13
s_add_u32 s3, s3, 33558528
s_add_u32 s18, s8, s3
s_addc_u32 s19, s9, 0
s_lshr_b32 s3, s42, 3
s_add_u32 s3, s3, 2
s_bitcmp1_b32 s44, s3
s_cselect_b32 s3, 8192, 0
s_lshr_b32 s22, s13, 1
s_lshl_b32 s22, s22, 14
s_add_u32 s3, s3, s22
s_and_b32 s22, s13, 1
s_lshl_b32 s22, s22, 12
s_add_u32 s3, s3, s22
s_add_u32 s3, s3, 167772160
s_add_u32 s20, s8, s3
s_addc_u32 s21, s9, 0
s_lshl_b32 s3, s42, 18
s_lshl_b32 s24, s41, 12
s_add_u32 s3, s3, s24
s_add_u32 s3, s3, 83886080
s_add_u32 s24, s8, s3
s_addc_u32 s25, s9, 0
s_add_u32 s26, s24, 131072
s_addc_u32 s27, s25, 0
global_load_dwordx4 v[12:15], v2, s[18:19] offset:-4096 sc1
global_load_dwordx4 v[28:31], v2, s[18:19] offset:0 sc1
global_load_dwordx4 v[44:47], v2, s[14:15] offset:-4096 sc1
global_load_dwordx4 v[60:63], v2, s[14:15] offset:0 sc1
global_load_dwordx4 v[16:19], v2, s[18:19] offset:-3072 sc1
global_load_dwordx4 v[32:35], v2, s[18:19] offset:1024 sc1
global_load_dwordx4 v[48:51], v2, s[14:15] offset:-3072 sc1
global_load_dwordx4 v[64:67], v2, s[14:15] offset:1024 sc1
global_load_dwordx4 v[20:23], v2, s[18:19] offset:-2048 sc1
global_load_dwordx4 v[36:39], v2, s[18:19] offset:2048 sc1
global_load_dwordx4 v[52:55], v2, s[14:15] offset:-2048 sc1
global_load_dwordx4 v[68:71], v2, s[14:15] offset:2048 sc1
global_load_dwordx4 v[24:27], v2, s[18:19] offset:-1024 sc1
global_load_dwordx4 v[40:43], v2, s[18:19] offset:3072 sc1
global_load_dwordx4 v[56:59], v2, s[14:15] offset:-1024 sc1
global_load_dwordx4 v[72:75], v2, s[14:15] offset:3072 sc1
global_load_dwordx4 v[92:95], v2, s[16:17] offset:-4096 sc1
global_load_dwordx4 v[96:99], v2, s[16:17] offset:-3072 sc1
global_load_dwordx4 v[100:103], v2, s[16:17] offset:-2048 sc1
global_load_dwordx4 v[104:107], v2, s[16:17] offset:-1024 sc1
global_load_dwordx4 v[108:111], v2, s[16:17] offset:0 sc1
global_load_dwordx4 v[112:115], v2, s[16:17] offset:1024 sc1
global_load_dwordx4 v[116:119], v2, s[16:17] offset:2048 sc1
global_load_dwordx4 v[120:123], v2, s[16:17] offset:3072 sc1
s_waitcnt vmcnt(8)
v_mfma_f32_16x16x32_bf16 v[132:135], v[44:47], v[12:15], 0
v_mfma_f32_16x16x32_bf16 v[136:139], v[44:47], v[28:31], 0
v_mfma_f32_16x16x32_bf16 v[140:143], v[60:63], v[28:31], 0
v_mfma_f32_16x16x32_bf16 v[132:135], v[48:51], v[16:19], v[132:135]
v_mfma_f32_16x16x32_bf16 v[136:139], v[48:51], v[32:35], v[136:139]
v_mfma_f32_16x16x32_bf16 v[140:143], v[64:67], v[32:35], v[140:143]
v_mfma_f32_16x16x32_bf16 v[132:135], v[52:55], v[20:23], v[132:135]
v_mfma_f32_16x16x32_bf16 v[136:139], v[52:55], v[36:39], v[136:139]
v_mfma_f32_16x16x32_bf16 v[140:143], v[68:71], v[36:39], v[140:143]
v_mfma_f32_16x16x32_bf16 v[132:135], v[56:59], v[24:27], v[132:135]
v_mfma_f32_16x16x32_bf16 v[136:139], v[56:59], v[40:43], v[136:139]
v_mfma_f32_16x16x32_bf16 v[140:143], v[72:75], v[40:43], v[140:143]
s_nop 0
v_cvt_pk_bf16_f32 v10, v132, v133
v_lshlrev_b32 v132, 16, v10
v_and_b32 v133, 0xffff0000, v10
v_mul_f32 v132, s29, v132
v_mul_f32 v133, s29, v133
v_cvt_pk_bf16_f32 v10, v132, v133
v_lshlrev_b32 v132, 16, v10
v_and_b32 v133, 0xffff0000, v10
v_cvt_pk_bf16_f32 v10, v134, v135
v_lshlrev_b32 v134, 16, v10
v_and_b32 v135, 0xffff0000, v10
v_mul_f32 v134, s29, v134
v_mul_f32 v135, s29, v135
v_cvt_pk_bf16_f32 v10, v134, v135
v_lshlrev_b32 v134, 16, v10
v_and_b32 v135, 0xffff0000, v10
v_cvt_pk_bf16_f32 v10, v136, v137
v_lshlrev_b32 v136, 16, v10
v_and_b32 v137, 0xffff0000, v10
v_mul_f32 v136, s29, v136
v_mul_f32 v137, s29, v137
v_cvt_pk_bf16_f32 v10, v136, v137
v_lshlrev_b32 v136, 16, v10
v_and_b32 v137, 0xffff0000, v10
v_cvt_pk_bf16_f32 v10, v138, v139
v_lshlrev_b32 v138, 16, v10
v_and_b32 v139, 0xffff0000, v10
v_mul_f32 v138, s29, v138
v_mul_f32 v139, s29, v139
v_cvt_pk_bf16_f32 v10, v138, v139
v_lshlrev_b32 v138, 16, v10
v_and_b32 v139, 0xffff0000, v10
v_cvt_pk_bf16_f32 v10, v140, v141
v_lshlrev_b32 v140, 16, v10
v_and_b32 v141, 0xffff0000, v10
v_mul_f32 v140, s29, v140
v_mul_f32 v141, s29, v141
v_cvt_pk_bf16_f32 v10, v140, v141
v_lshlrev_b32 v140, 16, v10
v_and_b32 v141, 0xffff0000, v10
v_cvt_pk_bf16_f32 v10, v142, v143
v_lshlrev_b32 v142, 16, v10
v_and_b32 v143, 0xffff0000, v10
v_mul_f32 v142, s29, v142
v_mul_f32 v143, s29, v143
v_cvt_pk_bf16_f32 v10, v142, v143
v_lshlrev_b32 v142, 16, v10
v_and_b32 v143, 0xffff0000, v10
v_cndmask_b32 v132, v132, v9, s[30:31]
v_cndmask_b32 v133, v133, v9, s[32:33]
v_cndmask_b32 v134, v134, v9, s[34:35]
v_cndmask_b32 v135, v135, v9, s[36:37]
v_cndmask_b32 v140, v140, v9, s[30:31]
v_cndmask_b32 v141, v141, v9, s[32:33]
v_cndmask_b32 v142, v142, v9, s[34:35]
v_cndmask_b32 v143, v143, v9, s[36:37]
s_mov_b32 s96, 0x80000
s_cmp_eq_u32 s42, 63
s_cbranch_scc1 L_at_p2
L_at_p1:
global_load_dwordx4 v[76:79], v5, s[20:21] offset:2048 sc1
s_waitcnt vmcnt(0)
v_cmp_eq_u32 vcc, -1, v76
s_nop 0
s_cbranch_vccz L_at_p2
s_sleep 2
s_sub_u32 s96, s96, 1
s_cbranch_scc0 L_at_p1
s_branch L_wabort
L_at_p2:
global_load_dwordx4 v[76:79], v5, s[20:21] offset:2048 sc1
global_load_dwordx4 v[80:83], v5, s[20:21] offset:2560 sc1
global_load_dwordx4 v[84:87], v5, s[20:21] offset:3072 sc1
global_load_dwordx4 v[88:91], v5, s[20:21] offset:3584 sc1
global_load_dword v124, v6, s[20:21] offset:0 sc1
global_load_dword v125, v6, s[20:21] offset:256 sc1
global_load_dword v126, v6, s[20:21] offset:512 sc1
global_load_dword v127, v6, s[20:21] offset:768 sc1
global_load_dword v128, v6, s[20:21] offset:1024 sc1
global_load_dword v129, v6, s[20:21] offset:1280 sc1
global_load_dword v130, v6, s[20:21] offset:1536 sc1
global_load_dword v131, v6, s[20:21] offset:1792 sc1
s_sub_u32 s96, s96, 1
s_cbranch_scc1 L_wabort
s_waitcnt vmcnt(0)
v_max_u32 v10, v76, v77
v_max3_u32 v10, v10, v78, v79
v_max3_u32 v10, v10, v80, v81
v_max3_u32 v10, v10, v82, v83
v_max3_u32 v10, v10, v84, v85
v_max3_u32 v10, v10, v86, v87
v_max3_u32 v10, v10, v88, v89
v_max3_u32 v10, v10, v90, v91
v_max3_u32 v10, v10, v124, v125
v_max3_u32 v10, v10, v126, v127
v_max3_u32 v10, v10, v128, v129
v_max3_u32 v10, v10, v130, v131
v_cmp_eq_u32 vcc, -1, v10
s_nop 0
s_cbranch_vccnz L_at_p2
v_mfma_f32_16x16x32_bf16 v[144:147], v[76:79], v[12:15], 0
v_mfma_f32_16x16x32_bf16 v[148:151], v[76:79], v[28:31], 0
v_mfma_f32_16x16x32_bf16 v[144:147], v[80:83], v[16:19], v[144:147]
v_mfma_f32_16x16x32_bf16 v[148:151], v[80:83], v[32:35], v[148:151]
v_mfma_f32_16x16x32_bf16 v[144:147], v[84:87], v[20:23], v[144:147]
v_mfma_f32_16x16x32_bf16 v[148:151], v[84:87], v[36:39], v[148:151]
v_mfma_f32_16x16x32_bf16 v[144:147], v[88:91], v[24:27], v[144:147]
v_mfma_f32_16x16x32_bf16 v[148:151], v[88:91], v[40:43], v[148:151]
s_nop 4
v_cvt_pk_bf16_f32 v10, v144, v145
v_lshlrev_b32 v144, 16, v10
v_and_b32 v145, 0xffff0000, v10
v_mul_f32 v144, s29, v144
v_mul_f32 v145, s29, v145
v_cvt_pk_bf16_f32 v10, v144, v145
v_lshlrev_b32 v144, 16, v10
v_and_b32 v145, 0xffff0000, v10
v_max3_f32 v10, v132, v133, v134
v_max3_f32 v10, v10, v135, v144
v_max_f32 v10, v10, v145
v_mov_b32 v11, v10
s_nop 1
v_permlane32_swap_b32 v10, v11
v_max_f32 v10, v10, v11
v_mov_b32 v11, v10
s_nop 1
v_permlane16_swap_b32 v10, v11
v_max_f32 v10, v10, v11
v_sub_f32 v132, v132, v10
v_mul_f32 v132, s28, v132
v_exp_f32 v132, v132
v_sub_f32 v133, v133, v10
v_mul_f32 v133, s28, v133
v_exp_f32 v133, v133
v_sub_f32 v134, v134, v10
v_mul_f32 v134, s28, v134
v_exp_f32 v134, v134
v_sub_f32 v135, v135, v10
v_mul_f32 v135, s28, v135
v_exp_f32 v135, v135
v_sub_f32 v144, v144, v10
v_mul_f32 v144, s28, v144
v_exp_f32 v144, v144
v_sub_f32 v145, v145, v10
v_mul_f32 v145, s28, v145
v_exp_f32 v145, v145
v_add_f32 v10, v132, v133
v_add_f32 v10, v10, v134
v_add_f32 v10, v10, v135
v_add_f32 v10, v10, v144
v_add_f32 v10, v10, v145
v_mov_b32 v11, v10
s_nop 1
v_permlane32_swap_b32 v10, v11
v_add_f32 v10, v10, v11
v_mov_b32 v11, v10
s_nop 1
v_permlane16_swap_b32 v10, v11
v_add_f32 v10, v10, v11
v_rcp_f32 v10, v10
s_nop 0
v_mul_f32 v132, v132, v10
v_mul_f32 v133, v133, v10
v_mul_f32 v134, v134, v10
v_mul_f32 v135, v135, v10
v_mul_f32 v144, v144, v10
v_mul_f32 v145, v145, v10
v_cvt_pk_bf16_f32 v162, v144, v145
v_cvt_pk_bf16_f32 v167, v144, v145
v_cvt_pk_bf16_f32 v152, v132, v133
v_cvt_pk_bf16_f32 v153, v134, v135
v_cvt_pk_bf16_f32 v10, v148, v149
v_lshlrev_b32 v148, 16, v10
v_and_b32 v149, 0xffff0000, v10
v_mul_f32 v148, s29, v148
v_mul_f32 v149, s29, v149
v_cvt_pk_bf16_f32 v10, v148, v149
v_lshlrev_b32 v148, 16, v10
v_and_b32 v149, 0xffff0000, v10
v_max3_f32 v10, v140, v141, v142
v_max3_f32 v10, v10, v143, v136
v_max3_f32 v10, v10, v137, v138
v_max3_f32 v10, v10, v139, v148
v_max_f32 v10, v10, v149
v_mov_b32 v11, v10
s_nop 1
v_permlane32_swap_b32 v10, v11
v_max_f32 v10, v10, v11
v_mov_b32 v11, v10
s_nop 1
v_permlane16_swap_b32 v10, v11
v_max_f32 v10, v10, v11
v_sub_f32 v140, v140, v10
v_mul_f32 v140, s28, v140
v_exp_f32 v140, v140
v_sub_f32 v141, v141, v10
v_mul_f32 v141, s28, v141
v_exp_f32 v141, v141
v_sub_f32 v142, v142, v10
v_mul_f32 v142, s28, v142
v_exp_f32 v142, v142
v_sub_f32 v143, v143, v10
v_mul_f32 v143, s28, v143
v_exp_f32 v143, v143
v_sub_f32 v136, v136, v10
v_mul_f32 v136, s28, v136
v_exp_f32 v136, v136
v_sub_f32 v137, v137, v10
v_mul_f32 v137, s28, v137
v_exp_f32 v137, v137
v_sub_f32 v138, v138, v10
v_mul_f32 v138, s28, v138
v_exp_f32 v138, v138
v_sub_f32 v139, v139, v10
v_mul_f32 v139, s28, v139
v_exp_f32 v139, v139
v_sub_f32 v148, v148, v10
v_mul_f32 v148, s28, v148
v_exp_f32 v148, v148
v_sub_f32 v149, v149, v10
v_mul_f32 v149, s28, v149
v_exp_f32 v149, v149
v_add_f32 v10, v140, v141
v_add_f32 v10, v10, v142
v_add_f32 v10, v10, v143
v_add_f32 v10, v10, v136
v_add_f32 v10, v10, v137
v_add_f32 v10, v10, v138
v_add_f32 v10, v10, v139
v_add_f32 v10, v10, v148
v_add_f32 v10, v10, v149
v_mov_b32 v11, v10
s_nop 1
v_permlane32_swap_b32 v10, v11
v_add_f32 v10, v10, v11
v_mov_b32 v11, v10
s_nop 1
v_permlane16_swap_b32 v10, v11
v_add_f32 v10, v10, v11
v_rcp_f32 v10, v10
s_nop 0
v_mul_f32 v140, v140, v10
v_mul_f32 v141, v141, v10
v_mul_f32 v142, v142, v10
v_mul_f32 v143, v143, v10
v_mul_f32 v136, v136, v10
v_mul_f32 v137, v137, v10
v_mul_f32 v138, v138, v10
v_mul_f32 v139, v139, v10
v_mul_f32 v148, v148, v10
v_mul_f32 v149, v149, v10
v_cvt_pk_bf16_f32 v172, v148, v149
v_cvt_pk_bf16_f32 v177, v148, v149
v_cvt_pk_bf16_f32 v156, v136, v137
v_cvt_pk_bf16_f32 v157, v138, v139
v_cvt_pk_bf16_f32 v158, v140, v141
v_cvt_pk_bf16_f32 v159, v142, v143
s_waitcnt vmcnt(0)
v_mfma_f32_16x16x32_bf16 v[12:15], v[92:95], v[152:155], 0
v_mfma_f32_16x16x32_bf16 v[12:15], v[124:127], v[162:165], v[12:15]
v_mfma_f32_16x16x32_bf16 v[16:19], v[96:99], v[152:155], 0
v_mfma_f32_16x16x32_bf16 v[16:19], v[124:127], v[166:169], v[16:19]
v_mfma_f32_16x16x32_bf16 v[20:23], v[100:103], v[152:155], 0
v_mfma_f32_16x16x32_bf16 v[20:23], v[124:127], v[160:163], v[20:23]
v_mfma_f32_16x16x32_bf16 v[24:27], v[104:107], v[152:155], 0
v_mfma_f32_16x16x32_bf16 v[24:27], v[124:127], v[164:167], v[24:27]
v_mfma_f32_16x16x32_bf16 v[28:31], v[108:111], v[152:155], 0
v_mfma_f32_16x16x32_bf16 v[28:31], v[128:131], v[162:165], v[28:31]
v_mfma_f32_16x16x32_bf16 v[32:35], v[112:115], v[152:155], 0
v_mfma_f32_16x16x32_bf16 v[32:35], v[128:131], v[166:169], v[32:35]
v_mfma_f32_16x16x32_bf16 v[36:39], v[116:119], v[152:155], 0
v_mfma_f32_16x16x32_bf16 v[36:39], v[128:131], v[160:163], v[36:39]
v_mfma_f32_16x16x32_bf16 v[40:43], v[120:123], v[152:155], 0
v_mfma_f32_16x16x32_bf16 v[40:43], v[128:131], v[164:167], v[40:43]
v_mfma_f32_16x16x32_bf16 v[44:47], v[92:95], v[156:159], 0
v_mfma_f32_16x16x32_bf16 v[44:47], v[124:127], v[172:175], v[44:47]
v_mfma_f32_16x16x32_bf16 v[48:51], v[96:99], v[156:159], 0
v_mfma_f32_16x16x32_bf16 v[48:51], v[124:127], v[176:179], v[48:51]
v_mfma_f32_16x16x32_bf16 v[52:55], v[100:103], v[156:159], 0
v_mfma_f32_16x16x32_bf16 v[52:55], v[124:127], v[170:173], v[52:55]
v_mfma_f32_16x16x32_bf16 v[56:59], v[104:107], v[156:159], 0
v_mfma_f32_16x16x32_bf16 v[56:59], v[124:127], v[174:177], v[56:59]
v_mfma_f32_16x16x32_bf16 v[60:63], v[108:111], v[156:159], 0
v_mfma_f32_16x16x32_bf16 v[60:63], v[128:131], v[172:175], v[60:63]
v_mfma_f32_16x16x32_bf16 v[64:67], v[112:115], v[156:159], 0
v_mfma_f32_16x16x32_bf16 v[64:67], v[128:131], v[176:179], v[64:67]
v_mfma_f32_16x16x32_bf16 v[68:71], v[116:119], v[156:159], 0
v_mfma_f32_16x16x32_bf16 v[68:71], v[128:131], v[170:173], v[68:71]
v_mfma_f32_16x16x32_bf16 v[72:75], v[120:123], v[156:159], 0
v_mfma_f32_16x16x32_bf16 v[72:75], v[128:131], v[174:177], v[72:75]
v_cvt_pk_bf16_f32 v12, v12, v13
v_cvt_pk_bf16_f32 v13, v14, v15
v_cvt_pk_bf16_f32 v14, v16, v17
v_cvt_pk_bf16_f32 v15, v18, v19
global_store_dwordx4 v2, v[12:15], s[24:25] offset:0 sc1
v_cvt_pk_bf16_f32 v20, v20, v21
v_cvt_pk_bf16_f32 v21, v22, v23
v_cvt_pk_bf16_f32 v22, v24, v25
v_cvt_pk_bf16_f32 v23, v26, v27
global_store_dwordx4 v2, v[20:23], s[24:25] offset:1024 sc1
v_cvt_pk_bf16_f32 v28, v28, v29
v_cvt_pk_bf16_f32 v29, v30, v31
v_cvt_pk_bf16_f32 v30, v32, v33
v_cvt_pk_bf16_f32 v31, v34, v35
global_store_dwordx4 v2, v[28:31], s[24:25] offset:2048 sc1
v_cvt_pk_bf16_f32 v36, v36, v37
v_cvt_pk_bf16_f32 v37, v38, v39
v_cvt_pk_bf16_f32 v38, v40, v41
v_cvt_pk_bf16_f32 v39, v42, v43
global_store_dwordx4 v2, v[36:39], s[24:25] offset:3072 sc1
v_cvt_pk_bf16_f32 v44, v44, v45
v_cvt_pk_bf16_f32 v45, v46, v47
v_cvt_pk_bf16_f32 v46, v48, v49
v_cvt_pk_bf16_f32 v47, v50, v51
global_store_dwordx4 v2, v[44:47], s[26:27] offset:0 sc1
v_cvt_pk_bf16_f32 v52, v52, v53
v_cvt_pk_bf16_f32 v53, v54, v55
v_cvt_pk_bf16_f32 v54, v56, v57
v_cvt_pk_bf16_f32 v55, v58, v59
global_store_dwordx4 v2, v[52:55], s[26:27] offset:1024 sc1
v_cvt_pk_bf16_f32 v60, v60, v61
v_cvt_pk_bf16_f32 v61, v62, v63
v_cvt_pk_bf16_f32 v62, v64, v65
v_cvt_pk_bf16_f32 v63, v66, v67
global_store_dwordx4 v2, v[60:63], s[26:27] offset:2048 sc1
v_cvt_pk_bf16_f32 v68, v68, v69
v_cvt_pk_bf16_f32 v69, v70, v71
v_cvt_pk_bf16_f32 v70, v72, v73
v_cvt_pk_bf16_f32 v71, v74, v75
global_store_dwordx4 v2, v[68:71], s[26:27] offset:3072 sc1
s_mul_i32 s3, s42, 10240
s_lshl_b32 s13, s41, 7
s_add_u32 s13, s13, s3
s_add_u32 s13, s13, 73400320
s_waitcnt vmcnt(0)
v_mov_b32 v10, s13
v_mov_b32 v11, 1
s_mov_b64 exec, 1
global_store_dword v10, v11, s[8:9] sc1
s_mov_b64 exec, -1
L_rf_57:
s_add_u32 s42, s42, 4
s_cmp_lt_u32 s42, 64
s_cbranch_scc1 L_at_loop
s_waitcnt vmcnt(0)
s_endpgm
L_st_op:
s_load_dwordx2 s[4:5], s[0:1], 40
s_load_dwordx2 s[10:11], s[0:1], 96
v_and_b32 v1, 63, v0
s_and_b32 s14, s40, 7
s_bfe_u32 s41, s40, 0x20003
s_lshr_b32 s42, s40, 5
s_lshl_b32 s43, s41, 5
s_lshl_b32 s3, s12, 3
s_add_u32 s43, s43, s3
v_lshlrev_b32 v2, 4, v1
v_add_u32 v11, 0, v1
v_mul_u32_u24 v12, 6554, v11
v_lshrrev_b32 v12, 16, v12
v_mul_u32_u24 v13, 10, v12
v_sub_u32 v13, v11, v13
v_mul_u32_u24 v12, 1280, v12
v_lshl_add_u32 v6, v13, 4, v12
v_add_u32 v11, 64, v1
v_mul_u32_u24 v12, 6554, v11
v_lshrrev_b32 v12, 16, v12
v_mul_u32_u24 v13, 10, v12
v_sub_u32 v13, v11, v13
v_mul_u32_u24 v12, 1280, v12
v_lshl_add_u32 v7, v13, 4, v12
v_add_u32 v11, 128, v1
v_mul_u32_u24 v12, 6554, v11
v_lshrrev_b32 v12, 16, v12
v_mul_u32_u24 v13, 10, v12
v_sub_u32 v13, v11, v13
v_mul_u32_u24 v12, 1280, v12
v_lshl_add_u32 v8, v13, 4, v12
v_add_u32 v11, 192, v1
v_mul_u32_u24 v12, 6554, v11
v_lshrrev_b32 v12, 16, v12
v_mul_u32_u24 v13, 10, v12
v_sub_u32 v13, v11, v13
v_mul_u32_u24 v12, 1280, v12
v_lshl_add_u32 v9, v13, 4, v12
v_add_u32 v11, 256, v1
v_mul_u32_u24 v12, 6554, v11
v_lshrrev_b32 v12, 16, v12
v_mul_u32_u24 v13, 10, v12
v_sub_u32 v13, v11, v13
v_mul_u32_u24 v12, 1280, v12
v_lshl_add_u32 v10, v13, 4, v12
s_mul_i32 s15, s12, 40960
v_lshrrev_b32 v12, 2, v1
v_mul_u32_u24 v12, 160, v12
v_and_b32 v13, 3, v1
v_lshl_add_u32 v12, v13, 3, v12
v_add_u32 v11, s15, v12
s_waitcnt lgkmcnt(0)
s_mov_b32 s6, 5242880
s_mov_b32 s7, 0x20000
s_mul_i32 s16, s43, 40960
s_mul_i32 s3, s14, 160
s_add_u32 s16, s16, s3
s_add_u32 m0, s15, 0
s_nop 0
buffer_load_dwordx4 v6, s[4:7], s16 offen lds
s_add_u32 m0, s15, 1024
s_nop 0
buffer_load_dwordx4 v7, s[4:7], s16 offen lds
s_add_u32 m0, s15, 2048
s_nop 0
buffer_load_dwordx4 v8, s[4:7], s16 offen lds
s_add_u32 m0, s15, 3072
s_nop 0
buffer_load_dwordx4 v9, s[4:7], s16 offen lds
s_add_u32 m0, s15, 4096
s_nop 0
buffer_load_dwordx4 v10, s[4:7], s16 offen lds
s_add_u32 s16, s16, 40960
s_add_u32 m0, s15, 5120
s_nop 0
buffer_load_dwordx4 v6, s[4:7], s16 offen lds
s_add_u32 m0, s15, 6144
s_nop 0
buffer_load_dwordx4 v7, s[4:7], s16 offen lds
s_add_u32 m0, s15, 7168
s_nop 0
buffer_load_dwordx4 v8, s[4:7], s16 offen lds
s_add_u32 m0, s15, 8192
s_nop 0
buffer_load_dwordx4 v9, s[4:7], s16 offen lds
s_add_u32 m0, s15, 9216
s_nop 0
buffer_load_dwordx4 v10, s[4:7], s16 offen lds
s_add_u32 s16, s16, 40960
s_add_u32 m0, s15, 10240
s_nop 0
buffer_load_dwordx4 v6, s[4:7], s16 offen lds
s_add_u32 m0, s15, 11264
s_nop 0
buffer_load_dwordx4 v7, s[4:7], s16 offen lds
s_add_u32 m0, s15, 12288
s_nop 0
buffer_load_dwordx4 v8, s[4:7], s16 offen lds
s_add_u32 m0, s15, 13312
s_nop 0
buffer_load_dwordx4 v9, s[4:7], s16 offen lds
s_add_u32 m0, s15, 14336
s_nop 0
buffer_load_dwordx4 v10, s[4:7], s16 offen lds
s_add_u32 s16, s16, 40960
s_add_u32 m0, s15, 15360
s_nop 0
buffer_load_dwordx4 v6, s[4:7], s16 offen lds
s_add_u32 m0, s15, 16384
s_nop 0
buffer_load_dwordx4 v7, s[4:7], s16 offen lds
s_add_u32 m0, s15, 17408
s_nop 0
buffer_load_dwordx4 v8, s[4:7], s16 offen lds
s_add_u32 m0, s15, 18432
s_nop 0
buffer_load_dwordx4 v9, s[4:7], s16 offen lds
s_add_u32 m0, s15, 19456
s_nop 0
buffer_load_dwordx4 v10, s[4:7], s16 offen lds
s_add_u32 s16, s16, 40960
s_add_u32 m0, s15, 20480
s_nop 0
buffer_load_dwordx4 v6, s[4:7], s16 offen lds
s_add_u32 m0, s15, 21504
s_nop 0
buffer_load_dwordx4 v7, s[4:7], s16 offen lds
s_add_u32 m0, s15, 22528
s_nop 0
buffer_load_dwordx4 v8, s[4:7], s16 offen lds
s_add_u32 m0, s15, 23552
s_nop 0
buffer_load_dwordx4 v9, s[4:7], s16 offen lds
s_add_u32 m0, s15, 24576
s_nop 0
buffer_load_dwordx4 v10, s[4:7], s16 offen lds
s_add_u32 s16, s16, 40960
s_add_u32 m0, s15, 25600
s_nop 0
buffer_load_dwordx4 v6, s[4:7], s16 offen lds
s_add_u32 m0, s15, 26624
s_nop 0
buffer_load_dwordx4 v7, s[4:7], s16 offen lds
s_add_u32 m0, s15, 27648
s_nop 0
buffer_load_dwordx4 v8, s[4:7], s16 offen lds
s_add_u32 m0, s15, 28672
s_nop 0
buffer_load_dwordx4 v9, s[4:7], s16 offen lds
s_add_u32 m0, s15, 29696
s_nop 0
buffer_load_dwordx4 v10, s[4:7], s16 offen lds
s_add_u32 s16, s16, 40960
s_add_u32 m0, s15, 30720
s_nop 0
buffer_load_dwordx4 v6, s[4:7], s16 offen lds
s_add_u32 m0, s15, 31744
s_nop 0
buffer_load_dwordx4 v7, s[4:7], s16 offen lds
s_add_u32 m0, s15, 32768
s_nop 0
buffer_load_dwordx4 v8, s[4:7], s16 offen lds
s_add_u32 m0, s15, 33792
s_nop 0
buffer_load_dwordx4 v9, s[4:7], s16 offen lds
s_add_u32 m0, s15, 34816
s_nop 0
buffer_load_dwordx4 v10, s[4:7], s16 offen lds
s_add_u32 s16, s16, 40960
s_add_u32 m0, s15, 35840
s_nop 0
buffer_load_dwordx4 v6, s[4:7], s16 offen lds
s_add_u32 m0, s15, 36864
s_nop 0
buffer_load_dwordx4 v7, s[4:7], s16 offen lds
s_add_u32 m0, s15, 37888
s_nop 0
buffer_load_dwordx4 v8, s[4:7], s16 offen lds
s_add_u32 m0, s15, 38912
s_nop 0
buffer_load_dwordx4 v9, s[4:7], s16 offen lds
s_add_u32 m0, s15, 39936
s_nop 0
buffer_load_dwordx4 v10, s[4:7], s16 offen lds
s_add_u32 s16, s16, 40960
s_waitcnt vmcnt(35)
ds_read_b64_tr_b16 a[0:1], v11 offset:0
ds_read_b64_tr_b16 a[2:3], v11 offset:2560
ds_read_b64_tr_b16 a[4:5], v11 offset:32
ds_read_b64_tr_b16 a[6:7], v11 offset:2592
ds_read_b64_tr_b16 a[8:9], v11 offset:64
ds_read_b64_tr_b16 a[10:11], v11 offset:2624
ds_read_b64_tr_b16 a[12:13], v11 offset:96
ds_read_b64_tr_b16 a[14:15], v11 offset:2656
ds_read_b64_tr_b16 a[16:17], v11 offset:128
ds_read_b64_tr_b16 a[18:19], v11 offset:2688
s_waitcnt vmcnt(30)
ds_read_b64_tr_b16 a[20:21], v11 offset:5120
ds_read_b64_tr_b16 a[22:23], v11 offset:7680
ds_read_b64_tr_b16 a[24:25], v11 offset:5152
ds_read_b64_tr_b16 a[26:27], v11 offset:7712
ds_read_b64_tr_b16 a[28:29], v11 offset:5184
ds_read_b64_tr_b16 a[30:31], v11 offset:7744
ds_read_b64_tr_b16 a[32:33], v11 offset:5216
ds_read_b64_tr_b16 a[34:35], v11 offset:7776
ds_read_b64_tr_b16 a[36:37], v11 offset:5248
ds_read_b64_tr_b16 a[38:39], v11 offset:7808
s_waitcnt vmcnt(25)
ds_read_b64_tr_b16 a[40:41], v11 offset:10240
ds_read_b64_tr_b16 a[42:43], v11 offset:12800
ds_read_b64_tr_b16 a[44:45], v11 offset:10272
ds_read_b64_tr_b16 a[46:47], v11 offset:12832
ds_read_b64_tr_b16 a[48:49], v11 offset:10304
ds_read_b64_tr_b16 a[50:51], v11 offset:12864
ds_read_b64_tr_b16 a[52:53], v11 offset:10336
ds_read_b64_tr_b16 a[54:55], v11 offset:12896
ds_read_b64_tr_b16 a[56:57], v11 offset:10368
ds_read_b64_tr_b16 a[58:59], v11 offset:12928
s_waitcnt vmcnt(20)
ds_read_b64_tr_b16 a[60:61], v11 offset:15360
ds_read_b64_tr_b16 a[62:63], v11 offset:17920
ds_read_b64_tr_b16 a[64:65], v11 offset:15392
ds_read_b64_tr_b16 a[66:67], v11 offset:17952
ds_read_b64_tr_b16 a[68:69], v11 offset:15424
ds_read_b64_tr_b16 a[70:71], v11 offset:17984
ds_read_b64_tr_b16 a[72:73], v11 offset:15456
ds_read_b64_tr_b16 a[74:75], v11 offset:18016
ds_read_b64_tr_b16 a[76:77], v11 offset:15488
ds_read_b64_tr_b16 a[78:79], v11 offset:18048
s_waitcnt vmcnt(15)
ds_read_b64_tr_b16 a[80:81], v11 offset:20480
ds_read_b64_tr_b16 a[82:83], v11 offset:23040
ds_read_b64_tr_b16 a[84:85], v11 offset:20512
ds_read_b64_tr_b16 a[86:87], v11 offset:23072
ds_read_b64_tr_b16 a[88:89], v11 offset:20544
ds_read_b64_tr_b16 a[90:91], v11 offset:23104
ds_read_b64_tr_b16 a[92:93], v11 offset:20576
ds_read_b64_tr_b16 a[94:95], v11 offset:23136
ds_read_b64_tr_b16 a[96:97], v11 offset:20608
ds_read_b64_tr_b16 a[98:99], v11 offset:23168
s_waitcnt vmcnt(10)
ds_read_b64_tr_b16 a[100:101], v11 offset:25600
ds_read_b64_tr_b16 a[102:103], v11 offset:28160
ds_read_b64_tr_b16 a[104:105], v11 offset:25632
ds_read_b64_tr_b16 a[106:107], v11 offset:28192
ds_read_b64_tr_b16 a[108:109], v11 offset:25664
ds_read_b64_tr_b16 a[110:111], v11 offset:28224
ds_read_b64_tr_b16 a[112:113], v11 offset:25696
ds_read_b64_tr_b16 a[114:115], v11 offset:28256
ds_read_b64_tr_b16 a[116:117], v11 offset:25728
ds_read_b64_tr_b16 a[118:119], v11 offset:28288
s_waitcnt vmcnt(5)
ds_read_b64_tr_b16 a[120:121], v11 offset:30720
ds_read_b64_tr_b16 a[122:123], v11 offset:33280
ds_read_b64_tr_b16 a[124:125], v11 offset:30752
ds_read_b64_tr_b16 a[126:127], v11 offset:33312
ds_read_b64_tr_b16 a[128:129], v11 offset:30784
ds_read_b64_tr_b16 a[130:131], v11 offset:33344
ds_read_b64_tr_b16 a[132:133], v11 offset:30816
ds_read_b64_tr_b16 a[134:135], v11 offset:33376
ds_read_b64_tr_b16 a[136:137], v11 offset:30848
ds_read_b64_tr_b16 a[138:139], v11 offset:33408
s_waitcnt vmcnt(0)
ds_read_b64_tr_b16 a[140:141], v11 offset:35840
ds_read_b64_tr_b16 a[142:143], v11 offset:38400
ds_read_b64_tr_b16 a[144:145], v11 offset:35872
ds_read_b64_tr_b16 a[146:147], v11 offset:38432
ds_read_b64_tr_b16 a[148:149], v11 offset:35904
ds_read_b64_tr_b16 a[150:151], v11 offset:38464
ds_read_b64_tr_b16 a[152:153], v11 offset:35936
ds_read_b64_tr_b16 a[154:155], v11 offset:38496
ds_read_b64_tr_b16 a[156:157], v11 offset:35968
ds_read_b64_tr_b16 a[158:159], v11 offset:38528
s_waitcnt lgkmcnt(0)
v_add_u32 v3, 131072, v2
v_add_u32 v4, s15, v2
v_lshrrev_b32 v12, 4, v1
v_and_b32 v13, 15, v1
s_add_u32 s45, s12, 4
s_add_u32 s46, s12, 8
s_min_u32 s46, s46, 9
s_mov_b32 s44, s12
s_lshl_b32 s3, s44, 10
v_add_u32 v6, s3, v2
s_cmp_ge_u32 s44, 5
s_cselect_b32 s50, 1, 0
s_mul_i32 s3, s50, 5
s_sub_u32 s51, s44, s3
s_mul_i32 s3, s14, 5
s_add_u32 s51, s51, s3
s_mul_i32 s3, s50, 40
s_add_u32 s3, s3, s51
s_lshl_b32 s3, s3, 10
v_add_u32 v168, s3, v2
s_lshl_b32 s3, s45, 10
v_add_u32 v7, s3, v2
s_cmp_ge_u32 s45, 5
s_cselect_b32 s50, 1, 0
s_mul_i32 s3, s50, 5
s_sub_u32 s51, s45, s3
s_mul_i32 s3, s14, 5
s_add_u32 s51, s51, s3
s_mul_i32 s3, s50, 40
s_add_u32 s3, s3, s51
s_lshl_b32 s3, s3, 10
v_add_u32 v169, s3, v2
s_lshl_b32 s3, s46, 10
v_add_u32 v8, s3, v2
s_cmp_ge_u32 s46, 5
s_cselect_b32 s50, 1, 0
s_mul_i32 s3, s50, 5
s_sub_u32 s51, s46, s3
s_mul_i32 s3, s14, 5
s_add_u32 s51, s51, s3
s_mul_i32 s3, s50, 40
s_add_u32 s3, s3, s51
s_lshl_b32 s3, s3, 10
v_add_u32 v170, s3, v2
s_waitcnt vmcnt(0)
v_and_b32 v10, 1, v1
s_lshr_b32 s3, s43, 2
v_add_u32 v10, s3, v10
v_lshlrev_b32 v10, 7, v10
s_barrier
L_op_loop:
s_mul_i32 s17, s42, 10240
s_add_u32 s17, s17, 73400320
v_add_u32 v5, s17, v10
s_mul_i32 s3, s42, 256
s_add_u32 s3, s3, s43
s_lshl_b32 s3, s3, 10
s_add_u32 s3, s3, 83886080
s_add_u32 s18, s8, s3
s_addc_u32 s19, s9, 0
s_mul_i32 s3, s42, 81920
s_mul_i32 s13, s41, 5242880
s_add_u32 s3, s3, s13
s_add_u32 s3, s3, 100663296
s_add_u32 s22, s8, s3
s_addc_u32 s23, s9, 0
s_mov_b32 s96, 0x80000
L_wf_58:
global_load_dword v14, v5, s[8:9] sc1
s_waitcnt vmcnt(0)
v_cmp_gt_u32 vcc, 1, v14
s_nop 0
s_cbranch_vccz L_wd_59
s_sleep 1
s_sub_u32 s96, s96, 1
s_cbranch_scc0 L_wf_58
s_branch L_wabort
L_wd_59:
global_load_dwordx4 v[16:19], v2, s[18:19] offset:0 sc1
global_load_dwordx4 v[20:23], v3, s[18:19] offset:0 sc1
global_load_dwordx4 v[24:27], v2, s[18:19] offset:1024 sc1
global_load_dwordx4 v[28:31], v3, s[18:19] offset:1024 sc1
global_load_dwordx4 v[32:35], v2, s[18:19] offset:2048 sc1
global_load_dwordx4 v[36:39], v3, s[18:19] offset:2048 sc1
global_load_dwordx4 v[40:43], v2, s[18:19] offset:3072 sc1
global_load_dwordx4 v[44:47], v3, s[18:19] offset:3072 sc1
s_add_u32 s18, s18, 4096
s_addc_u32 s19, s19, 0
global_load_dwordx4 v[48:51], v2, s[18:19] offset:0 sc1
global_load_dwordx4 v[52:55], v3, s[18:19] offset:0 sc1
global_load_dwordx4 v[56:59], v2, s[18:19] offset:1024 sc1
global_load_dwordx4 v[60:63], v3, s[18:19] offset:1024 sc1
global_load_dwordx4 v[64:67], v2, s[18:19] offset:2048 sc1
global_load_dwordx4 v[68:71], v3, s[18:19] offset:2048 sc1
global_load_dwordx4 v[72:75], v2, s[18:19] offset:3072 sc1
global_load_dwordx4 v[76:79], v3, s[18:19] offset:3072 sc1
s_waitcnt vmcnt(14)
v_mfma_f32_16x16x32_bf16 v[128:131], a[0:3], v[16:19], 0
v_mfma_f32_16x16x32_bf16 v[148:151], a[0:3], v[20:23], 0
v_mfma_f32_16x16x32_bf16 v[132:135], a[4:7], v[16:19], 0
v_mfma_f32_16x16x32_bf16 v[152:155], a[4:7], v[20:23], 0
v_mfma_f32_16x16x32_bf16 v[136:139], a[8:11], v[16:19], 0
v_mfma_f32_16x16x32_bf16 v[156:159], a[8:11], v[20:23], 0
v_mfma_f32_16x16x32_bf16 v[140:143], a[12:15], v[16:19], 0
v_mfma_f32_16x16x32_bf16 v[160:163], a[12:15], v[20:23], 0
v_mfma_f32_16x16x32_bf16 v[144:147], a[16:19], v[16:19], 0
v_mfma_f32_16x16x32_bf16 v[164:167], a[16:19], v[20:23], 0
s_waitcnt vmcnt(12)
v_mfma_f32_16x16x32_bf16 v[128:131], a[20:23], v[24:27], v[128:131]
v_mfma_f32_16x16x32_bf16 v[148:151], a[20:23], v[28:31], v[148:151]
v_mfma_f32_16x16x32_bf16 v[132:135], a[24:27], v[24:27], v[132:135]
v_mfma_f32_16x16x32_bf16 v[152:155], a[24:27], v[28:31], v[152:155]
v_mfma_f32_16x16x32_bf16 v[136:139], a[28:31], v[24:27], v[136:139]
v_mfma_f32_16x16x32_bf16 v[156:159], a[28:31], v[28:31], v[156:159]
v_mfma_f32_16x16x32_bf16 v[140:143], a[32:35], v[24:27], v[140:143]
v_mfma_f32_16x16x32_bf16 v[160:163], a[32:35], v[28:31], v[160:163]
v_mfma_f32_16x16x32_bf16 v[144:147], a[36:39], v[24:27], v[144:147]
v_mfma_f32_16x16x32_bf16 v[164:167], a[36:39], v[28:31], v[164:167]
s_waitcnt vmcnt(10)
v_mfma_f32_16x16x32_bf16 v[128:131], a[40:43], v[32:35], v[128:131]
v_mfma_f32_16x16x32_bf16 v[148:151], a[40:43], v[36:39], v[148:151]
v_mfma_f32_16x16x32_bf16 v[132:135], a[44:47], v[32:35], v[132:135]
v_mfma_f32_16x16x32_bf16 v[152:155], a[44:47], v[36:39], v[152:155]
v_mfma_f32_16x16x32_bf16 v[136:139], a[48:51], v[32:35], v[136:139]
v_mfma_f32_16x16x32_bf16 v[156:159], a[48:51], v[36:39], v[156:159]
v_mfma_f32_16x16x32_bf16 v[140:143], a[52:55], v[32:35], v[140:143]
v_mfma_f32_16x16x32_bf16 v[160:163], a[52:55], v[36:39], v[160:163]
v_mfma_f32_16x16x32_bf16 v[144:147], a[56:59], v[32:35], v[144:147]
v_mfma_f32_16x16x32_bf16 v[164:167], a[56:59], v[36:39], v[164:167]
s_waitcnt vmcnt(8)
v_mfma_f32_16x16x32_bf16 v[128:131], a[60:63], v[40:43], v[128:131]
v_mfma_f32_16x16x32_bf16 v[148:151], a[60:63], v[44:47], v[148:151]
v_mfma_f32_16x16x32_bf16 v[132:135], a[64:67], v[40:43], v[132:135]
v_mfma_f32_16x16x32_bf16 v[152:155], a[64:67], v[44:47], v[152:155]
v_mfma_f32_16x16x32_bf16 v[136:139], a[68:71], v[40:43], v[136:139]
v_mfma_f32_16x16x32_bf16 v[156:159], a[68:71], v[44:47], v[156:159]
v_mfma_f32_16x16x32_bf16 v[140:143], a[72:75], v[40:43], v[140:143]
v_mfma_f32_16x16x32_bf16 v[160:163], a[72:75], v[44:47], v[160:163]
v_mfma_f32_16x16x32_bf16 v[144:147], a[76:79], v[40:43], v[144:147]
v_mfma_f32_16x16x32_bf16 v[164:167], a[76:79], v[44:47], v[164:167]
s_waitcnt vmcnt(6)
v_mfma_f32_16x16x32_bf16 v[128:131], a[80:83], v[48:51], v[128:131]
v_mfma_f32_16x16x32_bf16 v[148:151], a[80:83], v[52:55], v[148:151]
v_mfma_f32_16x16x32_bf16 v[132:135], a[84:87], v[48:51], v[132:135]
v_mfma_f32_16x16x32_bf16 v[152:155], a[84:87], v[52:55], v[152:155]
v_mfma_f32_16x16x32_bf16 v[136:139], a[88:91], v[48:51], v[136:139]
v_mfma_f32_16x16x32_bf16 v[156:159], a[88:91], v[52:55], v[156:159]
v_mfma_f32_16x16x32_bf16 v[140:143], a[92:95], v[48:51], v[140:143]
v_mfma_f32_16x16x32_bf16 v[160:163], a[92:95], v[52:55], v[160:163]
v_mfma_f32_16x16x32_bf16 v[144:147], a[96:99], v[48:51], v[144:147]
v_mfma_f32_16x16x32_bf16 v[164:167], a[96:99], v[52:55], v[164:167]
s_waitcnt vmcnt(4)
v_mfma_f32_16x16x32_bf16 v[128:131], a[100:103], v[56:59], v[128:131]
v_mfma_f32_16x16x32_bf16 v[148:151], a[100:103], v[60:63], v[148:151]
v_mfma_f32_16x16x32_bf16 v[132:135], a[104:107], v[56:59], v[132:135]
v_mfma_f32_16x16x32_bf16 v[152:155], a[104:107], v[60:63], v[152:155]
v_mfma_f32_16x16x32_bf16 v[136:139], a[108:111], v[56:59], v[136:139]
v_mfma_f32_16x16x32_bf16 v[156:159], a[108:111], v[60:63], v[156:159]
v_mfma_f32_16x16x32_bf16 v[140:143], a[112:115], v[56:59], v[140:143]
v_mfma_f32_16x16x32_bf16 v[160:163], a[112:115], v[60:63], v[160:163]
v_mfma_f32_16x16x32_bf16 v[144:147], a[116:119], v[56:59], v[144:147]
v_mfma_f32_16x16x32_bf16 v[164:167], a[116:119], v[60:63], v[164:167]
s_waitcnt vmcnt(2)
v_mfma_f32_16x16x32_bf16 v[128:131], a[120:123], v[64:67], v[128:131]
v_mfma_f32_16x16x32_bf16 v[148:151], a[120:123], v[68:71], v[148:151]
v_mfma_f32_16x16x32_bf16 v[132:135], a[124:127], v[64:67], v[132:135]
v_mfma_f32_16x16x32_bf16 v[152:155], a[124:127], v[68:71], v[152:155]
v_mfma_f32_16x16x32_bf16 v[136:139], a[128:131], v[64:67], v[136:139]
v_mfma_f32_16x16x32_bf16 v[156:159], a[128:131], v[68:71], v[156:159]
v_mfma_f32_16x16x32_bf16 v[140:143], a[132:135], v[64:67], v[140:143]
v_mfma_f32_16x16x32_bf16 v[160:163], a[132:135], v[68:71], v[160:163]
v_mfma_f32_16x16x32_bf16 v[144:147], a[136:139], v[64:67], v[144:147]
v_mfma_f32_16x16x32_bf16 v[164:167], a[136:139], v[68:71], v[164:167]
s_waitcnt vmcnt(0)
v_mfma_f32_16x16x32_bf16 v[128:131], a[140:143], v[72:75], v[128:131]
v_mfma_f32_16x16x32_bf16 v[148:151], a[140:143], v[76:79], v[148:151]
v_mfma_f32_16x16x32_bf16 v[132:135], a[144:147], v[72:75], v[132:135]
v_mfma_f32_16x16x32_bf16 v[152:155], a[144:147], v[76:79], v[152:155]
v_mfma_f32_16x16x32_bf16 v[136:139], a[148:151], v[72:75], v[136:139]
v_mfma_f32_16x16x32_bf16 v[156:159], a[148:151], v[76:79], v[156:159]
v_mfma_f32_16x16x32_bf16 v[140:143], a[152:155], v[72:75], v[140:143]
v_mfma_f32_16x16x32_bf16 v[160:163], a[152:155], v[76:79], v[160:163]
v_mfma_f32_16x16x32_bf16 v[144:147], a[156:159], v[72:75], v[144:147]
v_mfma_f32_16x16x32_bf16 v[164:167], a[156:159], v[76:79], v[164:167]
ds_write_b128 v4, v[128:131] offset:0
ds_write_b128 v4, v[148:151] offset:5120
ds_write_b128 v4, v[132:135] offset:1024
ds_write_b128 v4, v[152:155] offset:6144
ds_write_b128 v4, v[136:139] offset:2048
ds_write_b128 v4, v[156:159] offset:7168
ds_write_b128 v4, v[140:143] offset:3072
ds_write_b128 v4, v[160:163] offset:8192
ds_write_b128 v4, v[144:147] offset:4096
ds_write_b128 v4, v[164:167] offset:9216
s_waitcnt lgkmcnt(0)
s_barrier
v_add_u32 v9, 81920, v6
ds_read_b128 v[16:19], v6 offset:0
ds_read_b128 v[20:23], v6 offset:40960
ds_read_b128 v[24:27], v9 offset:0
ds_read_b128 v[28:31], v9 offset:40960
v_add_u32 v9, 81920, v7
ds_read_b128 v[32:35], v7 offset:0
ds_read_b128 v[36:39], v7 offset:40960
ds_read_b128 v[40:43], v9 offset:0
ds_read_b128 v[44:47], v9 offset:40960
v_add_u32 v9, 81920, v8
ds_read_b128 v[48:51], v8 offset:0
ds_read_b128 v[52:55], v8 offset:40960
ds_read_b128 v[56:59], v9 offset:0
ds_read_b128 v[60:63], v9 offset:40960
s_waitcnt vmcnt(0) lgkmcnt(0)
v_add_f32 v16, v16, v20
v_add_f32 v24, v24, v28
v_add_f32 v16, v16, v24
v_add_f32 v17, v17, v21
v_add_f32 v25, v25, v29
v_add_f32 v17, v17, v25
v_add_f32 v18, v18, v22
v_add_f32 v26, v26, v30
v_add_f32 v18, v18, v26
v_add_f32 v19, v19, v23
v_add_f32 v27, v27, v31
v_add_f32 v19, v19, v27
global_store_dwordx4 v168, v[16:19], s[22:23] sc1
v_add_f32 v32, v32, v36
v_add_f32 v40, v40, v44
v_add_f32 v32, v32, v40
v_add_f32 v33, v33, v37
v_add_f32 v41, v41, v45
v_add_f32 v33, v33, v41
v_add_f32 v34, v34, v38
v_add_f32 v42, v42, v46
v_add_f32 v34, v34, v42
v_add_f32 v35, v35, v39
v_add_f32 v43, v43, v47
v_add_f32 v35, v35, v43
global_store_dwordx4 v169, v[32:35], s[22:23] sc1
v_add_f32 v48, v48, v52
v_add_f32 v56, v56, v60
v_add_f32 v48, v48, v56
v_add_f32 v49, v49, v53
v_add_f32 v57, v57, v61
v_add_f32 v49, v49, v57
v_add_f32 v50, v50, v54
v_add_f32 v58, v58, v62
v_add_f32 v50, v50, v58
v_add_f32 v51, v51, v55
v_add_f32 v59, v59, v63
v_add_f32 v51, v51, v59
global_store_dwordx4 v170, v[48:51], s[22:23] sc1
s_and_b32 s13, s40, 31
s_lshl_b32 s13, s13, 7
s_add_u32 s13, s13, s17
s_add_u32 s13, s13, 4096
s_waitcnt vmcnt(0)
s_barrier
s_cmp_lg_u32 s12, 3
s_cbranch_scc1 L_rf_60
v_mov_b32 v14, s13
v_mov_b32 v15, 1
s_mov_b64 exec, 1
global_store_dword v14, v15, s[8:9] sc1
s_mov_b64 exec, -1
L_rf_60:
s_add_u32 s42, s42, 2
s_cmp_lt_u32 s42, 64
s_cbranch_scc1 L_op_loop
s_waitcnt vmcnt(0)
s_endpgm
L_st_f2:
s_load_dwordx2 s[4:5], s[0:1], 72
s_load_dwordx2 s[10:11], s[0:1], 96
v_and_b32 v1, 63, v0
s_and_b32 s14, s40, 7
s_lshr_b32 s42, s40, 3
s_mov_b32 s43, s12
v_lshlrev_b32 v2, 4, v1
v_add_u32 v11, 0, v1
v_mul_u32_u24 v12, 6554, v11
v_lshrrev_b32 v12, 16, v12
v_mul_u32_u24 v13, 10, v12
v_sub_u32 v13, v11, v13
v_mul_u32_u24 v12, 1280, v12
v_lshl_add_u32 v6, v13, 4, v12
v_add_u32 v11, 64, v1
v_mul_u32_u24 v12, 6554, v11
v_lshrrev_b32 v12, 16, v12
v_mul_u32_u24 v13, 10, v12
v_sub_u32 v13, v11, v13
v_mul_u32_u24 v12, 1280, v12
v_lshl_add_u32 v7, v13, 4, v12
v_add_u32 v11, 128, v1
v_mul_u32_u24 v12, 6554, v11
v_lshrrev_b32 v12, 16, v12
v_mul_u32_u24 v13, 10, v12
v_sub_u32 v13, v11, v13
v_mul_u32_u24 v12, 1280, v12
v_lshl_add_u32 v8, v13, 4, v12
v_add_u32 v11, 192, v1
v_mul_u32_u24 v12, 6554, v11
v_lshrrev_b32 v12, 16, v12
v_mul_u32_u24 v13, 10, v12
v_sub_u32 v13, v11, v13
v_mul_u32_u24 v12, 1280, v12
v_lshl_add_u32 v9, v13, 4, v12
v_add_u32 v11, 256, v1
v_mul_u32_u24 v12, 6554, v11
v_lshrrev_b32 v12, 16, v12
v_mul_u32_u24 v13, 10, v12
v_sub_u32 v13, v11, v13
v_mul_u32_u24 v12, 1280, v12
v_lshl_add_u32 v10, v13, 4, v12
s_mul_i32 s15, s12, 40960
v_lshrrev_b32 v12, 2, v1
v_mul_u32_u24 v12, 160, v12
v_and_b32 v13, 3, v1
v_lshl_add_u32 v12, v13, 3, v12
v_add_u32 v11, s15, v12
s_waitcnt lgkmcnt(0)
s_mov_b32 s6, 2211840
s_mov_b32 s7, 0x20000
s_mul_i32 s16, s43, 40960
s_mul_i32 s3, s14, 160
s_add_u32 s16, s16, s3
s_add_u32 m0, s15, 0
s_nop 0
buffer_load_dwordx4 v6, s[4:7], s16 offen lds
s_add_u32 m0, s15, 1024
s_nop 0
buffer_load_dwordx4 v7, s[4:7], s16 offen lds
s_add_u32 m0, s15, 2048
s_nop 0
buffer_load_dwordx4 v8, s[4:7], s16 offen lds
s_add_u32 m0, s15, 3072
s_nop 0
buffer_load_dwordx4 v9, s[4:7], s16 offen lds
s_add_u32 m0, s15, 4096
s_nop 0
buffer_load_dwordx4 v10, s[4:7], s16 offen lds
s_add_u32 s16, s16, 163840
s_add_u32 m0, s15, 5120
s_nop 0
buffer_load_dwordx4 v6, s[4:7], s16 offen lds
s_add_u32 m0, s15, 6144
s_nop 0
buffer_load_dwordx4 v7, s[4:7], s16 offen lds
s_add_u32 m0, s15, 7168
s_nop 0
buffer_load_dwordx4 v8, s[4:7], s16 offen lds
s_add_u32 m0, s15, 8192
s_nop 0
buffer_load_dwordx4 v9, s[4:7], s16 offen lds
s_add_u32 m0, s15, 9216
s_nop 0
buffer_load_dwordx4 v10, s[4:7], s16 offen lds
s_add_u32 s16, s16, 163840
s_add_u32 m0, s15, 10240
s_nop 0
buffer_load_dwordx4 v6, s[4:7], s16 offen lds
s_add_u32 m0, s15, 11264
s_nop 0
buffer_load_dwordx4 v7, s[4:7], s16 offen lds
s_add_u32 m0, s15, 12288
s_nop 0
buffer_load_dwordx4 v8, s[4:7], s16 offen lds
s_add_u32 m0, s15, 13312
s_nop 0
buffer_load_dwordx4 v9, s[4:7], s16 offen lds
s_add_u32 m0, s15, 14336
s_nop 0
buffer_load_dwordx4 v10, s[4:7], s16 offen lds
s_add_u32 s16, s16, 163840
s_add_u32 m0, s15, 15360
s_nop 0
buffer_load_dwordx4 v6, s[4:7], s16 offen lds
s_add_u32 m0, s15, 16384
s_nop 0
buffer_load_dwordx4 v7, s[4:7], s16 offen lds
s_add_u32 m0, s15, 17408
s_nop 0
buffer_load_dwordx4 v8, s[4:7], s16 offen lds
s_add_u32 m0, s15, 18432
s_nop 0
buffer_load_dwordx4 v9, s[4:7], s16 offen lds
s_add_u32 m0, s15, 19456
s_nop 0
buffer_load_dwordx4 v10, s[4:7], s16 offen lds
s_add_u32 s16, s16, 163840
s_add_u32 m0, s15, 20480
s_nop 0
buffer_load_dwordx4 v6, s[4:7], s16 offen lds
s_add_u32 m0, s15, 21504
s_nop 0
buffer_load_dwordx4 v7, s[4:7], s16 offen lds
s_add_u32 m0, s15, 22528
s_nop 0
buffer_load_dwordx4 v8, s[4:7], s16 offen lds
s_add_u32 m0, s15, 23552
s_nop 0
buffer_load_dwordx4 v9, s[4:7], s16 offen lds
s_add_u32 m0, s15, 24576
s_nop 0
buffer_load_dwordx4 v10, s[4:7], s16 offen lds
s_add_u32 s16, s16, 163840
s_add_u32 m0, s15, 25600
s_nop 0
buffer_load_dwordx4 v6, s[4:7], s16 offen lds
s_add_u32 m0, s15, 26624
s_nop 0
buffer_load_dwordx4 v7, s[4:7], s16 offen lds
s_add_u32 m0, s15, 27648
s_nop 0
buffer_load_dwordx4 v8, s[4:7], s16 offen lds
s_add_u32 m0, s15, 28672
s_nop 0
buffer_load_dwordx4 v9, s[4:7], s16 offen lds
s_add_u32 m0, s15, 29696
s_nop 0
buffer_load_dwordx4 v10, s[4:7], s16 offen lds
s_add_u32 s16, s16, 163840
s_add_u32 m0, s15, 30720
s_nop 0
buffer_load_dwordx4 v6, s[4:7], s16 offen lds
s_add_u32 m0, s15, 31744
s_nop 0
buffer_load_dwordx4 v7, s[4:7], s16 offen lds
s_add_u32 m0, s15, 32768
s_nop 0
buffer_load_dwordx4 v8, s[4:7], s16 offen lds
s_add_u32 m0, s15, 33792
s_nop 0
buffer_load_dwordx4 v9, s[4:7], s16 offen lds
s_add_u32 m0, s15, 34816
s_nop 0
buffer_load_dwordx4 v10, s[4:7], s16 offen lds
s_add_u32 s16, s16, 163840
s_add_u32 m0, s15, 35840
s_nop 0
buffer_load_dwordx4 v6, s[4:7], s16 offen lds
s_add_u32 m0, s15, 36864
s_nop 0
buffer_load_dwordx4 v7, s[4:7], s16 offen lds
s_add_u32 m0, s15, 37888
s_nop 0
buffer_load_dwordx4 v8, s[4:7], s16 offen lds
s_add_u32 m0, s15, 38912
s_nop 0
buffer_load_dwordx4 v9, s[4:7], s16 offen lds
s_add_u32 m0, s15, 39936
s_nop 0
buffer_load_dwordx4 v10, s[4:7], s16 offen lds
s_add_u32 s16, s16, 163840
s_waitcnt vmcnt(35)
ds_read_b64_tr_b16 a[0:1], v11 offset:0
ds_read_b64_tr_b16 a[2:3], v11 offset:2560
ds_read_b64_tr_b16 a[4:5], v11 offset:32
ds_read_b64_tr_b16 a[6:7], v11 offset:2592
ds_read_b64_tr_b16 a[8:9], v11 offset:64
ds_read_b64_tr_b16 a[10:11], v11 offset:2624
ds_read_b64_tr_b16 a[12:13], v11 offset:96
ds_read_b64_tr_b16 a[14:15], v11 offset:2656
ds_read_b64_tr_b16 a[16:17], v11 offset:128
ds_read_b64_tr_b16 a[18:19], v11 offset:2688
s_waitcnt lgkmcnt(0)
s_add_u32 m0, s15, 0
s_nop 0
buffer_load_dwordx4 v6, s[4:7], s16 offen lds
s_add_u32 m0, s15, 1024
s_nop 0
buffer_load_dwordx4 v7, s[4:7], s16 offen lds
s_add_u32 m0, s15, 2048
s_nop 0
buffer_load_dwordx4 v8, s[4:7], s16 offen lds
s_add_u32 m0, s15, 3072
s_nop 0
buffer_load_dwordx4 v9, s[4:7], s16 offen lds
s_add_u32 m0, s15, 4096
s_nop 0
buffer_load_dwordx4 v10, s[4:7], s16 offen lds
s_add_u32 s16, s16, 163840
s_waitcnt vmcnt(35)
ds_read_b64_tr_b16 a[20:21], v11 offset:5120
ds_read_b64_tr_b16 a[22:23], v11 offset:7680
ds_read_b64_tr_b16 a[24:25], v11 offset:5152
ds_read_b64_tr_b16 a[26:27], v11 offset:7712
ds_read_b64_tr_b16 a[28:29], v11 offset:5184
ds_read_b64_tr_b16 a[30:31], v11 offset:7744
ds_read_b64_tr_b16 a[32:33], v11 offset:5216
ds_read_b64_tr_b16 a[34:35], v11 offset:7776
ds_read_b64_tr_b16 a[36:37], v11 offset:5248
ds_read_b64_tr_b16 a[38:39], v11 offset:7808
s_waitcnt lgkmcnt(0)
s_add_u32 m0, s15, 5120
s_nop 0
buffer_load_dwordx4 v6, s[4:7], s16 offen lds
s_add_u32 m0, s15, 6144
s_nop 0
buffer_load_dwordx4 v7, s[4:7], s16 offen lds
s_add_u32 m0, s15, 7168
s_nop 0
buffer_load_dwordx4 v8, s[4:7], s16 offen lds
s_add_u32 m0, s15, 8192
s_nop 0
buffer_load_dwordx4 v9, s[4:7], s16 offen lds
s_add_u32 m0, s15, 9216
s_nop 0
buffer_load_dwordx4 v10, s[4:7], s16 offen lds
s_add_u32 s16, s16, 163840
s_waitcnt vmcnt(35)
ds_read_b64_tr_b16 a[40:41], v11 offset:10240
ds_read_b64_tr_b16 a[42:43], v11 offset:12800
ds_read_b64_tr_b16 a[44:45], v11 offset:10272
ds_read_b64_tr_b16 a[46:47], v11 offset:12832
ds_read_b64_tr_b16 a[48:49], v11 offset:10304
ds_read_b64_tr_b16 a[50:51], v11 offset:12864
ds_read_b64_tr_b16 a[52:53], v11 offset:10336
ds_read_b64_tr_b16 a[54:55], v11 offset:12896
ds_read_b64_tr_b16 a[56:57], v11 offset:10368
ds_read_b64_tr_b16 a[58:59], v11 offset:12928
s_waitcnt lgkmcnt(0)
s_add_u32 m0, s15, 10240
s_nop 0
buffer_load_dwordx4 v6, s[4:7], s16 offen lds
s_add_u32 m0, s15, 11264
s_nop 0
buffer_load_dwordx4 v7, s[4:7], s16 offen lds
s_add_u32 m0, s15, 12288
s_nop 0
buffer_load_dwordx4 v8, s[4:7], s16 offen lds
s_add_u32 m0, s15, 13312
s_nop 0
buffer_load_dwordx4 v9, s[4:7], s16 offen lds
s_add_u32 m0, s15, 14336
s_nop 0
buffer_load_dwordx4 v10, s[4:7], s16 offen lds
s_add_u32 s16, s16, 163840
s_waitcnt vmcnt(35)
ds_read_b64_tr_b16 a[60:61], v11 offset:15360
ds_read_b64_tr_b16 a[62:63], v11 offset:17920
ds_read_b64_tr_b16 a[64:65], v11 offset:15392
ds_read_b64_tr_b16 a[66:67], v11 offset:17952
ds_read_b64_tr_b16 a[68:69], v11 offset:15424
ds_read_b64_tr_b16 a[70:71], v11 offset:17984
ds_read_b64_tr_b16 a[72:73], v11 offset:15456
ds_read_b64_tr_b16 a[74:75], v11 offset:18016
ds_read_b64_tr_b16 a[76:77], v11 offset:15488
ds_read_b64_tr_b16 a[78:79], v11 offset:18048
s_waitcnt lgkmcnt(0)
s_add_u32 m0, s15, 15360
s_nop 0
buffer_load_dwordx4 v6, s[4:7], s16 offen lds
s_add_u32 m0, s15, 16384
s_nop 0
buffer_load_dwordx4 v7, s[4:7], s16 offen lds
s_add_u32 m0, s15, 17408
s_nop 0
buffer_load_dwordx4 v8, s[4:7], s16 offen lds
s_add_u32 m0, s15, 18432
s_nop 0
buffer_load_dwordx4 v9, s[4:7], s16 offen lds
s_add_u32 m0, s15, 19456
s_nop 0
buffer_load_dwordx4 v10, s[4:7], s16 offen lds
s_add_u32 s16, s16, 163840
s_waitcnt vmcnt(35)
ds_read_b64_tr_b16 a[80:81], v11 offset:20480
ds_read_b64_tr_b16 a[82:83], v11 offset:23040
ds_read_b64_tr_b16 a[84:85], v11 offset:20512
ds_read_b64_tr_b16 a[86:87], v11 offset:23072
ds_read_b64_tr_b16 a[88:89], v11 offset:20544
ds_read_b64_tr_b16 a[90:91], v11 offset:23104
ds_read_b64_tr_b16 a[92:93], v11 offset:20576
ds_read_b64_tr_b16 a[94:95], v11 offset:23136
ds_read_b64_tr_b16 a[96:97], v11 offset:20608
ds_read_b64_tr_b16 a[98:99], v11 offset:23168
s_waitcnt lgkmcnt(0)
s_add_u32 m0, s15, 20480
s_nop 0
buffer_load_dwordx4 v6, s[4:7], s16 offen lds
s_add_u32 m0, s15, 21504
s_nop 0
buffer_load_dwordx4 v7, s[4:7], s16 offen lds
s_add_u32 m0, s15, 22528
s_nop 0
buffer_load_dwordx4 v8, s[4:7], s16 offen lds
s_add_u32 m0, s15, 23552
s_nop 0
buffer_load_dwordx4 v9, s[4:7], s16 offen lds
s_add_u32 m0, s15, 24576
s_nop 0
buffer_load_dwordx4 v10, s[4:7], s16 offen lds
s_add_u32 s16, s16, 163840
s_waitcnt vmcnt(35)
ds_read_b64_tr_b16 a[100:101], v11 offset:25600
ds_read_b64_tr_b16 a[102:103], v11 offset:28160
ds_read_b64_tr_b16 a[104:105], v11 offset:25632
ds_read_b64_tr_b16 a[106:107], v11 offset:28192
ds_read_b64_tr_b16 a[108:109], v11 offset:25664
ds_read_b64_tr_b16 a[110:111], v11 offset:28224
ds_read_b64_tr_b16 a[112:113], v11 offset:25696
ds_read_b64_tr_b16 a[114:115], v11 offset:28256
ds_read_b64_tr_b16 a[116:117], v11 offset:25728
ds_read_b64_tr_b16 a[118:119], v11 offset:28288
s_waitcnt lgkmcnt(0)
s_add_u32 m0, s15, 25600
s_nop 0
buffer_load_dwordx4 v6, s[4:7], s16 offen lds
s_add_u32 m0, s15, 26624
s_nop 0
buffer_load_dwordx4 v7, s[4:7], s16 offen lds
s_add_u32 m0, s15, 27648
s_nop 0
buffer_load_dwordx4 v8, s[4:7], s16 offen lds
s_add_u32 m0, s15, 28672
s_nop 0
buffer_load_dwordx4 v9, s[4:7], s16 offen lds
s_add_u32 m0, s15, 29696
s_nop 0
buffer_load_dwordx4 v10, s[4:7], s16 offen lds
s_add_u32 s16, s16, 163840
s_waitcnt vmcnt(35)
ds_read_b64_tr_b16 a[120:121], v11 offset:30720
ds_read_b64_tr_b16 a[122:123], v11 offset:33280
ds_read_b64_tr_b16 a[124:125], v11 offset:30752
ds_read_b64_tr_b16 a[126:127], v11 offset:33312
ds_read_b64_tr_b16 a[128:129], v11 offset:30784
ds_read_b64_tr_b16 a[130:131], v11 offset:33344
ds_read_b64_tr_b16 a[132:133], v11 offset:30816
ds_read_b64_tr_b16 a[134:135], v11 offset:33376
ds_read_b64_tr_b16 a[136:137], v11 offset:30848
ds_read_b64_tr_b16 a[138:139], v11 offset:33408
s_waitcnt vmcnt(30)
ds_read_b64_tr_b16 a[140:141], v11 offset:35840
ds_read_b64_tr_b16 a[142:143], v11 offset:38400
ds_read_b64_tr_b16 a[144:145], v11 offset:35872
ds_read_b64_tr_b16 a[146:147], v11 offset:38432
ds_read_b64_tr_b16 a[148:149], v11 offset:35904
ds_read_b64_tr_b16 a[150:151], v11 offset:38464
ds_read_b64_tr_b16 a[152:153], v11 offset:35936
ds_read_b64_tr_b16 a[154:155], v11 offset:38496
ds_read_b64_tr_b16 a[156:157], v11 offset:35968
ds_read_b64_tr_b16 a[158:159], v11 offset:38528
s_waitcnt vmcnt(25)
ds_read_b64_tr_b16 a[160:161], v11 offset:0
ds_read_b64_tr_b16 a[162:163], v11 offset:2560
ds_read_b64_tr_b16 a[164:165], v11 offset:32
ds_read_b64_tr_b16 a[166:167], v11 offset:2592
ds_read_b64_tr_b16 a[168:169], v11 offset:64
ds_read_b64_tr_b16 a[170:171], v11 offset:2624
ds_read_b64_tr_b16 a[172:173], v11 offset:96
ds_read_b64_tr_b16 a[174:175], v11 offset:2656
ds_read_b64_tr_b16 a[176:177], v11 offset:128
ds_read_b64_tr_b16 a[178:179], v11 offset:2688
s_waitcnt vmcnt(20)
ds_read_b64_tr_b16 a[180:181], v11 offset:5120
ds_read_b64_tr_b16 a[182:183], v11 offset:7680
ds_read_b64_tr_b16 a[184:185], v11 offset:5152
ds_read_b64_tr_b16 a[186:187], v11 offset:7712
ds_read_b64_tr_b16 a[188:189], v11 offset:5184
ds_read_b64_tr_b16 a[190:191], v11 offset:7744
ds_read_b64_tr_b16 a[192:193], v11 offset:5216
ds_read_b64_tr_b16 a[194:195], v11 offset:7776
ds_read_b64_tr_b16 a[196:197], v11 offset:5248
ds_read_b64_tr_b16 a[198:199], v11 offset:7808
s_waitcnt vmcnt(15)
ds_read_b64_tr_b16 a[200:201], v11 offset:10240
ds_read_b64_tr_b16 a[202:203], v11 offset:12800
ds_read_b64_tr_b16 a[204:205], v11 offset:10272
ds_read_b64_tr_b16 a[206:207], v11 offset:12832
ds_read_b64_tr_b16 a[208:209], v11 offset:10304
ds_read_b64_tr_b16 a[210:211], v11 offset:12864
ds_read_b64_tr_b16 a[212:213], v11 offset:10336
ds_read_b64_tr_b16 a[214:215], v11 offset:12896
ds_read_b64_tr_b16 a[216:217], v11 offset:10368
ds_read_b64_tr_b16 a[218:219], v11 offset:12928
s_waitcnt vmcnt(10)
ds_read_b64_tr_b16 a[220:221], v11 offset:15360
ds_read_b64_tr_b16 a[222:223], v11 offset:17920
ds_read_b64_tr_b16 a[224:225], v11 offset:15392
ds_read_b64_tr_b16 a[226:227], v11 offset:17952
ds_read_b64_tr_b16 a[228:229], v11 offset:15424
ds_read_b64_tr_b16 a[230:231], v11 offset:17984
ds_read_b64_tr_b16 a[232:233], v11 offset:15456
ds_read_b64_tr_b16 a[234:235], v11 offset:18016
ds_read_b64_tr_b16 a[236:237], v11 offset:15488
ds_read_b64_tr_b16 a[238:239], v11 offset:18048
s_waitcnt vmcnt(5)
ds_read_b64_tr_b16 a[240:241], v11 offset:20480
ds_read_b64_tr_b16 a[242:243], v11 offset:23040
ds_read_b64_tr_b16 a[244:245], v11 offset:20512
ds_read_b64_tr_b16 a[246:247], v11 offset:23072
ds_read_b64_tr_b16 a[248:249], v11 offset:20544
ds_read_b64_tr_b16 a[250:251], v11 offset:23104
ds_read_b64_tr_b16 a[252:253], v11 offset:20576
ds_read_b64_tr_b16 a[254:255], v11 offset:23136
ds_read_b64_tr_b16 v[192:193], v11 offset:20608
ds_read_b64_tr_b16 v[194:195], v11 offset:23168
s_waitcnt vmcnt(0)
ds_read_b64_tr_b16 v[196:197], v11 offset:25600
ds_read_b64_tr_b16 v[198:199], v11 offset:28160
ds_read_b64_tr_b16 v[200:201], v11 offset:25632
ds_read_b64_tr_b16 v[202:203], v11 offset:28192
ds_read_b64_tr_b16 v[204:205], v11 offset:25664
ds_read_b64_tr_b16 v[206:207], v11 offset:28224
ds_read_b64_tr_b16 v[208:209], v11 offset:25696
ds_read_b64_tr_b16 v[210:211], v11 offset:28256
ds_read_b64_tr_b16 v[212:213], v11 offset:25728
ds_read_b64_tr_b16 v[214:215], v11 offset:28288
s_waitcnt lgkmcnt(0)
v_mov_b32 v3, 144
s_cmp_lg_u32 s12, 0
s_cbranch_scc1 L_wd_62
s_mov_b32 s96, 0x80000
L_wf_61:
global_load_dword v4, v3, s[94:95] sc1
s_waitcnt vmcnt(0)
v_cmp_gt_u32 vcc, 1, v4
s_nop 0
s_cbranch_vccz L_wd_62
s_sleep 3
s_sub_u32 s96, s96, 1
s_cbranch_scc0 L_wf_61
s_branch L_wabort
L_wd_62:
s_barrier
v_add_u32 v3, 55296, v2
v_add_u32 v4, s15, v2
v_lshrrev_b32 v12, 4, v1
v_and_b32 v13, 15, v1
s_add_u32 s45, s12, 4
s_add_u32 s46, s12, 8
s_min_u32 s46, s46, 9
s_mov_b32 s44, s12
s_lshl_b32 s3, s44, 10
v_add_u32 v6, s3, v2
s_cmp_ge_u32 s44, 5
s_cselect_b32 s50, 1, 0
s_mul_i32 s3, s50, 5
s_sub_u32 s51, s44, s3
s_mul_i32 s3, s14, 5
s_add_u32 s51, s51, s3
s_mul_i32 s3, s50, 40
s_add_u32 s3, s3, s51
s_lshl_b32 s3, s3, 10
v_add_u32 v168, s3, v2
s_mul_i32 s3, s50, 20480
s_lshl_b32 s52, s51, 5
s_add_u32 s3, s3, s52
v_mul_u32_u24 v14, 1280, v13
v_lshl_add_u32 v14, v12, 3, v14
v_add_u32 v172, s3, v14
s_lshl_b32 s3, s51, 6
s_add_u32 s3, s3, 62927360
v_lshlrev_b32 v14, 4, v12
v_add_u32 v14, s3, v14
global_load_dwordx4 v[176:179], v14, s[8:9] sc1
s_lshl_b32 s3, s45, 10
v_add_u32 v7, s3, v2
s_cmp_ge_u32 s45, 5
s_cselect_b32 s50, 1, 0
s_mul_i32 s3, s50, 5
s_sub_u32 s51, s45, s3
s_mul_i32 s3, s14, 5
s_add_u32 s51, s51, s3
s_mul_i32 s3, s50, 40
s_add_u32 s3, s3, s51
s_lshl_b32 s3, s3, 10
v_add_u32 v169, s3, v2
s_mul_i32 s3, s50, 20480
s_lshl_b32 s52, s51, 5
s_add_u32 s3, s3, s52
v_mul_u32_u24 v14, 1280, v13
v_lshl_add_u32 v14, v12, 3, v14
v_add_u32 v173, s3, v14
s_lshl_b32 s3, s51, 6
s_add_u32 s3, s3, 62927360
v_lshlrev_b32 v14, 4, v12
v_add_u32 v14, s3, v14
global_load_dwordx4 v[180:183], v14, s[8:9] sc1
s_lshl_b32 s3, s46, 10
v_add_u32 v8, s3, v2
s_cmp_ge_u32 s46, 5
s_cselect_b32 s50, 1, 0
s_mul_i32 s3, s50, 5
s_sub_u32 s51, s46, s3
s_mul_i32 s3, s14, 5
s_add_u32 s51, s51, s3
s_mul_i32 s3, s50, 40
s_add_u32 s3, s3, s51
s_lshl_b32 s3, s3, 10
v_add_u32 v170, s3, v2
s_mul_i32 s3, s50, 20480
s_lshl_b32 s52, s51, 5
s_add_u32 s3, s3, s52
v_mul_u32_u24 v14, 1280, v13
v_lshl_add_u32 v14, v12, 3, v14
v_add_u32 v174, s3, v14
s_lshl_b32 s3, s51, 6
s_add_u32 s3, s3, 62927360
v_lshlrev_b32 v14, 4, v12
v_add_u32 v14, s3, v14
global_load_dwordx4 v[184:187], v14, s[8:9] sc1
s_waitcnt vmcnt(0)
s_cmp_ge_u32 s12, 2
s_cselect_b32 s47, 0, 4096
v_min_u32 v10, 13, v1
v_lshlrev_b32 v10, 7, v10
v_add_u32 v10, 8192, v10
s_barrier
L_f2_loop:
s_mul_i32 s17, s42, 10240
s_add_u32 s17, s17, 73400320
v_add_u32 v5, s17, v10
s_mul_i32 s3, s42, 108
s_add_u32 s3, s3, s43
s_lshl_b32 s3, s3, 10
s_add_u32 s3, s3, 138412032
s_add_u32 s18, s8, s3
s_addc_u32 s19, s9, 0
s_mul_i32 s3, s42, 81920
s_add_u32 s3, s3, 125829120
s_add_u32 s22, s8, s3
s_addc_u32 s23, s9, 0
s_mov_b32 s96, 0x80000
L_wf_63:
global_load_dword v14, v5, s[8:9] sc1
s_waitcnt vmcnt(0)
v_cmp_gt_u32 vcc, 1, v14
s_nop 0
s_cbranch_vccz L_wd_64
s_sleep 1
s_sub_u32 s96, s96, 1
s_cbranch_scc0 L_wf_63
s_branch L_wabort
L_wd_64:
global_load_dwordx4 v[16:19], v2, s[18:19] sc1
global_load_dwordx4 v[20:23], v3, s[18:19] sc1
s_add_u32 s18, s18, 4096
s_addc_u32 s19, s19, 0
global_load_dwordx4 v[24:27], v2, s[18:19] sc1
global_load_dwordx4 v[28:31], v3, s[18:19] sc1
s_add_u32 s18, s18, 4096
s_addc_u32 s19, s19, 0
global_load_dwordx4 v[32:35], v2, s[18:19] sc1
global_load_dwordx4 v[36:39], v3, s[18:19] sc1
s_add_u32 s18, s18, 4096
s_addc_u32 s19, s19, 0
global_load_dwordx4 v[40:43], v2, s[18:19] sc1
global_load_dwordx4 v[44:47], v3, s[18:19] sc1
s_add_u32 s18, s18, 4096
s_addc_u32 s19, s19, 0
global_load_dwordx4 v[48:51], v2, s[18:19] sc1
global_load_dwordx4 v[52:55], v3, s[18:19] sc1
s_add_u32 s18, s18, 4096
s_addc_u32 s19, s19, 0
global_load_dwordx4 v[56:59], v2, s[18:19] sc1
global_load_dwordx4 v[60:63], v3, s[18:19] sc1
s_add_u32 s18, s18, 4096
s_addc_u32 s19, s19, 0
global_load_dwordx4 v[64:67], v2, s[18:19] sc1
global_load_dwordx4 v[68:71], v3, s[18:19] sc1
s_add_u32 s18, s18, 4096
s_addc_u32 s19, s19, 0
global_load_dwordx4 v[72:75], v2, s[18:19] sc1
global_load_dwordx4 v[76:79], v3, s[18:19] sc1
s_add_u32 s18, s18, 4096
s_addc_u32 s19, s19, 0
global_load_dwordx4 v[80:83], v2, s[18:19] sc1
global_load_dwordx4 v[84:87], v3, s[18:19] sc1
s_add_u32 s18, s18, 4096
s_addc_u32 s19, s19, 0
global_load_dwordx4 v[88:91], v2, s[18:19] sc1
global_load_dwordx4 v[92:95], v3, s[18:19] sc1
s_add_u32 s18, s18, 4096
s_addc_u32 s19, s19, 0
global_load_dwordx4 v[96:99], v2, s[18:19] sc1
global_load_dwordx4 v[100:103], v3, s[18:19] sc1
s_add_u32 s18, s18, 4096
s_addc_u32 s19, s19, 0
global_load_dwordx4 v[104:107], v2, s[18:19] sc1
global_load_dwordx4 v[108:111], v3, s[18:19] sc1
s_add_u32 s18, s18, 4096
s_addc_u32 s19, s19, 0
global_load_dwordx4 v[112:115], v2, s[18:19] sc1
global_load_dwordx4 v[116:119], v3, s[18:19] sc1
s_add_u32 s18, s18, s47
s_addc_u32 s19, s19, 0
global_load_dwordx4 v[120:123], v2, s[18:19] sc1
global_load_dwordx4 v[124:127], v3, s[18:19] sc1
global_load_dwordx4 v[216:219], v168, s[22:23] sc1
global_load_dwordx4 v[220:223], v169, s[22:23] sc1
global_load_dwordx4 v[224:227], v170, s[22:23] sc1
s_mul_i32 s3, s42, 40960
s_add_u32 s20, s10, s3
s_addc_u32 s21, s11, 0
s_waitcnt vmcnt(29)
v_mfma_f32_16x16x32_bf16 v[128:131], a[0:3], v[16:19], 0
v_mfma_f32_16x16x32_bf16 v[148:151], a[0:3], v[20:23], 0
v_mfma_f32_16x16x32_bf16 v[132:135], a[4:7], v[16:19], 0
v_mfma_f32_16x16x32_bf16 v[152:155], a[4:7], v[20:23], 0
v_mfma_f32_16x16x32_bf16 v[136:139], a[8:11], v[16:19], 0
v_mfma_f32_16x16x32_bf16 v[156:159], a[8:11], v[20:23], 0
v_mfma_f32_16x16x32_bf16 v[140:143], a[12:15], v[16:19], 0
v_mfma_f32_16x16x32_bf16 v[160:163], a[12:15], v[20:23], 0
v_mfma_f32_16x16x32_bf16 v[144:147], a[16:19], v[16:19], 0
v_mfma_f32_16x16x32_bf16 v[164:167], a[16:19], v[20:23], 0
s_waitcnt vmcnt(27)
v_mfma_f32_16x16x32_bf16 v[128:131], a[20:23], v[24:27], v[128:131]
v_mfma_f32_16x16x32_bf16 v[148:151], a[20:23], v[28:31], v[148:151]
v_mfma_f32_16x16x32_bf16 v[132:135], a[24:27], v[24:27], v[132:135]
v_mfma_f32_16x16x32_bf16 v[152:155], a[24:27], v[28:31], v[152:155]
v_mfma_f32_16x16x32_bf16 v[136:139], a[28:31], v[24:27], v[136:139]
v_mfma_f32_16x16x32_bf16 v[156:159], a[28:31], v[28:31], v[156:159]
v_mfma_f32_16x16x32_bf16 v[140:143], a[32:35], v[24:27], v[140:143]
v_mfma_f32_16x16x32_bf16 v[160:163], a[32:35], v[28:31], v[160:163]
v_mfma_f32_16x16x32_bf16 v[144:147], a[36:39], v[24:27], v[144:147]
v_mfma_f32_16x16x32_bf16 v[164:167], a[36:39], v[28:31], v[164:167]
s_waitcnt vmcnt(25)
v_mfma_f32_16x16x32_bf16 v[128:131], a[40:43], v[32:35], v[128:131]
v_mfma_f32_16x16x32_bf16 v[148:151], a[40:43], v[36:39], v[148:151]
v_mfma_f32_16x16x32_bf16 v[132:135], a[44:47], v[32:35], v[132:135]
v_mfma_f32_16x16x32_bf16 v[152:155], a[44:47], v[36:39], v[152:155]
v_mfma_f32_16x16x32_bf16 v[136:139], a[48:51], v[32:35], v[136:139]
v_mfma_f32_16x16x32_bf16 v[156:159], a[48:51], v[36:39], v[156:159]
v_mfma_f32_16x16x32_bf16 v[140:143], a[52:55], v[32:35], v[140:143]
v_mfma_f32_16x16x32_bf16 v[160:163], a[52:55], v[36:39], v[160:163]
v_mfma_f32_16x16x32_bf16 v[144:147], a[56:59], v[32:35], v[144:147]
v_mfma_f32_16x16x32_bf16 v[164:167], a[56:59], v[36:39], v[164:167]
s_waitcnt vmcnt(23)
v_mfma_f32_16x16x32_bf16 v[128:131], a[60:63], v[40:43], v[128:131]
v_mfma_f32_16x16x32_bf16 v[148:151], a[60:63], v[44:47], v[148:151]
v_mfma_f32_16x16x32_bf16 v[132:135], a[64:67], v[40:43], v[132:135]
v_mfma_f32_16x16x32_bf16 v[152:155], a[64:67], v[44:47], v[152:155]
v_mfma_f32_16x16x32_bf16 v[136:139], a[68:71], v[40:43], v[136:139]
v_mfma_f32_16x16x32_bf16 v[156:159], a[68:71], v[44:47], v[156:159]
v_mfma_f32_16x16x32_bf16 v[140:143], a[72:75], v[40:43], v[140:143]
v_mfma_f32_16x16x32_bf16 v[160:163], a[72:75], v[44:47], v[160:163]
v_mfma_f32_16x16x32_bf16 v[144:147], a[76:79], v[40:43], v[144:147]
v_mfma_f32_16x16x32_bf16 v[164:167], a[76:79], v[44:47], v[164:167]
s_waitcnt vmcnt(21)
v_mfma_f32_16x16x32_bf16 v[128:131], a[80:83], v[48:51], v[128:131]
v_mfma_f32_16x16x32_bf16 v[148:151], a[80:83], v[52:55], v[148:151]
v_mfma_f32_16x16x32_bf16 v[132:135], a[84:87], v[48:51], v[132:135]
v_mfma_f32_16x16x32_bf16 v[152:155], a[84:87], v[52:55], v[152:155]
v_mfma_f32_16x16x32_bf16 v[136:139], a[88:91], v[48:51], v[136:139]
v_mfma_f32_16x16x32_bf16 v[156:159], a[88:91], v[52:55], v[156:159]
v_mfma_f32_16x16x32_bf16 v[140:143], a[92:95], v[48:51], v[140:143]
v_mfma_f32_16x16x32_bf16 v[160:163], a[92:95], v[52:55], v[160:163]
v_mfma_f32_16x16x32_bf16 v[144:147], a[96:99], v[48:51], v[144:147]
v_mfma_f32_16x16x32_bf16 v[164:167], a[96:99], v[52:55], v[164:167]
s_waitcnt vmcnt(19)
v_mfma_f32_16x16x32_bf16 v[128:131], a[100:103], v[56:59], v[128:131]
v_mfma_f32_16x16x32_bf16 v[148:151], a[100:103], v[60:63], v[148:151]
v_mfma_f32_16x16x32_bf16 v[132:135], a[104:107], v[56:59], v[132:135]
v_mfma_f32_16x16x32_bf16 v[152:155], a[104:107], v[60:63], v[152:155]
v_mfma_f32_16x16x32_bf16 v[136:139], a[108:111], v[56:59], v[136:139]
v_mfma_f32_16x16x32_bf16 v[156:159], a[108:111], v[60:63], v[156:159]
v_mfma_f32_16x16x32_bf16 v[140:143], a[112:115], v[56:59], v[140:143]
v_mfma_f32_16x16x32_bf16 v[160:163], a[112:115], v[60:63], v[160:163]
v_mfma_f32_16x16x32_bf16 v[144:147], a[116:119], v[56:59], v[144:147]
v_mfma_f32_16x16x32_bf16 v[164:167], a[116:119], v[60:63], v[164:167]
s_waitcnt vmcnt(17)
v_mfma_f32_16x16x32_bf16 v[128:131], a[120:123], v[64:67], v[128:131]
v_mfma_f32_16x16x32_bf16 v[148:151], a[120:123], v[68:71], v[148:151]
v_mfma_f32_16x16x32_bf16 v[132:135], a[124:127], v[64:67], v[132:135]
v_mfma_f32_16x16x32_bf16 v[152:155], a[124:127], v[68:71], v[152:155]
v_mfma_f32_16x16x32_bf16 v[136:139], a[128:131], v[64:67], v[136:139]
v_mfma_f32_16x16x32_bf16 v[156:159], a[128:131], v[68:71], v[156:159]
v_mfma_f32_16x16x32_bf16 v[140:143], a[132:135], v[64:67], v[140:143]
v_mfma_f32_16x16x32_bf16 v[160:163], a[132:135], v[68:71], v[160:163]
v_mfma_f32_16x16x32_bf16 v[144:147], a[136:139], v[64:67], v[144:147]
v_mfma_f32_16x16x32_bf16 v[164:167], a[136:139], v[68:71], v[164:167]
s_waitcnt vmcnt(15)
v_mfma_f32_16x16x32_bf16 v[128:131], a[140:143], v[72:75], v[128:131]
v_mfma_f32_16x16x32_bf16 v[148:151], a[140:143], v[76:79], v[148:151]
v_mfma_f32_16x16x32_bf16 v[132:135], a[144:147], v[72:75], v[132:135]
v_mfma_f32_16x16x32_bf16 v[152:155], a[144:147], v[76:79], v[152:155]
v_mfma_f32_16x16x32_bf16 v[136:139], a[148:151], v[72:75], v[136:139]
v_mfma_f32_16x16x32_bf16 v[156:159], a[148:151], v[76:79], v[156:159]
v_mfma_f32_16x16x32_bf16 v[140:143], a[152:155], v[72:75], v[140:143]
v_mfma_f32_16x16x32_bf16 v[160:163], a[152:155], v[76:79], v[160:163]
v_mfma_f32_16x16x32_bf16 v[144:147], a[156:159], v[72:75], v[144:147]
v_mfma_f32_16x16x32_bf16 v[164:167], a[156:159], v[76:79], v[164:167]
s_waitcnt vmcnt(13)
v_mfma_f32_16x16x32_bf16 v[128:131], a[160:163], v[80:83], v[128:131]
v_mfma_f32_16x16x32_bf16 v[148:151], a[160:163], v[84:87], v[148:151]
v_mfma_f32_16x16x32_bf16 v[132:135], a[164:167], v[80:83], v[132:135]
v_mfma_f32_16x16x32_bf16 v[152:155], a[164:167], v[84:87], v[152:155]
v_mfma_f32_16x16x32_bf16 v[136:139], a[168:171], v[80:83], v[136:139]
v_mfma_f32_16x16x32_bf16 v[156:159], a[168:171], v[84:87], v[156:159]
v_mfma_f32_16x16x32_bf16 v[140:143], a[172:175], v[80:83], v[140:143]
v_mfma_f32_16x16x32_bf16 v[160:163], a[172:175], v[84:87], v[160:163]
v_mfma_f32_16x16x32_bf16 v[144:147], a[176:179], v[80:83], v[144:147]
v_mfma_f32_16x16x32_bf16 v[164:167], a[176:179], v[84:87], v[164:167]
s_waitcnt vmcnt(11)
v_mfma_f32_16x16x32_bf16 v[128:131], a[180:183], v[88:91], v[128:131]
v_mfma_f32_16x16x32_bf16 v[148:151], a[180:183], v[92:95], v[148:151]
v_mfma_f32_16x16x32_bf16 v[132:135], a[184:187], v[88:91], v[132:135]
v_mfma_f32_16x16x32_bf16 v[152:155], a[184:187], v[92:95], v[152:155]
v_mfma_f32_16x16x32_bf16 v[136:139], a[188:191], v[88:91], v[136:139]
v_mfma_f32_16x16x32_bf16 v[156:159], a[188:191], v[92:95], v[156:159]
v_mfma_f32_16x16x32_bf16 v[140:143], a[192:195], v[88:91], v[140:143]
v_mfma_f32_16x16x32_bf16 v[160:163], a[192:195], v[92:95], v[160:163]
v_mfma_f32_16x16x32_bf16 v[144:147], a[196:199], v[88:91], v[144:147]
v_mfma_f32_16x16x32_bf16 v[164:167], a[196:199], v[92:95], v[164:167]
s_waitcnt vmcnt(9)
v_mfma_f32_16x16x32_bf16 v[128:131], a[200:203], v[96:99], v[128:131]
v_mfma_f32_16x16x32_bf16 v[148:151], a[200:203], v[100:103], v[148:151]
v_mfma_f32_16x16x32_bf16 v[132:135], a[204:207], v[96:99], v[132:135]
v_mfma_f32_16x16x32_bf16 v[152:155], a[204:207], v[100:103], v[152:155]
v_mfma_f32_16x16x32_bf16 v[136:139], a[208:211], v[96:99], v[136:139]
v_mfma_f32_16x16x32_bf16 v[156:159], a[208:211], v[100:103], v[156:159]
v_mfma_f32_16x16x32_bf16 v[140:143], a[212:215], v[96:99], v[140:143]
v_mfma_f32_16x16x32_bf16 v[160:163], a[212:215], v[100:103], v[160:163]
v_mfma_f32_16x16x32_bf16 v[144:147], a[216:219], v[96:99], v[144:147]
v_mfma_f32_16x16x32_bf16 v[164:167], a[216:219], v[100:103], v[164:167]
s_waitcnt vmcnt(7)
v_mfma_f32_16x16x32_bf16 v[128:131], a[220:223], v[104:107], v[128:131]
v_mfma_f32_16x16x32_bf16 v[148:151], a[220:223], v[108:111], v[148:151]
v_mfma_f32_16x16x32_bf16 v[132:135], a[224:227], v[104:107], v[132:135]
v_mfma_f32_16x16x32_bf16 v[152:155], a[224:227], v[108:111], v[152:155]
v_mfma_f32_16x16x32_bf16 v[136:139], a[228:231], v[104:107], v[136:139]
v_mfma_f32_16x16x32_bf16 v[156:159], a[228:231], v[108:111], v[156:159]
v_mfma_f32_16x16x32_bf16 v[140:143], a[232:235], v[104:107], v[140:143]
v_mfma_f32_16x16x32_bf16 v[160:163], a[232:235], v[108:111], v[160:163]
v_mfma_f32_16x16x32_bf16 v[144:147], a[236:239], v[104:107], v[144:147]
v_mfma_f32_16x16x32_bf16 v[164:167], a[236:239], v[108:111], v[164:167]
s_waitcnt vmcnt(5)
v_mfma_f32_16x16x32_bf16 v[128:131], a[240:243], v[112:115], v[128:131]
v_mfma_f32_16x16x32_bf16 v[148:151], a[240:243], v[116:119], v[148:151]
v_mfma_f32_16x16x32_bf16 v[132:135], a[244:247], v[112:115], v[132:135]
v_mfma_f32_16x16x32_bf16 v[152:155], a[244:247], v[116:119], v[152:155]
v_mfma_f32_16x16x32_bf16 v[136:139], a[248:251], v[112:115], v[136:139]
v_mfma_f32_16x16x32_bf16 v[156:159], a[248:251], v[116:119], v[156:159]
v_mfma_f32_16x16x32_bf16 v[140:143], a[252:255], v[112:115], v[140:143]
v_mfma_f32_16x16x32_bf16 v[160:163], a[252:255], v[116:119], v[160:163]
v_mfma_f32_16x16x32_bf16 v[144:147], v[192:195], v[112:115], v[144:147]
v_mfma_f32_16x16x32_bf16 v[164:167], v[192:195], v[116:119], v[164:167]
s_waitcnt vmcnt(3)
v_mfma_f32_16x16x32_bf16 v[128:131], v[196:199], v[120:123], v[128:131]
v_mfma_f32_16x16x32_bf16 v[148:151], v[196:199], v[124:127], v[148:151]
v_mfma_f32_16x16x32_bf16 v[132:135], v[200:203], v[120:123], v[132:135]
v_mfma_f32_16x16x32_bf16 v[152:155], v[200:203], v[124:127], v[152:155]
v_mfma_f32_16x16x32_bf16 v[136:139], v[204:207], v[120:123], v[136:139]
v_mfma_f32_16x16x32_bf16 v[156:159], v[204:207], v[124:127], v[156:159]
v_mfma_f32_16x16x32_bf16 v[140:143], v[208:211], v[120:123], v[140:143]
v_mfma_f32_16x16x32_bf16 v[160:163], v[208:211], v[124:127], v[160:163]
v_mfma_f32_16x16x32_bf16 v[144:147], v[212:215], v[120:123], v[144:147]
v_mfma_f32_16x16x32_bf16 v[164:167], v[212:215], v[124:127], v[164:167]
ds_write_b128 v4, v[128:131] offset:0
ds_write_b128 v4, v[148:151] offset:5120
ds_write_b128 v4, v[132:135] offset:1024
ds_write_b128 v4, v[152:155] offset:6144
ds_write_b128 v4, v[136:139] offset:2048
ds_write_b128 v4, v[156:159] offset:7168
ds_write_b128 v4, v[140:143] offset:3072
ds_write_b128 v4, v[160:163] offset:8192
ds_write_b128 v4, v[144:147] offset:4096
ds_write_b128 v4, v[164:167] offset:9216
s_waitcnt lgkmcnt(0)
s_barrier
v_add_u32 v9, 81920, v6
ds_read_b128 v[16:19], v6 offset:0
ds_read_b128 v[20:23], v6 offset:40960
ds_read_b128 v[24:27], v9 offset:0
ds_read_b128 v[28:31], v9 offset:40960
v_add_u32 v9, 81920, v7
ds_read_b128 v[32:35], v7 offset:0
ds_read_b128 v[36:39], v7 offset:40960
ds_read_b128 v[40:43], v9 offset:0
ds_read_b128 v[44:47], v9 offset:40960
v_add_u32 v9, 81920, v8
ds_read_b128 v[48:51], v8 offset:0
ds_read_b128 v[52:55], v8 offset:40960
ds_read_b128 v[56:59], v9 offset:0
ds_read_b128 v[60:63], v9 offset:40960
s_waitcnt vmcnt(0) lgkmcnt(0)
v_add_f32 v16, v16, v20
v_add_f32 v24, v24, v28
v_add_f32 v16, v16, v24
v_add_f32 v17, v17, v21
v_add_f32 v25, v25, v29
v_add_f32 v17, v17, v25
v_add_f32 v18, v18, v22
v_add_f32 v26, v26, v30
v_add_f32 v18, v18, v26
v_add_f32 v19, v19, v23
v_add_f32 v27, v27, v31
v_add_f32 v19, v19, v27
v_cvt_pk_bf16_f32 v14, v16, v17
v_lshlrev_b32 v16, 16, v14
v_and_b32 v17, 0xffff0000, v14
v_mul_f32 v16, v16, v176
v_mul_f32 v17, v17, v177
v_cvt_pk_bf16_f32 v14, v16, v17
v_lshlrev_b32 v16, 16, v14
v_and_b32 v17, 0xffff0000, v14
v_add_f32 v16, v16, v216
v_add_f32 v17, v17, v217
v_cvt_pk_bf16_f32 v20, v16, v17
v_cvt_pk_bf16_f32 v14, v18, v19
v_lshlrev_b32 v18, 16, v14
v_and_b32 v19, 0xffff0000, v14
v_mul_f32 v18, v18, v178
v_mul_f32 v19, v19, v179
v_cvt_pk_bf16_f32 v14, v18, v19
v_lshlrev_b32 v18, 16, v14
v_and_b32 v19, 0xffff0000, v14
v_add_f32 v18, v18, v218
v_add_f32 v19, v19, v219
v_cvt_pk_bf16_f32 v21, v18, v19
global_store_dwordx2 v172, v[20:21], s[20:21]
v_add_f32 v32, v32, v36
v_add_f32 v40, v40, v44
v_add_f32 v32, v32, v40
v_add_f32 v33, v33, v37
v_add_f32 v41, v41, v45
v_add_f32 v33, v33, v41
v_add_f32 v34, v34, v38
v_add_f32 v42, v42, v46
v_add_f32 v34, v34, v42
v_add_f32 v35, v35, v39
v_add_f32 v43, v43, v47
v_add_f32 v35, v35, v43
v_cvt_pk_bf16_f32 v14, v32, v33
v_lshlrev_b32 v32, 16, v14
v_and_b32 v33, 0xffff0000, v14
v_mul_f32 v32, v32, v180
v_mul_f32 v33, v33, v181
v_cvt_pk_bf16_f32 v14, v32, v33
v_lshlrev_b32 v32, 16, v14
v_and_b32 v33, 0xffff0000, v14
v_add_f32 v32, v32, v220
v_add_f32 v33, v33, v221
v_cvt_pk_bf16_f32 v36, v32, v33
v_cvt_pk_bf16_f32 v14, v34, v35
v_lshlrev_b32 v34, 16, v14
v_and_b32 v35, 0xffff0000, v14
v_mul_f32 v34, v34, v182
v_mul_f32 v35, v35, v183
v_cvt_pk_bf16_f32 v14, v34, v35
v_lshlrev_b32 v34, 16, v14
v_and_b32 v35, 0xffff0000, v14
v_add_f32 v34, v34, v222
v_add_f32 v35, v35, v223
v_cvt_pk_bf16_f32 v37, v34, v35
global_store_dwordx2 v173, v[36:37], s[20:21]
v_add_f32 v48, v48, v52
v_add_f32 v56, v56, v60
v_add_f32 v48, v48, v56
v_add_f32 v49, v49, v53
v_add_f32 v57, v57, v61
v_add_f32 v49, v49, v57
v_add_f32 v50, v50, v54
v_add_f32 v58, v58, v62
v_add_f32 v50, v50, v58
v_add_f32 v51, v51, v55
v_add_f32 v59, v59, v63
v_add_f32 v51, v51, v59
v_cvt_pk_bf16_f32 v14, v48, v49
v_lshlrev_b32 v48, 16, v14
v_and_b32 v49, 0xffff0000, v14
v_mul_f32 v48, v48, v184
v_mul_f32 v49, v49, v185
v_cvt_pk_bf16_f32 v14, v48, v49
v_lshlrev_b32 v48, 16, v14
v_and_b32 v49, 0xffff0000, v14
v_add_f32 v48, v48, v224
v_add_f32 v49, v49, v225
v_cvt_pk_bf16_f32 v52, v48, v49
v_cvt_pk_bf16_f32 v14, v50, v51
v_lshlrev_b32 v50, 16, v14
v_and_b32 v51, 0xffff0000, v14
v_mul_f32 v50, v50, v186
v_mul_f32 v51, v51, v187
v_cvt_pk_bf16_f32 v14, v50, v51
v_lshlrev_b32 v50, 16, v14
v_and_b32 v51, 0xffff0000, v14
v_add_f32 v50, v50, v226
v_add_f32 v51, v51, v227
v_cvt_pk_bf16_f32 v53, v50, v51
global_store_dwordx2 v174, v[52:53], s[20:21]
s_barrier
s_add_u32 s42, s42, 3
s_cmp_lt_u32 s42, 64
s_cbranch_scc1 L_f2_loop
s_waitcnt vmcnt(0)
s_endpgm
L_st_f1:
s_load_dwordx2 s[4:5], s[0:1], 64
v_and_b32 v1, 63, v0
s_mul_i32 s2, s40, 37
s_lshr_b32 s2, s2, 8
s_mul_i32 s3, s2, 7
s_sub_u32 s44, s40, s3
s_lshl_b32 s17, s44, 2
s_add_u32 s17, s17, s12
s_min_u32 s41, s17, 26
s_lshl_b32 s3, s41, 7
s_waitcnt lgkmcnt(0)
s_add_u32 s6, s4, s3
s_addc_u32 s7, s5, 0
v_lshrrev_b32 v2, 3, v1
v_bfe_u32 v3, v1, 1, 2
v_bfe_u32 v4, v1, 4, 2
v_xor_b32 v3, v3, v4
v_mul_u32_u24 v2, 3456, v2
v_lshl_add_u32 v2, v3, 5, v2
v_and_b32 v3, 1, v1
v_lshl_add_u32 v2, v3, 4, v2
s_mul_i32 s20, s12, 20480
s_add_u32 s20, s20, 81920
v_lshrrev_b32 v3, 2, v1
v_bfe_u32 v8, v1, 3, 2
v_and_b32 v9, 3, v1
v_lshlrev_b32 v9, 3, v9
v_lshl_add_u32 v9, v3, 7, v9
v_add_u32 v9, s20, v9
v_xor_b32 v3, 0, v8
v_lshl_add_u32 v4, v3, 5, v9
v_xor_b32 v3, 1, v8
v_lshl_add_u32 v5, v3, 5, v9
v_xor_b32 v3, 2, v8
v_lshl_add_u32 v6, v3, 5, v9
v_xor_b32 v3, 3, v8
v_lshl_add_u32 v7, v3, 5, v9
s_add_u32 m0, s20, 0
s_nop 0
global_load_lds_dwordx4 v2, s[6:7]
s_add_u32 s6, s6, 27648
s_addc_u32 s7, s7, 0
s_add_u32 m0, s20, 1024
s_nop 0
global_load_lds_dwordx4 v2, s[6:7]
s_add_u32 s6, s6, 27648
s_addc_u32 s7, s7, 0
s_add_u32 m0, s20, 2048
s_nop 0
global_load_lds_dwordx4 v2, s[6:7]
s_add_u32 s6, s6, 27648
s_addc_u32 s7, s7, 0
s_add_u32 m0, s20, 3072
s_nop 0
global_load_lds_dwordx4 v2, s[6:7]
s_add_u32 s6, s6, 27648
s_addc_u32 s7, s7, 0
s_add_u32 m0, s20, 4096
s_nop 0
global_load_lds_dwordx4 v2, s[6:7]
s_add_u32 s6, s6, 27648
s_addc_u32 s7, s7, 0
s_add_u32 m0, s20, 5120
s_nop 0
global_load_lds_dwordx4 v2, s[6:7]
s_add_u32 s6, s6, 27648
s_addc_u32 s7, s7, 0
s_add_u32 m0, s20, 6144
s_nop 0
global_load_lds_dwordx4 v2, s[6:7]
s_add_u32 s6, s6, 27648
s_addc_u32 s7, s7, 0
s_add_u32 m0, s20, 7168
s_nop 0
global_load_lds_dwordx4 v2, s[6:7]
s_add_u32 s6, s6, 27648
s_addc_u32 s7, s7, 0
s_add_u32 m0, s20, 8192
s_nop 0
global_load_lds_dwordx4 v2, s[6:7]
s_add_u32 s6, s6, 27648
s_addc_u32 s7, s7, 0
s_add_u32 m0, s20, 9216
s_nop 0
global_load_lds_dwordx4 v2, s[6:7]
s_add_u32 s6, s6, 27648
s_addc_u32 s7, s7, 0
s_add_u32 m0, s20, 10240
s_nop 0
global_load_lds_dwordx4 v2, s[6:7]
s_add_u32 s6, s6, 27648
s_addc_u32 s7, s7, 0
s_add_u32 m0, s20, 11264
s_nop 0
global_load_lds_dwordx4 v2, s[6:7]
s_add_u32 s6, s6, 27648
s_addc_u32 s7, s7, 0
s_add_u32 m0, s20, 12288
s_nop 0
global_load_lds_dwordx4 v2, s[6:7]
s_add_u32 s6, s6, 27648
s_addc_u32 s7, s7, 0
s_add_u32 m0, s20, 13312
s_nop 0
global_load_lds_dwordx4 v2, s[6:7]
s_add_u32 s6, s6, 27648
s_addc_u32 s7, s7, 0
s_add_u32 m0, s20, 14336
s_nop 0
global_load_lds_dwordx4 v2, s[6:7]
s_add_u32 s6, s6, 27648
s_addc_u32 s7, s7, 0
s_add_u32 m0, s20, 15360
s_nop 0
global_load_lds_dwordx4 v2, s[6:7]
s_add_u32 s6, s6, 27648
s_addc_u32 s7, s7, 0
s_add_u32 m0, s20, 16384
s_nop 0
global_load_lds_dwordx4 v2, s[6:7]
s_add_u32 s6, s6, 27648
s_addc_u32 s7, s7, 0
s_add_u32 m0, s20, 17408
s_nop 0
global_load_lds_dwordx4 v2, s[6:7]
s_add_u32 s6, s6, 27648
s_addc_u32 s7, s7, 0
s_add_u32 m0, s20, 18432
s_nop 0
global_load_lds_dwordx4 v2, s[6:7]
s_add_u32 s6, s6, 27648
s_addc_u32 s7, s7, 0
s_add_u32 m0, s20, 19456
s_nop 0
global_load_lds_dwordx4 v2, s[6:7]
s_add_u32 s6, s6, 27648
s_addc_u32 s7, s7, 0
s_waitcnt vmcnt(16)
ds_read_b64_tr_b16 a[0:1], v4 offset:0
ds_read_b64_tr_b16 a[2:3], v4 offset:2048
ds_read_b64_tr_b16 a[80:81], v5 offset:0
ds_read_b64_tr_b16 a[82:83], v5 offset:2048
ds_read_b64_tr_b16 a[160:161], v6 offset:0
ds_read_b64_tr_b16 a[162:163], v6 offset:2048
ds_read_b64_tr_b16 a[240:241], v7 offset:0
ds_read_b64_tr_b16 a[242:243], v7 offset:2048
s_waitcnt vmcnt(12)
ds_read_b64_tr_b16 a[4:5], v4 offset:4096
ds_read_b64_tr_b16 a[6:7], v4 offset:6144
ds_read_b64_tr_b16 a[84:85], v5 offset:4096
ds_read_b64_tr_b16 a[86:87], v5 offset:6144
ds_read_b64_tr_b16 a[164:165], v6 offset:4096
ds_read_b64_tr_b16 a[166:167], v6 offset:6144
ds_read_b64_tr_b16 a[244:245], v7 offset:4096
ds_read_b64_tr_b16 a[246:247], v7 offset:6144
s_waitcnt lgkmcnt(8)
s_add_u32 m0, s20, 0
s_nop 0
global_load_lds_dwordx4 v2, s[6:7]
s_add_u32 s6, s6, 27648
s_addc_u32 s7, s7, 0
s_add_u32 m0, s20, 1024
s_nop 0
global_load_lds_dwordx4 v2, s[6:7]
s_add_u32 s6, s6, 27648
s_addc_u32 s7, s7, 0
s_add_u32 m0, s20, 2048
s_nop 0
global_load_lds_dwordx4 v2, s[6:7]
s_add_u32 s6, s6, 27648
s_addc_u32 s7, s7, 0
s_add_u32 m0, s20, 3072
s_nop 0
global_load_lds_dwordx4 v2, s[6:7]
s_add_u32 s6, s6, 27648
s_addc_u32 s7, s7, 0
s_waitcnt vmcnt(12)
ds_read_b64_tr_b16 a[8:9], v4 offset:8192
ds_read_b64_tr_b16 a[10:11], v4 offset:10240
ds_read_b64_tr_b16 a[88:89], v5 offset:8192
ds_read_b64_tr_b16 a[90:91], v5 offset:10240
ds_read_b64_tr_b16 a[168:169], v6 offset:8192
ds_read_b64_tr_b16 a[170:171], v6 offset:10240
ds_read_b64_tr_b16 a[248:249], v7 offset:8192
ds_read_b64_tr_b16 a[250:251], v7 offset:10240
s_waitcnt lgkmcnt(8)
s_add_u32 m0, s20, 4096
s_nop 0
global_load_lds_dwordx4 v2, s[6:7]
s_add_u32 s6, s6, 27648
s_addc_u32 s7, s7, 0
s_add_u32 m0, s20, 5120
s_nop 0
global_load_lds_dwordx4 v2, s[6:7]
s_add_u32 s6, s6, 27648
s_addc_u32 s7, s7, 0
s_add_u32 m0, s20, 6144
s_nop 0
global_load_lds_dwordx4 v2, s[6:7]
s_add_u32 s6, s6, 27648
s_addc_u32 s7, s7, 0
s_add_u32 m0, s20, 7168
s_nop 0
global_load_lds_dwordx4 v2, s[6:7]
s_add_u32 s6, s6, 27648
s_addc_u32 s7, s7, 0
s_waitcnt vmcnt(12)
ds_read_b64_tr_b16 a[12:13], v4 offset:12288
ds_read_b64_tr_b16 a[14:15], v4 offset:14336
ds_read_b64_tr_b16 a[92:93], v5 offset:12288
ds_read_b64_tr_b16 a[94:95], v5 offset:14336
ds_read_b64_tr_b16 a[172:173], v6 offset:12288
ds_read_b64_tr_b16 a[174:175], v6 offset:14336
ds_read_b64_tr_b16 a[252:253], v7 offset:12288
ds_read_b64_tr_b16 a[254:255], v7 offset:14336
s_waitcnt lgkmcnt(8)
s_add_u32 m0, s20, 8192
s_nop 0
global_load_lds_dwordx4 v2, s[6:7]
s_add_u32 s6, s6, 27648
s_addc_u32 s7, s7, 0
s_add_u32 m0, s20, 9216
s_nop 0
global_load_lds_dwordx4 v2, s[6:7]
s_add_u32 s6, s6, 27648
s_addc_u32 s7, s7, 0
s_add_u32 m0, s20, 10240
s_nop 0
global_load_lds_dwordx4 v2, s[6:7]
s_add_u32 s6, s6, 27648
s_addc_u32 s7, s7, 0
s_add_u32 m0, s20, 11264
s_nop 0
global_load_lds_dwordx4 v2, s[6:7]
s_add_u32 s6, s6, 27648
s_addc_u32 s7, s7, 0
s_waitcnt vmcnt(12)
ds_read_b64_tr_b16 a[16:17], v4 offset:16384
ds_read_b64_tr_b16 a[18:19], v4 offset:18432
ds_read_b64_tr_b16 a[96:97], v5 offset:16384
ds_read_b64_tr_b16 a[98:99], v5 offset:18432
ds_read_b64_tr_b16 a[176:177], v6 offset:16384
ds_read_b64_tr_b16 a[178:179], v6 offset:18432
ds_read_b64_tr_b16 v[192:193], v7 offset:16384
ds_read_b64_tr_b16 v[194:195], v7 offset:18432
s_waitcnt lgkmcnt(8)
s_add_u32 m0, s20, 12288
s_nop 0
global_load_lds_dwordx4 v2, s[6:7]
s_add_u32 s6, s6, 27648
s_addc_u32 s7, s7, 0
s_add_u32 m0, s20, 13312
s_nop 0
global_load_lds_dwordx4 v2, s[6:7]
s_add_u32 s6, s6, 27648
s_addc_u32 s7, s7, 0
s_add_u32 m0, s20, 14336
s_nop 0
global_load_lds_dwordx4 v2, s[6:7]
s_add_u32 s6, s6, 27648
s_addc_u32 s7, s7, 0
s_add_u32 m0, s20, 15360
s_nop 0
global_load_lds_dwordx4 v2, s[6:7]
s_add_u32 s6, s6, 27648
s_addc_u32 s7, s7, 0
s_waitcnt vmcnt(12)
ds_read_b64_tr_b16 a[20:21], v4 offset:0
ds_read_b64_tr_b16 a[22:23], v4 offset:2048
ds_read_b64_tr_b16 a[100:101], v5 offset:0
ds_read_b64_tr_b16 a[102:103], v5 offset:2048
ds_read_b64_tr_b16 a[180:181], v6 offset:0
ds_read_b64_tr_b16 a[182:183], v6 offset:2048
ds_read_b64_tr_b16 v[196:197], v7 offset:0
ds_read_b64_tr_b16 v[198:199], v7 offset:2048
s_waitcnt lgkmcnt(8)
s_add_u32 m0, s20, 16384
s_nop 0
global_load_lds_dwordx4 v2, s[6:7]
s_add_u32 s6, s6, 27648
s_addc_u32 s7, s7, 0
s_add_u32 m0, s20, 17408
s_nop 0
global_load_lds_dwordx4 v2, s[6:7]
s_add_u32 s6, s6, 27648
s_addc_u32 s7, s7, 0
s_add_u32 m0, s20, 18432
s_nop 0
global_load_lds_dwordx4 v2, s[6:7]
s_add_u32 s6, s6, 27648
s_addc_u32 s7, s7, 0
s_add_u32 m0, s20, 19456
s_nop 0
global_load_lds_dwordx4 v2, s[6:7]
s_add_u32 s6, s6, 27648
s_addc_u32 s7, s7, 0
s_waitcnt vmcnt(12)
ds_read_b64_tr_b16 a[24:25], v4 offset:4096
ds_read_b64_tr_b16 a[26:27], v4 offset:6144
ds_read_b64_tr_b16 a[104:105], v5 offset:4096
ds_read_b64_tr_b16 a[106:107], v5 offset:6144
ds_read_b64_tr_b16 a[184:185], v6 offset:4096
ds_read_b64_tr_b16 a[186:187], v6 offset:6144
ds_read_b64_tr_b16 v[200:201], v7 offset:4096
ds_read_b64_tr_b16 v[202:203], v7 offset:6144
s_waitcnt lgkmcnt(8)
s_add_u32 m0, s20, 0
s_nop 0
global_load_lds_dwordx4 v2, s[6:7]
s_add_u32 s6, s6, 27648
s_addc_u32 s7, s7, 0
s_add_u32 m0, s20, 1024
s_nop 0
global_load_lds_dwordx4 v2, s[6:7]
s_add_u32 s6, s6, 27648
s_addc_u32 s7, s7, 0
s_add_u32 m0, s20, 2048
s_nop 0
global_load_lds_dwordx4 v2, s[6:7]
s_add_u32 s6, s6, 27648
s_addc_u32 s7, s7, 0
s_add_u32 m0, s20, 3072
s_nop 0
global_load_lds_dwordx4 v2, s[6:7]
s_add_u32 s6, s6, 27648
s_addc_u32 s7, s7, 0
s_waitcnt vmcnt(12)
ds_read_b64_tr_b16 a[28:29], v4 offset:8192
ds_read_b64_tr_b16 a[30:31], v4 offset:10240
ds_read_b64_tr_b16 a[108:109], v5 offset:8192
ds_read_b64_tr_b16 a[110:111], v5 offset:10240
ds_read_b64_tr_b16 a[188:189], v6 offset:8192
ds_read_b64_tr_b16 a[190:191], v6 offset:10240
ds_read_b64_tr_b16 v[204:205], v7 offset:8192
ds_read_b64_tr_b16 v[206:207], v7 offset:10240
s_waitcnt lgkmcnt(8)
s_add_u32 m0, s20, 4096
s_nop 0
global_load_lds_dwordx4 v2, s[6:7]
s_add_u32 s6, s6, 27648
s_addc_u32 s7, s7, 0
s_add_u32 m0, s20, 5120
s_nop 0
global_load_lds_dwordx4 v2, s[6:7]
s_add_u32 s6, s6, 27648
s_addc_u32 s7, s7, 0
s_add_u32 m0, s20, 6144
s_nop 0
global_load_lds_dwordx4 v2, s[6:7]
s_add_u32 s6, s6, 27648
s_addc_u32 s7, s7, 0
s_add_u32 m0, s20, 7168
s_nop 0
global_load_lds_dwordx4 v2, s[6:7]
s_add_u32 s6, s6, 27648
s_addc_u32 s7, s7, 0
s_waitcnt vmcnt(12)
ds_read_b64_tr_b16 a[32:33], v4 offset:12288
ds_read_b64_tr_b16 a[34:35], v4 offset:14336
ds_read_b64_tr_b16 a[112:113], v5 offset:12288
ds_read_b64_tr_b16 a[114:115], v5 offset:14336
ds_read_b64_tr_b16 a[192:193], v6 offset:12288
ds_read_b64_tr_b16 a[194:195], v6 offset:14336
ds_read_b64_tr_b16 v[208:209], v7 offset:12288
ds_read_b64_tr_b16 v[210:211], v7 offset:14336
s_waitcnt lgkmcnt(8)
s_add_u32 m0, s20, 8192
s_nop 0
global_load_lds_dwordx4 v2, s[6:7]
s_add_u32 s6, s6, 27648
s_addc_u32 s7, s7, 0
s_add_u32 m0, s20, 9216
s_nop 0
global_load_lds_dwordx4 v2, s[6:7]
s_add_u32 s6, s6, 27648
s_addc_u32 s7, s7, 0
s_add_u32 m0, s20, 10240
s_nop 0
global_load_lds_dwordx4 v2, s[6:7]
s_add_u32 s6, s6, 27648
s_addc_u32 s7, s7, 0
s_add_u32 m0, s20, 11264
s_nop 0
global_load_lds_dwordx4 v2, s[6:7]
s_add_u32 s6, s6, 27648
s_addc_u32 s7, s7, 0
s_waitcnt vmcnt(12)
ds_read_b64_tr_b16 a[36:37], v4 offset:16384
ds_read_b64_tr_b16 a[38:39], v4 offset:18432
ds_read_b64_tr_b16 a[116:117], v5 offset:16384
ds_read_b64_tr_b16 a[118:119], v5 offset:18432
ds_read_b64_tr_b16 a[196:197], v6 offset:16384
ds_read_b64_tr_b16 a[198:199], v6 offset:18432
ds_read_b64_tr_b16 v[212:213], v7 offset:16384
ds_read_b64_tr_b16 v[214:215], v7 offset:18432
s_waitcnt lgkmcnt(8)
s_add_u32 m0, s20, 12288
s_nop 0
global_load_lds_dwordx4 v2, s[6:7]
s_add_u32 s6, s6, 27648
s_addc_u32 s7, s7, 0
s_add_u32 m0, s20, 13312
s_nop 0
global_load_lds_dwordx4 v2, s[6:7]
s_add_u32 s6, s6, 27648
s_addc_u32 s7, s7, 0
s_add_u32 m0, s20, 14336
s_nop 0
global_load_lds_dwordx4 v2, s[6:7]
s_add_u32 s6, s6, 27648
s_addc_u32 s7, s7, 0
s_add_u32 m0, s20, 15360
s_nop 0
global_load_lds_dwordx4 v2, s[6:7]
s_add_u32 s6, s6, 27648
s_addc_u32 s7, s7, 0
s_waitcnt vmcnt(12)
ds_read_b64_tr_b16 a[40:41], v4 offset:0
ds_read_b64_tr_b16 a[42:43], v4 offset:2048
ds_read_b64_tr_b16 a[120:121], v5 offset:0
ds_read_b64_tr_b16 a[122:123], v5 offset:2048
ds_read_b64_tr_b16 a[200:201], v6 offset:0
ds_read_b64_tr_b16 a[202:203], v6 offset:2048
ds_read_b64_tr_b16 v[216:217], v7 offset:0
ds_read_b64_tr_b16 v[218:219], v7 offset:2048
s_waitcnt lgkmcnt(8)
s_add_u32 m0, s20, 16384
s_nop 0
global_load_lds_dwordx4 v2, s[6:7]
s_add_u32 s6, s6, 27648
s_addc_u32 s7, s7, 0
s_add_u32 m0, s20, 17408
s_nop 0
global_load_lds_dwordx4 v2, s[6:7]
s_add_u32 s6, s6, 27648
s_addc_u32 s7, s7, 0
s_add_u32 m0, s20, 18432
s_nop 0
global_load_lds_dwordx4 v2, s[6:7]
s_add_u32 s6, s6, 27648
s_addc_u32 s7, s7, 0
s_add_u32 m0, s20, 19456
s_nop 0
global_load_lds_dwordx4 v2, s[6:7]
s_add_u32 s6, s6, 27648
s_addc_u32 s7, s7, 0
s_waitcnt vmcnt(12)
ds_read_b64_tr_b16 a[44:45], v4 offset:4096
ds_read_b64_tr_b16 a[46:47], v4 offset:6144
ds_read_b64_tr_b16 a[124:125], v5 offset:4096
ds_read_b64_tr_b16 a[126:127], v5 offset:6144
ds_read_b64_tr_b16 a[204:205], v6 offset:4096
ds_read_b64_tr_b16 a[206:207], v6 offset:6144
ds_read_b64_tr_b16 v[220:221], v7 offset:4096
ds_read_b64_tr_b16 v[222:223], v7 offset:6144
s_waitcnt lgkmcnt(8)
s_add_u32 m0, s20, 0
s_nop 0
global_load_lds_dwordx4 v2, s[6:7]
s_add_u32 s6, s6, 27648
s_addc_u32 s7, s7, 0
s_add_u32 m0, s20, 1024
s_nop 0
global_load_lds_dwordx4 v2, s[6:7]
s_add_u32 s6, s6, 27648
s_addc_u32 s7, s7, 0
s_add_u32 m0, s20, 2048
s_nop 0
global_load_lds_dwordx4 v2, s[6:7]
s_add_u32 s6, s6, 27648
s_addc_u32 s7, s7, 0
s_add_u32 m0, s20, 3072
s_nop 0
global_load_lds_dwordx4 v2, s[6:7]
s_add_u32 s6, s6, 27648
s_addc_u32 s7, s7, 0
s_waitcnt vmcnt(12)
ds_read_b64_tr_b16 a[48:49], v4 offset:8192
ds_read_b64_tr_b16 a[50:51], v4 offset:10240
ds_read_b64_tr_b16 a[128:129], v5 offset:8192
ds_read_b64_tr_b16 a[130:131], v5 offset:10240
ds_read_b64_tr_b16 a[208:209], v6 offset:8192
ds_read_b64_tr_b16 a[210:211], v6 offset:10240
ds_read_b64_tr_b16 v[224:225], v7 offset:8192
ds_read_b64_tr_b16 v[226:227], v7 offset:10240
s_waitcnt lgkmcnt(8)
s_add_u32 m0, s20, 4096
s_nop 0
global_load_lds_dwordx4 v2, s[6:7]
s_add_u32 s6, s6, 27648
s_addc_u32 s7, s7, 0
s_add_u32 m0, s20, 5120
s_nop 0
global_load_lds_dwordx4 v2, s[6:7]
s_add_u32 s6, s6, 27648
s_addc_u32 s7, s7, 0
s_add_u32 m0, s20, 6144
s_nop 0
global_load_lds_dwordx4 v2, s[6:7]
s_add_u32 s6, s6, 27648
s_addc_u32 s7, s7, 0
s_add_u32 m0, s20, 7168
s_nop 0
global_load_lds_dwordx4 v2, s[6:7]
s_add_u32 s6, s6, 27648
s_addc_u32 s7, s7, 0
s_waitcnt vmcnt(12)
ds_read_b64_tr_b16 a[52:53], v4 offset:12288
ds_read_b64_tr_b16 a[54:55], v4 offset:14336
ds_read_b64_tr_b16 a[132:133], v5 offset:12288
ds_read_b64_tr_b16 a[134:135], v5 offset:14336
ds_read_b64_tr_b16 a[212:213], v6 offset:12288
ds_read_b64_tr_b16 a[214:215], v6 offset:14336
ds_read_b64_tr_b16 v[228:229], v7 offset:12288
ds_read_b64_tr_b16 v[230:231], v7 offset:14336
s_waitcnt lgkmcnt(8)
s_add_u32 m0, s20, 8192
s_nop 0
global_load_lds_dwordx4 v2, s[6:7]
s_add_u32 s6, s6, 27648
s_addc_u32 s7, s7, 0
s_add_u32 m0, s20, 9216
s_nop 0
global_load_lds_dwordx4 v2, s[6:7]
s_add_u32 s6, s6, 27648
s_addc_u32 s7, s7, 0
s_add_u32 m0, s20, 10240
s_nop 0
global_load_lds_dwordx4 v2, s[6:7]
s_add_u32 s6, s6, 27648
s_addc_u32 s7, s7, 0
s_add_u32 m0, s20, 11264
s_nop 0
global_load_lds_dwordx4 v2, s[6:7]
s_add_u32 s6, s6, 27648
s_addc_u32 s7, s7, 0
s_waitcnt vmcnt(12)
ds_read_b64_tr_b16 a[56:57], v4 offset:16384
ds_read_b64_tr_b16 a[58:59], v4 offset:18432
ds_read_b64_tr_b16 a[136:137], v5 offset:16384
ds_read_b64_tr_b16 a[138:139], v5 offset:18432
ds_read_b64_tr_b16 a[216:217], v6 offset:16384
ds_read_b64_tr_b16 a[218:219], v6 offset:18432
ds_read_b64_tr_b16 v[232:233], v7 offset:16384
ds_read_b64_tr_b16 v[234:235], v7 offset:18432
s_waitcnt lgkmcnt(8)
s_add_u32 m0, s20, 12288
s_nop 0
global_load_lds_dwordx4 v2, s[6:7]
s_add_u32 s6, s6, 27648
s_addc_u32 s7, s7, 0
s_add_u32 m0, s20, 13312
s_nop 0
global_load_lds_dwordx4 v2, s[6:7]
s_add_u32 s6, s6, 27648
s_addc_u32 s7, s7, 0
s_add_u32 m0, s20, 14336
s_nop 0
global_load_lds_dwordx4 v2, s[6:7]
s_add_u32 s6, s6, 27648
s_addc_u32 s7, s7, 0
s_add_u32 m0, s20, 15360
s_nop 0
global_load_lds_dwordx4 v2, s[6:7]
s_add_u32 s6, s6, 27648
s_addc_u32 s7, s7, 0
s_waitcnt vmcnt(12)
ds_read_b64_tr_b16 a[60:61], v4 offset:0
ds_read_b64_tr_b16 a[62:63], v4 offset:2048
ds_read_b64_tr_b16 a[140:141], v5 offset:0
ds_read_b64_tr_b16 a[142:143], v5 offset:2048
ds_read_b64_tr_b16 a[220:221], v6 offset:0
ds_read_b64_tr_b16 a[222:223], v6 offset:2048
ds_read_b64_tr_b16 v[236:237], v7 offset:0
ds_read_b64_tr_b16 v[238:239], v7 offset:2048
s_waitcnt lgkmcnt(8)
s_add_u32 m0, s20, 16384
s_nop 0
global_load_lds_dwordx4 v2, s[6:7]
s_add_u32 s6, s6, 27648
s_addc_u32 s7, s7, 0
s_add_u32 m0, s20, 17408
s_nop 0
global_load_lds_dwordx4 v2, s[6:7]
s_add_u32 s6, s6, 27648
s_addc_u32 s7, s7, 0
s_add_u32 m0, s20, 18432
s_nop 0
global_load_lds_dwordx4 v2, s[6:7]
s_add_u32 s6, s6, 27648
s_addc_u32 s7, s7, 0
s_add_u32 m0, s20, 19456
s_nop 0
global_load_lds_dwordx4 v2, s[6:7]
s_add_u32 s6, s6, 27648
s_addc_u32 s7, s7, 0
s_waitcnt vmcnt(12)
ds_read_b64_tr_b16 a[64:65], v4 offset:4096
ds_read_b64_tr_b16 a[66:67], v4 offset:6144
ds_read_b64_tr_b16 a[144:145], v5 offset:4096
ds_read_b64_tr_b16 a[146:147], v5 offset:6144
ds_read_b64_tr_b16 a[224:225], v6 offset:4096
ds_read_b64_tr_b16 a[226:227], v6 offset:6144
ds_read_b64_tr_b16 v[240:241], v7 offset:4096
ds_read_b64_tr_b16 v[242:243], v7 offset:6144
s_waitcnt vmcnt(8)
ds_read_b64_tr_b16 a[68:69], v4 offset:8192
ds_read_b64_tr_b16 a[70:71], v4 offset:10240
ds_read_b64_tr_b16 a[148:149], v5 offset:8192
ds_read_b64_tr_b16 a[150:151], v5 offset:10240
ds_read_b64_tr_b16 a[228:229], v6 offset:8192
ds_read_b64_tr_b16 a[230:231], v6 offset:10240
ds_read_b64_tr_b16 v[244:245], v7 offset:8192
ds_read_b64_tr_b16 v[246:247], v7 offset:10240
s_waitcnt vmcnt(4)
ds_read_b64_tr_b16 a[72:73], v4 offset:12288
ds_read_b64_tr_b16 a[74:75], v4 offset:14336
ds_read_b64_tr_b16 a[152:153], v5 offset:12288
ds_read_b64_tr_b16 a[154:155], v5 offset:14336
ds_read_b64_tr_b16 a[232:233], v6 offset:12288
ds_read_b64_tr_b16 a[234:235], v6 offset:14336
ds_read_b64_tr_b16 v[248:249], v7 offset:12288
ds_read_b64_tr_b16 v[250:251], v7 offset:14336
s_waitcnt vmcnt(0)
ds_read_b64_tr_b16 a[76:77], v4 offset:16384
ds_read_b64_tr_b16 a[78:79], v4 offset:18432
ds_read_b64_tr_b16 a[156:157], v5 offset:16384
ds_read_b64_tr_b16 a[158:159], v5 offset:18432
ds_read_b64_tr_b16 a[236:237], v6 offset:16384
ds_read_b64_tr_b16 a[238:239], v6 offset:18432
ds_read_b64_tr_b16 v[252:253], v7 offset:16384
ds_read_b64_tr_b16 v[254:255], v7 offset:18432
s_waitcnt lgkmcnt(0)
v_mov_b32 v2, 144
s_cmp_lg_u32 s12, 0
s_cbranch_scc1 L_wd_66
s_mov_b32 s96, 0x80000
L_wf_65:
global_load_dword v3, v2, s[94:95] sc1
s_waitcnt vmcnt(0)
v_cmp_gt_u32 vcc, 1, v3
s_nop 0
s_cbranch_vccz L_wd_66
s_sleep 3
s_sub_u32 s96, s96, 1
s_cbranch_scc0 L_wf_65
s_branch L_wabort
L_wd_66:
s_barrier
v_lshlrev_b32 v10, 4, v0
s_lshl_b32 s3, s12, 10
s_add_u32 m0, s3, 32768
s_add_u32 s14, s8, 62919680
s_addc_u32 s15, s9, 0
global_load_lds_dwordx4 v10, s[14:15] sc1
s_add_u32 m0, s3, 36864
s_add_u32 s14, s14, 4096
s_addc_u32 s15, s15, 0
global_load_lds_dwordx4 v10, s[14:15] sc1
s_load_dwordx2 s[4:5], s[0:1], 0
v_and_b32 v1, 63, v0
v_lshrrev_b32 v2, 4, v1
v_and_b32 v3, 15, v1
v_lshlrev_b32 v6, 4, v1
s_lshl_b32 s3, s12, 6
v_lshlrev_b32 v7, 2, v3
v_add_u32 v4, s3, v7
s_mul_i32 s29, s12, 5120
v_add_u32 v30, s29, v6
s_mul_i32 s3, s12, 640
v_lshlrev_b32 v31, 4, v2
v_add_u32 v31, s3, v31
s_waitcnt vmcnt(0) lgkmcnt(0)
s_barrier
s_mov_b32 s36, 0xbfb8aa3b
L_f1_loop:
s_lshr_b32 s43, s2, 1
s_mul_i32 s43, s43, 10240
s_add_u32 s43, s43, 73400320
s_mul_i32 s3, s2, 55296
s_lshl_b32 s13, s41, 11
s_add_u32 s3, s3, s13
s_add_u32 s3, s3, 138412032
s_add_u32 s26, s8, s3
s_addc_u32 s27, s9, 0
s_cmp_ge_u32 s2, 104
s_cbranch_scc1 L_f1_fused
s_and_b32 s3, s2, 1
s_lshl_b32 s3, s3, 7
s_add_u32 s3, s3, s43
s_add_u32 s3, s3, 9984
v_mov_b32 v9, s3
s_mul_i32 s3, s2, 20480
s_add_u32 s3, s3, 134217728
s_add_u32 s30, s8, s3
s_addc_u32 s31, s9, 0
v_add_u32 v5, 4096, v30
s_mov_b32 s96, 0x80000
L_wf_67:
global_load_dword v8, v9, s[8:9] sc1
s_waitcnt vmcnt(0)
v_cmp_gt_u32 vcc, 1, v8
s_nop 0
s_cbranch_vccz L_wd_68
s_sleep 1
s_sub_u32 s96, s96, 1
s_cbranch_scc0 L_wf_67
s_branch L_wabort
L_wd_68:
s_mov_b32 m0, s29
s_nop 0
global_load_lds_dwordx4 v30, s[30:31] offset:0 sc1
global_load_lds_dwordx4 v30, s[30:31] offset:1024 sc1
global_load_lds_dwordx4 v30, s[30:31] offset:2048 sc1
global_load_lds_dwordx4 v30, s[30:31] offset:3072 sc1
s_add_u32 m0, s29, 4096
s_nop 0
global_load_lds_dwordx4 v5, s[30:31] sc1
s_waitcnt vmcnt(0)
s_branch L_f1_gemm
L_f1_fused:
v_mul_u32_u24 v5, 1280, v3
v_lshl_add_u32 v5, v2, 3, v5
s_mul_i32 s3, s2, 20480
s_mul_i32 s13, s12, 320
s_add_u32 s3, s3, s13
v_add_u32 v5, s3, v5
global_load_dwordx2 v[10:11], v5, s[4:5] offset:0
global_load_dwordx2 v[12:13], v5, s[4:5] offset:32
global_load_dwordx2 v[14:15], v5, s[4:5] offset:64
global_load_dwordx2 v[16:17], v5, s[4:5] offset:96
global_load_dwordx2 v[18:19], v5, s[4:5] offset:128
global_load_dwordx2 v[20:21], v5, s[4:5] offset:160
global_load_dwordx2 v[22:23], v5, s[4:5] offset:192
global_load_dwordx2 v[24:25], v5, s[4:5] offset:224
global_load_dwordx2 v[26:27], v5, s[4:5] offset:256
global_load_dwordx2 v[28:29], v5, s[4:5] offset:288
v_and_b32 v9, 1, v1
v_bfe_u32 v8, v1, 1, 2
v_lshl_add_u32 v9, v8, 3, v9
v_lshlrev_b32 v9, 7, v9
s_lshl_b32 s3, s12, 8
s_add_u32 s3, s3, s43
s_add_u32 s3, s3, 4096
v_add_u32 v9, s3, v9
s_mul_i32 s3, s2, 40
s_mul_i32 s13, s12, 10
s_add_u32 s3, s3, s13
s_lshl_b32 s14, s3, 10
s_add_u32 s3, s14, 100667392
s_add_u32 s16, s8, s3
s_addc_u32 s17, s9, 0
s_add_u32 s3, s14, 125833216
s_add_u32 s18, s8, s3
s_addc_u32 s19, s9, 0
v_add_u32 v5, 8192, v6
s_mov_b32 s96, 0x80000
L_wf_69:
global_load_dword v8, v9, s[8:9] sc1
s_waitcnt vmcnt(0)
v_cmp_gt_u32 vcc, 1, v8
s_nop 0
s_cbranch_vccz L_wd_70
s_sleep 1
s_sub_u32 s96, s96, 1
s_cbranch_scc0 L_wf_69
s_branch L_wabort
L_wd_70:
global_load_dwordx4 v[32:35], v6, s[16:17] offset:-4096 sc1
global_load_dwordx4 v[36:39], v6, s[16:17] offset:-3072 sc1
global_load_dwordx4 v[40:43], v6, s[16:17] offset:-2048 sc1
global_load_dwordx4 v[44:47], v6, s[16:17] offset:-1024 sc1
global_load_dwordx4 v[48:51], v6, s[16:17] offset:0 sc1
global_load_dwordx4 v[52:55], v6, s[16:17] offset:1024 sc1
global_load_dwordx4 v[56:59], v6, s[16:17] offset:2048 sc1
global_load_dwordx4 v[60:63], v6, s[16:17] offset:3072 sc1
global_load_dwordx4 v[64:67], v5, s[16:17] offset:-4096 sc1
global_load_dwordx4 v[68:71], v5, s[16:17] offset:-3072 sc1
s_add_u32 s16, s16, 5242880
s_addc_u32 s17, s17, 0
global_load_dwordx4 v[72:75], v6, s[16:17] offset:-4096 sc1
global_load_dwordx4 v[76:79], v6, s[16:17] offset:-3072 sc1
global_load_dwordx4 v[80:83], v6, s[16:17] offset:-2048 sc1
global_load_dwordx4 v[84:87], v6, s[16:17] offset:-1024 sc1
global_load_dwordx4 v[88:91], v6, s[16:17] offset:0 sc1
global_load_dwordx4 v[92:95], v6, s[16:17] offset:1024 sc1
global_load_dwordx4 v[96:99], v6, s[16:17] offset:2048 sc1
global_load_dwordx4 v[100:103], v6, s[16:17] offset:3072 sc1
global_load_dwordx4 v[104:107], v5, s[16:17] offset:-4096 sc1
global_load_dwordx4 v[108:111], v5, s[16:17] offset:-3072 sc1
s_add_u32 s16, s16, 5242880
s_addc_u32 s17, s17, 0
global_load_dwordx4 v[112:115], v6, s[16:17] offset:-4096 sc1
global_load_dwordx4 v[116:119], v6, s[16:17] offset:-3072 sc1
global_load_dwordx4 v[120:123], v6, s[16:17] offset:-2048 sc1
global_load_dwordx4 v[124:127], v6, s[16:17] offset:-1024 sc1
global_load_dwordx4 v[128:131], v6, s[16:17] offset:0 sc1
global_load_dwordx4 v[132:135], v6, s[16:17] offset:1024 sc1
global_load_dwordx4 v[136:139], v6, s[16:17] offset:2048 sc1
global_load_dwordx4 v[140:143], v6, s[16:17] offset:3072 sc1
global_load_dwordx4 v[144:147], v5, s[16:17] offset:-4096 sc1
global_load_dwordx4 v[148:151], v5, s[16:17] offset:-3072 sc1
s_add_u32 s16, s16, 5242880
s_addc_u32 s17, s17, 0
global_load_dwordx4 v[152:155], v6, s[16:17] offset:-4096 sc1
global_load_dwordx4 v[156:159], v6, s[16:17] offset:-3072 sc1
global_load_dwordx4 v[160:163], v6, s[16:17] offset:-2048 sc1
global_load_dwordx4 v[164:167], v6, s[16:17] offset:-1024 sc1
global_load_dwordx4 v[168:171], v6, s[16:17] offset:0 sc1
global_load_dwordx4 v[172:175], v6, s[16:17] offset:1024 sc1
global_load_dwordx4 v[176:179], v6, s[16:17] offset:2048 sc1
global_load_dwordx4 v[180:183], v6, s[16:17] offset:3072 sc1
global_load_dwordx4 v[184:187], v5, s[16:17] offset:-4096 sc1
global_load_dwordx4 v[188:191], v5, s[16:17] offset:-3072 sc1
s_waitcnt vmcnt(20)
v_pk_add_f32 v[32:33], v[32:33], v[72:73]
v_pk_add_f32 v[34:35], v[34:35], v[74:75]
v_pk_add_f32 v[36:37], v[36:37], v[76:77]
v_pk_add_f32 v[38:39], v[38:39], v[78:79]
v_pk_add_f32 v[40:41], v[40:41], v[80:81]
v_pk_add_f32 v[42:43], v[42:43], v[82:83]
v_pk_add_f32 v[44:45], v[44:45], v[84:85]
v_pk_add_f32 v[46:47], v[46:47], v[86:87]
v_pk_add_f32 v[48:49], v[48:49], v[88:89]
v_pk_add_f32 v[50:51], v[50:51], v[90:91]
v_pk_add_f32 v[52:53], v[52:53], v[92:93]
v_pk_add_f32 v[54:55], v[54:55], v[94:95]
v_pk_add_f32 v[56:57], v[56:57], v[96:97]
v_pk_add_f32 v[58:59], v[58:59], v[98:99]
v_pk_add_f32 v[60:61], v[60:61], v[100:101]
v_pk_add_f32 v[62:63], v[62:63], v[102:103]
v_pk_add_f32 v[64:65], v[64:65], v[104:105]
v_pk_add_f32 v[66:67], v[66:67], v[106:107]
v_pk_add_f32 v[68:69], v[68:69], v[108:109]
v_pk_add_f32 v[70:71], v[70:71], v[110:111]
ds_read_b128 v[72:75], v31 offset:32768
ds_read_b128 v[76:79], v31 offset:32832
ds_read_b128 v[80:83], v31 offset:32896
ds_read_b128 v[84:87], v31 offset:32960
ds_read_b128 v[88:91], v31 offset:33024
ds_read_b128 v[92:95], v31 offset:33088
ds_read_b128 v[96:99], v31 offset:33152
ds_read_b128 v[100:103], v31 offset:33216
ds_read_b128 v[104:107], v31 offset:33280
ds_read_b128 v[108:111], v31 offset:33344
s_waitcnt vmcnt(10)
v_pk_add_f32 v[32:33], v[32:33], v[112:113]
v_pk_add_f32 v[34:35], v[34:35], v[114:115]
v_pk_add_f32 v[36:37], v[36:37], v[116:117]
v_pk_add_f32 v[38:39], v[38:39], v[118:119]
v_pk_add_f32 v[40:41], v[40:41], v[120:121]
v_pk_add_f32 v[42:43], v[42:43], v[122:123]
v_pk_add_f32 v[44:45], v[44:45], v[124:125]
v_pk_add_f32 v[46:47], v[46:47], v[126:127]
v_pk_add_f32 v[48:49], v[48:49], v[128:129]
v_pk_add_f32 v[50:51], v[50:51], v[130:131]
v_pk_add_f32 v[52:53], v[52:53], v[132:133]
v_pk_add_f32 v[54:55], v[54:55], v[134:135]
v_pk_add_f32 v[56:57], v[56:57], v[136:137]
v_pk_add_f32 v[58:59], v[58:59], v[138:139]
v_pk_add_f32 v[60:61], v[60:61], v[140:141]
v_pk_add_f32 v[62:63], v[62:63], v[142:143]
v_pk_add_f32 v[64:65], v[64:65], v[144:145]
v_pk_add_f32 v[66:67], v[66:67], v[146:147]
v_pk_add_f32 v[68:69], v[68:69], v[148:149]
v_pk_add_f32 v[70:71], v[70:71], v[150:151]
v_lshlrev_b32 v112, 16, v10
v_and_b32 v113, 0xffff0000, v10
v_lshlrev_b32 v114, 16, v11
v_and_b32 v115, 0xffff0000, v11
v_lshlrev_b32 v116, 16, v12
v_and_b32 v117, 0xffff0000, v12
v_lshlrev_b32 v118, 16, v13
v_and_b32 v119, 0xffff0000, v13
v_lshlrev_b32 v120, 16, v14
v_and_b32 v121, 0xffff0000, v14
v_lshlrev_b32 v122, 16, v15
v_and_b32 v123, 0xffff0000, v15
v_lshlrev_b32 v124, 16, v16
v_and_b32 v125, 0xffff0000, v16
v_lshlrev_b32 v126, 16, v17
v_and_b32 v127, 0xffff0000, v17
v_lshlrev_b32 v128, 16, v18
v_and_b32 v129, 0xffff0000, v18
v_lshlrev_b32 v130, 16, v19
v_and_b32 v131, 0xffff0000, v19
v_lshlrev_b32 v132, 16, v20
v_and_b32 v133, 0xffff0000, v20
v_lshlrev_b32 v134, 16, v21
v_and_b32 v135, 0xffff0000, v21
v_lshlrev_b32 v136, 16, v22
v_and_b32 v137, 0xffff0000, v22
v_lshlrev_b32 v138, 16, v23
v_and_b32 v139, 0xffff0000, v23
v_lshlrev_b32 v140, 16, v24
v_and_b32 v141, 0xffff0000, v24
v_lshlrev_b32 v142, 16, v25
v_and_b32 v143, 0xffff0000, v25
v_lshlrev_b32 v144, 16, v26
v_and_b32 v145, 0xffff0000, v26
v_lshlrev_b32 v146, 16, v27
v_and_b32 v147, 0xffff0000, v27
v_lshlrev_b32 v148, 16, v28
v_and_b32 v149, 0xffff0000, v28
v_lshlrev_b32 v150, 16, v29
v_and_b32 v151, 0xffff0000, v29
s_waitcnt lgkmcnt(0)
s_waitcnt vmcnt(9)
v_pk_add_f32 v[32:33], v[32:33], v[152:153]
v_cvt_pk_bf16_f32 v9, v32, v33
v_lshlrev_b32 v32, 16, v9
v_and_b32 v33, 0xffff0000, v9
v_pk_mul_f32 v[32:33], v[32:33], v[72:73]
v_cvt_pk_bf16_f32 v9, v32, v33
v_lshlrev_b32 v32, 16, v9
v_and_b32 v33, 0xffff0000, v9
v_pk_add_f32 v[32:33], v[32:33], v[112:113]
v_cvt_pk_bf16_f32 v9, v32, v33
v_lshlrev_b32 v32, 16, v9
v_and_b32 v33, 0xffff0000, v9
v_pk_add_f32 v[34:35], v[34:35], v[154:155]
v_cvt_pk_bf16_f32 v9, v34, v35
v_lshlrev_b32 v34, 16, v9
v_and_b32 v35, 0xffff0000, v9
v_pk_mul_f32 v[34:35], v[34:35], v[74:75]
v_cvt_pk_bf16_f32 v9, v34, v35
v_lshlrev_b32 v34, 16, v9
v_and_b32 v35, 0xffff0000, v9
v_pk_add_f32 v[34:35], v[34:35], v[114:115]
v_cvt_pk_bf16_f32 v9, v34, v35
v_lshlrev_b32 v34, 16, v9
v_and_b32 v35, 0xffff0000, v9
s_waitcnt vmcnt(8)
v_pk_add_f32 v[36:37], v[36:37], v[156:157]
v_cvt_pk_bf16_f32 v9, v36, v37
v_lshlrev_b32 v36, 16, v9
v_and_b32 v37, 0xffff0000, v9
v_pk_mul_f32 v[36:37], v[36:37], v[76:77]
v_cvt_pk_bf16_f32 v9, v36, v37
v_lshlrev_b32 v36, 16, v9
v_and_b32 v37, 0xffff0000, v9
v_pk_add_f32 v[36:37], v[36:37], v[116:117]
v_cvt_pk_bf16_f32 v9, v36, v37
v_lshlrev_b32 v36, 16, v9
v_and_b32 v37, 0xffff0000, v9
v_pk_add_f32 v[38:39], v[38:39], v[158:159]
v_cvt_pk_bf16_f32 v9, v38, v39
v_lshlrev_b32 v38, 16, v9
v_and_b32 v39, 0xffff0000, v9
v_pk_mul_f32 v[38:39], v[38:39], v[78:79]
v_cvt_pk_bf16_f32 v9, v38, v39
v_lshlrev_b32 v38, 16, v9
v_and_b32 v39, 0xffff0000, v9
v_pk_add_f32 v[38:39], v[38:39], v[118:119]
v_cvt_pk_bf16_f32 v9, v38, v39
v_lshlrev_b32 v38, 16, v9
v_and_b32 v39, 0xffff0000, v9
s_waitcnt vmcnt(7)
v_pk_add_f32 v[40:41], v[40:41], v[160:161]
v_cvt_pk_bf16_f32 v9, v40, v41
v_lshlrev_b32 v40, 16, v9
v_and_b32 v41, 0xffff0000, v9
v_pk_mul_f32 v[40:41], v[40:41], v[80:81]
v_cvt_pk_bf16_f32 v9, v40, v41
v_lshlrev_b32 v40, 16, v9
v_and_b32 v41, 0xffff0000, v9
v_pk_add_f32 v[40:41], v[40:41], v[120:121]
v_cvt_pk_bf16_f32 v9, v40, v41
v_lshlrev_b32 v40, 16, v9
v_and_b32 v41, 0xffff0000, v9
v_pk_add_f32 v[42:43], v[42:43], v[162:163]
v_cvt_pk_bf16_f32 v9, v42, v43
v_lshlrev_b32 v42, 16, v9
v_and_b32 v43, 0xffff0000, v9
v_pk_mul_f32 v[42:43], v[42:43], v[82:83]
v_cvt_pk_bf16_f32 v9, v42, v43
v_lshlrev_b32 v42, 16, v9
v_and_b32 v43, 0xffff0000, v9
v_pk_add_f32 v[42:43], v[42:43], v[122:123]
v_cvt_pk_bf16_f32 v9, v42, v43
v_lshlrev_b32 v42, 16, v9
v_and_b32 v43, 0xffff0000, v9
s_waitcnt vmcnt(6)
v_pk_add_f32 v[44:45], v[44:45], v[164:165]
v_cvt_pk_bf16_f32 v9, v44, v45
v_lshlrev_b32 v44, 16, v9
v_and_b32 v45, 0xffff0000, v9
v_pk_mul_f32 v[44:45], v[44:45], v[84:85]
v_cvt_pk_bf16_f32 v9, v44, v45
v_lshlrev_b32 v44, 16, v9
v_and_b32 v45, 0xffff0000, v9
v_pk_add_f32 v[44:45], v[44:45], v[124:125]
v_cvt_pk_bf16_f32 v9, v44, v45
v_lshlrev_b32 v44, 16, v9
v_and_b32 v45, 0xffff0000, v9
v_pk_add_f32 v[46:47], v[46:47], v[166:167]
v_cvt_pk_bf16_f32 v9, v46, v47
v_lshlrev_b32 v46, 16, v9
v_and_b32 v47, 0xffff0000, v9
v_pk_mul_f32 v[46:47], v[46:47], v[86:87]
v_cvt_pk_bf16_f32 v9, v46, v47
v_lshlrev_b32 v46, 16, v9
v_and_b32 v47, 0xffff0000, v9
v_pk_add_f32 v[46:47], v[46:47], v[126:127]
v_cvt_pk_bf16_f32 v9, v46, v47
v_lshlrev_b32 v46, 16, v9
v_and_b32 v47, 0xffff0000, v9
s_waitcnt vmcnt(5)
v_pk_add_f32 v[48:49], v[48:49], v[168:169]
v_cvt_pk_bf16_f32 v9, v48, v49
v_lshlrev_b32 v48, 16, v9
v_and_b32 v49, 0xffff0000, v9
v_pk_mul_f32 v[48:49], v[48:49], v[88:89]
v_cvt_pk_bf16_f32 v9, v48, v49
v_lshlrev_b32 v48, 16, v9
v_and_b32 v49, 0xffff0000, v9
v_pk_add_f32 v[48:49], v[48:49], v[128:129]
v_cvt_pk_bf16_f32 v9, v48, v49
v_lshlrev_b32 v48, 16, v9
v_and_b32 v49, 0xffff0000, v9
v_pk_add_f32 v[50:51], v[50:51], v[170:171]
v_cvt_pk_bf16_f32 v9, v50, v51
v_lshlrev_b32 v50, 16, v9
v_and_b32 v51, 0xffff0000, v9
v_pk_mul_f32 v[50:51], v[50:51], v[90:91]
v_cvt_pk_bf16_f32 v9, v50, v51
v_lshlrev_b32 v50, 16, v9
v_and_b32 v51, 0xffff0000, v9
v_pk_add_f32 v[50:51], v[50:51], v[130:131]
v_cvt_pk_bf16_f32 v9, v50, v51
v_lshlrev_b32 v50, 16, v9
v_and_b32 v51, 0xffff0000, v9
s_waitcnt vmcnt(4)
v_pk_add_f32 v[52:53], v[52:53], v[172:173]
v_cvt_pk_bf16_f32 v9, v52, v53
v_lshlrev_b32 v52, 16, v9
v_and_b32 v53, 0xffff0000, v9
v_pk_mul_f32 v[52:53], v[52:53], v[92:93]
v_cvt_pk_bf16_f32 v9, v52, v53
v_lshlrev_b32 v52, 16, v9
v_and_b32 v53, 0xffff0000, v9
v_pk_add_f32 v[52:53], v[52:53], v[132:133]
v_cvt_pk_bf16_f32 v9, v52, v53
v_lshlrev_b32 v52, 16, v9
v_and_b32 v53, 0xffff0000, v9
v_pk_add_f32 v[54:55], v[54:55], v[174:175]
v_cvt_pk_bf16_f32 v9, v54, v55
v_lshlrev_b32 v54, 16, v9
v_and_b32 v55, 0xffff0000, v9
v_pk_mul_f32 v[54:55], v[54:55], v[94:95]
v_cvt_pk_bf16_f32 v9, v54, v55
v_lshlrev_b32 v54, 16, v9
v_and_b32 v55, 0xffff0000, v9
v_pk_add_f32 v[54:55], v[54:55], v[134:135]
v_cvt_pk_bf16_f32 v9, v54, v55
v_lshlrev_b32 v54, 16, v9
v_and_b32 v55, 0xffff0000, v9
s_waitcnt vmcnt(3)
v_pk_add_f32 v[56:57], v[56:57], v[176:177]
v_cvt_pk_bf16_f32 v9, v56, v57
v_lshlrev_b32 v56, 16, v9
v_and_b32 v57, 0xffff0000, v9
v_pk_mul_f32 v[56:57], v[56:57], v[96:97]
v_cvt_pk_bf16_f32 v9, v56, v57
v_lshlrev_b32 v56, 16, v9
v_and_b32 v57, 0xffff0000, v9
v_pk_add_f32 v[56:57], v[56:57], v[136:137]
v_cvt_pk_bf16_f32 v9, v56, v57
v_lshlrev_b32 v56, 16, v9
v_and_b32 v57, 0xffff0000, v9
v_pk_add_f32 v[58:59], v[58:59], v[178:179]
v_cvt_pk_bf16_f32 v9, v58, v59
v_lshlrev_b32 v58, 16, v9
v_and_b32 v59, 0xffff0000, v9
v_pk_mul_f32 v[58:59], v[58:59], v[98:99]
v_cvt_pk_bf16_f32 v9, v58, v59
v_lshlrev_b32 v58, 16, v9
v_and_b32 v59, 0xffff0000, v9
v_pk_add_f32 v[58:59], v[58:59], v[138:139]
v_cvt_pk_bf16_f32 v9, v58, v59
v_lshlrev_b32 v58, 16, v9
v_and_b32 v59, 0xffff0000, v9
s_waitcnt vmcnt(2)
v_pk_add_f32 v[60:61], v[60:61], v[180:181]
v_cvt_pk_bf16_f32 v9, v60, v61
v_lshlrev_b32 v60, 16, v9
v_and_b32 v61, 0xffff0000, v9
v_pk_mul_f32 v[60:61], v[60:61], v[100:101]
v_cvt_pk_bf16_f32 v9, v60, v61
v_lshlrev_b32 v60, 16, v9
v_and_b32 v61, 0xffff0000, v9
v_pk_add_f32 v[60:61], v[60:61], v[140:141]
v_cvt_pk_bf16_f32 v9, v60, v61
v_lshlrev_b32 v60, 16, v9
v_and_b32 v61, 0xffff0000, v9
v_pk_add_f32 v[62:63], v[62:63], v[182:183]
v_cvt_pk_bf16_f32 v9, v62, v63
v_lshlrev_b32 v62, 16, v9
v_and_b32 v63, 0xffff0000, v9
v_pk_mul_f32 v[62:63], v[62:63], v[102:103]
v_cvt_pk_bf16_f32 v9, v62, v63
v_lshlrev_b32 v62, 16, v9
v_and_b32 v63, 0xffff0000, v9
v_pk_add_f32 v[62:63], v[62:63], v[142:143]
v_cvt_pk_bf16_f32 v9, v62, v63
v_lshlrev_b32 v62, 16, v9
v_and_b32 v63, 0xffff0000, v9
s_waitcnt vmcnt(1)
v_pk_add_f32 v[64:65], v[64:65], v[184:185]
v_cvt_pk_bf16_f32 v9, v64, v65
v_lshlrev_b32 v64, 16, v9
v_and_b32 v65, 0xffff0000, v9
v_pk_mul_f32 v[64:65], v[64:65], v[104:105]
v_cvt_pk_bf16_f32 v9, v64, v65
v_lshlrev_b32 v64, 16, v9
v_and_b32 v65, 0xffff0000, v9
v_pk_add_f32 v[64:65], v[64:65], v[144:145]
v_cvt_pk_bf16_f32 v9, v64, v65
v_lshlrev_b32 v64, 16, v9
v_and_b32 v65, 0xffff0000, v9
v_pk_add_f32 v[66:67], v[66:67], v[186:187]
v_cvt_pk_bf16_f32 v9, v66, v67
v_lshlrev_b32 v66, 16, v9
v_and_b32 v67, 0xffff0000, v9
v_pk_mul_f32 v[66:67], v[66:67], v[106:107]
v_cvt_pk_bf16_f32 v9, v66, v67
v_lshlrev_b32 v66, 16, v9
v_and_b32 v67, 0xffff0000, v9
v_pk_add_f32 v[66:67], v[66:67], v[146:147]
v_cvt_pk_bf16_f32 v9, v66, v67
v_lshlrev_b32 v66, 16, v9
v_and_b32 v67, 0xffff0000, v9
s_waitcnt vmcnt(0)
v_pk_add_f32 v[68:69], v[68:69], v[188:189]
v_cvt_pk_bf16_f32 v9, v68, v69
v_lshlrev_b32 v68, 16, v9
v_and_b32 v69, 0xffff0000, v9
v_pk_mul_f32 v[68:69], v[68:69], v[108:109]
v_cvt_pk_bf16_f32 v9, v68, v69
v_lshlrev_b32 v68, 16, v9
v_and_b32 v69, 0xffff0000, v9
v_pk_add_f32 v[68:69], v[68:69], v[148:149]
v_cvt_pk_bf16_f32 v9, v68, v69
v_lshlrev_b32 v68, 16, v9
v_and_b32 v69, 0xffff0000, v9
v_pk_add_f32 v[70:71], v[70:71], v[190:191]
v_cvt_pk_bf16_f32 v9, v70, v71
v_lshlrev_b32 v70, 16, v9
v_and_b32 v71, 0xffff0000, v9
v_pk_mul_f32 v[70:71], v[70:71], v[110:111]
v_cvt_pk_bf16_f32 v9, v70, v71
v_lshlrev_b32 v70, 16, v9
v_and_b32 v71, 0xffff0000, v9
v_pk_add_f32 v[70:71], v[70:71], v[150:151]
v_cvt_pk_bf16_f32 v9, v70, v71
v_lshlrev_b32 v70, 16, v9
v_and_b32 v71, 0xffff0000, v9
ds_read_b128 v[112:115], v31 offset:35328
ds_read_b128 v[152:155], v31 offset:37888
ds_read_b128 v[116:119], v31 offset:35392
ds_read_b128 v[156:159], v31 offset:37952
ds_read_b128 v[120:123], v31 offset:35456
ds_read_b128 v[160:163], v31 offset:38016
ds_read_b128 v[124:127], v31 offset:35520
ds_read_b128 v[164:167], v31 offset:38080
ds_read_b128 v[128:131], v31 offset:35584
ds_read_b128 v[168:171], v31 offset:38144
ds_read_b128 v[132:135], v31 offset:35648
ds_read_b128 v[172:175], v31 offset:38208
ds_read_b128 v[136:139], v31 offset:35712
ds_read_b128 v[176:179], v31 offset:38272
ds_read_b128 v[140:143], v31 offset:35776
ds_read_b128 v[180:183], v31 offset:38336
ds_read_b128 v[144:147], v31 offset:35840
ds_read_b128 v[184:187], v31 offset:38400
ds_read_b128 v[148:151], v31 offset:35904
ds_read_b128 v[188:191], v31 offset:38464
s_cmp_lg_u32 s44, 6
s_cbranch_scc1 L_f1_nox1
global_store_dwordx4 v6, v[32:35], s[18:19] offset:-4096 sc1
global_store_dwordx4 v6, v[36:39], s[18:19] offset:-3072 sc1
global_store_dwordx4 v6, v[40:43], s[18:19] offset:-2048 sc1
global_store_dwordx4 v6, v[44:47], s[18:19] offset:-1024 sc1
global_store_dwordx4 v6, v[48:51], s[18:19] offset:0 sc1
global_store_dwordx4 v6, v[52:55], s[18:19] offset:1024 sc1
global_store_dwordx4 v6, v[56:59], s[18:19] offset:2048 sc1
global_store_dwordx4 v6, v[60:63], s[18:19] offset:3072 sc1
global_store_dwordx4 v5, v[64:67], s[18:19] offset:-4096 sc1
global_store_dwordx4 v5, v[68:71], s[18:19] offset:-3072 sc1
L_f1_nox1:
v_pk_add_f32 v[8:9], v[32:33], v[34:35]
v_pk_add_f32 v[8:9], v[8:9], v[36:37]
v_pk_add_f32 v[8:9], v[8:9], v[38:39]
v_pk_add_f32 v[8:9], v[8:9], v[40:41]
v_pk_add_f32 v[8:9], v[8:9], v[42:43]
v_pk_add_f32 v[8:9], v[8:9], v[44:45]
v_pk_add_f32 v[8:9], v[8:9], v[46:47]
v_pk_add_f32 v[8:9], v[8:9], v[48:49]
v_pk_add_f32 v[8:9], v[8:9], v[50:51]
v_pk_add_f32 v[8:9], v[8:9], v[52:53]
v_pk_add_f32 v[8:9], v[8:9], v[54:55]
v_pk_add_f32 v[8:9], v[8:9], v[56:57]
v_pk_add_f32 v[8:9], v[8:9], v[58:59]
v_pk_add_f32 v[8:9], v[8:9], v[60:61]
v_pk_add_f32 v[8:9], v[8:9], v[62:63]
v_pk_add_f32 v[8:9], v[8:9], v[64:65]
v_pk_add_f32 v[8:9], v[8:9], v[66:67]
v_pk_add_f32 v[8:9], v[8:9], v[68:69]
v_pk_add_f32 v[8:9], v[8:9], v[70:71]
v_add_f32 v8, v8, v9
v_mov_b32 v9, v8
s_nop 1
v_permlane32_swap_b32 v8, v9
v_add_f32 v8, v8, v9
v_mov_b32 v9, v8
s_nop 1
v_permlane16_swap_b32 v8, v9
v_add_f32 v8, v8, v9
ds_write_b32 v4, v8 offset:40960
s_waitcnt lgkmcnt(0)
s_barrier
ds_read_b32 v10, v7 offset:40960
ds_read_b32 v11, v7 offset:41024
ds_read_b32 v12, v7 offset:41088
ds_read_b32 v13, v7 offset:41152
s_waitcnt lgkmcnt(0)
v_add_f32 v10, v10, v11
v_add_f32 v12, v12, v13
v_add_f32 v8, v10, v12
v_mul_f32 v14, 0x3acccccd, v8
v_mov_b32 v15, v14
v_cvt_pk_bf16_f32 v15, v15, v15
v_and_b32 v15, 0xffff0000, v15
v_mov_b32 v8, 0
v_mov_b32 v9, 0
v_pk_add_f32 v[32:33], v[32:33], v[14:15] op_sel_hi:[1,0] neg_lo:[0,1] neg_hi:[0,1]
s_nop 0
v_pk_fma_f32 v[8:9], v[32:33], v[32:33], v[8:9]
v_pk_add_f32 v[34:35], v[34:35], v[14:15] op_sel_hi:[1,0] neg_lo:[0,1] neg_hi:[0,1]
s_nop 0
v_pk_fma_f32 v[8:9], v[34:35], v[34:35], v[8:9]
v_pk_add_f32 v[36:37], v[36:37], v[14:15] op_sel_hi:[1,0] neg_lo:[0,1] neg_hi:[0,1]
s_nop 0
v_pk_fma_f32 v[8:9], v[36:37], v[36:37], v[8:9]
v_pk_add_f32 v[38:39], v[38:39], v[14:15] op_sel_hi:[1,0] neg_lo:[0,1] neg_hi:[0,1]
s_nop 0
v_pk_fma_f32 v[8:9], v[38:39], v[38:39], v[8:9]
v_pk_add_f32 v[40:41], v[40:41], v[14:15] op_sel_hi:[1,0] neg_lo:[0,1] neg_hi:[0,1]
s_nop 0
v_pk_fma_f32 v[8:9], v[40:41], v[40:41], v[8:9]
v_pk_add_f32 v[42:43], v[42:43], v[14:15] op_sel_hi:[1,0] neg_lo:[0,1] neg_hi:[0,1]
s_nop 0
v_pk_fma_f32 v[8:9], v[42:43], v[42:43], v[8:9]
v_pk_add_f32 v[44:45], v[44:45], v[14:15] op_sel_hi:[1,0] neg_lo:[0,1] neg_hi:[0,1]
s_nop 0
v_pk_fma_f32 v[8:9], v[44:45], v[44:45], v[8:9]
v_pk_add_f32 v[46:47], v[46:47], v[14:15] op_sel_hi:[1,0] neg_lo:[0,1] neg_hi:[0,1]
s_nop 0
v_pk_fma_f32 v[8:9], v[46:47], v[46:47], v[8:9]
v_pk_add_f32 v[48:49], v[48:49], v[14:15] op_sel_hi:[1,0] neg_lo:[0,1] neg_hi:[0,1]
s_nop 0
v_pk_fma_f32 v[8:9], v[48:49], v[48:49], v[8:9]
v_pk_add_f32 v[50:51], v[50:51], v[14:15] op_sel_hi:[1,0] neg_lo:[0,1] neg_hi:[0,1]
s_nop 0
v_pk_fma_f32 v[8:9], v[50:51], v[50:51], v[8:9]
v_pk_add_f32 v[52:53], v[52:53], v[14:15] op_sel_hi:[1,0] neg_lo:[0,1] neg_hi:[0,1]
s_nop 0
v_pk_fma_f32 v[8:9], v[52:53], v[52:53], v[8:9]
v_pk_add_f32 v[54:55], v[54:55], v[14:15] op_sel_hi:[1,0] neg_lo:[0,1] neg_hi:[0,1]
s_nop 0
v_pk_fma_f32 v[8:9], v[54:55], v[54:55], v[8:9]
v_pk_add_f32 v[56:57], v[56:57], v[14:15] op_sel_hi:[1,0] neg_lo:[0,1] neg_hi:[0,1]
s_nop 0
v_pk_fma_f32 v[8:9], v[56:57], v[56:57], v[8:9]
v_pk_add_f32 v[58:59], v[58:59], v[14:15] op_sel_hi:[1,0] neg_lo:[0,1] neg_hi:[0,1]
s_nop 0
v_pk_fma_f32 v[8:9], v[58:59], v[58:59], v[8:9]
v_pk_add_f32 v[60:61], v[60:61], v[14:15] op_sel_hi:[1,0] neg_lo:[0,1] neg_hi:[0,1]
s_nop 0
v_pk_fma_f32 v[8:9], v[60:61], v[60:61], v[8:9]
v_pk_add_f32 v[62:63], v[62:63], v[14:15] op_sel_hi:[1,0] neg_lo:[0,1] neg_hi:[0,1]
s_nop 0
v_pk_fma_f32 v[8:9], v[62:63], v[62:63], v[8:9]
v_pk_add_f32 v[64:65], v[64:65], v[14:15] op_sel_hi:[1,0] neg_lo:[0,1] neg_hi:[0,1]
s_nop 0
v_pk_fma_f32 v[8:9], v[64:65], v[64:65], v[8:9]
v_pk_add_f32 v[66:67], v[66:67], v[14:15] op_sel_hi:[1,0] neg_lo:[0,1] neg_hi:[0,1]
s_nop 0
v_pk_fma_f32 v[8:9], v[66:67], v[66:67], v[8:9]
v_pk_add_f32 v[68:69], v[68:69], v[14:15] op_sel_hi:[1,0] neg_lo:[0,1] neg_hi:[0,1]
s_nop 0
v_pk_fma_f32 v[8:9], v[68:69], v[68:69], v[8:9]
v_pk_add_f32 v[70:71], v[70:71], v[14:15] op_sel_hi:[1,0] neg_lo:[0,1] neg_hi:[0,1]
s_nop 0
v_pk_fma_f32 v[8:9], v[70:71], v[70:71], v[8:9]
v_add_f32 v8, v8, v9
v_mov_b32 v9, v8
s_nop 1
v_permlane32_swap_b32 v8, v9
v_add_f32 v8, v8, v9
v_mov_b32 v9, v8
s_nop 1
v_permlane16_swap_b32 v8, v9
v_add_f32 v8, v8, v9
ds_write_b32 v4, v8 offset:41216
s_waitcnt lgkmcnt(0)
s_barrier
ds_read_b32 v10, v7 offset:41216
ds_read_b32 v11, v7 offset:41280
ds_read_b32 v12, v7 offset:41344
ds_read_b32 v13, v7 offset:41408
s_waitcnt lgkmcnt(0)
v_add_f32 v10, v10, v11
v_add_f32 v12, v12, v13
v_add_f32 v8, v10, v12
v_mul_f32 v8, 0x3acccccd, v8
v_cvt_pk_bf16_f32 v8, v8, v8
v_and_b32 v8, 0xffff0000, v8
v_add_f32 v8, 0x3727c5ac, v8
v_cvt_pk_bf16_f32 v8, v8, v8
v_and_b32 v8, 0xffff0000, v8
v_sqrt_f32 v8, v8
s_nop 0
v_cvt_pk_bf16_f32 v8, v8, v8
v_and_b32 v8, 0xffff0000, v8
v_rcp_f32 v8, v8
v_sub_f32 v14, v14, v15
v_mul_f32 v14, v14, v8
v_pk_fma_f32 v[32:33], v[32:33], v[8:9], v[14:15] op_sel_hi:[1,0,0]
s_nop 0
v_pk_fma_f32 v[32:33], v[32:33], v[152:153], v[112:113]
v_cvt_pk_bf16_f32 v72, v32, v33
v_pk_fma_f32 v[34:35], v[34:35], v[8:9], v[14:15] op_sel_hi:[1,0,0]
s_nop 0
v_pk_fma_f32 v[34:35], v[34:35], v[154:155], v[114:115]
v_cvt_pk_bf16_f32 v73, v34, v35
v_pk_fma_f32 v[36:37], v[36:37], v[8:9], v[14:15] op_sel_hi:[1,0,0]
s_nop 0
v_pk_fma_f32 v[36:37], v[36:37], v[156:157], v[116:117]
v_cvt_pk_bf16_f32 v74, v36, v37
v_pk_fma_f32 v[38:39], v[38:39], v[8:9], v[14:15] op_sel_hi:[1,0,0]
s_nop 0
v_pk_fma_f32 v[38:39], v[38:39], v[158:159], v[118:119]
v_cvt_pk_bf16_f32 v75, v38, v39
ds_write_b128 v30, v[72:75] offset:0
v_pk_fma_f32 v[40:41], v[40:41], v[8:9], v[14:15] op_sel_hi:[1,0,0]
s_nop 0
v_pk_fma_f32 v[40:41], v[40:41], v[160:161], v[120:121]
v_cvt_pk_bf16_f32 v76, v40, v41
v_pk_fma_f32 v[42:43], v[42:43], v[8:9], v[14:15] op_sel_hi:[1,0,0]
s_nop 0
v_pk_fma_f32 v[42:43], v[42:43], v[162:163], v[122:123]
v_cvt_pk_bf16_f32 v77, v42, v43
v_pk_fma_f32 v[44:45], v[44:45], v[8:9], v[14:15] op_sel_hi:[1,0,0]
s_nop 0
v_pk_fma_f32 v[44:45], v[44:45], v[164:165], v[124:125]
v_cvt_pk_bf16_f32 v78, v44, v45
v_pk_fma_f32 v[46:47], v[46:47], v[8:9], v[14:15] op_sel_hi:[1,0,0]
s_nop 0
v_pk_fma_f32 v[46:47], v[46:47], v[166:167], v[126:127]
v_cvt_pk_bf16_f32 v79, v46, v47
ds_write_b128 v30, v[76:79] offset:1024
v_pk_fma_f32 v[48:49], v[48:49], v[8:9], v[14:15] op_sel_hi:[1,0,0]
s_nop 0
v_pk_fma_f32 v[48:49], v[48:49], v[168:169], v[128:129]
v_cvt_pk_bf16_f32 v80, v48, v49
v_pk_fma_f32 v[50:51], v[50:51], v[8:9], v[14:15] op_sel_hi:[1,0,0]
s_nop 0
v_pk_fma_f32 v[50:51], v[50:51], v[170:171], v[130:131]
v_cvt_pk_bf16_f32 v81, v50, v51
v_pk_fma_f32 v[52:53], v[52:53], v[8:9], v[14:15] op_sel_hi:[1,0,0]
s_nop 0
v_pk_fma_f32 v[52:53], v[52:53], v[172:173], v[132:133]
v_cvt_pk_bf16_f32 v82, v52, v53
v_pk_fma_f32 v[54:55], v[54:55], v[8:9], v[14:15] op_sel_hi:[1,0,0]
s_nop 0
v_pk_fma_f32 v[54:55], v[54:55], v[174:175], v[134:135]
v_cvt_pk_bf16_f32 v83, v54, v55
ds_write_b128 v30, v[80:83] offset:2048
v_pk_fma_f32 v[56:57], v[56:57], v[8:9], v[14:15] op_sel_hi:[1,0,0]
s_nop 0
v_pk_fma_f32 v[56:57], v[56:57], v[176:177], v[136:137]
v_cvt_pk_bf16_f32 v84, v56, v57
v_pk_fma_f32 v[58:59], v[58:59], v[8:9], v[14:15] op_sel_hi:[1,0,0]
s_nop 0
v_pk_fma_f32 v[58:59], v[58:59], v[178:179], v[138:139]
v_cvt_pk_bf16_f32 v85, v58, v59
v_pk_fma_f32 v[60:61], v[60:61], v[8:9], v[14:15] op_sel_hi:[1,0,0]
s_nop 0
v_pk_fma_f32 v[60:61], v[60:61], v[180:181], v[140:141]
v_cvt_pk_bf16_f32 v86, v60, v61
v_pk_fma_f32 v[62:63], v[62:63], v[8:9], v[14:15] op_sel_hi:[1,0,0]
s_nop 0
v_pk_fma_f32 v[62:63], v[62:63], v[182:183], v[142:143]
v_cvt_pk_bf16_f32 v87, v62, v63
ds_write_b128 v30, v[84:87] offset:3072
v_pk_fma_f32 v[64:65], v[64:65], v[8:9], v[14:15] op_sel_hi:[1,0,0]
s_nop 0
v_pk_fma_f32 v[64:65], v[64:65], v[184:185], v[144:145]
v_cvt_pk_bf16_f32 v88, v64, v65
v_pk_fma_f32 v[66:67], v[66:67], v[8:9], v[14:15] op_sel_hi:[1,0,0]
s_nop 0
v_pk_fma_f32 v[66:67], v[66:67], v[186:187], v[146:147]
v_cvt_pk_bf16_f32 v89, v66, v67
v_pk_fma_f32 v[68:69], v[68:69], v[8:9], v[14:15] op_sel_hi:[1,0,0]
s_nop 0
v_pk_fma_f32 v[68:69], v[68:69], v[188:189], v[148:149]
v_cvt_pk_bf16_f32 v90, v68, v69
v_pk_fma_f32 v[70:71], v[70:71], v[8:9], v[14:15] op_sel_hi:[1,0,0]
s_nop 0
v_pk_fma_f32 v[70:71], v[70:71], v[190:191], v[150:151]
v_cvt_pk_bf16_f32 v91, v70, v71
ds_write_b128 v30, v[88:91] offset:4096
s_waitcnt lgkmcnt(0)
L_f1_gemm:
s_barrier
ds_read_b128 v[72:75], v6 offset:0
ds_read_b128 v[76:79], v6 offset:1024
ds_read_b128 v[80:83], v6 offset:2048
ds_read_b128 v[84:87], v6 offset:3072
ds_read_b128 v[88:91], v6 offset:4096
ds_read_b128 v[92:95], v6 offset:5120
ds_read_b128 v[96:99], v6 offset:6144
ds_read_b128 v[100:103], v6 offset:7168
ds_read_b128 v[104:107], v6 offset:8192
ds_read_b128 v[108:111], v6 offset:9216
ds_read_b128 v[112:115], v6 offset:10240
ds_read_b128 v[116:119], v6 offset:11264
s_waitcnt lgkmcnt(11)
v_mfma_f32_16x16x32_bf16 v[32:35], a[0:3], v[72:75], 0
v_mfma_f32_16x16x32_bf16 v[36:39], a[80:83], v[72:75], 0
v_mfma_f32_16x16x32_bf16 v[40:43], a[160:163], v[72:75], 0
v_mfma_f32_16x16x32_bf16 v[44:47], a[240:243], v[72:75], 0
ds_read_b128 v[120:123], v6 offset:12288
s_waitcnt lgkmcnt(11)
v_mfma_f32_16x16x32_bf16 v[32:35], a[4:7], v[76:79], v[32:35]
v_mfma_f32_16x16x32_bf16 v[36:39], a[84:87], v[76:79], v[36:39]
v_mfma_f32_16x16x32_bf16 v[40:43], a[164:167], v[76:79], v[40:43]
v_mfma_f32_16x16x32_bf16 v[44:47], a[244:247], v[76:79], v[44:47]
ds_read_b128 v[124:127], v6 offset:13312
s_waitcnt lgkmcnt(11)
v_mfma_f32_16x16x32_bf16 v[32:35], a[8:11], v[80:83], v[32:35]
v_mfma_f32_16x16x32_bf16 v[36:39], a[88:91], v[80:83], v[36:39]
v_mfma_f32_16x16x32_bf16 v[40:43], a[168:171], v[80:83], v[40:43]
v_mfma_f32_16x16x32_bf16 v[44:47], a[248:251], v[80:83], v[44:47]
ds_read_b128 v[128:131], v6 offset:14336
s_waitcnt lgkmcnt(11)
v_mfma_f32_16x16x32_bf16 v[32:35], a[12:15], v[84:87], v[32:35]
v_mfma_f32_16x16x32_bf16 v[36:39], a[92:95], v[84:87], v[36:39]
v_mfma_f32_16x16x32_bf16 v[40:43], a[172:175], v[84:87], v[40:43]
v_mfma_f32_16x16x32_bf16 v[44:47], a[252:255], v[84:87], v[44:47]
ds_read_b128 v[132:135], v6 offset:15360
s_waitcnt lgkmcnt(11)
v_mfma_f32_16x16x32_bf16 v[32:35], a[16:19], v[88:91], v[32:35]
v_mfma_f32_16x16x32_bf16 v[36:39], a[96:99], v[88:91], v[36:39]
v_mfma_f32_16x16x32_bf16 v[40:43], a[176:179], v[88:91], v[40:43]
v_mfma_f32_16x16x32_bf16 v[44:47], v[192:195], v[88:91], v[44:47]
ds_read_b128 v[136:139], v6 offset:16384
s_waitcnt lgkmcnt(11)
v_mfma_f32_16x16x32_bf16 v[32:35], a[20:23], v[92:95], v[32:35]
v_mfma_f32_16x16x32_bf16 v[36:39], a[100:103], v[92:95], v[36:39]
v_mfma_f32_16x16x32_bf16 v[40:43], a[180:183], v[92:95], v[40:43]
v_mfma_f32_16x16x32_bf16 v[44:47], v[196:199], v[92:95], v[44:47]
ds_read_b128 v[140:143], v6 offset:17408
s_waitcnt lgkmcnt(11)
v_mfma_f32_16x16x32_bf16 v[32:35], a[24:27], v[96:99], v[32:35]
v_mfma_f32_16x16x32_bf16 v[36:39], a[104:107], v[96:99], v[36:39]
v_mfma_f32_16x16x32_bf16 v[40:43], a[184:187], v[96:99], v[40:43]
v_mfma_f32_16x16x32_bf16 v[44:47], v[200:203], v[96:99], v[44:47]
ds_read_b128 v[144:147], v6 offset:18432
s_waitcnt lgkmcnt(11)
v_mfma_f32_16x16x32_bf16 v[32:35], a[28:31], v[100:103], v[32:35]
v_mfma_f32_16x16x32_bf16 v[36:39], a[108:111], v[100:103], v[36:39]
v_mfma_f32_16x16x32_bf16 v[40:43], a[188:191], v[100:103], v[40:43]
v_mfma_f32_16x16x32_bf16 v[44:47], v[204:207], v[100:103], v[44:47]
ds_read_b128 v[148:151], v6 offset:19456
s_waitcnt lgkmcnt(11)
v_mfma_f32_16x16x32_bf16 v[32:35], a[32:35], v[104:107], v[32:35]
v_mfma_f32_16x16x32_bf16 v[36:39], a[112:115], v[104:107], v[36:39]
v_mfma_f32_16x16x32_bf16 v[40:43], a[192:195], v[104:107], v[40:43]
v_mfma_f32_16x16x32_bf16 v[44:47], v[208:211], v[104:107], v[44:47]
s_waitcnt lgkmcnt(10)
v_mfma_f32_16x16x32_bf16 v[32:35], a[36:39], v[108:111], v[32:35]
v_mfma_f32_16x16x32_bf16 v[36:39], a[116:119], v[108:111], v[36:39]
v_mfma_f32_16x16x32_bf16 v[40:43], a[196:199], v[108:111], v[40:43]
v_mfma_f32_16x16x32_bf16 v[44:47], v[212:215], v[108:111], v[44:47]
s_waitcnt lgkmcnt(9)
v_mfma_f32_16x16x32_bf16 v[32:35], a[40:43], v[112:115], v[32:35]
v_mfma_f32_16x16x32_bf16 v[36:39], a[120:123], v[112:115], v[36:39]
v_mfma_f32_16x16x32_bf16 v[40:43], a[200:203], v[112:115], v[40:43]
v_mfma_f32_16x16x32_bf16 v[44:47], v[216:219], v[112:115], v[44:47]
s_waitcnt lgkmcnt(8)
v_mfma_f32_16x16x32_bf16 v[32:35], a[44:47], v[116:119], v[32:35]
v_mfma_f32_16x16x32_bf16 v[36:39], a[124:127], v[116:119], v[36:39]
v_mfma_f32_16x16x32_bf16 v[40:43], a[204:207], v[116:119], v[40:43]
v_mfma_f32_16x16x32_bf16 v[44:47], v[220:223], v[116:119], v[44:47]
s_waitcnt lgkmcnt(7)
v_mfma_f32_16x16x32_bf16 v[32:35], a[48:51], v[120:123], v[32:35]
v_mfma_f32_16x16x32_bf16 v[36:39], a[128:131], v[120:123], v[36:39]
v_mfma_f32_16x16x32_bf16 v[40:43], a[208:211], v[120:123], v[40:43]
v_mfma_f32_16x16x32_bf16 v[44:47], v[224:227], v[120:123], v[44:47]
s_waitcnt lgkmcnt(6)
v_mfma_f32_16x16x32_bf16 v[32:35], a[52:55], v[124:127], v[32:35]
v_mfma_f32_16x16x32_bf16 v[36:39], a[132:135], v[124:127], v[36:39]
v_mfma_f32_16x16x32_bf16 v[40:43], a[212:215], v[124:127], v[40:43]
v_mfma_f32_16x16x32_bf16 v[44:47], v[228:231], v[124:127], v[44:47]
s_waitcnt lgkmcnt(5)
v_mfma_f32_16x16x32_bf16 v[32:35], a[56:59], v[128:131], v[32:35]
v_mfma_f32_16x16x32_bf16 v[36:39], a[136:139], v[128:131], v[36:39]
v_mfma_f32_16x16x32_bf16 v[40:43], a[216:219], v[128:131], v[40:43]
v_mfma_f32_16x16x32_bf16 v[44:47], v[232:235], v[128:131], v[44:47]
s_waitcnt lgkmcnt(4)
v_mfma_f32_16x16x32_bf16 v[32:35], a[60:63], v[132:135], v[32:35]
v_mfma_f32_16x16x32_bf16 v[36:39], a[140:143], v[132:135], v[36:39]
v_mfma_f32_16x16x32_bf16 v[40:43], a[220:223], v[132:135], v[40:43]
v_mfma_f32_16x16x32_bf16 v[44:47], v[236:239], v[132:135], v[44:47]
s_waitcnt lgkmcnt(3)
v_mfma_f32_16x16x32_bf16 v[32:35], a[64:67], v[136:139], v[32:35]
v_mfma_f32_16x16x32_bf16 v[36:39], a[144:147], v[136:139], v[36:39]
v_mfma_f32_16x16x32_bf16 v[40:43], a[224:227], v[136:139], v[40:43]
v_mfma_f32_16x16x32_bf16 v[44:47], v[240:243], v[136:139], v[44:47]
s_waitcnt lgkmcnt(2)
v_mfma_f32_16x16x32_bf16 v[32:35], a[68:71], v[140:143], v[32:35]
v_mfma_f32_16x16x32_bf16 v[36:39], a[148:151], v[140:143], v[36:39]
v_mfma_f32_16x16x32_bf16 v[40:43], a[228:231], v[140:143], v[40:43]
v_mfma_f32_16x16x32_bf16 v[44:47], v[244:247], v[140:143], v[44:47]
s_waitcnt lgkmcnt(1)
v_mfma_f32_16x16x32_bf16 v[32:35], a[72:75], v[144:147], v[32:35]
v_mfma_f32_16x16x32_bf16 v[36:39], a[152:155], v[144:147], v[36:39]
v_mfma_f32_16x16x32_bf16 v[40:43], a[232:235], v[144:147], v[40:43]
v_mfma_f32_16x16x32_bf16 v[44:47], v[248:251], v[144:147], v[44:47]
s_waitcnt lgkmcnt(0)
v_mfma_f32_16x16x32_bf16 v[32:35], a[76:79], v[148:151], v[32:35]
v_mfma_f32_16x16x32_bf16 v[36:39], a[156:159], v[148:151], v[36:39]
v_mfma_f32_16x16x32_bf16 v[40:43], a[236:239], v[148:151], v[40:43]
v_mfma_f32_16x16x32_bf16 v[44:47], v[252:255], v[148:151], v[44:47]
v_cvt_pk_bf16_f32 v8, v32, v33
v_lshlrev_b32 v32, 16, v8
v_and_b32 v33, 0xffff0000, v8
v_mul_f32 v8, s36, v32
v_mul_f32 v9, s36, v33
v_exp_f32 v8, v8
v_exp_f32 v9, v9
v_add_f32 v8, 1.0, v8
v_add_f32 v9, 1.0, v9
v_rcp_f32 v8, v8
v_rcp_f32 v9, v9
v_mul_f32 v32, v32, v8
v_mul_f32 v33, v33, v9
v_cvt_pk_bf16_f32 v48, v32, v33
v_cvt_pk_bf16_f32 v8, v34, v35
v_lshlrev_b32 v34, 16, v8
v_and_b32 v35, 0xffff0000, v8
v_mul_f32 v8, s36, v34
v_mul_f32 v9, s36, v35
v_exp_f32 v8, v8
v_exp_f32 v9, v9
v_add_f32 v8, 1.0, v8
v_add_f32 v9, 1.0, v9
v_rcp_f32 v8, v8
v_rcp_f32 v9, v9
v_mul_f32 v34, v34, v8
v_mul_f32 v35, v35, v9
v_cvt_pk_bf16_f32 v49, v34, v35
v_cvt_pk_bf16_f32 v8, v36, v37
v_lshlrev_b32 v36, 16, v8
v_and_b32 v37, 0xffff0000, v8
v_mul_f32 v8, s36, v36
v_mul_f32 v9, s36, v37
v_exp_f32 v8, v8
v_exp_f32 v9, v9
v_add_f32 v8, 1.0, v8
v_add_f32 v9, 1.0, v9
v_rcp_f32 v8, v8
v_rcp_f32 v9, v9
v_mul_f32 v36, v36, v8
v_mul_f32 v37, v37, v9
v_cvt_pk_bf16_f32 v50, v36, v37
v_cvt_pk_bf16_f32 v8, v38, v39
v_lshlrev_b32 v38, 16, v8
v_and_b32 v39, 0xffff0000, v8
v_mul_f32 v8, s36, v38
v_mul_f32 v9, s36, v39
v_exp_f32 v8, v8
v_exp_f32 v9, v9
v_add_f32 v8, 1.0, v8
v_add_f32 v9, 1.0, v9
v_rcp_f32 v8, v8
v_rcp_f32 v9, v9
v_mul_f32 v38, v38, v8
v_mul_f32 v39, v39, v9
v_cvt_pk_bf16_f32 v51, v38, v39
global_store_dwordx4 v6, v[48:51], s[26:27] offset:0 sc1
v_cvt_pk_bf16_f32 v8, v40, v41
v_lshlrev_b32 v40, 16, v8
v_and_b32 v41, 0xffff0000, v8
v_mul_f32 v8, s36, v40
v_mul_f32 v9, s36, v41
v_exp_f32 v8, v8
v_exp_f32 v9, v9
v_add_f32 v8, 1.0, v8
v_add_f32 v9, 1.0, v9
v_rcp_f32 v8, v8
v_rcp_f32 v9, v9
v_mul_f32 v40, v40, v8
v_mul_f32 v41, v41, v9
v_cvt_pk_bf16_f32 v52, v40, v41
v_cvt_pk_bf16_f32 v8, v42, v43
v_lshlrev_b32 v42, 16, v8
v_and_b32 v43, 0xffff0000, v8
v_mul_f32 v8, s36, v42
v_mul_f32 v9, s36, v43
v_exp_f32 v8, v8
v_exp_f32 v9, v9
v_add_f32 v8, 1.0, v8
v_add_f32 v9, 1.0, v9
v_rcp_f32 v8, v8
v_rcp_f32 v9, v9
v_mul_f32 v42, v42, v8
v_mul_f32 v43, v43, v9
v_cvt_pk_bf16_f32 v53, v42, v43
v_cvt_pk_bf16_f32 v8, v44, v45
v_lshlrev_b32 v44, 16, v8
v_and_b32 v45, 0xffff0000, v8
v_mul_f32 v8, s36, v44
v_mul_f32 v9, s36, v45
v_exp_f32 v8, v8
v_exp_f32 v9, v9
v_add_f32 v8, 1.0, v8
v_add_f32 v9, 1.0, v9
v_rcp_f32 v8, v8
v_rcp_f32 v9, v9
v_mul_f32 v44, v44, v8
v_mul_f32 v45, v45, v9
v_cvt_pk_bf16_f32 v54, v44, v45
v_cvt_pk_bf16_f32 v8, v46, v47
v_lshlrev_b32 v46, 16, v8
v_and_b32 v47, 0xffff0000, v8
v_mul_f32 v8, s36, v46
v_mul_f32 v9, s36, v47
v_exp_f32 v8, v8
v_exp_f32 v9, v9
v_add_f32 v8, 1.0, v8
v_add_f32 v9, 1.0, v9
v_rcp_f32 v8, v8
v_rcp_f32 v9, v9
v_mul_f32 v46, v46, v8
v_mul_f32 v47, v47, v9
v_cvt_pk_bf16_f32 v55, v46, v47
global_store_dwordx4 v6, v[52:55], s[26:27] offset:1024 sc1
s_and_b32 s13, s2, 1
s_mul_i32 s13, s13, 7
s_add_u32 s13, s13, s44
s_lshl_b32 s13, s13, 7
s_add_u32 s13, s13, s43
s_add_u32 s13, s13, 8192
s_waitcnt vmcnt(0)
s_barrier
s_cmp_lg_u32 s12, 3
s_cbranch_scc1 L_rf_71
v_mov_b32 v8, s13
v_mov_b32 v9, 1
s_mov_b64 exec, 1
global_store_dword v8, v9, s[8:9] sc1
s_mov_b64 exec, -1
L_rf_71:
s_add_u32 s2, s2, 8
s_cmp_lt_u32 s2, 128
s_cbranch_scc1 L_f1_loop
s_waitcnt vmcnt(0)
s_endpgm
L_st_ln:
s_mov_b32 s2, s40
s_mov_b32 s44, 6
v_mov_b32 v2, 144
s_cmp_lg_u32 s12, 0
s_cbranch_scc1 L_wd_73
s_mov_b32 s96, 0x80000
L_wf_72:
global_load_dword v3, v2, s[94:95] sc1
s_waitcnt vmcnt(0)
v_cmp_gt_u32 vcc, 1, v3
s_nop 0
s_cbranch_vccz L_wd_73
s_sleep 3
s_sub_u32 s96, s96, 1
s_cbranch_scc0 L_wf_72
s_branch L_wabort
L_wd_73:
s_barrier
v_lshlrev_b32 v10, 4, v0
s_lshl_b32 s3, s12, 10
s_add_u32 m0, s3, 32768
s_add_u32 s14, s8, 62919680
s_addc_u32 s15, s9, 0
global_load_lds_dwordx4 v10, s[14:15] sc1
s_add_u32 m0, s3, 36864
s_add_u32 s14, s14, 4096
s_addc_u32 s15, s15, 0
global_load_lds_dwordx4 v10, s[14:15] sc1
s_load_dwordx2 s[4:5], s[0:1], 0
v_and_b32 v1, 63, v0
v_lshrrev_b32 v2, 4, v1
v_and_b32 v3, 15, v1
v_lshlrev_b32 v6, 4, v1
s_lshl_b32 s3, s12, 6
v_lshlrev_b32 v7, 2, v3
v_add_u32 v4, s3, v7
s_mul_i32 s29, s12, 5120
v_add_u32 v30, s29, v6
s_mul_i32 s3, s12, 640
v_lshlrev_b32 v31, 4, v2
v_add_u32 v31, s3, v31
s_waitcnt vmcnt(0) lgkmcnt(0)
s_barrier
L_ln_loop:
s_lshr_b32 s43, s2, 1
s_mul_i32 s43, s43, 10240
s_add_u32 s43, s43, 73400320
s_mul_i32 s3, s2, 20480
s_add_u32 s3, s3, 134219776
s_add_u32 s26, s8, s3
s_addc_u32 s27, s9, 0
v_mul_u32_u24 v5, 1280, v3
v_lshl_add_u32 v5, v2, 3, v5
s_mul_i32 s3, s2, 20480
s_mul_i32 s13, s12, 320
s_add_u32 s3, s3, s13
v_add_u32 v5, s3, v5
global_load_dwordx2 v[10:11], v5, s[4:5] offset:0
global_load_dwordx2 v[12:13], v5, s[4:5] offset:32
global_load_dwordx2 v[14:15], v5, s[4:5] offset:64
global_load_dwordx2 v[16:17], v5, s[4:5] offset:96
global_load_dwordx2 v[18:19], v5, s[4:5] offset:128
global_load_dwordx2 v[20:21], v5, s[4:5] offset:160
global_load_dwordx2 v[22:23], v5, s[4:5] offset:192
global_load_dwordx2 v[24:25], v5, s[4:5] offset:224
global_load_dwordx2 v[26:27], v5, s[4:5] offset:256
global_load_dwordx2 v[28:29], v5, s[4:5] offset:288
v_and_b32 v9, 1, v1
v_bfe_u32 v8, v1, 1, 2
v_lshl_add_u32 v9, v8, 3, v9
v_lshlrev_b32 v9, 7, v9
s_lshl_b32 s3, s12, 8
s_add_u32 s3, s3, s43
s_add_u32 s3, s3, 4096
v_add_u32 v9, s3, v9
s_mul_i32 s3, s2, 40
s_mul_i32 s13, s12, 10
s_add_u32 s3, s3, s13
s_lshl_b32 s14, s3, 10
s_add_u32 s3, s14, 100667392
s_add_u32 s16, s8, s3
s_addc_u32 s17, s9, 0
s_add_u32 s3, s14, 125833216
s_add_u32 s18, s8, s3
s_addc_u32 s19, s9, 0
v_add_u32 v5, 8192, v6
s_mov_b32 s96, 0x80000
L_wf_74:
global_load_dword v8, v9, s[8:9] sc1
s_waitcnt vmcnt(0)
v_cmp_gt_u32 vcc, 1, v8
s_nop 0
s_cbranch_vccz L_wd_75
s_sleep 1
s_sub_u32 s96, s96, 1
s_cbranch_scc0 L_wf_74
s_branch L_wabort
L_wd_75:
global_load_dwordx4 v[32:35], v6, s[16:17] offset:-4096 sc1
global_load_dwordx4 v[36:39], v6, s[16:17] offset:-3072 sc1
global_load_dwordx4 v[40:43], v6, s[16:17] offset:-2048 sc1
global_load_dwordx4 v[44:47], v6, s[16:17] offset:-1024 sc1
global_load_dwordx4 v[48:51], v6, s[16:17] offset:0 sc1
global_load_dwordx4 v[52:55], v6, s[16:17] offset:1024 sc1
global_load_dwordx4 v[56:59], v6, s[16:17] offset:2048 sc1
global_load_dwordx4 v[60:63], v6, s[16:17] offset:3072 sc1
global_load_dwordx4 v[64:67], v5, s[16:17] offset:-4096 sc1
global_load_dwordx4 v[68:71], v5, s[16:17] offset:-3072 sc1
s_add_u32 s16, s16, 5242880
s_addc_u32 s17, s17, 0
global_load_dwordx4 v[72:75], v6, s[16:17] offset:-4096 sc1
global_load_dwordx4 v[76:79], v6, s[16:17] offset:-3072 sc1
global_load_dwordx4 v[80:83], v6, s[16:17] offset:-2048 sc1
global_load_dwordx4 v[84:87], v6, s[16:17] offset:-1024 sc1
global_load_dwordx4 v[88:91], v6, s[16:17] offset:0 sc1
global_load_dwordx4 v[92:95], v6, s[16:17] offset:1024 sc1
global_load_dwordx4 v[96:99], v6, s[16:17] offset:2048 sc1
global_load_dwordx4 v[100:103], v6, s[16:17] offset:3072 sc1
global_load_dwordx4 v[104:107], v5, s[16:17] offset:-4096 sc1
global_load_dwordx4 v[108:111], v5, s[16:17] offset:-3072 sc1
s_add_u32 s16, s16, 5242880
s_addc_u32 s17, s17, 0
global_load_dwordx4 v[112:115], v6, s[16:17] offset:-4096 sc1
global_load_dwordx4 v[116:119], v6, s[16:17] offset:-3072 sc1
global_load_dwordx4 v[120:123], v6, s[16:17] offset:-2048 sc1
global_load_dwordx4 v[124:127], v6, s[16:17] offset:-1024 sc1
global_load_dwordx4 v[128:131], v6, s[16:17] offset:0 sc1
global_load_dwordx4 v[132:135], v6, s[16:17] offset:1024 sc1
global_load_dwordx4 v[136:139], v6, s[16:17] offset:2048 sc1
global_load_dwordx4 v[140:143], v6, s[16:17] offset:3072 sc1
global_load_dwordx4 v[144:147], v5, s[16:17] offset:-4096 sc1
global_load_dwordx4 v[148:151], v5, s[16:17] offset:-3072 sc1
s_add_u32 s16, s16, 5242880
s_addc_u32 s17, s17, 0
global_load_dwordx4 v[152:155], v6, s[16:17] offset:-4096 sc1
global_load_dwordx4 v[156:159], v6, s[16:17] offset:-3072 sc1
global_load_dwordx4 v[160:163], v6, s[16:17] offset:-2048 sc1
global_load_dwordx4 v[164:167], v6, s[16:17] offset:-1024 sc1
global_load_dwordx4 v[168:171], v6, s[16:17] offset:0 sc1
global_load_dwordx4 v[172:175], v6, s[16:17] offset:1024 sc1
global_load_dwordx4 v[176:179], v6, s[16:17] offset:2048 sc1
global_load_dwordx4 v[180:183], v6, s[16:17] offset:3072 sc1
global_load_dwordx4 v[184:187], v5, s[16:17] offset:-4096 sc1
global_load_dwordx4 v[188:191], v5, s[16:17] offset:-3072 sc1
s_waitcnt vmcnt(20)
v_pk_add_f32 v[32:33], v[32:33], v[72:73]
v_pk_add_f32 v[34:35], v[34:35], v[74:75]
v_pk_add_f32 v[36:37], v[36:37], v[76:77]
v_pk_add_f32 v[38:39], v[38:39], v[78:79]
v_pk_add_f32 v[40:41], v[40:41], v[80:81]
v_pk_add_f32 v[42:43], v[42:43], v[82:83]
v_pk_add_f32 v[44:45], v[44:45], v[84:85]
v_pk_add_f32 v[46:47], v[46:47], v[86:87]
v_pk_add_f32 v[48:49], v[48:49], v[88:89]
v_pk_add_f32 v[50:51], v[50:51], v[90:91]
v_pk_add_f32 v[52:53], v[52:53], v[92:93]
v_pk_add_f32 v[54:55], v[54:55], v[94:95]
v_pk_add_f32 v[56:57], v[56:57], v[96:97]
v_pk_add_f32 v[58:59], v[58:59], v[98:99]
v_pk_add_f32 v[60:61], v[60:61], v[100:101]
v_pk_add_f32 v[62:63], v[62:63], v[102:103]
v_pk_add_f32 v[64:65], v[64:65], v[104:105]
v_pk_add_f32 v[66:67], v[66:67], v[106:107]
v_pk_add_f32 v[68:69], v[68:69], v[108:109]
v_pk_add_f32 v[70:71], v[70:71], v[110:111]
ds_read_b128 v[72:75], v31 offset:32768
ds_read_b128 v[76:79], v31 offset:32832
ds_read_b128 v[80:83], v31 offset:32896
ds_read_b128 v[84:87], v31 offset:32960
ds_read_b128 v[88:91], v31 offset:33024
ds_read_b128 v[92:95], v31 offset:33088
ds_read_b128 v[96:99], v31 offset:33152
ds_read_b128 v[100:103], v31 offset:33216
ds_read_b128 v[104:107], v31 offset:33280
ds_read_b128 v[108:111], v31 offset:33344
s_waitcnt vmcnt(10)
v_pk_add_f32 v[32:33], v[32:33], v[112:113]
v_pk_add_f32 v[34:35], v[34:35], v[114:115]
v_pk_add_f32 v[36:37], v[36:37], v[116:117]
v_pk_add_f32 v[38:39], v[38:39], v[118:119]
v_pk_add_f32 v[40:41], v[40:41], v[120:121]
v_pk_add_f32 v[42:43], v[42:43], v[122:123]
v_pk_add_f32 v[44:45], v[44:45], v[124:125]
v_pk_add_f32 v[46:47], v[46:47], v[126:127]
v_pk_add_f32 v[48:49], v[48:49], v[128:129]
v_pk_add_f32 v[50:51], v[50:51], v[130:131]
v_pk_add_f32 v[52:53], v[52:53], v[132:133]
v_pk_add_f32 v[54:55], v[54:55], v[134:135]
v_pk_add_f32 v[56:57], v[56:57], v[136:137]
v_pk_add_f32 v[58:59], v[58:59], v[138:139]
v_pk_add_f32 v[60:61], v[60:61], v[140:141]
v_pk_add_f32 v[62:63], v[62:63], v[142:143]
v_pk_add_f32 v[64:65], v[64:65], v[144:145]
v_pk_add_f32 v[66:67], v[66:67], v[146:147]
v_pk_add_f32 v[68:69], v[68:69], v[148:149]
v_pk_add_f32 v[70:71], v[70:71], v[150:151]
v_lshlrev_b32 v112, 16, v10
v_and_b32 v113, 0xffff0000, v10
v_lshlrev_b32 v114, 16, v11
v_and_b32 v115, 0xffff0000, v11
v_lshlrev_b32 v116, 16, v12
v_and_b32 v117, 0xffff0000, v12
v_lshlrev_b32 v118, 16, v13
v_and_b32 v119, 0xffff0000, v13
v_lshlrev_b32 v120, 16, v14
v_and_b32 v121, 0xffff0000, v14
v_lshlrev_b32 v122, 16, v15
v_and_b32 v123, 0xffff0000, v15
v_lshlrev_b32 v124, 16, v16
v_and_b32 v125, 0xffff0000, v16
v_lshlrev_b32 v126, 16, v17
v_and_b32 v127, 0xffff0000, v17
v_lshlrev_b32 v128, 16, v18
v_and_b32 v129, 0xffff0000, v18
v_lshlrev_b32 v130, 16, v19
v_and_b32 v131, 0xffff0000, v19
v_lshlrev_b32 v132, 16, v20
v_and_b32 v133, 0xffff0000, v20
v_lshlrev_b32 v134, 16, v21
v_and_b32 v135, 0xffff0000, v21
v_lshlrev_b32 v136, 16, v22
v_and_b32 v137, 0xffff0000, v22
v_lshlrev_b32 v138, 16, v23
v_and_b32 v139, 0xffff0000, v23
v_lshlrev_b32 v140, 16, v24
v_and_b32 v141, 0xffff0000, v24
v_lshlrev_b32 v142, 16, v25
v_and_b32 v143, 0xffff0000, v25
v_lshlrev_b32 v144, 16, v26
v_and_b32 v145, 0xffff0000, v26
v_lshlrev_b32 v146, 16, v27
v_and_b32 v147, 0xffff0000, v27
v_lshlrev_b32 v148, 16, v28
v_and_b32 v149, 0xffff0000, v28
v_lshlrev_b32 v150, 16, v29
v_and_b32 v151, 0xffff0000, v29
s_waitcnt lgkmcnt(0)
s_waitcnt vmcnt(9)
v_pk_add_f32 v[32:33], v[32:33], v[152:153]
v_cvt_pk_bf16_f32 v9, v32, v33
v_lshlrev_b32 v32, 16, v9
v_and_b32 v33, 0xffff0000, v9
v_pk_mul_f32 v[32:33], v[32:33], v[72:73]
v_cvt_pk_bf16_f32 v9, v32, v33
v_lshlrev_b32 v32, 16, v9
v_and_b32 v33, 0xffff0000, v9
v_pk_add_f32 v[32:33], v[32:33], v[112:113]
v_cvt_pk_bf16_f32 v9, v32, v33
v_lshlrev_b32 v32, 16, v9
v_and_b32 v33, 0xffff0000, v9
v_pk_add_f32 v[34:35], v[34:35], v[154:155]
v_cvt_pk_bf16_f32 v9, v34, v35
v_lshlrev_b32 v34, 16, v9
v_and_b32 v35, 0xffff0000, v9
v_pk_mul_f32 v[34:35], v[34:35], v[74:75]
v_cvt_pk_bf16_f32 v9, v34, v35
v_lshlrev_b32 v34, 16, v9
v_and_b32 v35, 0xffff0000, v9
v_pk_add_f32 v[34:35], v[34:35], v[114:115]
v_cvt_pk_bf16_f32 v9, v34, v35
v_lshlrev_b32 v34, 16, v9
v_and_b32 v35, 0xffff0000, v9
s_waitcnt vmcnt(8)
v_pk_add_f32 v[36:37], v[36:37], v[156:157]
v_cvt_pk_bf16_f32 v9, v36, v37
v_lshlrev_b32 v36, 16, v9
v_and_b32 v37, 0xffff0000, v9
v_pk_mul_f32 v[36:37], v[36:37], v[76:77]
v_cvt_pk_bf16_f32 v9, v36, v37
v_lshlrev_b32 v36, 16, v9
v_and_b32 v37, 0xffff0000, v9
v_pk_add_f32 v[36:37], v[36:37], v[116:117]
v_cvt_pk_bf16_f32 v9, v36, v37
v_lshlrev_b32 v36, 16, v9
v_and_b32 v37, 0xffff0000, v9
v_pk_add_f32 v[38:39], v[38:39], v[158:159]
v_cvt_pk_bf16_f32 v9, v38, v39
v_lshlrev_b32 v38, 16, v9
v_and_b32 v39, 0xffff0000, v9
v_pk_mul_f32 v[38:39], v[38:39], v[78:79]
v_cvt_pk_bf16_f32 v9, v38, v39
v_lshlrev_b32 v38, 16, v9
v_and_b32 v39, 0xffff0000, v9
v_pk_add_f32 v[38:39], v[38:39], v[118:119]
v_cvt_pk_bf16_f32 v9, v38, v39
v_lshlrev_b32 v38, 16, v9
v_and_b32 v39, 0xffff0000, v9
s_waitcnt vmcnt(7)
v_pk_add_f32 v[40:41], v[40:41], v[160:161]
v_cvt_pk_bf16_f32 v9, v40, v41
v_lshlrev_b32 v40, 16, v9
v_and_b32 v41, 0xffff0000, v9
v_pk_mul_f32 v[40:41], v[40:41], v[80:81]
v_cvt_pk_bf16_f32 v9, v40, v41
v_lshlrev_b32 v40, 16, v9
v_and_b32 v41, 0xffff0000, v9
v_pk_add_f32 v[40:41], v[40:41], v[120:121]
v_cvt_pk_bf16_f32 v9, v40, v41
v_lshlrev_b32 v40, 16, v9
v_and_b32 v41, 0xffff0000, v9
v_pk_add_f32 v[42:43], v[42:43], v[162:163]
v_cvt_pk_bf16_f32 v9, v42, v43
v_lshlrev_b32 v42, 16, v9
v_and_b32 v43, 0xffff0000, v9
v_pk_mul_f32 v[42:43], v[42:43], v[82:83]
v_cvt_pk_bf16_f32 v9, v42, v43
v_lshlrev_b32 v42, 16, v9
v_and_b32 v43, 0xffff0000, v9
v_pk_add_f32 v[42:43], v[42:43], v[122:123]
v_cvt_pk_bf16_f32 v9, v42, v43
v_lshlrev_b32 v42, 16, v9
v_and_b32 v43, 0xffff0000, v9
s_waitcnt vmcnt(6)
v_pk_add_f32 v[44:45], v[44:45], v[164:165]
v_cvt_pk_bf16_f32 v9, v44, v45
v_lshlrev_b32 v44, 16, v9
v_and_b32 v45, 0xffff0000, v9
v_pk_mul_f32 v[44:45], v[44:45], v[84:85]
v_cvt_pk_bf16_f32 v9, v44, v45
v_lshlrev_b32 v44, 16, v9
v_and_b32 v45, 0xffff0000, v9
v_pk_add_f32 v[44:45], v[44:45], v[124:125]
v_cvt_pk_bf16_f32 v9, v44, v45
v_lshlrev_b32 v44, 16, v9
v_and_b32 v45, 0xffff0000, v9
v_pk_add_f32 v[46:47], v[46:47], v[166:167]
v_cvt_pk_bf16_f32 v9, v46, v47
v_lshlrev_b32 v46, 16, v9
v_and_b32 v47, 0xffff0000, v9
v_pk_mul_f32 v[46:47], v[46:47], v[86:87]
v_cvt_pk_bf16_f32 v9, v46, v47
v_lshlrev_b32 v46, 16, v9
v_and_b32 v47, 0xffff0000, v9
v_pk_add_f32 v[46:47], v[46:47], v[126:127]
v_cvt_pk_bf16_f32 v9, v46, v47
v_lshlrev_b32 v46, 16, v9
v_and_b32 v47, 0xffff0000, v9
s_waitcnt vmcnt(5)
v_pk_add_f32 v[48:49], v[48:49], v[168:169]
v_cvt_pk_bf16_f32 v9, v48, v49
v_lshlrev_b32 v48, 16, v9
v_and_b32 v49, 0xffff0000, v9
v_pk_mul_f32 v[48:49], v[48:49], v[88:89]
v_cvt_pk_bf16_f32 v9, v48, v49
v_lshlrev_b32 v48, 16, v9
v_and_b32 v49, 0xffff0000, v9
v_pk_add_f32 v[48:49], v[48:49], v[128:129]
v_cvt_pk_bf16_f32 v9, v48, v49
v_lshlrev_b32 v48, 16, v9
v_and_b32 v49, 0xffff0000, v9
v_pk_add_f32 v[50:51], v[50:51], v[170:171]
v_cvt_pk_bf16_f32 v9, v50, v51
v_lshlrev_b32 v50, 16, v9
v_and_b32 v51, 0xffff0000, v9
v_pk_mul_f32 v[50:51], v[50:51], v[90:91]
v_cvt_pk_bf16_f32 v9, v50, v51
v_lshlrev_b32 v50, 16, v9
v_and_b32 v51, 0xffff0000, v9
v_pk_add_f32 v[50:51], v[50:51], v[130:131]
v_cvt_pk_bf16_f32 v9, v50, v51
v_lshlrev_b32 v50, 16, v9
v_and_b32 v51, 0xffff0000, v9
s_waitcnt vmcnt(4)
v_pk_add_f32 v[52:53], v[52:53], v[172:173]
v_cvt_pk_bf16_f32 v9, v52, v53
v_lshlrev_b32 v52, 16, v9
v_and_b32 v53, 0xffff0000, v9
v_pk_mul_f32 v[52:53], v[52:53], v[92:93]
v_cvt_pk_bf16_f32 v9, v52, v53
v_lshlrev_b32 v52, 16, v9
v_and_b32 v53, 0xffff0000, v9
v_pk_add_f32 v[52:53], v[52:53], v[132:133]
v_cvt_pk_bf16_f32 v9, v52, v53
v_lshlrev_b32 v52, 16, v9
v_and_b32 v53, 0xffff0000, v9
v_pk_add_f32 v[54:55], v[54:55], v[174:175]
v_cvt_pk_bf16_f32 v9, v54, v55
v_lshlrev_b32 v54, 16, v9
v_and_b32 v55, 0xffff0000, v9
v_pk_mul_f32 v[54:55], v[54:55], v[94:95]
v_cvt_pk_bf16_f32 v9, v54, v55
v_lshlrev_b32 v54, 16, v9
v_and_b32 v55, 0xffff0000, v9
v_pk_add_f32 v[54:55], v[54:55], v[134:135]
v_cvt_pk_bf16_f32 v9, v54, v55
v_lshlrev_b32 v54, 16, v9
v_and_b32 v55, 0xffff0000, v9
s_waitcnt vmcnt(3)
v_pk_add_f32 v[56:57], v[56:57], v[176:177]
v_cvt_pk_bf16_f32 v9, v56, v57
v_lshlrev_b32 v56, 16, v9
v_and_b32 v57, 0xffff0000, v9
v_pk_mul_f32 v[56:57], v[56:57], v[96:97]
v_cvt_pk_bf16_f32 v9, v56, v57
v_lshlrev_b32 v56, 16, v9
v_and_b32 v57, 0xffff0000, v9
v_pk_add_f32 v[56:57], v[56:57], v[136:137]
v_cvt_pk_bf16_f32 v9, v56, v57
v_lshlrev_b32 v56, 16, v9
v_and_b32 v57, 0xffff0000, v9
v_pk_add_f32 v[58:59], v[58:59], v[178:179]
v_cvt_pk_bf16_f32 v9, v58, v59
v_lshlrev_b32 v58, 16, v9
v_and_b32 v59, 0xffff0000, v9
v_pk_mul_f32 v[58:59], v[58:59], v[98:99]
v_cvt_pk_bf16_f32 v9, v58, v59
v_lshlrev_b32 v58, 16, v9
v_and_b32 v59, 0xffff0000, v9
v_pk_add_f32 v[58:59], v[58:59], v[138:139]
v_cvt_pk_bf16_f32 v9, v58, v59
v_lshlrev_b32 v58, 16, v9
v_and_b32 v59, 0xffff0000, v9
s_waitcnt vmcnt(2)
v_pk_add_f32 v[60:61], v[60:61], v[180:181]
v_cvt_pk_bf16_f32 v9, v60, v61
v_lshlrev_b32 v60, 16, v9
v_and_b32 v61, 0xffff0000, v9
v_pk_mul_f32 v[60:61], v[60:61], v[100:101]
v_cvt_pk_bf16_f32 v9, v60, v61
v_lshlrev_b32 v60, 16, v9
v_and_b32 v61, 0xffff0000, v9
v_pk_add_f32 v[60:61], v[60:61], v[140:141]
v_cvt_pk_bf16_f32 v9, v60, v61
v_lshlrev_b32 v60, 16, v9
v_and_b32 v61, 0xffff0000, v9
v_pk_add_f32 v[62:63], v[62:63], v[182:183]
v_cvt_pk_bf16_f32 v9, v62, v63
v_lshlrev_b32 v62, 16, v9
v_and_b32 v63, 0xffff0000, v9
v_pk_mul_f32 v[62:63], v[62:63], v[102:103]
v_cvt_pk_bf16_f32 v9, v62, v63
v_lshlrev_b32 v62, 16, v9
v_and_b32 v63, 0xffff0000, v9
v_pk_add_f32 v[62:63], v[62:63], v[142:143]
v_cvt_pk_bf16_f32 v9, v62, v63
v_lshlrev_b32 v62, 16, v9
v_and_b32 v63, 0xffff0000, v9
s_waitcnt vmcnt(1)
v_pk_add_f32 v[64:65], v[64:65], v[184:185]
v_cvt_pk_bf16_f32 v9, v64, v65
v_lshlrev_b32 v64, 16, v9
v_and_b32 v65, 0xffff0000, v9
v_pk_mul_f32 v[64:65], v[64:65], v[104:105]
v_cvt_pk_bf16_f32 v9, v64, v65
v_lshlrev_b32 v64, 16, v9
v_and_b32 v65, 0xffff0000, v9
v_pk_add_f32 v[64:65], v[64:65], v[144:145]
v_cvt_pk_bf16_f32 v9, v64, v65
v_lshlrev_b32 v64, 16, v9
v_and_b32 v65, 0xffff0000, v9
v_pk_add_f32 v[66:67], v[66:67], v[186:187]
v_cvt_pk_bf16_f32 v9, v66, v67
v_lshlrev_b32 v66, 16, v9
v_and_b32 v67, 0xffff0000, v9
v_pk_mul_f32 v[66:67], v[66:67], v[106:107]
v_cvt_pk_bf16_f32 v9, v66, v67
v_lshlrev_b32 v66, 16, v9
v_and_b32 v67, 0xffff0000, v9
v_pk_add_f32 v[66:67], v[66:67], v[146:147]
v_cvt_pk_bf16_f32 v9, v66, v67
v_lshlrev_b32 v66, 16, v9
v_and_b32 v67, 0xffff0000, v9
s_waitcnt vmcnt(0)
v_pk_add_f32 v[68:69], v[68:69], v[188:189]
v_cvt_pk_bf16_f32 v9, v68, v69
v_lshlrev_b32 v68, 16, v9
v_and_b32 v69, 0xffff0000, v9
v_pk_mul_f32 v[68:69], v[68:69], v[108:109]
v_cvt_pk_bf16_f32 v9, v68, v69
v_lshlrev_b32 v68, 16, v9
v_and_b32 v69, 0xffff0000, v9
v_pk_add_f32 v[68:69], v[68:69], v[148:149]
v_cvt_pk_bf16_f32 v9, v68, v69
v_lshlrev_b32 v68, 16, v9
v_and_b32 v69, 0xffff0000, v9
v_pk_add_f32 v[70:71], v[70:71], v[190:191]
v_cvt_pk_bf16_f32 v9, v70, v71
v_lshlrev_b32 v70, 16, v9
v_and_b32 v71, 0xffff0000, v9
v_pk_mul_f32 v[70:71], v[70:71], v[110:111]
v_cvt_pk_bf16_f32 v9, v70, v71
v_lshlrev_b32 v70, 16, v9
v_and_b32 v71, 0xffff0000, v9
v_pk_add_f32 v[70:71], v[70:71], v[150:151]
v_cvt_pk_bf16_f32 v9, v70, v71
v_lshlrev_b32 v70, 16, v9
v_and_b32 v71, 0xffff0000, v9
ds_read_b128 v[112:115], v31 offset:35328
ds_read_b128 v[152:155], v31 offset:37888
ds_read_b128 v[116:119], v31 offset:35392
ds_read_b128 v[156:159], v31 offset:37952
ds_read_b128 v[120:123], v31 offset:35456
ds_read_b128 v[160:163], v31 offset:38016
ds_read_b128 v[124:127], v31 offset:35520
ds_read_b128 v[164:167], v31 offset:38080
ds_read_b128 v[128:131], v31 offset:35584
ds_read_b128 v[168:171], v31 offset:38144
ds_read_b128 v[132:135], v31 offset:35648
ds_read_b128 v[172:175], v31 offset:38208
ds_read_b128 v[136:139], v31 offset:35712
ds_read_b128 v[176:179], v31 offset:38272
ds_read_b128 v[140:143], v31 offset:35776
ds_read_b128 v[180:183], v31 offset:38336
ds_read_b128 v[144:147], v31 offset:35840
ds_read_b128 v[184:187], v31 offset:38400
ds_read_b128 v[148:151], v31 offset:35904
ds_read_b128 v[188:191], v31 offset:38464
s_cmp_lg_u32 s44, 6
s_cbranch_scc1 L_ln_nox1
global_store_dwordx4 v6, v[32:35], s[18:19] offset:-4096 sc1
global_store_dwordx4 v6, v[36:39], s[18:19] offset:-3072 sc1
global_store_dwordx4 v6, v[40:43], s[18:19] offset:-2048 sc1
global_store_dwordx4 v6, v[44:47], s[18:19] offset:-1024 sc1
global_store_dwordx4 v6, v[48:51], s[18:19] offset:0 sc1
global_store_dwordx4 v6, v[52:55], s[18:19] offset:1024 sc1
global_store_dwordx4 v6, v[56:59], s[18:19] offset:2048 sc1
global_store_dwordx4 v6, v[60:63], s[18:19] offset:3072 sc1
global_store_dwordx4 v5, v[64:67], s[18:19] offset:-4096 sc1
global_store_dwordx4 v5, v[68:71], s[18:19] offset:-3072 sc1
L_ln_nox1:
v_pk_add_f32 v[8:9], v[32:33], v[34:35]
v_pk_add_f32 v[8:9], v[8:9], v[36:37]
v_pk_add_f32 v[8:9], v[8:9], v[38:39]
v_pk_add_f32 v[8:9], v[8:9], v[40:41]
v_pk_add_f32 v[8:9], v[8:9], v[42:43]
v_pk_add_f32 v[8:9], v[8:9], v[44:45]
v_pk_add_f32 v[8:9], v[8:9], v[46:47]
v_pk_add_f32 v[8:9], v[8:9], v[48:49]
v_pk_add_f32 v[8:9], v[8:9], v[50:51]
v_pk_add_f32 v[8:9], v[8:9], v[52:53]
v_pk_add_f32 v[8:9], v[8:9], v[54:55]
v_pk_add_f32 v[8:9], v[8:9], v[56:57]
v_pk_add_f32 v[8:9], v[8:9], v[58:59]
v_pk_add_f32 v[8:9], v[8:9], v[60:61]
v_pk_add_f32 v[8:9], v[8:9], v[62:63]
v_pk_add_f32 v[8:9], v[8:9], v[64:65]
v_pk_add_f32 v[8:9], v[8:9], v[66:67]
v_pk_add_f32 v[8:9], v[8:9], v[68:69]
v_pk_add_f32 v[8:9], v[8:9], v[70:71]
v_add_f32 v8, v8, v9
v_mov_b32 v9, v8
s_nop 1
v_permlane32_swap_b32 v8, v9
v_add_f32 v8, v8, v9
v_mov_b32 v9, v8
s_nop 1
v_permlane16_swap_b32 v8, v9
v_add_f32 v8, v8, v9
ds_write_b32 v4, v8 offset:40960
s_waitcnt lgkmcnt(0)
s_barrier
ds_read_b32 v10, v7 offset:40960
ds_read_b32 v11, v7 offset:41024
ds_read_b32 v12, v7 offset:41088
ds_read_b32 v13, v7 offset:41152
s_waitcnt lgkmcnt(0)
v_add_f32 v10, v10, v11
v_add_f32 v12, v12, v13
v_add_f32 v8, v10, v12
v_mul_f32 v14, 0x3acccccd, v8
v_mov_b32 v15, v14
v_cvt_pk_bf16_f32 v15, v15, v15
v_and_b32 v15, 0xffff0000, v15
v_mov_b32 v8, 0
v_mov_b32 v9, 0
v_pk_add_f32 v[32:33], v[32:33], v[14:15] op_sel_hi:[1,0] neg_lo:[0,1] neg_hi:[0,1]
s_nop 0
v_pk_fma_f32 v[8:9], v[32:33], v[32:33], v[8:9]
v_pk_add_f32 v[34:35], v[34:35], v[14:15] op_sel_hi:[1,0] neg_lo:[0,1] neg_hi:[0,1]
s_nop 0
v_pk_fma_f32 v[8:9], v[34:35], v[34:35], v[8:9]
v_pk_add_f32 v[36:37], v[36:37], v[14:15] op_sel_hi:[1,0] neg_lo:[0,1] neg_hi:[0,1]
s_nop 0
v_pk_fma_f32 v[8:9], v[36:37], v[36:37], v[8:9]
v_pk_add_f32 v[38:39], v[38:39], v[14:15] op_sel_hi:[1,0] neg_lo:[0,1] neg_hi:[0,1]
s_nop 0
v_pk_fma_f32 v[8:9], v[38:39], v[38:39], v[8:9]
v_pk_add_f32 v[40:41], v[40:41], v[14:15] op_sel_hi:[1,0] neg_lo:[0,1] neg_hi:[0,1]
s_nop 0
v_pk_fma_f32 v[8:9], v[40:41], v[40:41], v[8:9]
v_pk_add_f32 v[42:43], v[42:43], v[14:15] op_sel_hi:[1,0] neg_lo:[0,1] neg_hi:[0,1]
s_nop 0
v_pk_fma_f32 v[8:9], v[42:43], v[42:43], v[8:9]
v_pk_add_f32 v[44:45], v[44:45], v[14:15] op_sel_hi:[1,0] neg_lo:[0,1] neg_hi:[0,1]
s_nop 0
v_pk_fma_f32 v[8:9], v[44:45], v[44:45], v[8:9]
v_pk_add_f32 v[46:47], v[46:47], v[14:15] op_sel_hi:[1,0] neg_lo:[0,1] neg_hi:[0,1]
s_nop 0
v_pk_fma_f32 v[8:9], v[46:47], v[46:47], v[8:9]
v_pk_add_f32 v[48:49], v[48:49], v[14:15] op_sel_hi:[1,0] neg_lo:[0,1] neg_hi:[0,1]
s_nop 0
v_pk_fma_f32 v[8:9], v[48:49], v[48:49], v[8:9]
v_pk_add_f32 v[50:51], v[50:51], v[14:15] op_sel_hi:[1,0] neg_lo:[0,1] neg_hi:[0,1]
s_nop 0
v_pk_fma_f32 v[8:9], v[50:51], v[50:51], v[8:9]
v_pk_add_f32 v[52:53], v[52:53], v[14:15] op_sel_hi:[1,0] neg_lo:[0,1] neg_hi:[0,1]
s_nop 0
v_pk_fma_f32 v[8:9], v[52:53], v[52:53], v[8:9]
v_pk_add_f32 v[54:55], v[54:55], v[14:15] op_sel_hi:[1,0] neg_lo:[0,1] neg_hi:[0,1]
s_nop 0
v_pk_fma_f32 v[8:9], v[54:55], v[54:55], v[8:9]
v_pk_add_f32 v[56:57], v[56:57], v[14:15] op_sel_hi:[1,0] neg_lo:[0,1] neg_hi:[0,1]
s_nop 0
v_pk_fma_f32 v[8:9], v[56:57], v[56:57], v[8:9]
v_pk_add_f32 v[58:59], v[58:59], v[14:15] op_sel_hi:[1,0] neg_lo:[0,1] neg_hi:[0,1]
s_nop 0
v_pk_fma_f32 v[8:9], v[58:59], v[58:59], v[8:9]
v_pk_add_f32 v[60:61], v[60:61], v[14:15] op_sel_hi:[1,0] neg_lo:[0,1] neg_hi:[0,1]
s_nop 0
v_pk_fma_f32 v[8:9], v[60:61], v[60:61], v[8:9]
v_pk_add_f32 v[62:63], v[62:63], v[14:15] op_sel_hi:[1,0] neg_lo:[0,1] neg_hi:[0,1]
s_nop 0
v_pk_fma_f32 v[8:9], v[62:63], v[62:63], v[8:9]
v_pk_add_f32 v[64:65], v[64:65], v[14:15] op_sel_hi:[1,0] neg_lo:[0,1] neg_hi:[0,1]
s_nop 0
v_pk_fma_f32 v[8:9], v[64:65], v[64:65], v[8:9]
v_pk_add_f32 v[66:67], v[66:67], v[14:15] op_sel_hi:[1,0] neg_lo:[0,1] neg_hi:[0,1]
s_nop 0
v_pk_fma_f32 v[8:9], v[66:67], v[66:67], v[8:9]
v_pk_add_f32 v[68:69], v[68:69], v[14:15] op_sel_hi:[1,0] neg_lo:[0,1] neg_hi:[0,1]
s_nop 0
v_pk_fma_f32 v[8:9], v[68:69], v[68:69], v[8:9]
v_pk_add_f32 v[70:71], v[70:71], v[14:15] op_sel_hi:[1,0] neg_lo:[0,1] neg_hi:[0,1]
s_nop 0
v_pk_fma_f32 v[8:9], v[70:71], v[70:71], v[8:9]
v_add_f32 v8, v8, v9
v_mov_b32 v9, v8
s_nop 1
v_permlane32_swap_b32 v8, v9
v_add_f32 v8, v8, v9
v_mov_b32 v9, v8
s_nop 1
v_permlane16_swap_b32 v8, v9
v_add_f32 v8, v8, v9
ds_write_b32 v4, v8 offset:41216
s_waitcnt lgkmcnt(0)
s_barrier
ds_read_b32 v10, v7 offset:41216
ds_read_b32 v11, v7 offset:41280
ds_read_b32 v12, v7 offset:41344
ds_read_b32 v13, v7 offset:41408
s_waitcnt lgkmcnt(0)
v_add_f32 v10, v10, v11
v_add_f32 v12, v12, v13
v_add_f32 v8, v10, v12
v_mul_f32 v8, 0x3acccccd, v8
v_cvt_pk_bf16_f32 v8, v8, v8
v_and_b32 v8, 0xffff0000, v8
v_add_f32 v8, 0x3727c5ac, v8
v_cvt_pk_bf16_f32 v8, v8, v8
v_and_b32 v8, 0xffff0000, v8
v_sqrt_f32 v8, v8
s_nop 0
v_cvt_pk_bf16_f32 v8, v8, v8
v_and_b32 v8, 0xffff0000, v8
v_rcp_f32 v8, v8
v_sub_f32 v14, v14, v15
v_mul_f32 v14, v14, v8
v_pk_fma_f32 v[32:33], v[32:33], v[8:9], v[14:15] op_sel_hi:[1,0,0]
s_nop 0
v_pk_fma_f32 v[32:33], v[32:33], v[152:153], v[112:113]
v_cvt_pk_bf16_f32 v72, v32, v33
v_pk_fma_f32 v[34:35], v[34:35], v[8:9], v[14:15] op_sel_hi:[1,0,0]
s_nop 0
v_pk_fma_f32 v[34:35], v[34:35], v[154:155], v[114:115]
v_cvt_pk_bf16_f32 v73, v34, v35
v_pk_fma_f32 v[36:37], v[36:37], v[8:9], v[14:15] op_sel_hi:[1,0,0]
s_nop 0
v_pk_fma_f32 v[36:37], v[36:37], v[156:157], v[116:117]
v_cvt_pk_bf16_f32 v74, v36, v37
v_pk_fma_f32 v[38:39], v[38:39], v[8:9], v[14:15] op_sel_hi:[1,0,0]
s_nop 0
v_pk_fma_f32 v[38:39], v[38:39], v[158:159], v[118:119]
v_cvt_pk_bf16_f32 v75, v38, v39
global_store_dwordx4 v30, v[72:75], s[26:27] offset:-2048 sc1
v_pk_fma_f32 v[40:41], v[40:41], v[8:9], v[14:15] op_sel_hi:[1,0,0]
s_nop 0
v_pk_fma_f32 v[40:41], v[40:41], v[160:161], v[120:121]
v_cvt_pk_bf16_f32 v76, v40, v41
v_pk_fma_f32 v[42:43], v[42:43], v[8:9], v[14:15] op_sel_hi:[1,0,0]
s_nop 0
v_pk_fma_f32 v[42:43], v[42:43], v[162:163], v[122:123]
v_cvt_pk_bf16_f32 v77, v42, v43
v_pk_fma_f32 v[44:45], v[44:45], v[8:9], v[14:15] op_sel_hi:[1,0,0]
s_nop 0
v_pk_fma_f32 v[44:45], v[44:45], v[164:165], v[124:125]
v_cvt_pk_bf16_f32 v78, v44, v45
v_pk_fma_f32 v[46:47], v[46:47], v[8:9], v[14:15] op_sel_hi:[1,0,0]
s_nop 0
v_pk_fma_f32 v[46:47], v[46:47], v[166:167], v[126:127]
v_cvt_pk_bf16_f32 v79, v46, v47
global_store_dwordx4 v30, v[76:79], s[26:27] offset:-1024 sc1
v_pk_fma_f32 v[48:49], v[48:49], v[8:9], v[14:15] op_sel_hi:[1,0,0]
s_nop 0
v_pk_fma_f32 v[48:49], v[48:49], v[168:169], v[128:129]
v_cvt_pk_bf16_f32 v80, v48, v49
v_pk_fma_f32 v[50:51], v[50:51], v[8:9], v[14:15] op_sel_hi:[1,0,0]
s_nop 0
v_pk_fma_f32 v[50:51], v[50:51], v[170:171], v[130:131]
v_cvt_pk_bf16_f32 v81, v50, v51
v_pk_fma_f32 v[52:53], v[52:53], v[8:9], v[14:15] op_sel_hi:[1,0,0]
s_nop 0
v_pk_fma_f32 v[52:53], v[52:53], v[172:173], v[132:133]
v_cvt_pk_bf16_f32 v82, v52, v53
v_pk_fma_f32 v[54:55], v[54:55], v[8:9], v[14:15] op_sel_hi:[1,0,0]
s_nop 0
v_pk_fma_f32 v[54:55], v[54:55], v[174:175], v[134:135]
v_cvt_pk_bf16_f32 v83, v54, v55
global_store_dwordx4 v30, v[80:83], s[26:27] offset:0 sc1
v_pk_fma_f32 v[56:57], v[56:57], v[8:9], v[14:15] op_sel_hi:[1,0,0]
s_nop 0
v_pk_fma_f32 v[56:57], v[56:57], v[176:177], v[136:137]
v_cvt_pk_bf16_f32 v84, v56, v57
v_pk_fma_f32 v[58:59], v[58:59], v[8:9], v[14:15] op_sel_hi:[1,0,0]
s_nop 0
v_pk_fma_f32 v[58:59], v[58:59], v[178:179], v[138:139]
v_cvt_pk_bf16_f32 v85, v58, v59
v_pk_fma_f32 v[60:61], v[60:61], v[8:9], v[14:15] op_sel_hi:[1,0,0]
s_nop 0
v_pk_fma_f32 v[60:61], v[60:61], v[180:181], v[140:141]
v_cvt_pk_bf16_f32 v86, v60, v61
v_pk_fma_f32 v[62:63], v[62:63], v[8:9], v[14:15] op_sel_hi:[1,0,0]
s_nop 0
v_pk_fma_f32 v[62:63], v[62:63], v[182:183], v[142:143]
v_cvt_pk_bf16_f32 v87, v62, v63
global_store_dwordx4 v30, v[84:87], s[26:27] offset:1024 sc1
v_pk_fma_f32 v[64:65], v[64:65], v[8:9], v[14:15] op_sel_hi:[1,0,0]
s_nop 0
v_pk_fma_f32 v[64:65], v[64:65], v[184:185], v[144:145]
v_cvt_pk_bf16_f32 v88, v64, v65
v_pk_fma_f32 v[66:67], v[66:67], v[8:9], v[14:15] op_sel_hi:[1,0,0]
s_nop 0
v_pk_fma_f32 v[66:67], v[66:67], v[186:187], v[146:147]
v_cvt_pk_bf16_f32 v89, v66, v67
v_pk_fma_f32 v[68:69], v[68:69], v[8:9], v[14:15] op_sel_hi:[1,0,0]
s_nop 0
v_pk_fma_f32 v[68:69], v[68:69], v[188:189], v[148:149]
v_cvt_pk_bf16_f32 v90, v68, v69
v_pk_fma_f32 v[70:71], v[70:71], v[8:9], v[14:15] op_sel_hi:[1,0,0]
s_nop 0
v_pk_fma_f32 v[70:71], v[70:71], v[190:191], v[150:151]
v_cvt_pk_bf16_f32 v91, v70, v71
global_store_dwordx4 v30, v[88:91], s[26:27] offset:2048 sc1
s_and_b32 s13, s2, 1
s_lshl_b32 s13, s13, 7
s_add_u32 s13, s13, s43
s_add_u32 s13, s13, 9984
s_waitcnt vmcnt(0)
s_barrier
s_cmp_lg_u32 s12, 3
s_cbranch_scc1 L_rf_76
v_mov_b32 v8, s13
v_mov_b32 v9, 1
s_mov_b64 exec, 1
global_store_dword v8, v9, s[8:9] sc1
s_mov_b64 exec, -1
L_rf_76:
s_add_u32 s2, s2, 16
s_cmp_lt_u32 s2, 104
s_cbranch_scc1 L_ln_loop
s_waitcnt vmcnt(0)
s_endpgm
s_endpgm
L_codeend:

.section .rodata,"a"
.p2align 6
.amdhsa_kernel adaLN_cond__memory_aug_recurrent_mem_tr__dense_activation_silu__prompt_kernel
  .amdhsa_next_free_vgpr 512
  .amdhsa_next_free_sgpr 102
  .amdhsa_accum_offset 256
  .amdhsa_group_segment_fixed_size 0
  .amdhsa_kernarg_size 120
  .amdhsa_user_sgpr_count 2
  .amdhsa_user_sgpr_kernarg_segment_ptr 1
  .amdhsa_system_sgpr_workgroup_id_x 1
.end_amdhsa_kernel
```
